```python
import torch

def _softmax(x, axis=-1):
    return torch.softmax(x, dim=axis)

def _gelu(x):
    return torch.nn.functional.gelu(x, approximate='tanh')

def _silu(x):
    return torch.nn.functional.silu(x)

def _sigmoid(x):
    return torch.sigmoid(x)

def _layernorm(x, axis=-1, eps=1e-05):
    m = x.mean(dim=axis, keepdim=True)
    v = x.var(dim=axis, keepdim=True, unbiased=False)
    return (x - m) / torch.sqrt(v + eps)

def _scatter_add(tgt, idx, src, axis=0):
    return tgt.clone().index_add_(axis, idx, src)

def _segment_sum(src, seg, n):
    out = torch.zeros((n,) + src.shape[1:], dtype=src.dtype)
    return out.index_add_(0, seg, src)

def _pad(x, pw):
    flat = tuple((v for pair in reversed(pw) for v in pair))
    return torch.nn.functional.pad(x, flat)
kernel_name = 'adaLN_cond__gqa_block_cached__moe_arch_mod__prompt'

def setup_inputs():

    _w = lambda a: (lambda t: t.to(torch.bfloat16) if t.is_floating_point() else t)(torch.as_tensor(a))

    def _A_setup():
        B, Sq, D = (1, 2048, 576)
        Hq, Hkv, Sk, Dh = (32, 16, 2048, 128)
        assert Hq % Hkv == 0, (Hq, Hkv)
        return {'x': _w((lambda *s: torch.randn(*s, dtype=torch.bfloat16) * 0.05)(B, Sq, D)), 'k_cache': _w((lambda *s: torch.randn(*s, dtype=torch.bfloat16) * 3.2)(B, Hkv, Sk, Dh)), 'v_cache': _w((lambda *s: torch.randn(*s, dtype=torch.bfloat16) * 0.4)(B, Hkv, Sk, Dh)), 'wq': _w((lambda *s: torch.randn(*s, dtype=torch.bfloat16) * 3.2)(D, Hq * Dh) * D ** (-0.5)), 'wo': _w((lambda *s: torch.randn(*s, dtype=torch.bfloat16) * 0.4)(Hq * Dh, D) * (Hq * Dh) ** (-0.5))}
    _A_in = _A_setup()

    def _B_setup():
        B, S, D, F, C = (1, 2048, 576, 4608, 8)
        return {'x': _w((lambda *s: torch.randn(*s, dtype=torch.bfloat16) * 0.05)(B, S, D)), 'w_r': _w((lambda *s: torch.randn(*s, dtype=torch.bfloat16) * 0.05)(D)), 'w_gate': _w((lambda *s: torch.randn(*s, dtype=torch.bfloat16) * 0.05)(D, F)), 'w_up': _w((lambda *s: torch.randn(*s, dtype=torch.bfloat16) * 0.05)(D, F)), 'w_down': _w((lambda *s: torch.randn(*s, dtype=torch.bfloat16) * 0.05)(F, D))}
    _B_in = _B_setup()
    return {'A_x': _A_in['x'], 'A_k_cache': _A_in['k_cache'], 'A_v_cache': _A_in['v_cache'], 'A_wq': _A_in['wq'], 'A_wo': _A_in['wo'], 'B_x': _B_in['x'], 'B_w_r': _B_in['w_r'], 'B_w_gate': _B_in['w_gate'], 'B_w_up': _B_in['w_up'], 'B_w_down': _B_in['w_down'], 'c': _w((lambda *s: torch.randn(*s, dtype=torch.bfloat16) * 0.1)(1, 576) * 8.0), 'w_mod': _w((lambda *s: torch.randn(*s, dtype=torch.bfloat16) * 0.1)(576, 6 * 576) * 576 ** (-0.5) * 8.0)}

def reference(A_x, A_k_cache, A_v_cache, A_wq, A_wo, B_x, B_w_r, B_w_gate, B_w_up, B_w_down, c, w_mod):

    def _A_ref(x, k_cache, v_cache, wq, wo):
        B, Sq, D = x.shape
        Hq, Dh = (32, 128)
        Hkv = k_cache.shape[1]
        rep = Hq // Hkv
        q = (lambda x, *d: x.permute(*d))((x @ wq).reshape(B, Sq, Hq, Dh), 0, 2, 1, 3)
        k = (lambda x, n, axis: torch.repeat_interleave(x, n, dim=axis))(k_cache, rep, axis=1)
        v = (lambda x, n, axis: torch.repeat_interleave(x, n, dim=axis))(v_cache, rep, axis=1)
        scores = torch.einsum('bhqd,bhkd->bhqk', q, k) * Dh ** (-0.5)
        p = _softmax(scores, axis=-1)
        o = torch.einsum('bhqk,bhkd->bhqd', p, v)
        return (lambda x, *d: x.permute(*d))(o, 0, 2, 1, 3).reshape(B, Sq, Hq * Dh) @ wo

    def _B_ref(x, w_r, w_gate, w_up, w_down):
        B, S, D = x.shape
        C = 8
        r = x @ w_r
        idx = torch.argsort(-r, axis=-1)[:, :C]
        idx_e = (lambda x, n, axis: torch.repeat_interleave(x, n, dim=axis))(idx.reshape(B, C, 1), D, axis=2)
        x_sel = (lambda x, i, axis: torch.take_along_dim(x, i, dim=axis))(x, idx_e, axis=1)
        g = _silu(x_sel @ w_gate)
        u = x_sel @ w_up
        y = g * u @ w_down
        r_sel = _sigmoid((lambda x, i, axis: torch.take_along_dim(x, i, dim=axis))(r, idx, axis=1))
        y = y * r_sel.reshape(B, C, 1)
        b_off = (torch.arange(B) * S).reshape(B, 1)
        flat_idx = (idx + b_off).reshape(B * C)
        zero = (x * 0.0).reshape(B * S, D)
        upd = _scatter_add(zero, flat_idx, y.reshape(B * C, D), axis=0)
        return x + upd.reshape(B, S, D)
    x = A_x
    mod = (_silu(c) @ w_mod).reshape(c.shape[0], 6, 1, -1)
    sa, ca, ga, sb, cb, gb = (mod[:, 0].clone(), mod[:, 1].clone(), mod[:, 2].clone(), mod[:, 3].clone(), mod[:, 4].clone(), mod[:, 5].clone())
    h = _layernorm(x, axis=-1) * (1 + ca) + sa
    x = x + ga * _A_ref(h, A_k_cache, A_v_cache, A_wq, A_wo)
    h = _layernorm(x, axis=-1) * (1 + cb) + sb
    x = x + gb * _B_ref(h, B_w_r, B_w_gate, B_w_up, B_w_down)
    return x
```

```asm
; @launch kernel=prep_kernel grid=(256,1,1) block=(576,1,1) lds=1536
; @launch kernel=attn_kernel grid=(256,1,1) block=(256,1,1) lds=163328
.amdgcn_target "amdgcn-amd-amdhsa--gfx950"
.text
.globl prep_kernel
.p2align 8
.type prep_kernel,@function
prep_kernel:
    s_cmp_ge_u32 s2, 112
    s_cbranch_scc1 L_k1_x
    s_load_dwordx4 s[4:7], s[0:1], 80
    s_load_dwordx2 s[20:21], s[0:1], 112
    s_and_b32 s32, s2, 0x70
    s_and_b32 s3, s2, 7
    s_lshl_b32 s3, s3, 1
    s_add_u32 s32, s32, s3
    s_bfe_u32 s3, s2, 0x10003
    s_add_u32 s32, s32, s3
    s_cmp_ge_u32 s32, 108
    s_cbranch_scc1 L_k1_exit
    v_and_b32 v1, 3, v0
    v_lshrrev_b32 v2, 2, v0
    v_mul_u32_u24 v3, 27648, v2
    v_lshl_add_u32 v3, v1, 4, v3
    s_lshl_b32 s3, s32, 6
    v_lshlrev_b32 v4, 3, v2
    s_waitcnt lgkmcnt(0)
    s_mov_b32 s12, s6
    s_mov_b32 s13, s7
    s_mov_b32 s14, 0x3cc000
    s_mov_b32 s15, 0x20000
    s_mov_b32 s8, s4
    s_mov_b32 s9, s5
    s_mov_b32 s10, 0x480
    s_mov_b32 s11, 0x20000
    buffer_load_dwordx2 v[8:9], v4, s[8:11], 0 offen
    buffer_load_dwordx4 v[32:35], v3, s[12:15], s3 offen nt
    s_add_u32 s3, s3, 6912
    buffer_load_dwordx4 v[36:39], v3, s[12:15], s3 offen nt
    s_add_u32 s3, s3, 6912
    buffer_load_dwordx4 v[40:43], v3, s[12:15], s3 offen nt
    s_add_u32 s3, s3, 6912
    buffer_load_dwordx4 v[44:47], v3, s[12:15], s3 offen nt
    s_add_u32 s3, s3, 6912
    s_mov_b32 s16, s20
    s_mov_b32 s17, s21
    s_mov_b32 s18, 0x3600
    s_mov_b32 s19, 0x20000
    v_lshrrev_b32 v5, 6, v0
    v_bfe_u32 v7, v0, 4, 2
    v_lshlrev_b32 v5, 5, v5
    v_lshl_add_u32 v5, v1, 3, v5
    v_add_lshl_u32 v5, v5, v7, 2
    s_waitcnt vmcnt(4)
    v_lshlrev_b32 v12, 16, v8
    v_and_b32 v13, 0xffff0000, v8
    v_lshlrev_b32 v14, 16, v9
    v_and_b32 v15, 0xffff0000, v9
    v_mul_f32 v20, 0xbfb8aa3b, v12
    v_mul_f32 v21, 0xbfb8aa3b, v13
    v_mul_f32 v22, 0xbfb8aa3b, v14
    v_mul_f32 v23, 0xbfb8aa3b, v15
    v_exp_f32 v20, v20
    v_exp_f32 v21, v21
    v_exp_f32 v22, v22
    v_exp_f32 v23, v23
    v_add_f32 v20, 1.0, v20
    v_add_f32 v21, 1.0, v21
    v_add_f32 v22, 1.0, v22
    v_add_f32 v23, 1.0, v23
    v_rcp_f32 v20, v20
    v_rcp_f32 v21, v21
    v_rcp_f32 v22, v22
    v_rcp_f32 v23, v23
    v_mul_f32 v12, v12, v20
    v_mul_f32 v13, v13, v21
    v_mul_f32 v14, v14, v22
    v_mul_f32 v15, v15, v23
    v_cvt_pk_bf16_f32 v20, v12, v13
    v_lshlrev_b32 v12, 16, v20
    v_and_b32 v13, 0xffff0000, v20
    v_cvt_pk_bf16_f32 v21, v14, v15
    v_lshlrev_b32 v14, 16, v21
    v_and_b32 v15, 0xffff0000, v21
    s_waitcnt vmcnt(3)
    v_lshlrev_b32 v28, 16, v32
    v_and_b32 v32, 0xffff0000, v32
    v_lshlrev_b32 v29, 16, v33
    v_and_b32 v33, 0xffff0000, v33
    v_lshlrev_b32 v30, 16, v34
    v_and_b32 v34, 0xffff0000, v34
    v_lshlrev_b32 v31, 16, v35
    v_and_b32 v35, 0xffff0000, v35
    v_mul_f32 v20, v28, v12
    v_mul_f32 v21, v32, v12
    v_mul_f32 v22, v29, v12
    v_mul_f32 v23, v33, v12
    v_mul_f32 v24, v30, v12
    v_mul_f32 v25, v34, v12
    v_mul_f32 v26, v31, v12
    v_mul_f32 v27, v35, v12
    s_waitcnt vmcnt(2)
    v_lshlrev_b32 v28, 16, v36
    v_and_b32 v36, 0xffff0000, v36
    v_lshlrev_b32 v29, 16, v37
    v_and_b32 v37, 0xffff0000, v37
    v_lshlrev_b32 v30, 16, v38
    v_and_b32 v38, 0xffff0000, v38
    v_lshlrev_b32 v31, 16, v39
    v_and_b32 v39, 0xffff0000, v39
    v_fmac_f32 v20, v28, v13
    v_fmac_f32 v21, v36, v13
    v_fmac_f32 v22, v29, v13
    v_fmac_f32 v23, v37, v13
    v_fmac_f32 v24, v30, v13
    v_fmac_f32 v25, v38, v13
    v_fmac_f32 v26, v31, v13
    v_fmac_f32 v27, v39, v13
    s_waitcnt vmcnt(1)
    v_lshlrev_b32 v28, 16, v40
    v_and_b32 v40, 0xffff0000, v40
    v_lshlrev_b32 v29, 16, v41
    v_and_b32 v41, 0xffff0000, v41
    v_lshlrev_b32 v30, 16, v42
    v_and_b32 v42, 0xffff0000, v42
    v_lshlrev_b32 v31, 16, v43
    v_and_b32 v43, 0xffff0000, v43
    v_fmac_f32 v20, v28, v14
    v_fmac_f32 v21, v40, v14
    v_fmac_f32 v22, v29, v14
    v_fmac_f32 v23, v41, v14
    v_fmac_f32 v24, v30, v14
    v_fmac_f32 v25, v42, v14
    v_fmac_f32 v26, v31, v14
    v_fmac_f32 v27, v43, v14
    s_waitcnt vmcnt(0)
    v_lshlrev_b32 v28, 16, v44
    v_and_b32 v44, 0xffff0000, v44
    v_lshlrev_b32 v29, 16, v45
    v_and_b32 v45, 0xffff0000, v45
    v_lshlrev_b32 v30, 16, v46
    v_and_b32 v46, 0xffff0000, v46
    v_lshlrev_b32 v31, 16, v47
    v_and_b32 v47, 0xffff0000, v47
    v_fmac_f32 v20, v28, v15
    v_fmac_f32 v21, v44, v15
    v_fmac_f32 v22, v29, v15
    v_fmac_f32 v23, v45, v15
    v_fmac_f32 v24, v30, v15
    v_fmac_f32 v25, v46, v15
    v_fmac_f32 v26, v31, v15
    v_fmac_f32 v27, v47, v15
    s_nop 1
    v_add_f32_dpp v20, v20, v20 row_ror:4 row_mask:0xf bank_mask:0xf
    v_add_f32_dpp v21, v21, v21 row_ror:4 row_mask:0xf bank_mask:0xf
    v_add_f32_dpp v22, v22, v22 row_ror:4 row_mask:0xf bank_mask:0xf
    v_add_f32_dpp v23, v23, v23 row_ror:4 row_mask:0xf bank_mask:0xf
    v_add_f32_dpp v24, v24, v24 row_ror:4 row_mask:0xf bank_mask:0xf
    v_add_f32_dpp v25, v25, v25 row_ror:4 row_mask:0xf bank_mask:0xf
    v_add_f32_dpp v26, v26, v26 row_ror:4 row_mask:0xf bank_mask:0xf
    v_add_f32_dpp v27, v27, v27 row_ror:4 row_mask:0xf bank_mask:0xf
    v_add_f32_dpp v20, v20, v20 row_ror:8 row_mask:0xf bank_mask:0xf
    v_add_f32_dpp v21, v21, v21 row_ror:8 row_mask:0xf bank_mask:0xf
    v_add_f32_dpp v22, v22, v22 row_ror:8 row_mask:0xf bank_mask:0xf
    v_add_f32_dpp v23, v23, v23 row_ror:8 row_mask:0xf bank_mask:0xf
    v_add_f32_dpp v24, v24, v24 row_ror:8 row_mask:0xf bank_mask:0xf
    v_add_f32_dpp v25, v25, v25 row_ror:8 row_mask:0xf bank_mask:0xf
    v_add_f32_dpp v26, v26, v26 row_ror:8 row_mask:0xf bank_mask:0xf
    v_add_f32_dpp v27, v27, v27 row_ror:8 row_mask:0xf bank_mask:0xf
    s_nop 0
    v_permlane16_swap_b32 v20, v21
    v_permlane16_swap_b32 v22, v23
    v_permlane16_swap_b32 v24, v25
    v_permlane16_swap_b32 v26, v27
    v_add_f32 v20, v20, v21
    v_add_f32 v22, v22, v23
    v_add_f32 v24, v24, v25
    v_add_f32 v26, v26, v27
    s_nop 1
    v_permlane32_swap_b32 v20, v22
    v_permlane32_swap_b32 v24, v26
    v_add_f32 v20, v20, v22
    v_add_f32 v24, v24, v26
    ds_write_b32 v5, v20
    ds_write_b32 v5, v24 offset:16
    s_waitcnt lgkmcnt(0)
    s_barrier
    v_cmp_gt_u32 vcc, 32, v0
    s_and_saveexec_b64 s[30:31], vcc
    s_cbranch_execz L_k1_modend
    v_lshlrev_b32 v5, 2, v0
    ds_read_b32 v20, v5 offset:0
    ds_read_b32 v21, v5 offset:128
    ds_read_b32 v22, v5 offset:256
    ds_read_b32 v23, v5 offset:384
    ds_read_b32 v24, v5 offset:512
    ds_read_b32 v25, v5 offset:640
    ds_read_b32 v26, v5 offset:768
    ds_read_b32 v27, v5 offset:896
    ds_read_b32 v28, v5 offset:1024
    s_sub_u32 s3, s32, 18
    s_cmp_lt_u32 s3, 18
    s_cselect_b32 s22, 1.0, 0
    s_sub_u32 s3, s32, 72
    s_cmp_lt_u32 s3, 18
    s_cselect_b32 s22, 1.0, s22
    s_lshl_b32 s3, s32, 7
    s_waitcnt lgkmcnt(0)
    v_add_f32 v20, v20, v21
    v_add_f32 v22, v22, v23
    v_add_f32 v24, v24, v25
    v_add_f32 v26, v26, v27
    v_add_f32 v20, v20, v22
    v_add_f32 v24, v24, v26
    v_add_f32 v20, v20, v28
    v_add_f32 v20, v20, v24
    v_cvt_pk_bf16_f32 v20, v20, v20
    v_and_b32 v20, 0xffff0000, v20
    v_add_f32 v20, s22, v20
    v_cvt_pk_bf16_f32 v20, v20, v20
    v_and_b32 v20, 0xffff0000, v20
    s_sub_u32 s23, s32, 18
    s_cmp_lt_u32 s23, 18
    s_cbranch_scc1 L_k1_half
    buffer_store_dword v20, v5, s[16:19], s3 offen sc1
    s_branch L_k1_modend
L_k1_half:
    s_lshl_b32 s3, s23, 6
    v_lshlrev_b32 v5, 1, v0
    buffer_store_short_d16_hi v20, v5, s[16:19], s3 offen offset:2304 sc1
L_k1_modend:
    s_endpgm
L_k1_x:
    s_cmp_ge_u32 s2, 240
    s_cbranch_scc1 L_k1_pf
    s_load_dwordx2 s[4:5], s[0:1], 0
    s_load_dwordx2 s[6:7], s[0:1], 112
    v_and_b32 v1, 15, v0
    v_bfe_u32 v2, v0, 4, 2
    v_lshrrev_b32 v3, 6, v0
    v_lshlrev_b32 v4, 7, v3
    v_lshl_add_u32 v4, v2, 4, v4
    v_mul_u32_u24 v5, 1152, v1
    v_add_u32 v5, v5, v4
    s_sub_u32 s3, s2, 112
    s_mul_i32 s3, s3, 18432
    s_waitcnt lgkmcnt(0)
    s_mov_b32 s8, s4
    s_mov_b32 s9, s5
    s_mov_b32 s10, 0x240000
    s_mov_b32 s11, 0x20000
    buffer_load_dwordx4 v[12:15], v5, s[8:11], s3 offen nt
    buffer_load_dwordx4 v[16:19], v5, s[8:11], s3 offen offset:64 nt
    s_add_u32 s16, s6, 0x8000
    s_addc_u32 s17, s7, 0
    s_mov_b32 s18, 0x240000
    s_mov_b32 s19, 0x20000
    v_and_b32 v6, 63, v0
    v_lshlrev_b32 v6, 4, v6
    v_lshl_add_u32 v6, v3, 11, v6
    v_mul_u32_u24 v9, 96, v1
    v_lshl_add_u32 v8, v3, 3, v9
    s_waitcnt vmcnt(0)
    v_lshlrev_b32 v20, 16, v12
    v_and_b32 v21, 0xffff0000, v12
    v_lshlrev_b32 v22, 16, v13
    v_and_b32 v23, 0xffff0000, v13
    v_lshlrev_b32 v24, 16, v14
    v_and_b32 v25, 0xffff0000, v14
    v_lshlrev_b32 v26, 16, v15
    v_and_b32 v27, 0xffff0000, v15
    v_lshlrev_b32 v28, 16, v16
    v_and_b32 v29, 0xffff0000, v16
    v_lshlrev_b32 v30, 16, v17
    v_and_b32 v31, 0xffff0000, v17
    v_lshlrev_b32 v32, 16, v18
    v_and_b32 v33, 0xffff0000, v18
    v_lshlrev_b32 v34, 16, v19
    v_and_b32 v35, 0xffff0000, v19
    v_add_f32 v56, v20, v24
    v_add_f32 v57, v21, v25
    v_add_f32 v58, v22, v26
    v_add_f32 v59, v23, v27
    v_add_f32 v56, v56, v28
    v_add_f32 v57, v57, v29
    v_add_f32 v58, v58, v30
    v_add_f32 v59, v59, v31
    v_add_f32 v56, v56, v32
    v_add_f32 v57, v57, v33
    v_add_f32 v58, v58, v34
    v_add_f32 v59, v59, v35
    v_add_f32 v56, v56, v57
    v_add_f32 v58, v58, v59
    v_add_f32 v10, v56, v58
    v_mov_b32 v56, v10
    s_nop 1
    v_permlane16_swap_b32 v10, v56
    v_add_f32 v10, v10, v56
    v_mov_b32 v56, v10
    s_nop 1
    v_permlane32_swap_b32 v10, v56
    v_add_f32 v10, v10, v56
    v_mul_f32 v10, 0x3c800000, v10
    v_sub_f32 v36, v20, v10
    v_sub_f32 v37, v21, v10
    v_sub_f32 v38, v22, v10
    v_sub_f32 v39, v23, v10
    v_sub_f32 v40, v24, v10
    v_sub_f32 v41, v25, v10
    v_sub_f32 v42, v26, v10
    v_sub_f32 v43, v27, v10
    v_sub_f32 v44, v28, v10
    v_sub_f32 v45, v29, v10
    v_sub_f32 v46, v30, v10
    v_sub_f32 v47, v31, v10
    v_sub_f32 v48, v32, v10
    v_sub_f32 v49, v33, v10
    v_sub_f32 v50, v34, v10
    v_sub_f32 v51, v35, v10
    v_mul_f32 v56, v36, v36
    v_mul_f32 v57, v37, v37
    v_mul_f32 v58, v38, v38
    v_mul_f32 v59, v39, v39
    v_fmac_f32 v56, v40, v40
    v_fmac_f32 v57, v41, v41
    v_fmac_f32 v58, v42, v42
    v_fmac_f32 v59, v43, v43
    v_fmac_f32 v56, v44, v44
    v_fmac_f32 v57, v45, v45
    v_fmac_f32 v58, v46, v46
    v_fmac_f32 v59, v47, v47
    v_fmac_f32 v56, v48, v48
    v_fmac_f32 v57, v49, v49
    v_fmac_f32 v58, v50, v50
    v_fmac_f32 v59, v51, v51
    v_add_f32 v56, v56, v57
    v_add_f32 v58, v58, v59
    v_add_f32 v11, v56, v58
    v_mov_b32 v56, v11
    s_nop 1
    v_permlane16_swap_b32 v11, v56
    v_add_f32 v11, v11, v56
    v_mov_b32 v56, v11
    s_nop 1
    v_permlane32_swap_b32 v11, v56
    v_add_f32 v11, v11, v56
    ds_write_b64 v8, v[10:11]
    s_waitcnt lgkmcnt(0)
    s_barrier
    ds_read_b128 v[36:39], v9 offset:0
    ds_read_b128 v[40:43], v9 offset:16
    ds_read_b128 v[44:47], v9 offset:32
    ds_read_b128 v[48:51], v9 offset:48
    ds_read_b64 v[52:53], v9 offset:64
    s_waitcnt lgkmcnt(0)
    v_add_f32 v10, v36, v38
    v_add_f32 v11, v37, v39
    v_add_f32 v56, v40, v42
    v_add_f32 v57, v41, v43
    v_add_f32 v10, v10, v44
    v_add_f32 v11, v11, v45
    v_add_f32 v56, v56, v46
    v_add_f32 v57, v57, v47
    v_add_f32 v10, v10, v48
    v_add_f32 v11, v11, v49
    v_add_f32 v56, v56, v50
    v_add_f32 v57, v57, v51
    v_add_f32 v10, v10, v52
    v_add_f32 v11, v11, v53
    v_add_f32 v10, v10, v56
    v_add_f32 v11, v11, v57
    v_mul_f32 v10, 0x3de38e39, v10
    v_sub_f32 v36, v36, v10
    v_sub_f32 v38, v38, v10
    v_sub_f32 v40, v40, v10
    v_sub_f32 v42, v42, v10
    v_sub_f32 v44, v44, v10
    v_sub_f32 v46, v46, v10
    v_sub_f32 v48, v48, v10
    v_sub_f32 v50, v50, v10
    v_sub_f32 v52, v52, v10
    v_mul_f32 v56, v36, v36
    v_mul_f32 v57, v38, v38
    v_fmac_f32 v56, v40, v40
    v_fmac_f32 v57, v42, v42
    v_fmac_f32 v56, v44, v44
    v_fmac_f32 v57, v46, v46
    v_fmac_f32 v56, v48, v48
    v_fmac_f32 v57, v50, v50
    v_fmac_f32 v56, v52, v52
    v_add_f32 v56, v56, v57
    v_fmac_f32 v11, 0x42800000, v56
    v_mul_f32 v11, 0x3ae38e39, v11
    v_cvt_pk_bf16_f32 v56, v10, v11
    v_lshlrev_b32 v10, 16, v56
    v_and_b32 v11, 0xffff0000, v56
    v_add_f32 v11, 0x3727c5ac, v11
    v_cvt_pk_bf16_f32 v11, v11, v11
    v_and_b32 v11, 0xffff0000, v11
    v_sqrt_f32 v11, v11
    v_sub_f32 v20, v20, v10
    v_sub_f32 v21, v21, v10
    v_sub_f32 v22, v22, v10
    v_sub_f32 v23, v23, v10
    v_sub_f32 v24, v24, v10
    v_sub_f32 v25, v25, v10
    v_sub_f32 v26, v26, v10
    v_sub_f32 v27, v27, v10
    v_sub_f32 v28, v28, v10
    v_sub_f32 v29, v29, v10
    v_sub_f32 v30, v30, v10
    v_sub_f32 v31, v31, v10
    v_sub_f32 v32, v32, v10
    v_sub_f32 v33, v33, v10
    v_sub_f32 v34, v34, v10
    v_sub_f32 v35, v35, v10
    v_cvt_pk_bf16_f32 v11, v11, v11
    v_and_b32 v11, 0xffff0000, v11
    v_rcp_f32 v11, v11
    v_cvt_pk_bf16_f32 v56, v20, v21
    v_cvt_pk_bf16_f32 v57, v22, v23
    v_cvt_pk_bf16_f32 v58, v24, v25
    v_cvt_pk_bf16_f32 v59, v26, v27
    v_lshlrev_b32 v20, 16, v56
    v_and_b32 v21, 0xffff0000, v56
    v_lshlrev_b32 v22, 16, v57
    v_and_b32 v23, 0xffff0000, v57
    v_lshlrev_b32 v24, 16, v58
    v_and_b32 v25, 0xffff0000, v58
    v_lshlrev_b32 v26, 16, v59
    v_and_b32 v27, 0xffff0000, v59
    v_cvt_pk_bf16_f32 v60, v28, v29
    v_cvt_pk_bf16_f32 v61, v30, v31
    v_cvt_pk_bf16_f32 v62, v32, v33
    v_cvt_pk_bf16_f32 v63, v34, v35
    v_lshlrev_b32 v28, 16, v60
    v_and_b32 v29, 0xffff0000, v60
    v_lshlrev_b32 v30, 16, v61
    v_and_b32 v31, 0xffff0000, v61
    v_lshlrev_b32 v32, 16, v62
    v_and_b32 v33, 0xffff0000, v62
    v_lshlrev_b32 v34, 16, v63
    v_and_b32 v35, 0xffff0000, v63
    v_mul_f32 v20, v20, v11
    v_mul_f32 v21, v21, v11
    v_mul_f32 v22, v22, v11
    v_mul_f32 v23, v23, v11
    v_mul_f32 v24, v24, v11
    v_mul_f32 v25, v25, v11
    v_mul_f32 v26, v26, v11
    v_mul_f32 v27, v27, v11
    v_cvt_pk_bf16_f32 v12, v20, v21
    v_cvt_pk_bf16_f32 v13, v22, v23
    v_cvt_pk_bf16_f32 v14, v24, v25
    v_cvt_pk_bf16_f32 v15, v26, v27
    buffer_store_dwordx4 v[12:15], v6, s[16:19], s3 offen offset:0 sc1
    v_mul_f32 v28, v28, v11
    v_mul_f32 v29, v29, v11
    v_mul_f32 v30, v30, v11
    v_mul_f32 v31, v31, v11
    v_mul_f32 v32, v32, v11
    v_mul_f32 v33, v33, v11
    v_mul_f32 v34, v34, v11
    v_mul_f32 v35, v35, v11
    v_cvt_pk_bf16_f32 v16, v28, v29
    v_cvt_pk_bf16_f32 v17, v30, v31
    v_cvt_pk_bf16_f32 v18, v32, v33
    v_cvt_pk_bf16_f32 v19, v34, v35
    buffer_store_dwordx4 v[16:19], v6, s[16:19], s3 offen offset:1024 sc1
    s_endpgm
L_k1_pf:
    s_cmp_ge_u32 s2, 256
    s_cbranch_scc1 L_k1_exit
    s_load_dwordx2 s[4:5], s[0:1], 24
    s_load_dwordx2 s[12:13], s[0:1], 112
    s_sub_u32 s33, s2, 240
    s_lshr_b32 s33, s33, 3
    v_cmp_gt_u32 vcc, 512, v0
    s_and_saveexec_b64 s[30:31], vcc
    s_cbranch_execz L_k1_pf2
    v_lshrrev_b32 v3, 3, v0
    v_lshlrev_b32 v3, 13, v3
    v_and_b32 v4, 7, v0
    v_lshl_add_u32 v3, v4, 7, v3
    s_and_b32 s3, s2, 7
    s_lshl_b32 s3, s3, 10
    s_lshl_b32 s34, s33, 19
    s_add_u32 s3, s3, s34
    s_waitcnt lgkmcnt(0)
    s_mov_b32 s8, s4
    s_mov_b32 s9, s5
    s_mov_b32 s10, 0x480000
    s_mov_b32 s11, 0x20000
    buffer_load_dword v5, v3, s[8:11], s3 offen nt
    s_add_u32 s3, s3, 1048576
    s_endpgm
L_k1_pf2:
    s_cmp_ge_u32 s33, 2
    s_cbranch_scc1 L_k1_exit
    s_mov_b64 exec, -1
    s_getpc_b64 s[60:61]
L_pc_k1:
    s_add_u32 s60, s60, attn_kernel-L_pc_k1
    s_addc_u32 s61, s61, 0
    s_mov_b32 s62, L_attn_tail-attn_kernel
    s_mov_b32 s63, 0x20000
    v_and_b32 v1, 63, v0
    v_lshlrev_b32 v8, 4, v1
    v_lshlrev_b32 v1, 7, v1
    s_lshl_b32 s3, s33, 13
    buffer_load_dword v2, v1, s[60:63], s3 offen
    s_add_u32 s3, s3, 0x4000
    buffer_load_dword v3, v1, s[60:63], s3 offen
    s_add_u32 s3, s3, 0x4000
    v_mov_b32 v4, 0
    v_mov_b32 v5, 0
    v_mov_b32 v6, 0
    v_mov_b32 v7, 0
    s_and_b32 s3, s2, 15
    s_lshl_b32 s3, s3, 10
    s_add_u32 s3, s3, 16384
    s_mov_b32 s14, 32768
    s_mov_b32 s15, 0x20000
    s_waitcnt lgkmcnt(0)
    buffer_store_dwordx4 v[4:7], v8, s[12:15], s3 offen sc1
    v_mov_b32 v12, -1
    v_mov_b32 v13, -1
    v_mov_b32 v14, -1
    v_mov_b32 v15, -1
    s_add_u32 s20, s12, 0x248000
    s_addc_u32 s21, s13, 0
    s_mov_b32 s22, 0x2400
    s_mov_b32 s23, 0x20000
    s_sub_u32 s3, s3, 16384
    buffer_store_dwordx4 v[12:15], v8, s[20:23], s3 offen sc1
L_k1_exit:
    s_endpgm
.globl attn_kernel
.p2align 8
.type attn_kernel,@function
attn_kernel:
    s_cmp_ge_u32 s2, 256
    s_cbranch_scc1 L_attn_exit
    s_load_dwordx4 s[52:55], s[0:1], 24
    s_load_dwordx2 s[30:31], s[0:1], 112
    s_load_dwordx2 s[72:73], s[0:1], 0
    s_load_dwordx4 s[4:7], s[0:1], 8
    s_load_dwordx4 s[44:47], s[0:1], 56
    s_load_dwordx2 s[76:77], s[0:1], 96
    s_load_dwordx2 s[68:69], s[0:1], 72
    v_lshrrev_b32 v1, 6, v0
    v_and_b32 v2, 63, v0
    v_readfirstlane_b32 s33, v1
    s_bfe_u32 s34, s2, 0x30000
    s_lshl_b32 s34, s34, 1
    s_bfe_u32 s3, s2, 0x10003
    s_add_u32 s34, s34, s3
    s_lshr_b32 s35, s2, 4
    v_lshrrev_b32 v3, 5, v2
    v_and_b32 v4, 1, v1
    v_lshl_add_u32 v4, v4, 2, v3
    v_lshlrev_b32 v4, 1, v4
    v_and_b32 v5, 31, v2
    v_xor_b32 v4, v4, v5
    v_lshl_add_u32 v3, v1, 3, v3
    v_lshlrev_b32 v3, 13, v3
    v_lshl_add_u32 v180, v4, 4, v3
    v_xor_b32 v181, 64, v180
    v_add_u32 v181, 15360, v181
    v_add_u32 v182, 30720, v180
    v_add_u32 v183, 30720, v181
    v_lshlrev_b32 v26, 4, v2
    v_add_u32 v27, 18432, v26
    s_lshl_b32 s3, s34, 9
    s_sub_u32 s18, 0x480000, s3
    s_lshl_b32 s37, s35, 3
    s_lshl_b32 s36, s33, 1
    s_add_u32 s37, s37, s36
    s_mul_i32 s36, s37, 18432
    s_add_u32 s36, s36, 0x8000
    s_lshl_b32 s38, s33, 12
    v_bfe_u32 v3, v2, 2, 2
    v_lshrrev_b32 v5, 4, v2
    v_lshl_add_u32 v6, v5, 3, v3
    v_lshlrev_b32 v6, 9, v6
    v_and_b32 v4, 3, v2
    v_lshl_add_u32 v6, v4, 3, v6
    v_and_b32 v5, 1, v5
    v_lshl_add_u32 v5, v5, 2, v3
    v_lshl_add_u32 v172, v5, 5, v6
    v_xor_b32 v32, 0x10000, v172
    v_xor_b32 v173, 32, v172
    v_xor_b32 v33, 0x10020, v172
    v_xor_b32 v174, 64, v172
    v_xor_b32 v34, 0x10040, v172
    v_xor_b32 v175, 96, v172
    v_xor_b32 v35, 0x10060, v172
    v_xor_b32 v176, 128, v172
    v_xor_b32 v36, 0x10080, v172
    v_xor_b32 v177, 160, v172
    v_xor_b32 v37, 0x100a0, v172
    v_xor_b32 v178, 192, v172
    v_xor_b32 v38, 0x100c0, v172
    v_xor_b32 v179, 224, v172
    v_xor_b32 v39, 0x100e0, v172
    v_and_b32 v3, 1, v2
    v_lshlrev_b32 v3, 4, v3
    v_mov_b32 v4, 0xffff
    v_lshlrev_b32 v3, v3, v4
    v_lshrrev_b32 v4, 4, v2
    v_bfe_u32 v5, v2, 1, 3
    v_lshlrev_b32 v6, 1, v4
    v_or_b32 v7, 1, v6
    v_cmp_eq_u32 vcc, v5, v6
    v_cmp_eq_u32 s[40:41], v5, v7
    v_mov_b32 v254, v2
    v_cndmask_b32 v184, 0, v3, vcc
    v_cndmask_b32 v185, 0, v3, s[40:41]
    v_and_b32 v6, 0x3f803f80, v184
    v_and_b32 v7, 0x3f803f80, v185
    v_accvgpr_write_b32 a248, v6
    v_accvgpr_write_b32 a249, v7
    v_accvgpr_write_b32 a250, 0
    v_accvgpr_write_b32 a251, 0
    v_accvgpr_write_b32 a252, v6
    v_accvgpr_write_b32 a253, v7
    v_lshlrev_b32 v1, 4, v4
    v_add_u32 v0, 133632, v1
    v_lshlrev_b32 v1, 1, v1
    v_add_u32 v1, 131328, v1
    v_mov_b32 v4, 0
    v_mov_b32 v5, 0
    s_waitcnt lgkmcnt(0)
    s_add_u32 s16, s52, s3
    s_addc_u32 s17, s53, 0
    s_mov_b32 s18, s18
    s_mov_b32 s19, 0x20000
    s_add_u32 s20, s30, s36
    s_addc_u32 s21, s31, 0
    s_mov_b32 s22, 0x9000
    s_mov_b32 s23, 0x20000
    s_lshl_b32 s3, s33, 10
    s_add_u32 m0, s3, 131328
    s_mov_b32 s24, s30
    s_mov_b32 s25, s31
    s_mov_b32 s26, 0xd80
    s_mov_b32 s27, 0x20000
    buffer_load_dwordx4 v26, s[24:27], s3 offen lds
    s_mov_b32 s43, 0x0
    buffer_load_dwordx4 v[188:191], v26, s[20:23], s43 offen offset:0
    buffer_load_dwordx4 v[192:195], v27, s[20:23], s43 offen offset:0
    buffer_load_dwordx4 v[196:199], v26, s[20:23], s43 offen offset:1024
    buffer_load_dwordx4 v[200:203], v27, s[20:23], s43 offen offset:1024
    s_add_u32 m0, s38, 98304
    s_mov_b32 s42, 0x0
    buffer_load_dwordx4 v180, s[16:19], s42 offen offset:0 nt lds
    buffer_load_dwordx4 v181, s[16:19], s42 offen offset:1024 nt lds
    buffer_load_dwordx4 v182, s[16:19], s42 offen offset:2048 nt lds
    buffer_load_dwordx4 v183, s[16:19], s42 offen offset:3072 nt lds
    s_add_u32 m0, s38, 114688
    s_mov_b32 s42, 0x40000
    buffer_load_dwordx4 v180, s[16:19], s42 offen offset:0 nt lds
    buffer_load_dwordx4 v181, s[16:19], s42 offen offset:1024 nt lds
    buffer_load_dwordx4 v182, s[16:19], s42 offen offset:2048 nt lds
    buffer_load_dwordx4 v183, s[16:19], s42 offen offset:3072 nt lds
    s_mov_b32 s43, 0x800
    buffer_load_dwordx4 v[204:207], v26, s[20:23], s43 offen offset:0
    buffer_load_dwordx4 v[208:211], v27, s[20:23], s43 offen offset:0
    buffer_load_dwordx4 v[212:215], v26, s[20:23], s43 offen offset:1024
    buffer_load_dwordx4 v[216:219], v27, s[20:23], s43 offen offset:1024
    s_add_u32 m0, s38, 0
    s_mov_b32 s42, 0x80000
    buffer_load_dwordx4 v180, s[16:19], s42 offen offset:0 nt lds
    buffer_load_dwordx4 v181, s[16:19], s42 offen offset:1024 nt lds
    buffer_load_dwordx4 v182, s[16:19], s42 offen offset:2048 nt lds
    buffer_load_dwordx4 v183, s[16:19], s42 offen offset:3072 nt lds
    s_add_u32 m0, s38, 16384
    s_mov_b32 s42, 0xc0000
    buffer_load_dwordx4 v180, s[16:19], s42 offen offset:0 nt lds
    buffer_load_dwordx4 v181, s[16:19], s42 offen offset:1024 nt lds
    buffer_load_dwordx4 v182, s[16:19], s42 offen offset:2048 nt lds
    buffer_load_dwordx4 v183, s[16:19], s42 offen offset:3072 nt lds
    s_getpc_b64 s[28:29]
L_attn_pc:
    s_waitcnt vmcnt(12)
    s_barrier
    v_mov_b32 v58, 0
    v_mov_b32 v59, 0
    ds_read_b128 v[44:47], v0 offset:0
    ds_read_b128 v[48:51], v1 offset:0
    ds_read_b128 v[52:55], v1 offset:16
    ds_read_b128 v[8:11], v0 offset:64
    ds_read_b128 v[12:15], v1 offset:128
    ds_read_b128 v[16:19], v1 offset:144
    s_waitcnt lgkmcnt(5)
    v_and_b32 v56, v44, v184
    v_and_b32 v57, v45, v185
    v_and_b32 v60, v46, v184
    v_and_b32 v61, v47, v185
    s_nop 1
    v_mfma_f32_16x16x32_bf16 v[64:67], v[56:59], v[188:191], 0
    v_mfma_f32_16x16x32_bf16 v[68:71], v[58:61], v[188:191], 0
    v_mfma_f32_16x16x32_bf16 v[72:75], v[56:59], v[192:195], 0
    v_mfma_f32_16x16x32_bf16 v[76:79], v[58:61], v[192:195], 0
    ds_read_b64_tr_b16 a[128:129], v32 offset:32768
    ds_read_b64_tr_b16 a[130:131], v32 offset:34816
    ds_read_b64_tr_b16 a[132:133], v33 offset:32768
    ds_read_b64_tr_b16 a[134:135], v33 offset:34816
    ds_read_b64_tr_b16 a[136:137], v34 offset:32768
    ds_read_b64_tr_b16 a[138:139], v34 offset:34816
    v_cvt_pk_bf16_f32 v188, v64, v65
    v_cvt_pk_bf16_f32 v189, v66, v67
    v_cvt_pk_bf16_f32 v190, v68, v69
    v_cvt_pk_bf16_f32 v191, v70, v71
    v_cvt_pk_bf16_f32 v192, v72, v73
    v_cvt_pk_bf16_f32 v193, v74, v75
    v_cvt_pk_bf16_f32 v194, v76, v77
    v_cvt_pk_bf16_f32 v195, v78, v79
    s_waitcnt lgkmcnt(10)
    v_mfma_f32_16x16x32_bf16 v[64:67], a[248:251], v[188:191], v[48:51]
    s_waitcnt lgkmcnt(9)
    v_mfma_f32_16x16x32_bf16 v[68:71], a[250:253], v[188:191], v[52:55]
    v_mfma_f32_16x16x32_bf16 v[72:75], a[248:251], v[192:195], v[48:51]
    v_mfma_f32_16x16x32_bf16 v[76:79], a[250:253], v[192:195], v[52:55]
    ds_read_b64_tr_b16 a[140:141], v35 offset:32768
    ds_read_b64_tr_b16 a[142:143], v35 offset:34816
    ds_read_b64_tr_b16 a[144:145], v36 offset:32768
    ds_read_b64_tr_b16 a[146:147], v36 offset:34816
    ds_read_b64_tr_b16 a[148:149], v37 offset:32768
    ds_read_b64_tr_b16 a[150:151], v37 offset:34816
    s_waitcnt lgkmcnt(14)
    v_and_b32 v2, v8, v184
    v_and_b32 v3, v9, v185
    v_and_b32 v6, v10, v184
    v_and_b32 v7, v11, v185
    v_cvt_pk_bf16_f32 v188, v64, v65
    v_cvt_pk_bf16_f32 v189, v66, v67
    v_cvt_pk_bf16_f32 v190, v68, v69
    v_cvt_pk_bf16_f32 v191, v70, v71
    v_cvt_pk_bf16_f32 v192, v72, v73
    v_cvt_pk_bf16_f32 v193, v74, v75
    v_cvt_pk_bf16_f32 v194, v76, v77
    v_cvt_pk_bf16_f32 v195, v78, v79
    s_nop 3
    s_waitcnt lgkmcnt(10)
    v_mfma_f32_16x16x32_bf16 v[44:47], a[128:131], v[188:191], 0
    ds_read_b64_tr_b16 a[152:153], v38 offset:32768
    s_mov_b32 s43, 0x1000
    v_mfma_f32_16x16x32_bf16 v[76:79], a[128:131], v[192:195], 0
    ds_read_b64_tr_b16 a[154:155], v38 offset:34816
    buffer_load_dwordx4 v[220:223], v26, s[20:23], s43 offen offset:0
    v_mfma_f32_16x16x32_bf16 v[28:31], v[2:5], v[196:199], 0
    ds_read_b64_tr_b16 a[156:157], v39 offset:32768
    s_lshl_b32 s3, s34, 19
    v_mfma_f32_16x16x32_bf16 v[40:43], v[4:7], v[196:199], 0
    ds_read_b64_tr_b16 a[158:159], v39 offset:34816
    buffer_load_dwordx4 v[224:227], v27, s[20:23], s43 offen offset:0
    s_waitcnt lgkmcnt(12)
    v_mfma_f32_16x16x32_bf16 v[48:51], a[132:135], v[188:191], 0
    ds_read_b64_tr_b16 a[160:161], v32 offset:33024
    s_add_u32 s8, s4, s3
    s_addc_u32 s9, s5, 0
    v_mfma_f32_16x16x32_bf16 v[80:83], a[132:135], v[192:195], 0
    ds_read_b64_tr_b16 a[162:163], v32 offset:35072
    s_mov_b32 s10, 0x80000
    s_waitcnt lgkmcnt(12)
    v_mfma_f32_16x16x32_bf16 v[52:55], a[136:139], v[188:191], 0
    ds_read_b64_tr_b16 a[164:165], v33 offset:33024
    buffer_load_dwordx4 v[228:231], v26, s[20:23], s43 offen offset:1024
    v_mfma_f32_16x16x32_bf16 v[84:87], a[136:139], v[192:195], 0
    v_cvt_pk_bf16_f32 v196, v28, v29
    v_cvt_pk_bf16_f32 v197, v30, v31
    s_waitcnt lgkmcnt(11)
    v_mfma_f32_16x16x32_bf16 v[56:59], a[140:143], v[188:191], 0
    v_cvt_pk_bf16_f32 v198, v40, v41
    v_cvt_pk_bf16_f32 v199, v42, v43
    v_mfma_f32_16x16x32_bf16 v[88:91], a[140:143], v[192:195], 0
    s_waitcnt lgkmcnt(3)
    ds_read_b64_tr_b16 a[166:167], v33 offset:35072
    v_mfma_f32_16x16x32_bf16 v[60:63], a[144:147], v[188:191], 0
    ds_read_b64_tr_b16 a[168:169], v34 offset:33024
    buffer_load_dwordx4 v[232:235], v27, s[20:23], s43 offen offset:1024
    v_mfma_f32_16x16x32_bf16 v[92:95], a[144:147], v[192:195], 0
    ds_read_b64_tr_b16 a[170:171], v34 offset:35072
    s_add_u32 m0, s38, 32768
    v_mfma_f32_16x16x32_bf16 v[28:31], a[248:251], v[196:199], v[12:15]
    ds_read_b64_tr_b16 a[172:173], v35 offset:33024
    ds_read_b128 v[8:11], v0 offset:128
    v_mfma_f32_16x16x32_bf16 v[40:43], a[250:253], v[196:199], v[16:19]
    ds_read_b64_tr_b16 a[174:175], v35 offset:35072
    s_mov_b32 s11, 0x20000
    v_mfma_f32_16x16x32_bf16 v[64:67], a[148:151], v[188:191], 0
    ds_read_b64_tr_b16 a[176:177], v36 offset:33024
    s_mov_b32 s42, 0x100000
    v_mfma_f32_16x16x32_bf16 v[96:99], a[148:151], v[192:195], 0
    ds_read_b64_tr_b16 a[178:179], v36 offset:35072
    s_add_u32 s12, s6, s3
    s_addc_u32 s13, s7, 0
    v_mfma_f32_16x16x32_bf16 v[68:71], a[152:155], v[188:191], 0
    ds_read_b64_tr_b16 a[180:181], v37 offset:33024
    s_mov_b32 s14, 0x80000
    v_mfma_f32_16x16x32_bf16 v[100:103], a[152:155], v[192:195], 0
    v_cvt_pk_bf16_f32 v196, v28, v29
    v_cvt_pk_bf16_f32 v197, v30, v31
    v_mfma_f32_16x16x32_bf16 v[72:75], a[156:159], v[188:191], 0
    v_cvt_pk_bf16_f32 v198, v40, v41
    v_cvt_pk_bf16_f32 v199, v42, v43
    v_mfma_f32_16x16x32_bf16 v[104:107], a[156:159], v[192:195], 0
    s_waitcnt lgkmcnt(3)
    ds_read_b64_tr_b16 a[182:183], v37 offset:35072
    v_mfma_f32_16x16x32_bf16 v[108:111], a[160:163], v[188:191], 0
    buffer_load_dwordx4 v180, s[16:19], s42 offen offset:0 nt lds
    ds_read_b64_tr_b16 a[184:185], v38 offset:33024
    v_mfma_f32_16x16x32_bf16 v[140:143], a[160:163], v[192:195], 0
    ds_read_b64_tr_b16 a[186:187], v38 offset:35072
    buffer_load_dwordx4 v181, s[16:19], s42 offen offset:1024 nt lds
    v_mfma_f32_16x16x32_bf16 v[28:31], v[2:5], v[200:203], 0
    ds_read_b64_tr_b16 a[188:189], v39 offset:33024
    buffer_load_dwordx4 v182, s[16:19], s42 offen offset:2048 nt lds
    v_mfma_f32_16x16x32_bf16 v[40:43], v[4:7], v[200:203], 0
    ds_read_b64_tr_b16 a[190:191], v39 offset:35072
    s_mov_b32 s15, 0x20000
    v_mfma_f32_16x16x32_bf16 v[112:115], a[164:167], v[188:191], 0
    ds_read_b64_tr_b16 a[128:129], v32 offset:49152
    v_and_b32 v2, v8, v184
    v_mfma_f32_16x16x32_bf16 v[144:147], a[164:167], v[192:195], 0
    ds_read_b64_tr_b16 a[130:131], v32 offset:51200
    buffer_load_dwordx4 v183, s[16:19], s42 offen offset:3072 nt lds
    v_mfma_f32_16x16x32_bf16 v[116:119], a[168:171], v[188:191], 0
    ds_read_b64_tr_b16 a[132:133], v33 offset:49152
    v_and_b32 v3, v9, v185
    v_mfma_f32_16x16x32_bf16 v[148:151], a[168:171], v[192:195], 0
    v_cvt_pk_bf16_f32 v200, v28, v29
    v_cvt_pk_bf16_f32 v201, v30, v31
    v_mfma_f32_16x16x32_bf16 v[120:123], a[172:175], v[188:191], 0
    v_cvt_pk_bf16_f32 v202, v40, v41
    v_cvt_pk_bf16_f32 v203, v42, v43
    v_mfma_f32_16x16x32_bf16 v[152:155], a[172:175], v[192:195], 0
    s_waitcnt lgkmcnt(3)
    ds_read_b64_tr_b16 a[134:135], v33 offset:51200
    v_mfma_f32_16x16x32_bf16 v[124:127], a[176:179], v[188:191], 0
    ds_read_b64_tr_b16 a[136:137], v34 offset:49152
    s_add_u32 m0, s38, 49152
    v_mfma_f32_16x16x32_bf16 v[156:159], a[176:179], v[192:195], 0
    ds_read_b64_tr_b16 a[138:139], v34 offset:51200
    s_mov_b32 s42, 0x140000
    v_mfma_f32_16x16x32_bf16 v[28:31], a[248:251], v[200:203], v[12:15]
    v_and_b32 v6, v10, v184
    v_and_b32 v7, v11, v185
    v_mfma_f32_16x16x32_bf16 v[40:43], a[250:253], v[200:203], v[16:19]
    ds_read_b64_tr_b16 a[140:141], v35 offset:49152
    buffer_load_dwordx4 v180, s[16:19], s42 offen offset:0 nt lds
    v_mfma_f32_16x16x32_bf16 v[128:131], a[180:183], v[188:191], 0
    ds_read_b64_tr_b16 a[142:143], v35 offset:51200
    s_waitcnt vmcnt(17)
    v_mfma_f32_16x16x32_bf16 v[160:163], a[180:183], v[192:195], 0
    ds_read_b64_tr_b16 a[144:145], v36 offset:49152
    v_and_b32 v255, 15, v254
    v_mfma_f32_16x16x32_bf16 v[132:135], a[184:187], v[188:191], 0
    ds_read_b64_tr_b16 a[146:147], v36 offset:51200
    buffer_load_dwordx4 v181, s[16:19], s42 offen offset:1024 nt lds
    v_mfma_f32_16x16x32_bf16 v[164:167], a[184:187], v[192:195], 0
    v_cvt_pk_bf16_f32 v200, v28, v29
    v_cvt_pk_bf16_f32 v201, v30, v31
    v_mfma_f32_16x16x32_bf16 v[136:139], a[188:191], v[188:191], 0
    v_cvt_pk_bf16_f32 v202, v40, v41
    v_cvt_pk_bf16_f32 v203, v42, v43
    v_mfma_f32_16x16x32_bf16 v[168:171], a[188:191], v[192:195], 0
    s_waitcnt lgkmcnt(2)
    ds_read_b64_tr_b16 a[148:149], v37 offset:49152
    v_mfma_f32_16x16x32_bf16 v[44:47], a[128:131], v[196:199], v[44:47]
    ds_read_b64_tr_b16 a[150:151], v37 offset:51200
    buffer_load_dwordx4 v182, s[16:19], s42 offen offset:2048 nt lds
    v_mfma_f32_16x16x32_bf16 v[76:79], a[128:131], v[200:203], v[76:79]
    ds_read_b64_tr_b16 a[152:153], v38 offset:49152
    buffer_load_dwordx4 v183, s[16:19], s42 offen offset:3072 nt lds
    v_mfma_f32_16x16x32_bf16 v[28:31], v[2:5], v[204:207], 0
    ds_read_b64_tr_b16 a[154:155], v38 offset:51200
    ds_read_b128 v[12:15], v1 offset:256
    v_mfma_f32_16x16x32_bf16 v[40:43], v[4:7], v[204:207], 0
    ds_read_b128 v[16:19], v1 offset:272
    ds_read_b64_tr_b16 a[156:157], v39 offset:49152
    v_mfma_f32_16x16x32_bf16 v[48:51], a[132:135], v[196:199], v[48:51]
    ds_read_b64_tr_b16 a[158:159], v39 offset:51200
    s_mov_b32 s43, 0x1800
    v_mfma_f32_16x16x32_bf16 v[80:83], a[132:135], v[200:203], v[80:83]
    ds_read_b64_tr_b16 a[160:161], v32 offset:49408
    v_lshrrev_b32 v186, 4, v254
    v_mfma_f32_16x16x32_bf16 v[52:55], a[136:139], v[196:199], v[52:55]
    ds_read_b64_tr_b16 a[162:163], v32 offset:51456
    ds_read_b128 v[8:11], v0 offset:192
    v_mfma_f32_16x16x32_bf16 v[84:87], a[136:139], v[200:203], v[84:87]
    v_cvt_pk_bf16_f32 v204, v28, v29
    v_cvt_pk_bf16_f32 v205, v30, v31
    v_mfma_f32_16x16x32_bf16 v[56:59], a[140:143], v[196:199], v[56:59]
    v_cvt_pk_bf16_f32 v206, v40, v41
    v_cvt_pk_bf16_f32 v207, v42, v43
    v_mfma_f32_16x16x32_bf16 v[88:91], a[140:143], v[200:203], v[88:91]
    s_waitcnt lgkmcnt(3)
    ds_read_b64_tr_b16 a[164:165], v33 offset:49408
    v_mfma_f32_16x16x32_bf16 v[60:63], a[144:147], v[196:199], v[60:63]
    ds_read_b64_tr_b16 a[166:167], v33 offset:51456
    buffer_load_dwordx4 v[236:239], v26, s[20:23], s43 offen offset:0
    v_mfma_f32_16x16x32_bf16 v[92:95], a[144:147], v[200:203], v[92:95]
    ds_read_b64_tr_b16 a[168:169], v34 offset:49408
    buffer_load_dwordx4 v[240:243], v27, s[20:23], s43 offen offset:0
    v_mfma_f32_16x16x32_bf16 v[28:31], a[248:251], v[204:207], v[12:15]
    ds_read_b64_tr_b16 a[170:171], v34 offset:51456
    buffer_load_dwordx4 v[244:247], v26, s[20:23], s43 offen offset:1024
    v_mfma_f32_16x16x32_bf16 v[40:43], a[250:253], v[204:207], v[16:19]
    ds_read_b64_tr_b16 a[172:173], v35 offset:49408
    v_xor_b32 v187, v255, v186
    v_mfma_f32_16x16x32_bf16 v[64:67], a[148:151], v[196:199], v[64:67]
    ds_read_b64_tr_b16 a[174:175], v35 offset:51456
    v_lshlrev_b32 v252, 8, v255
    v_mfma_f32_16x16x32_bf16 v[96:99], a[148:151], v[200:203], v[96:99]
    ds_read_b64_tr_b16 a[176:177], v36 offset:49408
    buffer_load_dwordx4 v[248:251], v27, s[20:23], s43 offen offset:1024
    v_mfma_f32_16x16x32_bf16 v[68:71], a[152:155], v[196:199], v[68:71]
    ds_read_b64_tr_b16 a[178:179], v36 offset:51456
    v_lshl_add_u32 v253, v187, 4, v252
    v_mfma_f32_16x16x32_bf16 v[100:103], a[152:155], v[200:203], v[100:103]
    v_cvt_pk_bf16_f32 v204, v28, v29
    v_cvt_pk_bf16_f32 v205, v30, v31
    v_mfma_f32_16x16x32_bf16 v[72:75], a[156:159], v[196:199], v[72:75]
    v_cvt_pk_bf16_f32 v206, v40, v41
    v_cvt_pk_bf16_f32 v207, v42, v43
    v_mfma_f32_16x16x32_bf16 v[104:107], a[156:159], v[200:203], v[104:107]
    s_waitcnt lgkmcnt(2)
    ds_read_b64_tr_b16 a[180:181], v37 offset:49408
    v_mfma_f32_16x16x32_bf16 v[108:111], a[160:163], v[196:199], v[108:111]
    ds_read_b64_tr_b16 a[182:183], v37 offset:51456
    v_accvgpr_write_b32 a192, v253
    v_mfma_f32_16x16x32_bf16 v[140:143], a[160:163], v[200:203], v[140:143]
    ds_read_b64_tr_b16 a[184:185], v38 offset:49408
    v_lshlrev_b32 v252, 8, v186
    v_mfma_f32_16x16x32_bf16 v[28:31], v[2:5], v[208:211], 0
    ds_read_b64_tr_b16 a[186:187], v38 offset:51456
    v_add_u32 v252, s38, v252
    v_mfma_f32_16x16x32_bf16 v[40:43], v[4:7], v[208:211], 0
    ds_read_b64_tr_b16 a[188:189], v39 offset:49408
    v_lshl_add_u32 v20, v187, 4, v252
    v_mfma_f32_16x16x32_bf16 v[112:115], a[164:167], v[196:199], v[112:115]
    ds_read_b64_tr_b16 a[190:191], v39 offset:51456
    s_waitcnt vmcnt(16)
    v_mfma_f32_16x16x32_bf16 v[144:147], a[164:167], v[200:203], v[144:147]
    s_barrier
    v_and_b32 v2, v8, v184
    v_mfma_f32_16x16x32_bf16 v[116:119], a[168:171], v[196:199], v[116:119]
    ds_read_b64_tr_b16 a[128:129], v172 offset:0
    s_add_u32 m0, s38, 65536
    v_mfma_f32_16x16x32_bf16 v[148:151], a[168:171], v[200:203], v[148:151]
    v_cvt_pk_bf16_f32 v208, v28, v29
    v_cvt_pk_bf16_f32 v209, v30, v31
    v_mfma_f32_16x16x32_bf16 v[120:123], a[172:175], v[196:199], v[120:123]
    ds_read_b64_tr_b16 a[130:131], v172 offset:2048
    v_cvt_pk_bf16_f32 v210, v40, v41
    v_mfma_f32_16x16x32_bf16 v[152:155], a[172:175], v[200:203], v[152:155]
    s_waitcnt lgkmcnt(2)
    v_cvt_pk_bf16_f32 v211, v42, v43
    v_mfma_f32_16x16x32_bf16 v[124:127], a[176:179], v[196:199], v[124:127]
    ds_read_b64_tr_b16 a[132:133], v173 offset:0
    s_mov_b32 s42, 0x180000
    v_mfma_f32_16x16x32_bf16 v[156:159], a[176:179], v[200:203], v[156:159]
    ds_read_b64_tr_b16 a[134:135], v173 offset:2048
    buffer_load_dwordx4 v180, s[16:19], s42 offen offset:0 nt lds
    v_mfma_f32_16x16x32_bf16 v[28:31], a[248:251], v[208:211], v[12:15]
    ds_read_b64_tr_b16 a[136:137], v174 offset:0
    v_and_b32 v3, v9, v185
    v_mfma_f32_16x16x32_bf16 v[40:43], a[250:253], v[208:211], v[16:19]
    ds_read_b64_tr_b16 a[138:139], v174 offset:2048
    v_and_b32 v6, v10, v184
    v_mfma_f32_16x16x32_bf16 v[128:131], a[180:183], v[196:199], v[128:131]
    v_and_b32 v7, v11, v185
    ds_read_b64_tr_b16 a[140:141], v175 offset:0
    v_mfma_f32_16x16x32_bf16 v[160:163], a[180:183], v[200:203], v[160:163]
    ds_read_b64_tr_b16 a[142:143], v175 offset:2048
    buffer_load_dwordx4 v181, s[16:19], s42 offen offset:1024 nt lds
    v_mfma_f32_16x16x32_bf16 v[132:135], a[184:187], v[196:199], v[132:135]
    ds_read_b64_tr_b16 a[144:145], v176 offset:0
    v_xor_b32 v21, 64, v20
    v_mfma_f32_16x16x32_bf16 v[164:167], a[184:187], v[200:203], v[164:167]
    v_cvt_pk_bf16_f32 v208, v28, v29
    v_cvt_pk_bf16_f32 v209, v30, v31
    v_mfma_f32_16x16x32_bf16 v[136:139], a[188:191], v[196:199], v[136:139]
    v_cvt_pk_bf16_f32 v210, v40, v41
    v_cvt_pk_bf16_f32 v211, v42, v43
    v_mfma_f32_16x16x32_bf16 v[168:171], a[188:191], v[200:203], v[168:171]
    s_waitcnt lgkmcnt(1)
    ds_read_b64_tr_b16 a[146:147], v176 offset:2048
    v_mfma_f32_16x16x32_bf16 v[44:47], a[128:131], v[204:207], v[44:47]
    ds_read_b64_tr_b16 a[148:149], v177 offset:0
    buffer_load_dwordx4 v182, s[16:19], s42 offen offset:2048 nt lds
    v_mfma_f32_16x16x32_bf16 v[76:79], a[128:131], v[208:211], v[76:79]
    ds_read_b64_tr_b16 a[150:151], v177 offset:2048
    ds_read_b128 v[12:15], v1 offset:384
    v_mfma_f32_16x16x32_bf16 v[28:31], v[2:5], v[212:215], 0
    ds_read_b64_tr_b16 a[152:153], v178 offset:0
    ds_read_b128 v[16:19], v1 offset:400
    v_mfma_f32_16x16x32_bf16 v[40:43], v[4:7], v[212:215], 0
    ds_read_b64_tr_b16 a[154:155], v178 offset:2048
    v_xor_b32 v22, 128, v20
    v_mfma_f32_16x16x32_bf16 v[48:51], a[132:135], v[204:207], v[48:51]
    ds_read_b64_tr_b16 a[156:157], v179 offset:0
    v_xor_b32 v23, 192, v20
    v_mfma_f32_16x16x32_bf16 v[80:83], a[132:135], v[208:211], v[80:83]
    ds_read_b64_tr_b16 a[158:159], v179 offset:2048
    v_lshlrev_b32 v253, 1, v186
    v_mfma_f32_16x16x32_bf16 v[52:55], a[136:139], v[204:207], v[52:55]
    ds_read_b64_tr_b16 a[160:161], v172 offset:256
    buffer_load_dwordx4 v183, s[16:19], s42 offen offset:3072 nt lds
    v_mfma_f32_16x16x32_bf16 v[84:87], a[136:139], v[208:211], v[84:87]
    v_cvt_pk_bf16_f32 v212, v28, v29
    v_cvt_pk_bf16_f32 v213, v30, v31
    v_mfma_f32_16x16x32_bf16 v[56:59], a[140:143], v[204:207], v[56:59]
    ds_read_b64_tr_b16 a[162:163], v172 offset:2304
    v_cvt_pk_bf16_f32 v214, v40, v41
    v_mfma_f32_16x16x32_bf16 v[88:91], a[140:143], v[208:211], v[88:91]
    s_waitcnt lgkmcnt(2)
    v_cvt_pk_bf16_f32 v215, v42, v43
    v_mfma_f32_16x16x32_bf16 v[60:63], a[144:147], v[204:207], v[60:63]
    ds_read_b64_tr_b16 a[164:165], v173 offset:256
    s_mov_b32 s43, 0x2000
    v_mfma_f32_16x16x32_bf16 v[92:95], a[144:147], v[208:211], v[92:95]
    ds_read_b64_tr_b16 a[166:167], v173 offset:2304
    ds_read_b128 v[8:11], v0 offset:256
    v_mfma_f32_16x16x32_bf16 v[28:31], a[248:251], v[212:215], v[12:15]
    ds_read_b64_tr_b16 a[168:169], v174 offset:256
    buffer_load_dwordx4 v[188:191], v26, s[20:23], s43 offen offset:0
    v_mfma_f32_16x16x32_bf16 v[40:43], a[250:253], v[212:215], v[16:19]
    ds_read_b64_tr_b16 a[170:171], v174 offset:2304
    v_xor_b32 v253, v253, v255
    v_mfma_f32_16x16x32_bf16 v[64:67], a[148:151], v[204:207], v[64:67]
    ds_read_b64_tr_b16 a[172:173], v175 offset:256
    v_lshl_add_u32 v24, v253, 4, v252
    v_mfma_f32_16x16x32_bf16 v[96:99], a[148:151], v[208:211], v[96:99]
    ds_read_b64_tr_b16 a[174:175], v175 offset:2304
    v_xor_b32 v25, 0x80, v24
    v_mfma_f32_16x16x32_bf16 v[68:71], a[152:155], v[204:207], v[68:71]
    ds_read_b64_tr_b16 a[176:177], v176 offset:256
    v_lshrrev_b32 v255, 2, v254
    v_mfma_f32_16x16x32_bf16 v[100:103], a[152:155], v[208:211], v[100:103]
    v_cvt_pk_bf16_f32 v212, v28, v29
    v_cvt_pk_bf16_f32 v213, v30, v31
    v_mfma_f32_16x16x32_bf16 v[72:75], a[156:159], v[204:207], v[72:75]
    ds_read_b64_tr_b16 a[178:179], v176 offset:2304
    v_cvt_pk_bf16_f32 v214, v40, v41
    v_mfma_f32_16x16x32_bf16 v[104:107], a[156:159], v[208:211], v[104:107]
    s_waitcnt lgkmcnt(2)
    v_cvt_pk_bf16_f32 v215, v42, v43
    v_mfma_f32_16x16x32_bf16 v[108:111], a[160:163], v[204:207], v[108:111]
    ds_read_b64_tr_b16 a[180:181], v177 offset:256
    buffer_load_dwordx4 v[192:195], v27, s[20:23], s43 offen offset:0
    v_mfma_f32_16x16x32_bf16 v[140:143], a[160:163], v[208:211], v[140:143]
    ds_read_b64_tr_b16 a[182:183], v177 offset:2304
    v_and_b32 v186, 3, v254
    v_mfma_f32_16x16x32_bf16 v[28:31], v[2:5], v[216:219], 0
    ds_read_b64_tr_b16 a[184:185], v178 offset:256
    v_lshlrev_b32 v187, 8, v255
    v_mfma_f32_16x16x32_bf16 v[40:43], v[4:7], v[216:219], 0
    ds_read_b64_tr_b16 a[186:187], v178 offset:2304
    v_lshl_add_u32 v187, v186, 3, v187
    v_mfma_f32_16x16x32_bf16 v[112:115], a[164:167], v[204:207], v[112:115]
    ds_read_b64_tr_b16 a[188:189], v179 offset:256
    v_and_b32 v2, v8, v184
    v_mfma_f32_16x16x32_bf16 v[144:147], a[164:167], v[208:211], v[144:147]
    ds_read_b64_tr_b16 a[190:191], v179 offset:2304
    buffer_load_dwordx4 v[196:199], v26, s[20:23], s43 offen offset:1024
    v_mfma_f32_16x16x32_bf16 v[116:119], a[168:171], v[204:207], v[116:119]
    ds_read_b64_tr_b16 a[128:129], v172 offset:16384
    v_and_b32 v3, v9, v185
    v_mfma_f32_16x16x32_bf16 v[148:151], a[168:171], v[208:211], v[148:151]
    v_cvt_pk_bf16_f32 v216, v28, v29
    v_cvt_pk_bf16_f32 v217, v30, v31
    v_mfma_f32_16x16x32_bf16 v[120:123], a[172:175], v[204:207], v[120:123]
    ds_read_b64_tr_b16 a[130:131], v172 offset:18432
    v_cvt_pk_bf16_f32 v218, v40, v41
    v_mfma_f32_16x16x32_bf16 v[152:155], a[172:175], v[208:211], v[152:155]
    s_waitcnt lgkmcnt(2)
    v_cvt_pk_bf16_f32 v219, v42, v43
    v_mfma_f32_16x16x32_bf16 v[124:127], a[176:179], v[204:207], v[124:127]
    ds_read_b64_tr_b16 a[132:133], v173 offset:16384
    v_and_b32 v6, v10, v184
    v_mfma_f32_16x16x32_bf16 v[156:159], a[176:179], v[208:211], v[156:159]
    ds_read_b64_tr_b16 a[134:135], v173 offset:18432
    v_and_b32 v7, v11, v185
    v_mfma_f32_16x16x32_bf16 v[28:31], a[248:251], v[216:219], v[12:15]
    ds_read_b64_tr_b16 a[136:137], v174 offset:16384
    buffer_load_dwordx4 v[200:203], v27, s[20:23], s43 offen offset:1024
    v_mfma_f32_16x16x32_bf16 v[40:43], a[250:253], v[216:219], v[16:19]
    ds_read_b64_tr_b16 a[138:139], v174 offset:18432
    s_add_u32 m0, s38, 81920
    v_mfma_f32_16x16x32_bf16 v[128:131], a[180:183], v[204:207], v[128:131]
    ds_read_b64_tr_b16 a[140:141], v175 offset:16384
    s_mov_b32 s42, 0x1c0000
    v_mfma_f32_16x16x32_bf16 v[160:163], a[180:183], v[208:211], v[160:163]
    ds_read_b64_tr_b16 a[142:143], v175 offset:18432
    s_waitcnt vmcnt(20)
    v_mfma_f32_16x16x32_bf16 v[132:135], a[184:187], v[204:207], v[132:135]
    ds_read_b64_tr_b16 a[144:145], v176 offset:16384
    v_add_u32 v187, 0x10000, v187
    v_mfma_f32_16x16x32_bf16 v[164:167], a[184:187], v[208:211], v[164:167]
    v_cvt_pk_bf16_f32 v216, v28, v29
    v_cvt_pk_bf16_f32 v217, v30, v31
    v_mfma_f32_16x16x32_bf16 v[136:139], a[188:191], v[204:207], v[136:139]
    v_cvt_pk_bf16_f32 v218, v40, v41
    v_cvt_pk_bf16_f32 v219, v42, v43
    v_mfma_f32_16x16x32_bf16 v[168:171], a[188:191], v[208:211], v[168:171]
    s_waitcnt lgkmcnt(1)
    ds_read_b64_tr_b16 a[146:147], v176 offset:18432
    v_mfma_f32_16x16x32_bf16 v[44:47], a[128:131], v[212:215], v[44:47]
    ds_read_b64_tr_b16 a[148:149], v177 offset:16384
    buffer_load_dwordx4 v180, s[16:19], s42 offen offset:0 nt lds
    v_mfma_f32_16x16x32_bf16 v[76:79], a[128:131], v[216:219], v[76:79]
    ds_read_b64_tr_b16 a[150:151], v177 offset:18432
    ds_read_b128 v[12:15], v1 offset:512
    v_mfma_f32_16x16x32_bf16 v[28:31], v[2:5], v[220:223], 0
    ds_read_b64_tr_b16 a[152:153], v178 offset:16384
    ds_read_b128 v[16:19], v1 offset:528
    v_mfma_f32_16x16x32_bf16 v[40:43], v[4:7], v[220:223], 0
    ds_read_b64_tr_b16 a[154:155], v178 offset:18432
    v_and_b32 v252, 7, v255
    v_mfma_f32_16x16x32_bf16 v[48:51], a[132:135], v[212:215], v[48:51]
    ds_read_b64_tr_b16 a[156:157], v179 offset:16384
    buffer_load_dwordx4 v181, s[16:19], s42 offen offset:1024 nt lds
    v_mfma_f32_16x16x32_bf16 v[80:83], a[132:135], v[216:219], v[80:83]
    ds_read_b64_tr_b16 a[158:159], v179 offset:18432
    v_lshl_add_u32 v187, v252, 5, v187
    v_mfma_f32_16x16x32_bf16 v[52:55], a[136:139], v[212:215], v[52:55]
    ds_read_b64_tr_b16 a[160:161], v172 offset:16640
    ds_read_b128 v[8:11], v0 offset:320
    v_mfma_f32_16x16x32_bf16 v[84:87], a[136:139], v[216:219], v[84:87]
    v_cvt_pk_bf16_f32 v220, v28, v29
    v_cvt_pk_bf16_f32 v221, v30, v31
    v_mfma_f32_16x16x32_bf16 v[56:59], a[140:143], v[212:215], v[56:59]
    ds_read_b64_tr_b16 a[162:163], v172 offset:18688
    v_cvt_pk_bf16_f32 v222, v40, v41
    v_mfma_f32_16x16x32_bf16 v[88:91], a[140:143], v[216:219], v[88:91]
    s_waitcnt lgkmcnt(3)
    v_cvt_pk_bf16_f32 v223, v42, v43
    v_mfma_f32_16x16x32_bf16 v[60:63], a[144:147], v[212:215], v[60:63]
    ds_read_b64_tr_b16 a[164:165], v173 offset:16640
    buffer_load_dwordx4 v182, s[16:19], s42 offen offset:2048 nt lds
    v_mfma_f32_16x16x32_bf16 v[92:95], a[144:147], v[216:219], v[92:95]
    ds_read_b64_tr_b16 a[166:167], v173 offset:18688
    v_accvgpr_write_b32 a193, v187
    v_mfma_f32_16x16x32_bf16 v[28:31], a[248:251], v[220:223], v[12:15]
    ds_read_b64_tr_b16 a[168:169], v174 offset:16640
    v_cmp_eq_u32 vcc, 0, v186
    v_mfma_f32_16x16x32_bf16 v[40:43], a[250:253], v[220:223], v[16:19]
    ds_read_b64_tr_b16 a[170:171], v174 offset:18688
    v_lshlrev_b32 v255, 7, v255
    v_mfma_f32_16x16x32_bf16 v[64:67], a[148:151], v[212:215], v[64:67]
    ds_read_b64_tr_b16 a[172:173], v175 offset:16640
    v_lshl_add_u32 v255, v186, 3, v255
    v_mfma_f32_16x16x32_bf16 v[96:99], a[148:151], v[216:219], v[96:99]
    ds_read_b64_tr_b16 a[174:175], v175 offset:18688
    v_mov_b32 v253, 0x3f803f80
    v_mfma_f32_16x16x32_bf16 v[68:71], a[152:155], v[212:215], v[68:71]
    ds_read_b64_tr_b16 a[176:177], v176 offset:16640
    buffer_load_dwordx4 v183, s[16:19], s42 offen offset:3072 nt lds
    v_mfma_f32_16x16x32_bf16 v[100:103], a[152:155], v[216:219], v[100:103]
    v_cvt_pk_bf16_f32 v220, v28, v29
    v_cvt_pk_bf16_f32 v221, v30, v31
    v_mfma_f32_16x16x32_bf16 v[72:75], a[156:159], v[212:215], v[72:75]
    ds_read_b64_tr_b16 a[178:179], v176 offset:18688
    v_cvt_pk_bf16_f32 v222, v40, v41
    v_mfma_f32_16x16x32_bf16 v[104:107], a[156:159], v[216:219], v[104:107]
    s_waitcnt lgkmcnt(2)
    v_cvt_pk_bf16_f32 v223, v42, v43
    v_mfma_f32_16x16x32_bf16 v[108:111], a[160:163], v[212:215], v[108:111]
    ds_read_b64_tr_b16 a[180:181], v177 offset:16640
    v_cndmask_b32 v253, 0, v253, vcc
    v_mfma_f32_16x16x32_bf16 v[140:143], a[160:163], v[216:219], v[140:143]
    ds_read_b64_tr_b16 a[182:183], v177 offset:18688
    v_accvgpr_write_b32 a196, v253
    v_mfma_f32_16x16x32_bf16 v[28:31], v[2:5], v[224:227], 0
    ds_read_b64_tr_b16 a[184:185], v178 offset:16640
    v_accvgpr_write_b32 a197, v253
    v_mfma_f32_16x16x32_bf16 v[40:43], v[4:7], v[224:227], 0
    ds_read_b64_tr_b16 a[186:187], v178 offset:18688
    v_accvgpr_write_b32 a198, v253
    v_mfma_f32_16x16x32_bf16 v[112:115], a[164:167], v[212:215], v[112:115]
    ds_read_b64_tr_b16 a[188:189], v179 offset:16640
    v_and_b32 v2, v8, v184
    v_mfma_f32_16x16x32_bf16 v[144:147], a[164:167], v[216:219], v[144:147]
    ds_read_b64_tr_b16 a[190:191], v179 offset:18688
    s_waitcnt vmcnt(16)
    v_mfma_f32_16x16x32_bf16 v[116:119], a[168:171], v[212:215], v[116:119]
    s_barrier
    v_and_b32 v3, v9, v185
    v_mfma_f32_16x16x32_bf16 v[148:151], a[168:171], v[216:219], v[148:151]
    ds_read_b64_tr_b16 a[128:129], v172 offset:32768
    v_cvt_pk_bf16_f32 v224, v28, v29
    v_mfma_f32_16x16x32_bf16 v[120:123], a[172:175], v[212:215], v[120:123]
    v_cvt_pk_bf16_f32 v225, v30, v31
    ds_read_b64_tr_b16 a[130:131], v172 offset:34816
    v_mfma_f32_16x16x32_bf16 v[152:155], a[172:175], v[216:219], v[152:155]
    s_waitcnt lgkmcnt(2)
    v_cvt_pk_bf16_f32 v226, v40, v41
    v_cvt_pk_bf16_f32 v227, v42, v43
    v_mfma_f32_16x16x32_bf16 v[124:127], a[176:179], v[212:215], v[124:127]
    ds_read_b64_tr_b16 a[132:133], v173 offset:32768
    s_add_u32 m0, s38, 98304
    s_mov_b32 s42, 0x200000
    v_mfma_f32_16x16x32_bf16 v[156:159], a[176:179], v[216:219], v[156:159]
    ds_read_b64_tr_b16 a[134:135], v173 offset:34816
    buffer_load_dwordx4 v180, s[16:19], s42 offen offset:0 nt lds
    v_mfma_f32_16x16x32_bf16 v[28:31], a[248:251], v[224:227], v[12:15]
    ds_read_b64_tr_b16 a[136:137], v174 offset:32768
    v_and_b32 v6, v10, v184
    v_mfma_f32_16x16x32_bf16 v[40:43], a[250:253], v[224:227], v[16:19]
    ds_read_b64_tr_b16 a[138:139], v174 offset:34816
    v_and_b32 v7, v11, v185
    v_mfma_f32_16x16x32_bf16 v[128:131], a[180:183], v[212:215], v[128:131]
    ds_read_b64_tr_b16 a[140:141], v175 offset:32768
    buffer_load_dwordx4 v181, s[16:19], s42 offen offset:1024 nt lds
    v_mfma_f32_16x16x32_bf16 v[160:163], a[180:183], v[216:219], v[160:163]
    ds_read_b64_tr_b16 a[142:143], v175 offset:34816
    v_accvgpr_write_b32 a199, v253
    v_mfma_f32_16x16x32_bf16 v[132:135], a[184:187], v[212:215], v[132:135]
    ds_read_b64_tr_b16 a[144:145], v176 offset:32768
    v_bfe_u32 v186, v254, 3, 2
    v_mfma_f32_16x16x32_bf16 v[164:167], a[184:187], v[216:219], v[164:167]
    v_cvt_pk_bf16_f32 v224, v28, v29
    v_cvt_pk_bf16_f32 v225, v30, v31
    v_mfma_f32_16x16x32_bf16 v[136:139], a[188:191], v[212:215], v[136:139]
    v_cvt_pk_bf16_f32 v226, v40, v41
    v_cvt_pk_bf16_f32 v227, v42, v43
    v_mfma_f32_16x16x32_bf16 v[168:171], a[188:191], v[216:219], v[168:171]
    s_waitcnt lgkmcnt(1)
    ds_read_b64_tr_b16 a[146:147], v176 offset:34816
    v_mfma_f32_16x16x32_bf16 v[44:47], a[128:131], v[220:223], v[44:47]
    ds_read_b64_tr_b16 a[148:149], v177 offset:32768
    buffer_load_dwordx4 v182, s[16:19], s42 offen offset:2048 nt lds
    v_mfma_f32_16x16x32_bf16 v[76:79], a[128:131], v[224:227], v[76:79]
    ds_read_b64_tr_b16 a[150:151], v177 offset:34816
    ds_read_b128 v[12:15], v1 offset:640
    v_mfma_f32_16x16x32_bf16 v[28:31], v[2:5], v[228:231], 0
    ds_read_b64_tr_b16 a[152:153], v178 offset:32768
    ds_read_b128 v[16:19], v1 offset:656
    v_mfma_f32_16x16x32_bf16 v[40:43], v[4:7], v[228:231], 0
    ds_read_b64_tr_b16 a[154:155], v178 offset:34816
    v_lshl_add_u32 v255, v186, 5, v255
    v_mfma_f32_16x16x32_bf16 v[48:51], a[132:135], v[220:223], v[48:51]
    ds_read_b64_tr_b16 a[156:157], v179 offset:32768
    v_accvgpr_write_b32 a209, v255
    v_mfma_f32_16x16x32_bf16 v[80:83], a[132:135], v[224:227], v[80:83]
    ds_read_b64_tr_b16 a[158:159], v179 offset:34816
    s_lshl_b32 s3, s34, 7
    v_mfma_f32_16x16x32_bf16 v[52:55], a[136:139], v[220:223], v[52:55]
    ds_read_b64_tr_b16 a[160:161], v172 offset:33024
    buffer_load_dwordx4 v183, s[16:19], s42 offen offset:3072 nt lds
    v_mfma_f32_16x16x32_bf16 v[84:87], a[136:139], v[224:227], v[84:87]
    v_cvt_pk_bf16_f32 v228, v28, v29
    v_cvt_pk_bf16_f32 v229, v30, v31
    v_mfma_f32_16x16x32_bf16 v[56:59], a[140:143], v[220:223], v[56:59]
    ds_read_b64_tr_b16 a[162:163], v172 offset:35072
    v_cvt_pk_bf16_f32 v230, v40, v41
    v_mfma_f32_16x16x32_bf16 v[88:91], a[140:143], v[224:227], v[88:91]
    s_waitcnt lgkmcnt(2)
    v_cvt_pk_bf16_f32 v231, v42, v43
    v_mfma_f32_16x16x32_bf16 v[60:63], a[144:147], v[220:223], v[60:63]
    ds_read_b64_tr_b16 a[164:165], v173 offset:33024
    s_mov_b32 s43, 0x2800
    v_mfma_f32_16x16x32_bf16 v[92:95], a[144:147], v[224:227], v[92:95]
    ds_read_b64_tr_b16 a[166:167], v173 offset:35072
    ds_read_b128 v[8:11], v0 offset:384
    v_mfma_f32_16x16x32_bf16 v[28:31], a[248:251], v[228:231], v[12:15]
    ds_read_b64_tr_b16 a[168:169], v174 offset:33024
    buffer_load_dwordx4 v[204:207], v26, s[20:23], s43 offen offset:0
    v_mfma_f32_16x16x32_bf16 v[40:43], a[250:253], v[228:231], v[16:19]
    ds_read_b64_tr_b16 a[170:171], v174 offset:35072
    s_add_u32 s3, s3, s37
    v_mfma_f32_16x16x32_bf16 v[64:67], a[148:151], v[220:223], v[64:67]
    ds_read_b64_tr_b16 a[172:173], v175 offset:33024
    s_mul_i32 s3, s3, 18432
    v_mfma_f32_16x16x32_bf16 v[96:99], a[148:151], v[224:227], v[96:99]
    ds_read_b64_tr_b16 a[174:175], v175 offset:35072
    s_add_u32 s3, s3, 0x6c8000
    v_mfma_f32_16x16x32_bf16 v[68:71], a[152:155], v[220:223], v[68:71]
    ds_read_b64_tr_b16 a[176:177], v176 offset:33024
    s_add_u32 s24, s30, s3
    s_addc_u32 s25, s31, 0
    v_mfma_f32_16x16x32_bf16 v[100:103], a[152:155], v[224:227], v[100:103]
    v_cvt_pk_bf16_f32 v228, v28, v29
    v_cvt_pk_bf16_f32 v229, v30, v31
    v_mfma_f32_16x16x32_bf16 v[72:75], a[156:159], v[220:223], v[72:75]
    ds_read_b64_tr_b16 a[178:179], v176 offset:35072
    v_cvt_pk_bf16_f32 v230, v40, v41
    v_mfma_f32_16x16x32_bf16 v[104:107], a[156:159], v[224:227], v[104:107]
    s_waitcnt lgkmcnt(2)
    v_cvt_pk_bf16_f32 v231, v42, v43
    v_mfma_f32_16x16x32_bf16 v[108:111], a[160:163], v[220:223], v[108:111]
    ds_read_b64_tr_b16 a[180:181], v177 offset:33024
    buffer_load_dwordx4 v[208:211], v27, s[20:23], s43 offen offset:0
    v_mfma_f32_16x16x32_bf16 v[140:143], a[160:163], v[224:227], v[140:143]
    ds_read_b64_tr_b16 a[182:183], v177 offset:35072
    s_mov_b32 s26, 0x9000
    v_mfma_f32_16x16x32_bf16 v[28:31], v[2:5], v[232:235], 0
    ds_read_b64_tr_b16 a[184:185], v178 offset:33024
    s_mov_b32 s27, 0x20000
    v_mfma_f32_16x16x32_bf16 v[40:43], v[4:7], v[232:235], 0
    ds_read_b64_tr_b16 a[186:187], v178 offset:35072
    s_mul_i32 s3, s34, 294912
    v_mfma_f32_16x16x32_bf16 v[112:115], a[164:167], v[220:223], v[112:115]
    ds_read_b64_tr_b16 a[188:189], v179 offset:33024
    v_and_b32 v2, v8, v184
    v_mfma_f32_16x16x32_bf16 v[144:147], a[164:167], v[224:227], v[144:147]
    ds_read_b64_tr_b16 a[190:191], v179 offset:35072
    buffer_load_dwordx4 v[212:215], v26, s[20:23], s43 offen offset:1024
    v_mfma_f32_16x16x32_bf16 v[116:119], a[168:171], v[220:223], v[116:119]
    ds_read_b64_tr_b16 a[128:129], v172 offset:49152
    v_and_b32 v3, v9, v185
    v_mfma_f32_16x16x32_bf16 v[148:151], a[168:171], v[224:227], v[148:151]
    v_cvt_pk_bf16_f32 v232, v28, v29
    v_cvt_pk_bf16_f32 v233, v30, v31
    v_mfma_f32_16x16x32_bf16 v[120:123], a[172:175], v[220:223], v[120:123]
    ds_read_b64_tr_b16 a[130:131], v172 offset:51200
    v_cvt_pk_bf16_f32 v234, v40, v41
    v_mfma_f32_16x16x32_bf16 v[152:155], a[172:175], v[224:227], v[152:155]
    s_waitcnt lgkmcnt(2)
    v_cvt_pk_bf16_f32 v235, v42, v43
    v_mfma_f32_16x16x32_bf16 v[124:127], a[176:179], v[220:223], v[124:127]
    ds_read_b64_tr_b16 a[132:133], v173 offset:49152
    v_and_b32 v6, v10, v184
    v_mfma_f32_16x16x32_bf16 v[156:159], a[176:179], v[224:227], v[156:159]
    ds_read_b64_tr_b16 a[134:135], v173 offset:51200
    v_and_b32 v7, v11, v185
    v_mfma_f32_16x16x32_bf16 v[28:31], a[248:251], v[232:235], v[12:15]
    ds_read_b64_tr_b16 a[136:137], v174 offset:49152
    buffer_load_dwordx4 v[216:219], v27, s[20:23], s43 offen offset:1024
    v_mfma_f32_16x16x32_bf16 v[40:43], a[250:253], v[232:235], v[16:19]
    ds_read_b64_tr_b16 a[138:139], v174 offset:51200
    s_add_u32 m0, s38, 114688
    v_mfma_f32_16x16x32_bf16 v[128:131], a[180:183], v[220:223], v[128:131]
    ds_read_b64_tr_b16 a[140:141], v175 offset:49152
    s_mov_b32 s42, 0x240000
    v_mfma_f32_16x16x32_bf16 v[160:163], a[180:183], v[224:227], v[160:163]
    ds_read_b64_tr_b16 a[142:143], v175 offset:51200
    s_waitcnt vmcnt(20)
    v_mfma_f32_16x16x32_bf16 v[132:135], a[184:187], v[220:223], v[132:135]
    ds_read_b64_tr_b16 a[144:145], v176 offset:49152
    s_add_u32 s56, s54, s3
    s_addc_u32 s57, s55, 0
    v_mfma_f32_16x16x32_bf16 v[164:167], a[184:187], v[224:227], v[164:167]
    v_cvt_pk_bf16_f32 v232, v28, v29
    v_cvt_pk_bf16_f32 v233, v30, v31
    v_mfma_f32_16x16x32_bf16 v[136:139], a[188:191], v[220:223], v[136:139]
    v_cvt_pk_bf16_f32 v234, v40, v41
    v_cvt_pk_bf16_f32 v235, v42, v43
    v_mfma_f32_16x16x32_bf16 v[168:171], a[188:191], v[224:227], v[168:171]
    s_waitcnt lgkmcnt(1)
    ds_read_b64_tr_b16 a[146:147], v176 offset:51200
    v_mfma_f32_16x16x32_bf16 v[44:47], a[128:131], v[228:231], v[44:47]
    ds_read_b64_tr_b16 a[148:149], v177 offset:49152
    buffer_load_dwordx4 v180, s[16:19], s42 offen offset:0 nt lds
    v_mfma_f32_16x16x32_bf16 v[76:79], a[128:131], v[232:235], v[76:79]
    ds_read_b64_tr_b16 a[150:151], v177 offset:51200
    ds_read_b128 v[12:15], v1 offset:768
    v_mfma_f32_16x16x32_bf16 v[28:31], v[2:5], v[236:239], 0
    ds_read_b64_tr_b16 a[152:153], v178 offset:49152
    ds_read_b128 v[16:19], v1 offset:784
    v_mfma_f32_16x16x32_bf16 v[40:43], v[4:7], v[236:239], 0
    ds_read_b64_tr_b16 a[154:155], v178 offset:51200
    s_mov_b32 s58, 0x48000
    v_mfma_f32_16x16x32_bf16 v[48:51], a[132:135], v[228:231], v[48:51]
    ds_read_b64_tr_b16 a[156:157], v179 offset:49152
    buffer_load_dwordx4 v181, s[16:19], s42 offen offset:1024 nt lds
    v_mfma_f32_16x16x32_bf16 v[80:83], a[132:135], v[232:235], v[80:83]
    ds_read_b64_tr_b16 a[158:159], v179 offset:51200
    s_mov_b32 s59, 0x20000
    v_mfma_f32_16x16x32_bf16 v[52:55], a[136:139], v[228:231], v[52:55]
    ds_read_b64_tr_b16 a[160:161], v172 offset:49408
    ds_read_b128 v[8:11], v0 offset:448
    v_mfma_f32_16x16x32_bf16 v[84:87], a[136:139], v[232:235], v[84:87]
    v_cvt_pk_bf16_f32 v236, v28, v29
    v_cvt_pk_bf16_f32 v237, v30, v31
    v_mfma_f32_16x16x32_bf16 v[56:59], a[140:143], v[228:231], v[56:59]
    ds_read_b64_tr_b16 a[162:163], v172 offset:51456
    v_cvt_pk_bf16_f32 v238, v40, v41
    v_mfma_f32_16x16x32_bf16 v[88:91], a[140:143], v[232:235], v[88:91]
    s_waitcnt lgkmcnt(3)
    v_cvt_pk_bf16_f32 v239, v42, v43
    v_mfma_f32_16x16x32_bf16 v[60:63], a[144:147], v[228:231], v[60:63]
    ds_read_b64_tr_b16 a[164:165], v173 offset:49408
    buffer_load_dwordx4 v182, s[16:19], s42 offen offset:2048 nt lds
    v_mfma_f32_16x16x32_bf16 v[92:95], a[144:147], v[232:235], v[92:95]
    ds_read_b64_tr_b16 a[166:167], v173 offset:51456
    s_mov_b32 s54, s34
    v_mfma_f32_16x16x32_bf16 v[28:31], a[248:251], v[236:239], v[12:15]
    ds_read_b64_tr_b16 a[168:169], v174 offset:49408
    s_and_b32 s3, s2, 7
    v_mfma_f32_16x16x32_bf16 v[40:43], a[250:253], v[236:239], v[16:19]
    ds_read_b64_tr_b16 a[170:171], v174 offset:51456
    s_lshl_b32 s3, s3, 1
    v_mfma_f32_16x16x32_bf16 v[64:67], a[148:151], v[228:231], v[64:67]
    ds_read_b64_tr_b16 a[172:173], v175 offset:49408
    s_bfe_u32 s36, s2, 0x10003
    v_mfma_f32_16x16x32_bf16 v[96:99], a[148:151], v[232:235], v[96:99]
    ds_read_b64_tr_b16 a[174:175], v175 offset:51456
    s_add_u32 s3, s3, s36
    v_mfma_f32_16x16x32_bf16 v[68:71], a[152:155], v[228:231], v[68:71]
    ds_read_b64_tr_b16 a[176:177], v176 offset:49408
    buffer_load_dwordx4 v183, s[16:19], s42 offen offset:3072 nt lds
    v_mfma_f32_16x16x32_bf16 v[100:103], a[152:155], v[232:235], v[100:103]
    v_cvt_pk_bf16_f32 v236, v28, v29
    v_cvt_pk_bf16_f32 v237, v30, v31
    v_mfma_f32_16x16x32_bf16 v[72:75], a[156:159], v[228:231], v[72:75]
    ds_read_b64_tr_b16 a[178:179], v176 offset:51456
    v_cvt_pk_bf16_f32 v238, v40, v41
    v_mfma_f32_16x16x32_bf16 v[104:107], a[156:159], v[232:235], v[104:107]
    s_waitcnt lgkmcnt(2)
    v_cvt_pk_bf16_f32 v239, v42, v43
    v_mfma_f32_16x16x32_bf16 v[108:111], a[160:163], v[228:231], v[108:111]
    ds_read_b64_tr_b16 a[180:181], v177 offset:49408
    s_and_b32 s36, s2, 0xf0
    v_mfma_f32_16x16x32_bf16 v[140:143], a[160:163], v[232:235], v[140:143]
    ds_read_b64_tr_b16 a[182:183], v177 offset:51456
    s_add_u32 s55, s3, s36
    v_mfma_f32_16x16x32_bf16 v[28:31], v[2:5], v[240:243], 0
    ds_read_b64_tr_b16 a[184:185], v178 offset:49408
    s_lshl_b32 s40, s55, 6
    v_mfma_f32_16x16x32_bf16 v[40:43], v[4:7], v[240:243], 0
    ds_read_b64_tr_b16 a[186:187], v178 offset:51456
    s_mul_i32 s3, s33, 147456
    v_mfma_f32_16x16x32_bf16 v[112:115], a[164:167], v[228:231], v[112:115]
    ds_read_b64_tr_b16 a[188:189], v179 offset:49408
    v_and_b32 v2, v8, v184
    v_mfma_f32_16x16x32_bf16 v[144:147], a[164:167], v[232:235], v[144:147]
    ds_read_b64_tr_b16 a[190:191], v179 offset:51456
    s_waitcnt vmcnt(12)
    v_mfma_f32_16x16x32_bf16 v[116:119], a[168:171], v[228:231], v[116:119]
    s_barrier
    v_and_b32 v3, v9, v185
    v_mfma_f32_16x16x32_bf16 v[148:151], a[168:171], v[232:235], v[148:151]
    ds_read_b64_tr_b16 a[128:129], v32 offset:0
    v_cvt_pk_bf16_f32 v240, v28, v29
    v_mfma_f32_16x16x32_bf16 v[120:123], a[172:175], v[228:231], v[120:123]
    v_cvt_pk_bf16_f32 v241, v30, v31
    ds_read_b64_tr_b16 a[130:131], v32 offset:2048
    v_mfma_f32_16x16x32_bf16 v[152:155], a[172:175], v[232:235], v[152:155]
    s_waitcnt lgkmcnt(2)
    v_cvt_pk_bf16_f32 v242, v40, v41
    v_cvt_pk_bf16_f32 v243, v42, v43
    v_mfma_f32_16x16x32_bf16 v[124:127], a[176:179], v[228:231], v[124:127]
    ds_read_b64_tr_b16 a[132:133], v33 offset:0
    s_add_u32 m0, s38, 0
    s_mov_b32 s42, 0x280000
    v_mfma_f32_16x16x32_bf16 v[156:159], a[176:179], v[232:235], v[156:159]
    ds_read_b64_tr_b16 a[134:135], v33 offset:2048
    buffer_load_dwordx4 v180, s[16:19], s42 offen offset:0 nt lds
    v_mfma_f32_16x16x32_bf16 v[28:31], a[248:251], v[240:243], v[12:15]
    ds_read_b64_tr_b16 a[136:137], v34 offset:0
    v_and_b32 v6, v10, v184
    v_mfma_f32_16x16x32_bf16 v[40:43], a[250:253], v[240:243], v[16:19]
    ds_read_b64_tr_b16 a[138:139], v34 offset:2048
    v_and_b32 v7, v11, v185
    v_mfma_f32_16x16x32_bf16 v[128:131], a[180:183], v[228:231], v[128:131]
    ds_read_b64_tr_b16 a[140:141], v35 offset:0
    buffer_load_dwordx4 v181, s[16:19], s42 offen offset:1024 nt lds
    v_mfma_f32_16x16x32_bf16 v[160:163], a[180:183], v[232:235], v[160:163]
    ds_read_b64_tr_b16 a[142:143], v35 offset:2048
    s_add_u32 s40, s40, s3
    v_mfma_f32_16x16x32_bf16 v[132:135], a[184:187], v[228:231], v[132:135]
    ds_read_b64_tr_b16 a[144:145], v36 offset:0
    s_cmp_lt_u32 s55, 144
    s_cselect_b32 s40, s40, 0x1000000
    v_mfma_f32_16x16x32_bf16 v[164:167], a[184:187], v[232:235], v[164:167]
    v_cvt_pk_bf16_f32 v240, v28, v29
    v_cvt_pk_bf16_f32 v241, v30, v31
    v_mfma_f32_16x16x32_bf16 v[136:139], a[188:191], v[228:231], v[136:139]
    v_cvt_pk_bf16_f32 v242, v40, v41
    v_cvt_pk_bf16_f32 v243, v42, v43
    v_mfma_f32_16x16x32_bf16 v[168:171], a[188:191], v[232:235], v[168:171]
    s_waitcnt lgkmcnt(1)
    ds_read_b64_tr_b16 a[146:147], v36 offset:2048
    v_mfma_f32_16x16x32_bf16 v[44:47], a[128:131], v[236:239], v[44:47]
    ds_read_b64_tr_b16 a[148:149], v37 offset:0
    buffer_load_dwordx4 v182, s[16:19], s42 offen offset:2048 nt lds
    v_mfma_f32_16x16x32_bf16 v[76:79], a[128:131], v[240:243], v[76:79]
    ds_read_b64_tr_b16 a[150:151], v37 offset:2048
    ds_read_b128 v[12:15], v1 offset:896
    v_mfma_f32_16x16x32_bf16 v[28:31], v[2:5], v[244:247], 0
    ds_read_b64_tr_b16 a[152:153], v38 offset:0
    ds_read_b128 v[16:19], v1 offset:912
    v_mfma_f32_16x16x32_bf16 v[40:43], v[4:7], v[244:247], 0
    ds_read_b64_tr_b16 a[154:155], v38 offset:2048
    s_mul_i32 s41, s55, 36864
    v_mfma_f32_16x16x32_bf16 v[48:51], a[132:135], v[236:239], v[48:51]
    ds_read_b64_tr_b16 a[156:157], v39 offset:0
    s_mul_i32 s3, s33, 9216
    v_mfma_f32_16x16x32_bf16 v[80:83], a[132:135], v[240:243], v[80:83]
    ds_read_b64_tr_b16 a[158:159], v39 offset:2048
    s_add_u32 s41, s41, s3
    v_mfma_f32_16x16x32_bf16 v[52:55], a[136:139], v[236:239], v[52:55]
    ds_read_b64_tr_b16 a[160:161], v32 offset:256
    buffer_load_dwordx4 v183, s[16:19], s42 offen offset:3072 nt lds
    v_mfma_f32_16x16x32_bf16 v[84:87], a[136:139], v[240:243], v[84:87]
    v_cvt_pk_bf16_f32 v244, v28, v29
    v_cvt_pk_bf16_f32 v245, v30, v31
    v_mfma_f32_16x16x32_bf16 v[56:59], a[140:143], v[236:239], v[56:59]
    ds_read_b64_tr_b16 a[162:163], v32 offset:2304
    v_cvt_pk_bf16_f32 v246, v40, v41
    v_mfma_f32_16x16x32_bf16 v[88:91], a[140:143], v[240:243], v[88:91]
    s_waitcnt lgkmcnt(2)
    v_cvt_pk_bf16_f32 v247, v42, v43
    v_mfma_f32_16x16x32_bf16 v[60:63], a[144:147], v[236:239], v[60:63]
    ds_read_b64_tr_b16 a[164:165], v33 offset:256
    s_mov_b32 s43, 0x3000
    v_mfma_f32_16x16x32_bf16 v[92:95], a[144:147], v[240:243], v[92:95]
    ds_read_b64_tr_b16 a[166:167], v33 offset:2304
    ds_read_b128 v[8:11], v0 offset:512
    v_mfma_f32_16x16x32_bf16 v[28:31], a[248:251], v[244:247], v[12:15]
    ds_read_b64_tr_b16 a[168:169], v34 offset:256
    buffer_load_dwordx4 v[220:223], v26, s[20:23], s43 offen offset:0
    v_mfma_f32_16x16x32_bf16 v[40:43], a[250:253], v[244:247], v[16:19]
    ds_read_b64_tr_b16 a[170:171], v34 offset:2304
    s_mul_i32 s36, s33, 36864
    v_mfma_f32_16x16x32_bf16 v[64:67], a[148:151], v[236:239], v[64:67]
    ds_read_b64_tr_b16 a[172:173], v35 offset:256
    v_lshrrev_b32 v255, 2, v254
    v_mfma_f32_16x16x32_bf16 v[96:99], a[148:151], v[240:243], v[96:99]
    ds_read_b64_tr_b16 a[174:175], v35 offset:2304
    v_mul_u32_u24 v255, 9216, v255
    v_mfma_f32_16x16x32_bf16 v[68:71], a[152:155], v[236:239], v[68:71]
    ds_read_b64_tr_b16 a[176:177], v36 offset:256
    v_lshrrev_b32 v252, 4, v254
    v_mfma_f32_16x16x32_bf16 v[100:103], a[152:155], v[240:243], v[100:103]
    v_cvt_pk_bf16_f32 v244, v28, v29
    v_cvt_pk_bf16_f32 v245, v30, v31
    v_mfma_f32_16x16x32_bf16 v[72:75], a[156:159], v[236:239], v[72:75]
    ds_read_b64_tr_b16 a[178:179], v36 offset:2304
    v_cvt_pk_bf16_f32 v246, v40, v41
    v_mfma_f32_16x16x32_bf16 v[104:107], a[156:159], v[240:243], v[104:107]
    s_waitcnt lgkmcnt(2)
    v_cvt_pk_bf16_f32 v247, v42, v43
    v_mfma_f32_16x16x32_bf16 v[108:111], a[160:163], v[236:239], v[108:111]
    ds_read_b64_tr_b16 a[180:181], v37 offset:256
    buffer_load_dwordx4 v[224:227], v27, s[20:23], s43 offen offset:0
    v_mfma_f32_16x16x32_bf16 v[140:143], a[160:163], v[240:243], v[140:143]
    ds_read_b64_tr_b16 a[182:183], v37 offset:2304
    v_and_b32 v253, 2, v252
    v_mfma_f32_16x16x32_bf16 v[28:31], v[2:5], v[248:251], 0
    ds_read_b64_tr_b16 a[184:185], v38 offset:256
    v_and_b32 v186, 3, v254
    v_mfma_f32_16x16x32_bf16 v[40:43], v[4:7], v[248:251], 0
    ds_read_b64_tr_b16 a[186:187], v38 offset:2304
    v_xor_b32 v186, v186, v253
    v_mfma_f32_16x16x32_bf16 v[112:115], a[164:167], v[236:239], v[112:115]
    ds_read_b64_tr_b16 a[188:189], v39 offset:256
    v_and_b32 v2, v8, v184
    v_mfma_f32_16x16x32_bf16 v[144:147], a[164:167], v[240:243], v[144:147]
    ds_read_b64_tr_b16 a[190:191], v39 offset:2304
    buffer_load_dwordx4 v[228:231], v26, s[20:23], s43 offen offset:1024
    v_mfma_f32_16x16x32_bf16 v[116:119], a[168:171], v[236:239], v[116:119]
    ds_read_b64_tr_b16 a[128:129], v32 offset:16384
    v_and_b32 v3, v9, v185
    v_mfma_f32_16x16x32_bf16 v[148:151], a[168:171], v[240:243], v[148:151]
    v_cvt_pk_bf16_f32 v248, v28, v29
    v_cvt_pk_bf16_f32 v249, v30, v31
    v_mfma_f32_16x16x32_bf16 v[120:123], a[172:175], v[236:239], v[120:123]
    ds_read_b64_tr_b16 a[130:131], v32 offset:18432
    v_cvt_pk_bf16_f32 v250, v40, v41
    v_mfma_f32_16x16x32_bf16 v[152:155], a[172:175], v[240:243], v[152:155]
    s_waitcnt lgkmcnt(2)
    v_cvt_pk_bf16_f32 v251, v42, v43
    v_mfma_f32_16x16x32_bf16 v[124:127], a[176:179], v[236:239], v[124:127]
    ds_read_b64_tr_b16 a[132:133], v33 offset:16384
    v_and_b32 v6, v10, v184
    v_mfma_f32_16x16x32_bf16 v[156:159], a[176:179], v[240:243], v[156:159]
    ds_read_b64_tr_b16 a[134:135], v33 offset:18432
    v_and_b32 v7, v11, v185
    v_mfma_f32_16x16x32_bf16 v[28:31], a[248:251], v[248:251], v[12:15]
    ds_read_b64_tr_b16 a[136:137], v34 offset:16384
    buffer_load_dwordx4 v[232:235], v27, s[20:23], s43 offen offset:1024
    v_mfma_f32_16x16x32_bf16 v[40:43], a[250:253], v[248:251], v[16:19]
    ds_read_b64_tr_b16 a[138:139], v34 offset:18432
    s_add_u32 m0, s38, 16384
    v_mfma_f32_16x16x32_bf16 v[128:131], a[180:183], v[236:239], v[128:131]
    ds_read_b64_tr_b16 a[140:141], v35 offset:16384
    s_mov_b32 s42, 0x2c0000
    v_mfma_f32_16x16x32_bf16 v[160:163], a[180:183], v[240:243], v[160:163]
    ds_read_b64_tr_b16 a[142:143], v35 offset:18432
    v_mfma_f32_16x16x32_bf16 v[132:135], a[184:187], v[236:239], v[132:135]
    ds_read_b64_tr_b16 a[144:145], v36 offset:16384
    v_lshl_add_u32 v255, v186, 4, v255
    v_mfma_f32_16x16x32_bf16 v[164:167], a[184:187], v[240:243], v[164:167]
    v_cvt_pk_bf16_f32 v248, v28, v29
    v_cvt_pk_bf16_f32 v249, v30, v31
    v_mfma_f32_16x16x32_bf16 v[136:139], a[188:191], v[236:239], v[136:139]
    v_cvt_pk_bf16_f32 v250, v40, v41
    v_cvt_pk_bf16_f32 v251, v42, v43
    v_mfma_f32_16x16x32_bf16 v[168:171], a[188:191], v[240:243], v[168:171]
    s_waitcnt lgkmcnt(1)
    ds_read_b64_tr_b16 a[146:147], v36 offset:18432
    v_mfma_f32_16x16x32_bf16 v[44:47], a[128:131], v[244:247], v[44:47]
    ds_read_b64_tr_b16 a[148:149], v37 offset:16384
    buffer_load_dwordx4 v180, s[16:19], s42 offen offset:0 nt lds
    v_mfma_f32_16x16x32_bf16 v[76:79], a[128:131], v[248:251], v[76:79]
    ds_read_b64_tr_b16 a[150:151], v37 offset:18432
    ds_read_b128 v[12:15], v1 offset:1024
    v_mfma_f32_16x16x32_bf16 v[28:31], v[2:5], v[188:191], 0
    ds_read_b64_tr_b16 a[152:153], v38 offset:16384
    ds_read_b128 v[16:19], v1 offset:1040
    v_mfma_f32_16x16x32_bf16 v[40:43], v[4:7], v[188:191], 0
    ds_read_b64_tr_b16 a[154:155], v38 offset:18432
    v_add_u32 v255, s40, v255
    v_mfma_f32_16x16x32_bf16 v[48:51], a[132:135], v[244:247], v[48:51]
    ds_read_b64_tr_b16 a[156:157], v39 offset:16384
    buffer_load_dwordx4 v181, s[16:19], s42 offen offset:1024 nt lds
    v_mfma_f32_16x16x32_bf16 v[80:83], a[132:135], v[248:251], v[80:83]
    ds_read_b64_tr_b16 a[158:159], v39 offset:18432
    v_accvgpr_write_b32 a205, v255
    v_mfma_f32_16x16x32_bf16 v[52:55], a[136:139], v[244:247], v[52:55]
    ds_read_b64_tr_b16 a[160:161], v32 offset:16640
    ds_read_b128 v[8:11], v0 offset:576
    v_mfma_f32_16x16x32_bf16 v[84:87], a[136:139], v[248:251], v[84:87]
    v_cvt_pk_bf16_f32 v188, v28, v29
    v_cvt_pk_bf16_f32 v189, v30, v31
    v_mfma_f32_16x16x32_bf16 v[56:59], a[140:143], v[244:247], v[56:59]
    ds_read_b64_tr_b16 a[162:163], v32 offset:18688
    v_cvt_pk_bf16_f32 v190, v40, v41
    v_mfma_f32_16x16x32_bf16 v[88:91], a[140:143], v[248:251], v[88:91]
    s_waitcnt lgkmcnt(3)
    v_cvt_pk_bf16_f32 v191, v42, v43
    v_mfma_f32_16x16x32_bf16 v[60:63], a[144:147], v[244:247], v[60:63]
    ds_read_b64_tr_b16 a[164:165], v33 offset:16640
    buffer_load_dwordx4 v182, s[16:19], s42 offen offset:2048 nt lds
    v_mfma_f32_16x16x32_bf16 v[92:95], a[144:147], v[248:251], v[92:95]
    ds_read_b64_tr_b16 a[166:167], v33 offset:18688
    v_lshrrev_b32 v186, 3, v254
    v_mfma_f32_16x16x32_bf16 v[28:31], a[248:251], v[188:191], v[12:15]
    ds_read_b64_tr_b16 a[168:169], v34 offset:16640
    v_mul_u32_u24 v186, 1152, v186
    v_mfma_f32_16x16x32_bf16 v[40:43], a[250:253], v[188:191], v[16:19]
    ds_read_b64_tr_b16 a[170:171], v34 offset:18688
    v_lshlrev_b32 v252, 1, v252
    v_mfma_f32_16x16x32_bf16 v[64:67], a[148:151], v[244:247], v[64:67]
    ds_read_b64_tr_b16 a[172:173], v35 offset:16640
    v_and_b32 v253, 7, v254
    v_mfma_f32_16x16x32_bf16 v[96:99], a[148:151], v[248:251], v[96:99]
    ds_read_b64_tr_b16 a[174:175], v35 offset:18688
    v_xor_b32 v252, v252, v253
    v_mfma_f32_16x16x32_bf16 v[68:71], a[152:155], v[244:247], v[68:71]
    ds_read_b64_tr_b16 a[176:177], v36 offset:16640
    buffer_load_dwordx4 v183, s[16:19], s42 offen offset:3072 nt lds
    v_mfma_f32_16x16x32_bf16 v[100:103], a[152:155], v[248:251], v[100:103]
    v_cvt_pk_bf16_f32 v188, v28, v29
    v_cvt_pk_bf16_f32 v189, v30, v31
    v_mfma_f32_16x16x32_bf16 v[72:75], a[156:159], v[244:247], v[72:75]
    ds_read_b64_tr_b16 a[178:179], v36 offset:18688
    v_cvt_pk_bf16_f32 v190, v40, v41
    v_mfma_f32_16x16x32_bf16 v[104:107], a[156:159], v[248:251], v[104:107]
    s_waitcnt lgkmcnt(2)
    v_cvt_pk_bf16_f32 v191, v42, v43
    v_mfma_f32_16x16x32_bf16 v[108:111], a[160:163], v[244:247], v[108:111]
    ds_read_b64_tr_b16 a[180:181], v37 offset:16640
    v_lshl_add_u32 v186, v252, 4, v186
    v_mfma_f32_16x16x32_bf16 v[140:143], a[160:163], v[248:251], v[140:143]
    ds_read_b64_tr_b16 a[182:183], v37 offset:18688
    v_add_u32 v255, s41, v186
    v_mfma_f32_16x16x32_bf16 v[28:31], v[2:5], v[192:195], 0
    ds_read_b64_tr_b16 a[184:185], v38 offset:16640
    v_accvgpr_write_b32 a206, v255
    v_mfma_f32_16x16x32_bf16 v[40:43], v[4:7], v[192:195], 0
    ds_read_b64_tr_b16 a[186:187], v38 offset:18688
    v_add_u32 v255, s36, v186
    v_mfma_f32_16x16x32_bf16 v[112:115], a[164:167], v[244:247], v[112:115]
    ds_read_b64_tr_b16 a[188:189], v39 offset:16640
    v_and_b32 v2, v8, v184
    v_mfma_f32_16x16x32_bf16 v[144:147], a[164:167], v[248:251], v[144:147]
    ds_read_b64_tr_b16 a[190:191], v39 offset:18688
    s_waitcnt vmcnt(12)
    v_mfma_f32_16x16x32_bf16 v[116:119], a[168:171], v[244:247], v[116:119]
    s_barrier
    v_and_b32 v3, v9, v185
    v_mfma_f32_16x16x32_bf16 v[148:151], a[168:171], v[248:251], v[148:151]
    ds_read_b64_tr_b16 a[128:129], v32 offset:32768
    v_cvt_pk_bf16_f32 v192, v28, v29
    v_mfma_f32_16x16x32_bf16 v[120:123], a[172:175], v[244:247], v[120:123]
    v_cvt_pk_bf16_f32 v193, v30, v31
    ds_read_b64_tr_b16 a[130:131], v32 offset:34816
    v_mfma_f32_16x16x32_bf16 v[152:155], a[172:175], v[248:251], v[152:155]
    s_waitcnt lgkmcnt(2)
    v_cvt_pk_bf16_f32 v194, v40, v41
    v_cvt_pk_bf16_f32 v195, v42, v43
    v_mfma_f32_16x16x32_bf16 v[124:127], a[176:179], v[244:247], v[124:127]
    ds_read_b64_tr_b16 a[132:133], v33 offset:32768
    s_add_u32 m0, s38, 32768
    s_mov_b32 s42, 0x300000
    v_mfma_f32_16x16x32_bf16 v[156:159], a[176:179], v[248:251], v[156:159]
    ds_read_b64_tr_b16 a[134:135], v33 offset:34816
    buffer_load_dwordx4 v180, s[16:19], s42 offen offset:0 nt lds
    v_mfma_f32_16x16x32_bf16 v[28:31], a[248:251], v[192:195], v[12:15]
    ds_read_b64_tr_b16 a[136:137], v34 offset:32768
    v_and_b32 v6, v10, v184
    v_mfma_f32_16x16x32_bf16 v[40:43], a[250:253], v[192:195], v[16:19]
    ds_read_b64_tr_b16 a[138:139], v34 offset:34816
    v_and_b32 v7, v11, v185
    v_mfma_f32_16x16x32_bf16 v[128:131], a[180:183], v[244:247], v[128:131]
    ds_read_b64_tr_b16 a[140:141], v35 offset:32768
    buffer_load_dwordx4 v181, s[16:19], s42 offen offset:1024 nt lds
    v_mfma_f32_16x16x32_bf16 v[160:163], a[180:183], v[248:251], v[160:163]
    ds_read_b64_tr_b16 a[142:143], v35 offset:34816
    v_accvgpr_write_b32 a208, v255
    v_mfma_f32_16x16x32_bf16 v[132:135], a[184:187], v[244:247], v[132:135]
    ds_read_b64_tr_b16 a[144:145], v36 offset:32768
    s_lshl_b32 s36, s33, 10
    v_mfma_f32_16x16x32_bf16 v[164:167], a[184:187], v[248:251], v[164:167]
    v_cvt_pk_bf16_f32 v192, v28, v29
    v_cvt_pk_bf16_f32 v193, v30, v31
    v_mfma_f32_16x16x32_bf16 v[136:139], a[188:191], v[244:247], v[136:139]
    v_cvt_pk_bf16_f32 v194, v40, v41
    v_cvt_pk_bf16_f32 v195, v42, v43
    v_mfma_f32_16x16x32_bf16 v[168:171], a[188:191], v[248:251], v[168:171]
    s_waitcnt lgkmcnt(1)
    ds_read_b64_tr_b16 a[146:147], v36 offset:34816
    v_mfma_f32_16x16x32_bf16 v[44:47], a[128:131], v[188:191], v[44:47]
    ds_read_b64_tr_b16 a[148:149], v37 offset:32768
    buffer_load_dwordx4 v182, s[16:19], s42 offen offset:2048 nt lds
    v_mfma_f32_16x16x32_bf16 v[76:79], a[128:131], v[192:195], v[76:79]
    ds_read_b64_tr_b16 a[150:151], v37 offset:34816
    ds_read_b128 v[12:15], v1 offset:1152
    v_mfma_f32_16x16x32_bf16 v[28:31], v[2:5], v[196:199], 0
    ds_read_b64_tr_b16 a[152:153], v38 offset:32768
    ds_read_b128 v[16:19], v1 offset:1168
    v_mfma_f32_16x16x32_bf16 v[40:43], v[4:7], v[196:199], 0
    ds_read_b64_tr_b16 a[154:155], v38 offset:34816
    v_lshrrev_b32 v186, 4, v254
    v_mfma_f32_16x16x32_bf16 v[48:51], a[132:135], v[188:191], v[48:51]
    ds_read_b64_tr_b16 a[156:157], v39 offset:32768
    v_bfe_u32 v252, v254, 2, 1
    v_mfma_f32_16x16x32_bf16 v[80:83], a[132:135], v[192:195], v[80:83]
    ds_read_b64_tr_b16 a[158:159], v39 offset:34816
    v_lshlrev_b32 v252, 1, v252
    v_mfma_f32_16x16x32_bf16 v[52:55], a[136:139], v[188:191], v[52:55]
    ds_read_b64_tr_b16 a[160:161], v32 offset:33024
    buffer_load_dwordx4 v183, s[16:19], s42 offen offset:3072 nt lds
    v_mfma_f32_16x16x32_bf16 v[84:87], a[136:139], v[192:195], v[84:87]
    v_cvt_pk_bf16_f32 v196, v28, v29
    v_cvt_pk_bf16_f32 v197, v30, v31
    v_mfma_f32_16x16x32_bf16 v[56:59], a[140:143], v[188:191], v[56:59]
    ds_read_b64_tr_b16 a[162:163], v32 offset:35072
    v_cvt_pk_bf16_f32 v198, v40, v41
    v_mfma_f32_16x16x32_bf16 v[88:91], a[140:143], v[192:195], v[88:91]
    s_waitcnt lgkmcnt(2)
    v_cvt_pk_bf16_f32 v199, v42, v43
    v_mfma_f32_16x16x32_bf16 v[60:63], a[144:147], v[188:191], v[60:63]
    ds_read_b64_tr_b16 a[164:165], v33 offset:33024
    s_mov_b32 s43, 0x3800
    v_mfma_f32_16x16x32_bf16 v[92:95], a[144:147], v[192:195], v[92:95]
    ds_read_b64_tr_b16 a[166:167], v33 offset:35072
    ds_read_b128 v[8:11], v0 offset:640
    v_mfma_f32_16x16x32_bf16 v[28:31], a[248:251], v[196:199], v[12:15]
    ds_read_b64_tr_b16 a[168:169], v34 offset:33024
    buffer_load_dwordx4 v[236:239], v26, s[20:23], s43 offen offset:0
    v_mfma_f32_16x16x32_bf16 v[40:43], a[250:253], v[196:199], v[16:19]
    ds_read_b64_tr_b16 a[170:171], v34 offset:35072
    v_sub_u32 v186, v186, v252
    v_mfma_f32_16x16x32_bf16 v[64:67], a[148:151], v[188:191], v[64:67]
    ds_read_b64_tr_b16 a[172:173], v35 offset:33024
    v_bfe_u32 v252, v254, 3, 1
    v_mfma_f32_16x16x32_bf16 v[96:99], a[148:151], v[192:195], v[96:99]
    ds_read_b64_tr_b16 a[174:175], v35 offset:35072
    v_bfe_u32 v187, v254, 1, 1
    v_mfma_f32_16x16x32_bf16 v[68:71], a[152:155], v[188:191], v[68:71]
    ds_read_b64_tr_b16 a[176:177], v36 offset:33024
    v_lshl_add_u32 v187, v252, 1, v187
    v_mfma_f32_16x16x32_bf16 v[100:103], a[152:155], v[192:195], v[100:103]
    v_cvt_pk_bf16_f32 v196, v28, v29
    v_cvt_pk_bf16_f32 v197, v30, v31
    v_mfma_f32_16x16x32_bf16 v[72:75], a[156:159], v[188:191], v[72:75]
    ds_read_b64_tr_b16 a[178:179], v36 offset:35072
    v_cvt_pk_bf16_f32 v198, v40, v41
    v_mfma_f32_16x16x32_bf16 v[104:107], a[156:159], v[192:195], v[104:107]
    s_waitcnt lgkmcnt(2)
    v_cvt_pk_bf16_f32 v199, v42, v43
    v_mfma_f32_16x16x32_bf16 v[108:111], a[160:163], v[188:191], v[108:111]
    ds_read_b64_tr_b16 a[180:181], v37 offset:33024
    buffer_load_dwordx4 v[240:243], v27, s[20:23], s43 offen offset:0
    v_mfma_f32_16x16x32_bf16 v[140:143], a[160:163], v[192:195], v[140:143]
    ds_read_b64_tr_b16 a[182:183], v37 offset:35072
    v_lshl_add_u32 v187, v186, 2, v187
    v_mfma_f32_16x16x32_bf16 v[28:31], v[2:5], v[200:203], 0
    ds_read_b64_tr_b16 a[184:185], v38 offset:33024
    v_and_b32 v255, 1, v254
    v_mfma_f32_16x16x32_bf16 v[40:43], v[4:7], v[200:203], 0
    ds_read_b64_tr_b16 a[186:187], v38 offset:35072
    v_lshlrev_b32 v255, 4, v255
    v_mfma_f32_16x16x32_bf16 v[112:115], a[164:167], v[188:191], v[112:115]
    ds_read_b64_tr_b16 a[188:189], v39 offset:33024
    v_and_b32 v2, v8, v184
    v_mfma_f32_16x16x32_bf16 v[144:147], a[164:167], v[192:195], v[144:147]
    ds_read_b64_tr_b16 a[190:191], v39 offset:35072
    buffer_load_dwordx4 v[244:247], v26, s[20:23], s43 offen offset:1024
    v_mfma_f32_16x16x32_bf16 v[116:119], a[168:171], v[188:191], v[116:119]
    ds_read_b64_tr_b16 a[128:129], v32 offset:49152
    v_and_b32 v3, v9, v185
    v_mfma_f32_16x16x32_bf16 v[148:151], a[168:171], v[192:195], v[148:151]
    v_cvt_pk_bf16_f32 v200, v28, v29
    v_cvt_pk_bf16_f32 v201, v30, v31
    v_mfma_f32_16x16x32_bf16 v[120:123], a[172:175], v[188:191], v[120:123]
    ds_read_b64_tr_b16 a[130:131], v32 offset:51200
    v_cvt_pk_bf16_f32 v202, v40, v41
    v_mfma_f32_16x16x32_bf16 v[152:155], a[172:175], v[192:195], v[152:155]
    s_waitcnt lgkmcnt(2)
    v_cvt_pk_bf16_f32 v203, v42, v43
    v_mfma_f32_16x16x32_bf16 v[124:127], a[176:179], v[188:191], v[124:127]
    ds_read_b64_tr_b16 a[132:133], v33 offset:49152
    v_and_b32 v6, v10, v184
    v_mfma_f32_16x16x32_bf16 v[156:159], a[176:179], v[192:195], v[156:159]
    ds_read_b64_tr_b16 a[134:135], v33 offset:51200
    v_and_b32 v7, v11, v185
    v_mfma_f32_16x16x32_bf16 v[28:31], a[248:251], v[200:203], v[12:15]
    ds_read_b64_tr_b16 a[136:137], v34 offset:49152
    buffer_load_dwordx4 v[248:251], v27, s[20:23], s43 offen offset:1024
    v_mfma_f32_16x16x32_bf16 v[40:43], a[250:253], v[200:203], v[16:19]
    ds_read_b64_tr_b16 a[138:139], v34 offset:51200
    s_add_u32 m0, s38, 49152
    v_mfma_f32_16x16x32_bf16 v[128:131], a[180:183], v[188:191], v[128:131]
    ds_read_b64_tr_b16 a[140:141], v35 offset:49152
    s_mov_b32 s42, 0x340000
    v_mfma_f32_16x16x32_bf16 v[160:163], a[180:183], v[192:195], v[160:163]
    ds_read_b64_tr_b16 a[142:143], v35 offset:51200
    v_mfma_f32_16x16x32_bf16 v[132:135], a[184:187], v[188:191], v[132:135]
    ds_read_b64_tr_b16 a[144:145], v36 offset:49152
    v_mov_b32 v252, 0x3e03
    v_mfma_f32_16x16x32_bf16 v[164:167], a[184:187], v[192:195], v[164:167]
    v_cvt_pk_bf16_f32 v200, v28, v29
    v_cvt_pk_bf16_f32 v201, v30, v31
    v_mfma_f32_16x16x32_bf16 v[136:139], a[188:191], v[188:191], v[136:139]
    v_cvt_pk_bf16_f32 v202, v40, v41
    v_cvt_pk_bf16_f32 v203, v42, v43
    v_mfma_f32_16x16x32_bf16 v[168:171], a[188:191], v[192:195], v[168:171]
    s_waitcnt lgkmcnt(1)
    ds_read_b64_tr_b16 a[146:147], v36 offset:51200
    v_mfma_f32_16x16x32_bf16 v[44:47], a[128:131], v[196:199], v[44:47]
    ds_read_b64_tr_b16 a[148:149], v37 offset:49152
    buffer_load_dwordx4 v180, s[16:19], s42 offen offset:0 nt lds
    v_mfma_f32_16x16x32_bf16 v[76:79], a[128:131], v[200:203], v[76:79]
    ds_read_b64_tr_b16 a[150:151], v37 offset:51200
    ds_read_b128 v[12:15], v1 offset:1280
    v_mfma_f32_16x16x32_bf16 v[28:31], v[2:5], v[204:207], 0
    ds_read_b64_tr_b16 a[152:153], v38 offset:49152
    ds_read_b128 v[16:19], v1 offset:1296
    v_mfma_f32_16x16x32_bf16 v[40:43], v[4:7], v[204:207], 0
    ds_read_b64_tr_b16 a[154:155], v38 offset:51200
    v_mov_b32 v253, 0xb9d8
    v_mfma_f32_16x16x32_bf16 v[48:51], a[132:135], v[196:199], v[48:51]
    ds_read_b64_tr_b16 a[156:157], v39 offset:49152
    buffer_load_dwordx4 v181, s[16:19], s42 offen offset:1024 nt lds
    v_mfma_f32_16x16x32_bf16 v[80:83], a[132:135], v[200:203], v[80:83]
    ds_read_b64_tr_b16 a[158:159], v39 offset:51200
    v_lshlrev_b32 v252, v255, v252
    v_mfma_f32_16x16x32_bf16 v[52:55], a[136:139], v[196:199], v[52:55]
    ds_read_b64_tr_b16 a[160:161], v32 offset:49408
    ds_read_b128 v[8:11], v0 offset:704
    v_mfma_f32_16x16x32_bf16 v[84:87], a[136:139], v[200:203], v[84:87]
    v_cvt_pk_bf16_f32 v204, v28, v29
    v_cvt_pk_bf16_f32 v205, v30, v31
    v_mfma_f32_16x16x32_bf16 v[56:59], a[140:143], v[196:199], v[56:59]
    ds_read_b64_tr_b16 a[162:163], v32 offset:51456
    v_cvt_pk_bf16_f32 v206, v40, v41
    v_mfma_f32_16x16x32_bf16 v[88:91], a[140:143], v[200:203], v[88:91]
    s_waitcnt lgkmcnt(3)
    v_cvt_pk_bf16_f32 v207, v42, v43
    v_mfma_f32_16x16x32_bf16 v[60:63], a[144:147], v[196:199], v[60:63]
    ds_read_b64_tr_b16 a[164:165], v33 offset:49408
    buffer_load_dwordx4 v182, s[16:19], s42 offen offset:2048 nt lds
    v_mfma_f32_16x16x32_bf16 v[92:95], a[144:147], v[200:203], v[92:95]
    ds_read_b64_tr_b16 a[166:167], v33 offset:51456
    v_lshlrev_b32 v253, v255, v253
    v_mfma_f32_16x16x32_bf16 v[28:31], a[248:251], v[204:207], v[12:15]
    ds_read_b64_tr_b16 a[168:169], v34 offset:49408
    v_cmp_eq_u32 vcc, 0, v187
    v_mfma_f32_16x16x32_bf16 v[40:43], a[250:253], v[204:207], v[16:19]
    ds_read_b64_tr_b16 a[170:171], v34 offset:51456
    s_mov_b32 s60, s44
    v_mfma_f32_16x16x32_bf16 v[64:67], a[148:151], v[196:199], v[64:67]
    ds_read_b64_tr_b16 a[172:173], v35 offset:49408
    s_mov_b32 s61, s45
    v_mfma_f32_16x16x32_bf16 v[96:99], a[148:151], v[200:203], v[96:99]
    ds_read_b64_tr_b16 a[174:175], v35 offset:51456
    v_cndmask_b32 v255, 0, v252, vcc
    v_mfma_f32_16x16x32_bf16 v[68:71], a[152:155], v[196:199], v[68:71]
    ds_read_b64_tr_b16 a[176:177], v36 offset:49408
    buffer_load_dwordx4 v183, s[16:19], s42 offen offset:3072 nt lds
    v_mfma_f32_16x16x32_bf16 v[100:103], a[152:155], v[200:203], v[100:103]
    v_cvt_pk_bf16_f32 v204, v28, v29
    v_cvt_pk_bf16_f32 v205, v30, v31
    v_mfma_f32_16x16x32_bf16 v[72:75], a[156:159], v[196:199], v[72:75]
    ds_read_b64_tr_b16 a[178:179], v36 offset:51456
    v_cvt_pk_bf16_f32 v206, v40, v41
    v_mfma_f32_16x16x32_bf16 v[104:107], a[156:159], v[200:203], v[104:107]
    s_waitcnt lgkmcnt(2)
    v_cvt_pk_bf16_f32 v207, v42, v43
    v_mfma_f32_16x16x32_bf16 v[108:111], a[160:163], v[196:199], v[108:111]
    ds_read_b64_tr_b16 a[180:181], v37 offset:49408
    v_cndmask_b32 v186, 0, v253, vcc
    v_mfma_f32_16x16x32_bf16 v[140:143], a[160:163], v[200:203], v[140:143]
    ds_read_b64_tr_b16 a[182:183], v37 offset:51456
    v_cmp_eq_u32 vcc, 1, v187
    v_mfma_f32_16x16x32_bf16 v[28:31], v[2:5], v[208:211], 0
    ds_read_b64_tr_b16 a[184:185], v38 offset:49408
    v_accvgpr_write_b32 a216, v255
    v_mfma_f32_16x16x32_bf16 v[40:43], v[4:7], v[208:211], 0
    ds_read_b64_tr_b16 a[186:187], v38 offset:51456
    v_accvgpr_write_b32 a224, v186
    v_mfma_f32_16x16x32_bf16 v[112:115], a[164:167], v[196:199], v[112:115]
    ds_read_b64_tr_b16 a[188:189], v39 offset:49408
    v_and_b32 v2, v8, v184
    v_mfma_f32_16x16x32_bf16 v[144:147], a[164:167], v[200:203], v[144:147]
    ds_read_b64_tr_b16 a[190:191], v39 offset:51456
    s_waitcnt vmcnt(12)
    v_mfma_f32_16x16x32_bf16 v[116:119], a[168:171], v[196:199], v[116:119]
    s_barrier
    v_and_b32 v3, v9, v185
    v_mfma_f32_16x16x32_bf16 v[148:151], a[168:171], v[200:203], v[148:151]
    ds_read_b64_tr_b16 a[128:129], v172 offset:0
    v_cvt_pk_bf16_f32 v208, v28, v29
    v_mfma_f32_16x16x32_bf16 v[120:123], a[172:175], v[196:199], v[120:123]
    v_cvt_pk_bf16_f32 v209, v30, v31
    ds_read_b64_tr_b16 a[130:131], v172 offset:2048
    v_mfma_f32_16x16x32_bf16 v[152:155], a[172:175], v[200:203], v[152:155]
    s_waitcnt lgkmcnt(2)
    v_cvt_pk_bf16_f32 v210, v40, v41
    v_cvt_pk_bf16_f32 v211, v42, v43
    v_mfma_f32_16x16x32_bf16 v[124:127], a[176:179], v[196:199], v[124:127]
    ds_read_b64_tr_b16 a[132:133], v173 offset:0
    s_add_u32 m0, s38, 65536
    s_mov_b32 s42, 0x380000
    v_mfma_f32_16x16x32_bf16 v[156:159], a[176:179], v[200:203], v[156:159]
    ds_read_b64_tr_b16 a[134:135], v173 offset:2048
    buffer_load_dwordx4 v180, s[16:19], s42 offen offset:0 nt lds
    v_mfma_f32_16x16x32_bf16 v[28:31], a[248:251], v[208:211], v[12:15]
    ds_read_b64_tr_b16 a[136:137], v174 offset:0
    v_and_b32 v6, v10, v184
    v_mfma_f32_16x16x32_bf16 v[40:43], a[250:253], v[208:211], v[16:19]
    ds_read_b64_tr_b16 a[138:139], v174 offset:2048
    v_and_b32 v7, v11, v185
    v_mfma_f32_16x16x32_bf16 v[128:131], a[180:183], v[196:199], v[128:131]
    ds_read_b64_tr_b16 a[140:141], v175 offset:0
    buffer_load_dwordx4 v181, s[16:19], s42 offen offset:1024 nt lds
    v_mfma_f32_16x16x32_bf16 v[160:163], a[180:183], v[200:203], v[160:163]
    ds_read_b64_tr_b16 a[142:143], v175 offset:2048
    v_cndmask_b32 v255, 0, v252, vcc
    v_mfma_f32_16x16x32_bf16 v[132:135], a[184:187], v[196:199], v[132:135]
    ds_read_b64_tr_b16 a[144:145], v176 offset:0
    v_cndmask_b32 v186, 0, v253, vcc
    v_mfma_f32_16x16x32_bf16 v[164:167], a[184:187], v[200:203], v[164:167]
    v_cvt_pk_bf16_f32 v208, v28, v29
    v_cvt_pk_bf16_f32 v209, v30, v31
    v_mfma_f32_16x16x32_bf16 v[136:139], a[188:191], v[196:199], v[136:139]
    v_cvt_pk_bf16_f32 v210, v40, v41
    v_cvt_pk_bf16_f32 v211, v42, v43
    v_mfma_f32_16x16x32_bf16 v[168:171], a[188:191], v[200:203], v[168:171]
    s_waitcnt lgkmcnt(1)
    ds_read_b64_tr_b16 a[146:147], v176 offset:2048
    v_mfma_f32_16x16x32_bf16 v[44:47], a[128:131], v[204:207], v[44:47]
    ds_read_b64_tr_b16 a[148:149], v177 offset:0
    buffer_load_dwordx4 v182, s[16:19], s42 offen offset:2048 nt lds
    v_mfma_f32_16x16x32_bf16 v[76:79], a[128:131], v[208:211], v[76:79]
    ds_read_b64_tr_b16 a[150:151], v177 offset:2048
    ds_read_b128 v[12:15], v1 offset:1408
    v_mfma_f32_16x16x32_bf16 v[28:31], v[2:5], v[212:215], 0
    ds_read_b64_tr_b16 a[152:153], v178 offset:0
    ds_read_b128 v[16:19], v1 offset:1424
    v_mfma_f32_16x16x32_bf16 v[40:43], v[4:7], v[212:215], 0
    ds_read_b64_tr_b16 a[154:155], v178 offset:2048
    v_cmp_eq_u32 vcc, 2, v187
    v_mfma_f32_16x16x32_bf16 v[48:51], a[132:135], v[204:207], v[48:51]
    ds_read_b64_tr_b16 a[156:157], v179 offset:0
    v_accvgpr_write_b32 a217, v255
    v_mfma_f32_16x16x32_bf16 v[80:83], a[132:135], v[208:211], v[80:83]
    ds_read_b64_tr_b16 a[158:159], v179 offset:2048
    v_accvgpr_write_b32 a225, v186
    v_mfma_f32_16x16x32_bf16 v[52:55], a[136:139], v[204:207], v[52:55]
    ds_read_b64_tr_b16 a[160:161], v172 offset:256
    buffer_load_dwordx4 v183, s[16:19], s42 offen offset:3072 nt lds
    v_mfma_f32_16x16x32_bf16 v[84:87], a[136:139], v[208:211], v[84:87]
    v_cvt_pk_bf16_f32 v212, v28, v29
    v_cvt_pk_bf16_f32 v213, v30, v31
    v_mfma_f32_16x16x32_bf16 v[56:59], a[140:143], v[204:207], v[56:59]
    ds_read_b64_tr_b16 a[162:163], v172 offset:2304
    v_cvt_pk_bf16_f32 v214, v40, v41
    v_mfma_f32_16x16x32_bf16 v[88:91], a[140:143], v[208:211], v[88:91]
    s_waitcnt lgkmcnt(2)
    v_cvt_pk_bf16_f32 v215, v42, v43
    v_mfma_f32_16x16x32_bf16 v[60:63], a[144:147], v[204:207], v[60:63]
    ds_read_b64_tr_b16 a[164:165], v173 offset:256
    s_mov_b32 s43, 0x4000
    v_mfma_f32_16x16x32_bf16 v[92:95], a[144:147], v[208:211], v[92:95]
    ds_read_b64_tr_b16 a[166:167], v173 offset:2304
    ds_read_b128 v[8:11], v0 offset:768
    v_mfma_f32_16x16x32_bf16 v[28:31], a[248:251], v[212:215], v[12:15]
    ds_read_b64_tr_b16 a[168:169], v174 offset:256
    buffer_load_dwordx4 v[188:191], v26, s[20:23], s43 offen offset:0
    v_mfma_f32_16x16x32_bf16 v[40:43], a[250:253], v[212:215], v[16:19]
    ds_read_b64_tr_b16 a[170:171], v174 offset:2304
    v_cndmask_b32 v255, 0, v252, vcc
    v_mfma_f32_16x16x32_bf16 v[64:67], a[148:151], v[204:207], v[64:67]
    ds_read_b64_tr_b16 a[172:173], v175 offset:256
    v_cndmask_b32 v186, 0, v253, vcc
    v_mfma_f32_16x16x32_bf16 v[96:99], a[148:151], v[208:211], v[96:99]
    ds_read_b64_tr_b16 a[174:175], v175 offset:2304
    v_cmp_eq_u32 vcc, 3, v187
    v_mfma_f32_16x16x32_bf16 v[68:71], a[152:155], v[204:207], v[68:71]
    ds_read_b64_tr_b16 a[176:177], v176 offset:256
    v_accvgpr_write_b32 a218, v255
    v_mfma_f32_16x16x32_bf16 v[100:103], a[152:155], v[208:211], v[100:103]
    v_cvt_pk_bf16_f32 v212, v28, v29
    v_cvt_pk_bf16_f32 v213, v30, v31
    v_mfma_f32_16x16x32_bf16 v[72:75], a[156:159], v[204:207], v[72:75]
    ds_read_b64_tr_b16 a[178:179], v176 offset:2304
    v_cvt_pk_bf16_f32 v214, v40, v41
    v_mfma_f32_16x16x32_bf16 v[104:107], a[156:159], v[208:211], v[104:107]
    s_waitcnt lgkmcnt(2)
    v_cvt_pk_bf16_f32 v215, v42, v43
    v_mfma_f32_16x16x32_bf16 v[108:111], a[160:163], v[204:207], v[108:111]
    ds_read_b64_tr_b16 a[180:181], v177 offset:256
    buffer_load_dwordx4 v[192:195], v27, s[20:23], s43 offen offset:0
    v_mfma_f32_16x16x32_bf16 v[140:143], a[160:163], v[208:211], v[140:143]
    ds_read_b64_tr_b16 a[182:183], v177 offset:2304
    v_accvgpr_write_b32 a226, v186
    v_mfma_f32_16x16x32_bf16 v[28:31], v[2:5], v[216:219], 0
    ds_read_b64_tr_b16 a[184:185], v178 offset:256
    v_cndmask_b32 v255, 0, v252, vcc
    v_mfma_f32_16x16x32_bf16 v[40:43], v[4:7], v[216:219], 0
    ds_read_b64_tr_b16 a[186:187], v178 offset:2304
    v_cndmask_b32 v186, 0, v253, vcc
    v_mfma_f32_16x16x32_bf16 v[112:115], a[164:167], v[204:207], v[112:115]
    ds_read_b64_tr_b16 a[188:189], v179 offset:256
    v_and_b32 v2, v8, v184
    v_mfma_f32_16x16x32_bf16 v[144:147], a[164:167], v[208:211], v[144:147]
    ds_read_b64_tr_b16 a[190:191], v179 offset:2304
    buffer_load_dwordx4 v[196:199], v26, s[20:23], s43 offen offset:1024
    v_mfma_f32_16x16x32_bf16 v[116:119], a[168:171], v[204:207], v[116:119]
    ds_read_b64_tr_b16 a[128:129], v172 offset:16384
    v_and_b32 v3, v9, v185
    v_mfma_f32_16x16x32_bf16 v[148:151], a[168:171], v[208:211], v[148:151]
    v_cvt_pk_bf16_f32 v216, v28, v29
    v_cvt_pk_bf16_f32 v217, v30, v31
    v_mfma_f32_16x16x32_bf16 v[120:123], a[172:175], v[204:207], v[120:123]
    ds_read_b64_tr_b16 a[130:131], v172 offset:18432
    v_cvt_pk_bf16_f32 v218, v40, v41
    v_mfma_f32_16x16x32_bf16 v[152:155], a[172:175], v[208:211], v[152:155]
    s_waitcnt lgkmcnt(2)
    v_cvt_pk_bf16_f32 v219, v42, v43
    v_mfma_f32_16x16x32_bf16 v[124:127], a[176:179], v[204:207], v[124:127]
    ds_read_b64_tr_b16 a[132:133], v173 offset:16384
    v_and_b32 v6, v10, v184
    v_mfma_f32_16x16x32_bf16 v[156:159], a[176:179], v[208:211], v[156:159]
    ds_read_b64_tr_b16 a[134:135], v173 offset:18432
    v_and_b32 v7, v11, v185
    v_mfma_f32_16x16x32_bf16 v[28:31], a[248:251], v[216:219], v[12:15]
    ds_read_b64_tr_b16 a[136:137], v174 offset:16384
    buffer_load_dwordx4 v[200:203], v27, s[20:23], s43 offen offset:1024
    v_mfma_f32_16x16x32_bf16 v[40:43], a[250:253], v[216:219], v[16:19]
    ds_read_b64_tr_b16 a[138:139], v174 offset:18432
    s_add_u32 m0, s38, 81920
    v_mfma_f32_16x16x32_bf16 v[128:131], a[180:183], v[204:207], v[128:131]
    ds_read_b64_tr_b16 a[140:141], v175 offset:16384
    s_mov_b32 s42, 0x3c0000
    v_mfma_f32_16x16x32_bf16 v[160:163], a[180:183], v[208:211], v[160:163]
    ds_read_b64_tr_b16 a[142:143], v175 offset:18432
    v_mfma_f32_16x16x32_bf16 v[132:135], a[184:187], v[204:207], v[132:135]
    ds_read_b64_tr_b16 a[144:145], v176 offset:16384
    v_cmp_eq_u32 vcc, 4, v187
    v_mfma_f32_16x16x32_bf16 v[164:167], a[184:187], v[208:211], v[164:167]
    v_cvt_pk_bf16_f32 v216, v28, v29
    v_cvt_pk_bf16_f32 v217, v30, v31
    v_mfma_f32_16x16x32_bf16 v[136:139], a[188:191], v[204:207], v[136:139]
    v_cvt_pk_bf16_f32 v218, v40, v41
    v_cvt_pk_bf16_f32 v219, v42, v43
    v_mfma_f32_16x16x32_bf16 v[168:171], a[188:191], v[208:211], v[168:171]
    s_waitcnt lgkmcnt(1)
    ds_read_b64_tr_b16 a[146:147], v176 offset:18432
    v_mfma_f32_16x16x32_bf16 v[44:47], a[128:131], v[212:215], v[44:47]
    ds_read_b64_tr_b16 a[148:149], v177 offset:16384
    buffer_load_dwordx4 v180, s[16:19], s42 offen offset:0 nt lds
    v_mfma_f32_16x16x32_bf16 v[76:79], a[128:131], v[216:219], v[76:79]
    ds_read_b64_tr_b16 a[150:151], v177 offset:18432
    ds_read_b128 v[12:15], v1 offset:1536
    v_mfma_f32_16x16x32_bf16 v[28:31], v[2:5], v[220:223], 0
    ds_read_b64_tr_b16 a[152:153], v178 offset:16384
    ds_read_b128 v[16:19], v1 offset:1552
    v_mfma_f32_16x16x32_bf16 v[40:43], v[4:7], v[220:223], 0
    ds_read_b64_tr_b16 a[154:155], v178 offset:18432
    v_accvgpr_write_b32 a219, v255
    v_mfma_f32_16x16x32_bf16 v[48:51], a[132:135], v[212:215], v[48:51]
    ds_read_b64_tr_b16 a[156:157], v179 offset:16384
    buffer_load_dwordx4 v181, s[16:19], s42 offen offset:1024 nt lds
    v_mfma_f32_16x16x32_bf16 v[80:83], a[132:135], v[216:219], v[80:83]
    ds_read_b64_tr_b16 a[158:159], v179 offset:18432
    v_accvgpr_write_b32 a227, v186
    v_mfma_f32_16x16x32_bf16 v[52:55], a[136:139], v[212:215], v[52:55]
    ds_read_b64_tr_b16 a[160:161], v172 offset:16640
    ds_read_b128 v[8:11], v0 offset:832
    v_mfma_f32_16x16x32_bf16 v[84:87], a[136:139], v[216:219], v[84:87]
    v_cvt_pk_bf16_f32 v220, v28, v29
    v_cvt_pk_bf16_f32 v221, v30, v31
    v_mfma_f32_16x16x32_bf16 v[56:59], a[140:143], v[212:215], v[56:59]
    ds_read_b64_tr_b16 a[162:163], v172 offset:18688
    v_cvt_pk_bf16_f32 v222, v40, v41
    v_mfma_f32_16x16x32_bf16 v[88:91], a[140:143], v[216:219], v[88:91]
    s_waitcnt lgkmcnt(3)
    v_cvt_pk_bf16_f32 v223, v42, v43
    v_mfma_f32_16x16x32_bf16 v[60:63], a[144:147], v[212:215], v[60:63]
    ds_read_b64_tr_b16 a[164:165], v173 offset:16640
    buffer_load_dwordx4 v182, s[16:19], s42 offen offset:2048 nt lds
    v_mfma_f32_16x16x32_bf16 v[92:95], a[144:147], v[216:219], v[92:95]
    ds_read_b64_tr_b16 a[166:167], v173 offset:18688
    v_cndmask_b32 v255, 0, v252, vcc
    v_mfma_f32_16x16x32_bf16 v[28:31], a[248:251], v[220:223], v[12:15]
    ds_read_b64_tr_b16 a[168:169], v174 offset:16640
    v_cndmask_b32 v186, 0, v253, vcc
    v_mfma_f32_16x16x32_bf16 v[40:43], a[250:253], v[220:223], v[16:19]
    ds_read_b64_tr_b16 a[170:171], v174 offset:18688
    v_cmp_eq_u32 vcc, 5, v187
    v_mfma_f32_16x16x32_bf16 v[64:67], a[148:151], v[212:215], v[64:67]
    ds_read_b64_tr_b16 a[172:173], v175 offset:16640
    v_accvgpr_write_b32 a220, v255
    v_mfma_f32_16x16x32_bf16 v[96:99], a[148:151], v[216:219], v[96:99]
    ds_read_b64_tr_b16 a[174:175], v175 offset:18688
    v_accvgpr_write_b32 a228, v186
    v_mfma_f32_16x16x32_bf16 v[68:71], a[152:155], v[212:215], v[68:71]
    ds_read_b64_tr_b16 a[176:177], v176 offset:16640
    buffer_load_dwordx4 v183, s[16:19], s42 offen offset:3072 nt lds
    v_mfma_f32_16x16x32_bf16 v[100:103], a[152:155], v[216:219], v[100:103]
    v_cvt_pk_bf16_f32 v220, v28, v29
    v_cvt_pk_bf16_f32 v221, v30, v31
    v_mfma_f32_16x16x32_bf16 v[72:75], a[156:159], v[212:215], v[72:75]
    ds_read_b64_tr_b16 a[178:179], v176 offset:18688
    v_cvt_pk_bf16_f32 v222, v40, v41
    v_mfma_f32_16x16x32_bf16 v[104:107], a[156:159], v[216:219], v[104:107]
    s_waitcnt lgkmcnt(2)
    v_cvt_pk_bf16_f32 v223, v42, v43
    v_mfma_f32_16x16x32_bf16 v[108:111], a[160:163], v[212:215], v[108:111]
    ds_read_b64_tr_b16 a[180:181], v177 offset:16640
    v_cndmask_b32 v255, 0, v252, vcc
    v_mfma_f32_16x16x32_bf16 v[140:143], a[160:163], v[216:219], v[140:143]
    ds_read_b64_tr_b16 a[182:183], v177 offset:18688
    v_cndmask_b32 v186, 0, v253, vcc
    v_mfma_f32_16x16x32_bf16 v[28:31], v[2:5], v[224:227], 0
    ds_read_b64_tr_b16 a[184:185], v178 offset:16640
    v_cmp_eq_u32 vcc, 6, v187
    v_mfma_f32_16x16x32_bf16 v[40:43], v[4:7], v[224:227], 0
    ds_read_b64_tr_b16 a[186:187], v178 offset:18688
    v_accvgpr_write_b32 a221, v255
    v_mfma_f32_16x16x32_bf16 v[112:115], a[164:167], v[212:215], v[112:115]
    ds_read_b64_tr_b16 a[188:189], v179 offset:16640
    v_and_b32 v2, v8, v184
    v_mfma_f32_16x16x32_bf16 v[144:147], a[164:167], v[216:219], v[144:147]
    ds_read_b64_tr_b16 a[190:191], v179 offset:18688
    s_waitcnt vmcnt(12)
    v_mfma_f32_16x16x32_bf16 v[116:119], a[168:171], v[212:215], v[116:119]
    s_barrier
    v_and_b32 v3, v9, v185
    v_mfma_f32_16x16x32_bf16 v[148:151], a[168:171], v[216:219], v[148:151]
    ds_read_b64_tr_b16 a[128:129], v172 offset:32768
    v_cvt_pk_bf16_f32 v224, v28, v29
    v_mfma_f32_16x16x32_bf16 v[120:123], a[172:175], v[212:215], v[120:123]
    v_cvt_pk_bf16_f32 v225, v30, v31
    ds_read_b64_tr_b16 a[130:131], v172 offset:34816
    v_mfma_f32_16x16x32_bf16 v[152:155], a[172:175], v[216:219], v[152:155]
    s_waitcnt lgkmcnt(2)
    v_cvt_pk_bf16_f32 v226, v40, v41
    v_cvt_pk_bf16_f32 v227, v42, v43
    v_mfma_f32_16x16x32_bf16 v[124:127], a[176:179], v[212:215], v[124:127]
    ds_read_b64_tr_b16 a[132:133], v173 offset:32768
    s_add_u32 m0, s38, 98304
    s_mov_b32 s42, 0x400000
    v_mfma_f32_16x16x32_bf16 v[156:159], a[176:179], v[216:219], v[156:159]
    ds_read_b64_tr_b16 a[134:135], v173 offset:34816
    buffer_load_dwordx4 v180, s[16:19], s42 offen offset:0 nt lds
    v_mfma_f32_16x16x32_bf16 v[28:31], a[248:251], v[224:227], v[12:15]
    ds_read_b64_tr_b16 a[136:137], v174 offset:32768
    v_and_b32 v6, v10, v184
    v_mfma_f32_16x16x32_bf16 v[40:43], a[250:253], v[224:227], v[16:19]
    ds_read_b64_tr_b16 a[138:139], v174 offset:34816
    v_and_b32 v7, v11, v185
    v_mfma_f32_16x16x32_bf16 v[128:131], a[180:183], v[212:215], v[128:131]
    ds_read_b64_tr_b16 a[140:141], v175 offset:32768
    v_accvgpr_write_b32 a229, v186
    v_mfma_f32_16x16x32_bf16 v[160:163], a[180:183], v[216:219], v[160:163]
    ds_read_b64_tr_b16 a[142:143], v175 offset:34816
    v_cndmask_b32 v255, 0, v252, vcc
    v_mfma_f32_16x16x32_bf16 v[132:135], a[184:187], v[212:215], v[132:135]
    ds_read_b64_tr_b16 a[144:145], v176 offset:32768
    buffer_load_dwordx4 v181, s[16:19], s42 offen offset:1024 nt lds
    v_mfma_f32_16x16x32_bf16 v[164:167], a[184:187], v[216:219], v[164:167]
    v_cvt_pk_bf16_f32 v224, v28, v29
    v_cvt_pk_bf16_f32 v225, v30, v31
    v_mfma_f32_16x16x32_bf16 v[136:139], a[188:191], v[212:215], v[136:139]
    v_cvt_pk_bf16_f32 v226, v40, v41
    v_cvt_pk_bf16_f32 v227, v42, v43
    v_mfma_f32_16x16x32_bf16 v[168:171], a[188:191], v[216:219], v[168:171]
    s_waitcnt lgkmcnt(1)
    ds_read_b64_tr_b16 a[146:147], v176 offset:34816
    v_mfma_f32_16x16x32_bf16 v[44:47], a[128:131], v[220:223], v[44:47]
    ds_read_b64_tr_b16 a[148:149], v177 offset:32768
    ds_read_b128 v[12:15], v1 offset:1664
    v_mfma_f32_16x16x32_bf16 v[76:79], a[128:131], v[224:227], v[76:79]
    ds_read_b64_tr_b16 a[150:151], v177 offset:34816
    ds_read_b128 v[16:19], v1 offset:1680
    v_mfma_f32_16x16x32_bf16 v[28:31], v[2:5], v[228:231], 0
    ds_read_b64_tr_b16 a[152:153], v178 offset:32768
    v_cndmask_b32 v186, 0, v253, vcc
    v_mfma_f32_16x16x32_bf16 v[40:43], v[4:7], v[228:231], 0
    ds_read_b64_tr_b16 a[154:155], v178 offset:34816
    v_cmp_eq_u32 vcc, 7, v187
    v_mfma_f32_16x16x32_bf16 v[48:51], a[132:135], v[220:223], v[48:51]
    ds_read_b64_tr_b16 a[156:157], v179 offset:32768
    v_accvgpr_write_b32 a222, v255
    v_mfma_f32_16x16x32_bf16 v[80:83], a[132:135], v[224:227], v[80:83]
    ds_read_b64_tr_b16 a[158:159], v179 offset:34816
    v_accvgpr_write_b32 a230, v186
    v_mfma_f32_16x16x32_bf16 v[52:55], a[136:139], v[220:223], v[52:55]
    ds_read_b64_tr_b16 a[160:161], v172 offset:33024
    buffer_load_dwordx4 v182, s[16:19], s42 offen offset:2048 nt lds
    v_mfma_f32_16x16x32_bf16 v[84:87], a[136:139], v[224:227], v[84:87]
    v_cvt_pk_bf16_f32 v228, v28, v29
    v_cvt_pk_bf16_f32 v229, v30, v31
    v_mfma_f32_16x16x32_bf16 v[56:59], a[140:143], v[220:223], v[56:59]
    ds_read_b64_tr_b16 a[162:163], v172 offset:35072
    v_cvt_pk_bf16_f32 v230, v40, v41
    v_mfma_f32_16x16x32_bf16 v[88:91], a[140:143], v[224:227], v[88:91]
    s_waitcnt lgkmcnt(2)
    v_cvt_pk_bf16_f32 v231, v42, v43
    v_mfma_f32_16x16x32_bf16 v[60:63], a[144:147], v[220:223], v[60:63]
    ds_read_b64_tr_b16 a[164:165], v173 offset:33024
    ds_read_b128 v[8:11], v0 offset:896
    v_mfma_f32_16x16x32_bf16 v[92:95], a[144:147], v[224:227], v[92:95]
    ds_read_b64_tr_b16 a[166:167], v173 offset:35072
    v_cndmask_b32 v255, 0, v252, vcc
    v_mfma_f32_16x16x32_bf16 v[28:31], a[248:251], v[228:231], v[12:15]
    ds_read_b64_tr_b16 a[168:169], v174 offset:33024
    v_cndmask_b32 v186, 0, v253, vcc
    v_mfma_f32_16x16x32_bf16 v[40:43], a[250:253], v[228:231], v[16:19]
    ds_read_b64_tr_b16 a[170:171], v174 offset:35072
    v_cmp_eq_u32 vcc, 8, v187
    v_mfma_f32_16x16x32_bf16 v[64:67], a[148:151], v[220:223], v[64:67]
    ds_read_b64_tr_b16 a[172:173], v175 offset:33024
    v_accvgpr_write_b32 a223, v255
    v_mfma_f32_16x16x32_bf16 v[96:99], a[148:151], v[224:227], v[96:99]
    ds_read_b64_tr_b16 a[174:175], v175 offset:35072
    buffer_load_dwordx4 v183, s[16:19], s42 offen offset:3072 nt lds
    v_mfma_f32_16x16x32_bf16 v[68:71], a[152:155], v[220:223], v[68:71]
    ds_read_b64_tr_b16 a[176:177], v176 offset:33024
    s_add_u32 m0, s38, 114688
    v_mfma_f32_16x16x32_bf16 v[100:103], a[152:155], v[224:227], v[100:103]
    v_cvt_pk_bf16_f32 v228, v28, v29
    v_cvt_pk_bf16_f32 v229, v30, v31
    v_mfma_f32_16x16x32_bf16 v[72:75], a[156:159], v[220:223], v[72:75]
    ds_read_b64_tr_b16 a[178:179], v176 offset:35072
    v_cvt_pk_bf16_f32 v230, v40, v41
    v_mfma_f32_16x16x32_bf16 v[104:107], a[156:159], v[224:227], v[104:107]
    s_waitcnt lgkmcnt(2)
    v_cvt_pk_bf16_f32 v231, v42, v43
    v_mfma_f32_16x16x32_bf16 v[108:111], a[160:163], v[220:223], v[108:111]
    ds_read_b64_tr_b16 a[180:181], v177 offset:33024
    s_mov_b32 s42, 0x440000
    v_mfma_f32_16x16x32_bf16 v[140:143], a[160:163], v[224:227], v[140:143]
    ds_read_b64_tr_b16 a[182:183], v177 offset:35072
    v_accvgpr_write_b32 a231, v186
    v_mfma_f32_16x16x32_bf16 v[28:31], v[2:5], v[232:235], 0
    ds_read_b64_tr_b16 a[184:185], v178 offset:33024
    s_mov_b64 s[64:65], s[46:47]
    v_mfma_f32_16x16x32_bf16 v[40:43], v[4:7], v[232:235], 0
    ds_read_b64_tr_b16 a[186:187], v178 offset:35072
    s_mov_b32 s62, 5308416
    v_mfma_f32_16x16x32_bf16 v[112:115], a[164:167], v[220:223], v[112:115]
    ds_read_b64_tr_b16 a[188:189], v179 offset:33024
    v_and_b32 v2, v8, v184
    v_mfma_f32_16x16x32_bf16 v[144:147], a[164:167], v[224:227], v[144:147]
    ds_read_b64_tr_b16 a[190:191], v179 offset:35072
    buffer_load_dwordx4 v180, s[16:19], s42 offen offset:0 nt lds
    v_mfma_f32_16x16x32_bf16 v[116:119], a[168:171], v[220:223], v[116:119]
    ds_read_b64_tr_b16 a[128:129], v172 offset:49152
    v_and_b32 v3, v9, v185
    v_mfma_f32_16x16x32_bf16 v[148:151], a[168:171], v[224:227], v[148:151]
    v_cvt_pk_bf16_f32 v232, v28, v29
    v_cvt_pk_bf16_f32 v233, v30, v31
    v_mfma_f32_16x16x32_bf16 v[120:123], a[172:175], v[220:223], v[120:123]
    ds_read_b64_tr_b16 a[130:131], v172 offset:51200
    v_cvt_pk_bf16_f32 v234, v40, v41
    v_mfma_f32_16x16x32_bf16 v[152:155], a[172:175], v[224:227], v[152:155]
    s_waitcnt lgkmcnt(2)
    v_cvt_pk_bf16_f32 v235, v42, v43
    v_mfma_f32_16x16x32_bf16 v[124:127], a[176:179], v[220:223], v[124:127]
    ds_read_b64_tr_b16 a[132:133], v173 offset:49152
    v_and_b32 v6, v10, v184
    v_mfma_f32_16x16x32_bf16 v[156:159], a[176:179], v[224:227], v[156:159]
    ds_read_b64_tr_b16 a[134:135], v173 offset:51200
    v_and_b32 v7, v11, v185
    v_mfma_f32_16x16x32_bf16 v[28:31], a[248:251], v[232:235], v[12:15]
    ds_read_b64_tr_b16 a[136:137], v174 offset:49152
    s_mov_b32 s63, 0x20000
    v_mfma_f32_16x16x32_bf16 v[40:43], a[250:253], v[232:235], v[16:19]
    ds_read_b64_tr_b16 a[138:139], v174 offset:51200
    s_mov_b32 s66, 5308416
    v_mfma_f32_16x16x32_bf16 v[128:131], a[180:183], v[220:223], v[128:131]
    ds_read_b64_tr_b16 a[140:141], v175 offset:49152
    buffer_load_dwordx4 v181, s[16:19], s42 offen offset:1024 nt lds
    v_mfma_f32_16x16x32_bf16 v[160:163], a[180:183], v[224:227], v[160:163]
    ds_read_b64_tr_b16 a[142:143], v175 offset:51200
    v_mfma_f32_16x16x32_bf16 v[132:135], a[184:187], v[220:223], v[132:135]
    ds_read_b64_tr_b16 a[144:145], v176 offset:49152
    s_mov_b32 s67, 0x20000
    v_mfma_f32_16x16x32_bf16 v[164:167], a[184:187], v[224:227], v[164:167]
    v_cvt_pk_bf16_f32 v232, v28, v29
    v_cvt_pk_bf16_f32 v233, v30, v31
    v_mfma_f32_16x16x32_bf16 v[136:139], a[188:191], v[220:223], v[136:139]
    v_cvt_pk_bf16_f32 v234, v40, v41
    v_cvt_pk_bf16_f32 v235, v42, v43
    v_mfma_f32_16x16x32_bf16 v[168:171], a[188:191], v[224:227], v[168:171]
    s_waitcnt lgkmcnt(1)
    ds_read_b64_tr_b16 a[146:147], v176 offset:51200
    v_mfma_f32_16x16x32_bf16 v[44:47], a[128:131], v[228:231], v[44:47]
    ds_read_b64_tr_b16 a[148:149], v177 offset:49152
    ds_read_b128 v[12:15], v1 offset:1792
    v_mfma_f32_16x16x32_bf16 v[76:79], a[128:131], v[232:235], v[76:79]
    ds_read_b64_tr_b16 a[150:151], v177 offset:51200
    ds_read_b128 v[16:19], v1 offset:1808
    v_mfma_f32_16x16x32_bf16 v[28:31], v[2:5], v[236:239], 0
    ds_read_b64_tr_b16 a[152:153], v178 offset:49152
    s_mov_b32 s70, 5308416
    v_mfma_f32_16x16x32_bf16 v[40:43], v[4:7], v[236:239], 0
    ds_read_b64_tr_b16 a[154:155], v178 offset:51200
    s_mov_b32 s71, 0x20000
    v_mfma_f32_16x16x32_bf16 v[48:51], a[132:135], v[228:231], v[48:51]
    ds_read_b64_tr_b16 a[156:157], v179 offset:49152
    buffer_load_dwordx4 v182, s[16:19], s42 offen offset:2048 nt lds
    v_mfma_f32_16x16x32_bf16 v[80:83], a[132:135], v[232:235], v[80:83]
    ds_read_b64_tr_b16 a[158:159], v179 offset:51200
    s_mov_b32 s74, 2359296
    v_mfma_f32_16x16x32_bf16 v[52:55], a[136:139], v[228:231], v[52:55]
    ds_read_b64_tr_b16 a[160:161], v172 offset:49408
    ds_read_b128 v[8:11], v0 offset:960
    v_mfma_f32_16x16x32_bf16 v[84:87], a[136:139], v[232:235], v[84:87]
    v_cvt_pk_bf16_f32 v236, v28, v29
    v_cvt_pk_bf16_f32 v237, v30, v31
    v_mfma_f32_16x16x32_bf16 v[56:59], a[140:143], v[228:231], v[56:59]
    ds_read_b64_tr_b16 a[162:163], v172 offset:51456
    v_cvt_pk_bf16_f32 v238, v40, v41
    v_mfma_f32_16x16x32_bf16 v[88:91], a[140:143], v[232:235], v[88:91]
    s_waitcnt lgkmcnt(3)
    v_cvt_pk_bf16_f32 v239, v42, v43
    v_mfma_f32_16x16x32_bf16 v[60:63], a[144:147], v[228:231], v[60:63]
    ds_read_b64_tr_b16 a[164:165], v173 offset:49408
    s_mov_b32 s75, 0x20000
    v_mfma_f32_16x16x32_bf16 v[92:95], a[144:147], v[232:235], v[92:95]
    ds_read_b64_tr_b16 a[166:167], v173 offset:51456
    s_mov_b32 s78, 2359296
    v_mfma_f32_16x16x32_bf16 v[28:31], a[248:251], v[236:239], v[12:15]
    ds_read_b64_tr_b16 a[168:169], v174 offset:49408
    s_mov_b32 s79, 0x20000
    v_mfma_f32_16x16x32_bf16 v[40:43], a[250:253], v[236:239], v[16:19]
    ds_read_b64_tr_b16 a[170:171], v174 offset:51456
    buffer_load_dwordx4 v183, s[16:19], s42 offen offset:3072 nt lds
    v_mfma_f32_16x16x32_bf16 v[64:67], a[148:151], v[228:231], v[64:67]
    ds_read_b64_tr_b16 a[172:173], v175 offset:49408
    s_add_u32 s4, s28, 0x3000
    s_addc_u32 s5, s29, 0
    v_mfma_f32_16x16x32_bf16 v[96:99], a[148:151], v[232:235], v[96:99]
    ds_read_b64_tr_b16 a[174:175], v175 offset:51456
    s_mov_b32 s6, L_code_end-L_attn_pc-0x3000
    v_mfma_f32_16x16x32_bf16 v[68:71], a[152:155], v[228:231], v[68:71]
    ds_read_b64_tr_b16 a[176:177], v176 offset:49408
    s_mov_b32 s7, 0x20000
    v_mfma_f32_16x16x32_bf16 v[100:103], a[152:155], v[232:235], v[100:103]
    v_cvt_pk_bf16_f32 v236, v28, v29
    v_cvt_pk_bf16_f32 v237, v30, v31
    v_mfma_f32_16x16x32_bf16 v[72:75], a[156:159], v[228:231], v[72:75]
    ds_read_b64_tr_b16 a[178:179], v176 offset:51456
    v_cvt_pk_bf16_f32 v238, v40, v41
    v_mfma_f32_16x16x32_bf16 v[104:107], a[156:159], v[232:235], v[104:107]
    s_waitcnt lgkmcnt(2)
    v_cvt_pk_bf16_f32 v239, v42, v43
    v_mfma_f32_16x16x32_bf16 v[108:111], a[160:163], v[228:231], v[108:111]
    ds_read_b64_tr_b16 a[180:181], v177 offset:49408
    s_sub_u32 s53, s55, 144
    v_mfma_f32_16x16x32_bf16 v[140:143], a[160:163], v[232:235], v[140:143]
    ds_read_b64_tr_b16 a[182:183], v177 offset:51456
    s_cmp_lt_u32 s53, 72
    s_cselect_b32 s40, 2654208, 0
    v_mfma_f32_16x16x32_bf16 v[28:31], v[2:5], v[240:243], 0
    ds_read_b64_tr_b16 a[184:185], v178 offset:49408
    s_add_u32 s48, s30, 0x2ac8000
    s_addc_u32 s49, s31, 0
    v_mfma_f32_16x16x32_bf16 v[40:43], v[4:7], v[240:243], 0
    ds_read_b64_tr_b16 a[186:187], v178 offset:51456
    s_mov_b32 s50, s40
    v_mfma_f32_16x16x32_bf16 v[112:115], a[164:167], v[228:231], v[112:115]
    ds_read_b64_tr_b16 a[188:189], v179 offset:49408
    v_and_b32 v2, v8, v184
    v_mfma_f32_16x16x32_bf16 v[144:147], a[164:167], v[232:235], v[144:147]
    ds_read_b64_tr_b16 a[190:191], v179 offset:51456
    s_waitcnt vmcnt(8)
    v_mfma_f32_16x16x32_bf16 v[116:119], a[168:171], v[228:231], v[116:119]
    s_barrier
    v_and_b32 v3, v9, v185
    v_mfma_f32_16x16x32_bf16 v[148:151], a[168:171], v[232:235], v[148:151]
    ds_read_b64_tr_b16 a[128:129], v32 offset:0
    v_cvt_pk_bf16_f32 v240, v28, v29
    v_mfma_f32_16x16x32_bf16 v[120:123], a[172:175], v[228:231], v[120:123]
    v_cvt_pk_bf16_f32 v241, v30, v31
    ds_read_b64_tr_b16 a[130:131], v32 offset:2048
    v_mfma_f32_16x16x32_bf16 v[152:155], a[172:175], v[232:235], v[152:155]
    s_waitcnt lgkmcnt(2)
    v_cvt_pk_bf16_f32 v242, v40, v41
    v_cvt_pk_bf16_f32 v243, v42, v43
    v_mfma_f32_16x16x32_bf16 v[124:127], a[176:179], v[228:231], v[124:127]
    ds_read_b64_tr_b16 a[132:133], v33 offset:0
    s_add_u32 m0, s38, 0
    s_mov_b32 s42, 0x0
    v_mfma_f32_16x16x32_bf16 v[156:159], a[176:179], v[232:235], v[156:159]
    ds_read_b64_tr_b16 a[134:135], v33 offset:2048
    buffer_load_dwordx4 v20, s[8:11], s42 offen offset:0 nt lds
    v_mfma_f32_16x16x32_bf16 v[28:31], a[248:251], v[240:243], v[12:15]
    ds_read_b64_tr_b16 a[136:137], v34 offset:0
    v_and_b32 v6, v10, v184
    v_mfma_f32_16x16x32_bf16 v[40:43], a[250:253], v[240:243], v[16:19]
    ds_read_b64_tr_b16 a[138:139], v34 offset:2048
    v_and_b32 v7, v11, v185
    v_mfma_f32_16x16x32_bf16 v[128:131], a[180:183], v[228:231], v[128:131]
    ds_read_b64_tr_b16 a[140:141], v35 offset:0
    buffer_load_dwordx4 v21, s[8:11], s42 offen offset:1024 nt lds
    v_mfma_f32_16x16x32_bf16 v[160:163], a[180:183], v[232:235], v[160:163]
    ds_read_b64_tr_b16 a[142:143], v35 offset:2048
    s_mov_b32 s51, 0x20000
    v_mfma_f32_16x16x32_bf16 v[132:135], a[184:187], v[228:231], v[132:135]
    ds_read_b64_tr_b16 a[144:145], v36 offset:0
    s_lshl_b32 s53, s53, 8
    v_mfma_f32_16x16x32_bf16 v[164:167], a[184:187], v[232:235], v[164:167]
    v_cvt_pk_bf16_f32 v240, v28, v29
    v_cvt_pk_bf16_f32 v241, v30, v31
    v_mfma_f32_16x16x32_bf16 v[136:139], a[188:191], v[228:231], v[136:139]
    v_cvt_pk_bf16_f32 v242, v40, v41
    v_cvt_pk_bf16_f32 v243, v42, v43
    v_mfma_f32_16x16x32_bf16 v[168:171], a[188:191], v[232:235], v[168:171]
    s_waitcnt lgkmcnt(1)
    ds_read_b64_tr_b16 a[146:147], v36 offset:2048
    v_mfma_f32_16x16x32_bf16 v[44:47], a[128:131], v[236:239], v[44:47]
    ds_read_b64_tr_b16 a[148:149], v37 offset:0
    buffer_load_dwordx4 v22, s[8:11], s42 offen offset:2048 nt lds
    v_mfma_f32_16x16x32_bf16 v[76:79], a[128:131], v[240:243], v[76:79]
    ds_read_b64_tr_b16 a[150:151], v37 offset:2048
    ds_read_b128 v[12:15], v1 offset:1920
    v_mfma_f32_16x16x32_bf16 v[28:31], v[2:5], v[244:247], 0
    ds_read_b64_tr_b16 a[152:153], v38 offset:0
    ds_read_b128 v[16:19], v1 offset:1936
    v_mfma_f32_16x16x32_bf16 v[40:43], v[4:7], v[244:247], 0
    ds_read_b64_tr_b16 a[154:155], v38 offset:2048
    s_lshl_b32 s28, s33, 2
    v_mfma_f32_16x16x32_bf16 v[48:51], a[132:135], v[236:239], v[48:51]
    ds_read_b64_tr_b16 a[156:157], v39 offset:0
    s_bfe_u32 s3, s2, 0x10003
    v_mfma_f32_16x16x32_bf16 v[80:83], a[132:135], v[240:243], v[80:83]
    ds_read_b64_tr_b16 a[158:159], v39 offset:2048
    buffer_load_dwordx4 v23, s[8:11], s42 offen offset:3072 nt lds
    v_mfma_f32_16x16x32_bf16 v[52:55], a[136:139], v[236:239], v[52:55]
    ds_read_b64_tr_b16 a[160:161], v32 offset:256
    s_add_u32 m0, s38, 16384
    v_mfma_f32_16x16x32_bf16 v[84:87], a[136:139], v[240:243], v[84:87]
    v_cvt_pk_bf16_f32 v244, v28, v29
    v_cvt_pk_bf16_f32 v245, v30, v31
    v_mfma_f32_16x16x32_bf16 v[56:59], a[140:143], v[236:239], v[56:59]
    ds_read_b64_tr_b16 a[162:163], v32 offset:2304
    v_cvt_pk_bf16_f32 v246, v40, v41
    v_mfma_f32_16x16x32_bf16 v[88:91], a[140:143], v[240:243], v[88:91]
    s_waitcnt lgkmcnt(2)
    v_cvt_pk_bf16_f32 v247, v42, v43
    v_mfma_f32_16x16x32_bf16 v[60:63], a[144:147], v[236:239], v[60:63]
    ds_read_b64_tr_b16 a[164:165], v33 offset:256
    s_mov_b32 s42, 0x4000
    v_mfma_f32_16x16x32_bf16 v[92:95], a[144:147], v[240:243], v[92:95]
    ds_read_b64_tr_b16 a[166:167], v33 offset:2304
    ds_read_b128 v[8:11], v0 offset:1024
    v_mfma_f32_16x16x32_bf16 v[28:31], a[248:251], v[244:247], v[12:15]
    ds_read_b64_tr_b16 a[168:169], v34 offset:256
    buffer_load_dwordx4 v20, s[8:11], s42 offen offset:0 nt lds
    v_mfma_f32_16x16x32_bf16 v[40:43], a[250:253], v[244:247], v[16:19]
    ds_read_b64_tr_b16 a[170:171], v34 offset:2304
    s_lshl_b32 s3, s3, 2
    v_mfma_f32_16x16x32_bf16 v[64:67], a[148:151], v[236:239], v[64:67]
    ds_read_b64_tr_b16 a[172:173], v35 offset:256
    s_add_u32 s3, s3, s33
    v_mfma_f32_16x16x32_bf16 v[96:99], a[148:151], v[240:243], v[96:99]
    ds_read_b64_tr_b16 a[174:175], v35 offset:2304
    s_lshl_b32 s52, s3, 13
    v_mfma_f32_16x16x32_bf16 v[68:71], a[152:155], v[236:239], v[68:71]
    ds_read_b64_tr_b16 a[176:177], v36 offset:256
    s_add_u32 s52, s52, L_attn_tail-L_attn_pc-0x3000
    v_mfma_f32_16x16x32_bf16 v[100:103], a[152:155], v[240:243], v[100:103]
    v_cvt_pk_bf16_f32 v244, v28, v29
    v_cvt_pk_bf16_f32 v245, v30, v31
    v_mfma_f32_16x16x32_bf16 v[72:75], a[156:159], v[236:239], v[72:75]
    ds_read_b64_tr_b16 a[178:179], v36 offset:2304
    v_cvt_pk_bf16_f32 v246, v40, v41
    v_mfma_f32_16x16x32_bf16 v[104:107], a[156:159], v[240:243], v[104:107]
    s_waitcnt lgkmcnt(2)
    v_cvt_pk_bf16_f32 v247, v42, v43
    v_mfma_f32_16x16x32_bf16 v[108:111], a[160:163], v[236:239], v[108:111]
    ds_read_b64_tr_b16 a[180:181], v37 offset:256
    buffer_load_dwordx4 v21, s[8:11], s42 offen offset:1024 nt lds
    v_mfma_f32_16x16x32_bf16 v[140:143], a[160:163], v[240:243], v[140:143]
    ds_read_b64_tr_b16 a[182:183], v37 offset:2304
    s_lshl_b32 s37, s35, 4
    v_mfma_f32_16x16x32_bf16 v[28:31], v[2:5], v[248:251], 0
    ds_read_b64_tr_b16 a[184:185], v38 offset:256
    s_add_u32 s37, s37, s54
    v_mfma_f32_16x16x32_bf16 v[40:43], v[4:7], v[248:251], 0
    ds_read_b64_tr_b16 a[186:187], v38 offset:2304
    s_lshl_b32 s37, s37, 2
    v_mfma_f32_16x16x32_bf16 v[112:115], a[164:167], v[236:239], v[112:115]
    ds_read_b64_tr_b16 a[188:189], v39 offset:256
    buffer_load_dwordx4 v22, s[8:11], s42 offen offset:2048 nt lds
    v_mfma_f32_16x16x32_bf16 v[144:147], a[164:167], v[240:243], v[144:147]
    ds_read_b64_tr_b16 a[190:191], v39 offset:2304
    v_and_b32 v2, v8, v184
    v_mfma_f32_16x16x32_bf16 v[116:119], a[168:171], v[236:239], v[116:119]
    ds_read_b64_tr_b16 a[128:129], v32 offset:16384
    v_and_b32 v3, v9, v185
    v_mfma_f32_16x16x32_bf16 v[148:151], a[168:171], v[240:243], v[148:151]
    v_cvt_pk_bf16_f32 v248, v28, v29
    v_cvt_pk_bf16_f32 v249, v30, v31
    v_mfma_f32_16x16x32_bf16 v[120:123], a[172:175], v[236:239], v[120:123]
    ds_read_b64_tr_b16 a[130:131], v32 offset:18432
    v_cvt_pk_bf16_f32 v250, v40, v41
    v_mfma_f32_16x16x32_bf16 v[152:155], a[172:175], v[240:243], v[152:155]
    s_waitcnt lgkmcnt(2)
    v_cvt_pk_bf16_f32 v251, v42, v43
    v_mfma_f32_16x16x32_bf16 v[124:127], a[176:179], v[236:239], v[124:127]
    ds_read_b64_tr_b16 a[132:133], v33 offset:16384
    buffer_load_dwordx4 v23, s[8:11], s42 offen offset:3072 nt lds
    v_mfma_f32_16x16x32_bf16 v[156:159], a[176:179], v[240:243], v[156:159]
    ds_read_b64_tr_b16 a[134:135], v33 offset:18432
    v_and_b32 v6, v10, v184
    v_mfma_f32_16x16x32_bf16 v[28:31], a[248:251], v[248:251], v[12:15]
    ds_read_b64_tr_b16 a[136:137], v34 offset:16384
    v_and_b32 v7, v11, v185
    v_mfma_f32_16x16x32_bf16 v[40:43], a[250:253], v[248:251], v[16:19]
    ds_read_b64_tr_b16 a[138:139], v34 offset:18432
    s_add_u32 s37, s37, s33
    v_mfma_f32_16x16x32_bf16 v[128:131], a[180:183], v[236:239], v[128:131]
    ds_read_b64_tr_b16 a[140:141], v35 offset:16384
    v_mfma_f32_16x16x32_bf16 v[160:163], a[180:183], v[240:243], v[160:163]
    ds_read_b64_tr_b16 a[142:143], v35 offset:18432
    s_mul_i32 s37, s37, 2304
    v_mfma_f32_16x16x32_bf16 v[132:135], a[184:187], v[236:239], v[132:135]
    ds_read_b64_tr_b16 a[144:145], v36 offset:16384
    s_lshr_b32 s3, s2, 3
    v_mfma_f32_16x16x32_bf16 v[164:167], a[184:187], v[240:243], v[164:167]
    v_cvt_pk_bf16_f32 v248, v28, v29
    v_cvt_pk_bf16_f32 v249, v30, v31
    v_mfma_f32_16x16x32_bf16 v[136:139], a[188:191], v[236:239], v[136:139]
    v_cvt_pk_bf16_f32 v250, v40, v41
    v_cvt_pk_bf16_f32 v251, v42, v43
    v_mfma_f32_16x16x32_bf16 v[168:171], a[188:191], v[240:243], v[168:171]
    s_waitcnt lgkmcnt(1)
    ds_read_b64_tr_b16 a[146:147], v36 offset:18432
    v_mfma_f32_16x16x32_bf16 v[44:47], a[128:131], v[244:247], v[44:47]
    ds_read_b64_tr_b16 a[148:149], v37 offset:16384
    ds_read_b128 v[12:15], v1 offset:2048
    v_mfma_f32_16x16x32_bf16 v[76:79], a[128:131], v[248:251], v[76:79]
    ds_read_b64_tr_b16 a[150:151], v37 offset:18432
    ds_read_b128 v[16:19], v1 offset:2064
    v_mfma_f32_16x16x32_bf16 v[28:31], v[2:5], v[188:191], 0
    ds_read_b64_tr_b16 a[152:153], v38 offset:16384
    s_lshl_b32 s3, s3, 2
    v_mfma_f32_16x16x32_bf16 v[40:43], v[4:7], v[188:191], 0
    ds_read_b64_tr_b16 a[154:155], v38 offset:18432
    s_add_u32 s3, s3, s33
    v_mfma_f32_16x16x32_bf16 v[48:51], a[132:135], v[244:247], v[48:51]
    ds_read_b64_tr_b16 a[156:157], v39 offset:16384
    s_min_u32 s3, s3, 95
    v_mfma_f32_16x16x32_bf16 v[80:83], a[132:135], v[248:251], v[80:83]
    ds_read_b64_tr_b16 a[158:159], v39 offset:18432
    s_and_b32 s40, s2, 7
    v_mfma_f32_16x16x32_bf16 v[52:55], a[136:139], v[244:247], v[52:55]
    ds_read_b64_tr_b16 a[160:161], v32 offset:16640
    ds_read_b128 v[8:11], v0 offset:1088
    v_mfma_f32_16x16x32_bf16 v[84:87], a[136:139], v[248:251], v[84:87]
    v_cvt_pk_bf16_f32 v188, v28, v29
    v_cvt_pk_bf16_f32 v189, v30, v31
    v_mfma_f32_16x16x32_bf16 v[56:59], a[140:143], v[244:247], v[56:59]
    ds_read_b64_tr_b16 a[162:163], v32 offset:18688
    v_cvt_pk_bf16_f32 v190, v40, v41
    v_mfma_f32_16x16x32_bf16 v[88:91], a[140:143], v[248:251], v[88:91]
    s_waitcnt lgkmcnt(3)
    v_cvt_pk_bf16_f32 v191, v42, v43
    v_mfma_f32_16x16x32_bf16 v[60:63], a[144:147], v[244:247], v[60:63]
    ds_read_b64_tr_b16 a[164:165], v33 offset:16640
    s_mul_i32 s39, s3, 9216
    v_mfma_f32_16x16x32_bf16 v[92:95], a[144:147], v[248:251], v[92:95]
    ds_read_b64_tr_b16 a[166:167], v33 offset:18688
    s_lshl_b32 s34, s40, 7
    v_mfma_f32_16x16x32_bf16 v[28:31], a[248:251], v[188:191], v[12:15]
    ds_read_b64_tr_b16 a[168:169], v34 offset:16640
    s_add_u32 s39, s39, s34
    v_mfma_f32_16x16x32_bf16 v[40:43], a[250:253], v[188:191], v[16:19]
    ds_read_b64_tr_b16 a[170:171], v34 offset:18688
    s_mul_i32 s34, s40, 73728
    v_mfma_f32_16x16x32_bf16 v[64:67], a[148:151], v[244:247], v[64:67]
    ds_read_b64_tr_b16 a[172:173], v35 offset:16640
    s_lshl_b32 s3, s3, 7
    v_mfma_f32_16x16x32_bf16 v[96:99], a[148:151], v[248:251], v[96:99]
    ds_read_b64_tr_b16 a[174:175], v35 offset:18688
    s_add_u32 s34, s34, s3
    v_mfma_f32_16x16x32_bf16 v[68:71], a[152:155], v[244:247], v[68:71]
    ds_read_b64_tr_b16 a[176:177], v36 offset:16640
    v_min_u32 v255, 8, v254
    v_mfma_f32_16x16x32_bf16 v[100:103], a[152:155], v[248:251], v[100:103]
    v_cvt_pk_bf16_f32 v188, v28, v29
    v_cvt_pk_bf16_f32 v189, v30, v31
    v_mfma_f32_16x16x32_bf16 v[72:75], a[156:159], v[244:247], v[72:75]
    ds_read_b64_tr_b16 a[178:179], v36 offset:18688
    v_cvt_pk_bf16_f32 v190, v40, v41
    v_mfma_f32_16x16x32_bf16 v[104:107], a[156:159], v[248:251], v[104:107]
    s_waitcnt lgkmcnt(2)
    v_cvt_pk_bf16_f32 v191, v42, v43
    v_mfma_f32_16x16x32_bf16 v[108:111], a[160:163], v[244:247], v[108:111]
    ds_read_b64_tr_b16 a[180:181], v37 offset:16640
    v_lshlrev_b32 v186, 10, v255
    v_mfma_f32_16x16x32_bf16 v[140:143], a[160:163], v[248:251], v[140:143]
    ds_read_b64_tr_b16 a[182:183], v37 offset:18688
    v_mul_u32_u24 v187, 589824, v255
    v_mfma_f32_16x16x32_bf16 v[28:31], v[2:5], v[192:195], 0
    ds_read_b64_tr_b16 a[184:185], v38 offset:16640
    v_lshlrev_b32 v255, 3, v254
    v_mfma_f32_16x16x32_bf16 v[40:43], v[4:7], v[192:195], 0
    ds_read_b64_tr_b16 a[186:187], v38 offset:18688
    v_lshlrev_b32 v254, 7, v254
    v_mfma_f32_16x16x32_bf16 v[112:115], a[164:167], v[244:247], v[112:115]
    ds_read_b64_tr_b16 a[188:189], v39 offset:16640
    v_and_b32 v2, v8, v184
    v_mfma_f32_16x16x32_bf16 v[144:147], a[164:167], v[248:251], v[144:147]
    ds_read_b64_tr_b16 a[190:191], v39 offset:18688
    s_waitcnt vmcnt(8)
    v_mfma_f32_16x16x32_bf16 v[116:119], a[168:171], v[244:247], v[116:119]
    s_barrier
    v_and_b32 v3, v9, v185
    v_mfma_f32_16x16x32_bf16 v[148:151], a[168:171], v[248:251], v[148:151]
    ds_read_b64_tr_b16 a[128:129], v32 offset:32768
    v_cvt_pk_bf16_f32 v192, v28, v29
    v_mfma_f32_16x16x32_bf16 v[120:123], a[172:175], v[244:247], v[120:123]
    v_cvt_pk_bf16_f32 v193, v30, v31
    ds_read_b64_tr_b16 a[130:131], v32 offset:34816
    v_mfma_f32_16x16x32_bf16 v[152:155], a[172:175], v[248:251], v[152:155]
    s_waitcnt lgkmcnt(2)
    v_cvt_pk_bf16_f32 v194, v40, v41
    v_cvt_pk_bf16_f32 v195, v42, v43
    v_mfma_f32_16x16x32_bf16 v[124:127], a[176:179], v[244:247], v[124:127]
    ds_read_b64_tr_b16 a[132:133], v33 offset:32768
    s_add_u32 m0, s38, 32768
    s_mov_b32 s42, 0x8000
    v_mfma_f32_16x16x32_bf16 v[156:159], a[176:179], v[248:251], v[156:159]
    ds_read_b64_tr_b16 a[134:135], v33 offset:34816
    buffer_load_dwordx4 v20, s[8:11], s42 offen offset:0 nt lds
    v_mfma_f32_16x16x32_bf16 v[28:31], a[248:251], v[192:195], v[12:15]
    ds_read_b64_tr_b16 a[136:137], v34 offset:32768
    v_and_b32 v6, v10, v184
    v_mfma_f32_16x16x32_bf16 v[40:43], a[250:253], v[192:195], v[16:19]
    ds_read_b64_tr_b16 a[138:139], v34 offset:34816
    v_and_b32 v7, v11, v185
    v_mfma_f32_16x16x32_bf16 v[128:131], a[180:183], v[244:247], v[128:131]
    ds_read_b64_tr_b16 a[140:141], v35 offset:32768
    buffer_load_dwordx4 v21, s[8:11], s42 offen offset:1024 nt lds
    v_mfma_f32_16x16x32_bf16 v[160:163], a[180:183], v[248:251], v[160:163]
    ds_read_b64_tr_b16 a[142:143], v35 offset:34816
    s_lshl_b32 s32, s35, 2
    v_mfma_f32_16x16x32_bf16 v[132:135], a[184:187], v[244:247], v[132:135]
    ds_read_b64_tr_b16 a[144:145], v36 offset:32768
    s_add_u32 s32, s32, s33
    v_mfma_f32_16x16x32_bf16 v[164:167], a[184:187], v[248:251], v[164:167]
    v_cvt_pk_bf16_f32 v192, v28, v29
    v_cvt_pk_bf16_f32 v193, v30, v31
    v_mfma_f32_16x16x32_bf16 v[136:139], a[188:191], v[244:247], v[136:139]
    v_cvt_pk_bf16_f32 v194, v40, v41
    v_cvt_pk_bf16_f32 v195, v42, v43
    v_mfma_f32_16x16x32_bf16 v[168:171], a[188:191], v[248:251], v[168:171]
    s_waitcnt lgkmcnt(1)
    ds_read_b64_tr_b16 a[146:147], v36 offset:34816
    v_mfma_f32_16x16x32_bf16 v[44:47], a[128:131], v[188:191], v[44:47]
    ds_read_b64_tr_b16 a[148:149], v37 offset:32768
    ds_read_b128 v[12:15], v1 offset:2176
    v_mfma_f32_16x16x32_bf16 v[76:79], a[128:131], v[192:195], v[76:79]
    ds_read_b64_tr_b16 a[150:151], v37 offset:34816
    ds_read_b128 v[16:19], v1 offset:2192
    v_mfma_f32_16x16x32_bf16 v[28:31], v[2:5], v[196:199], 0
    ds_read_b64_tr_b16 a[152:153], v38 offset:32768
    buffer_load_dwordx4 v22, s[8:11], s42 offen offset:2048 nt lds
    v_mfma_f32_16x16x32_bf16 v[40:43], v[4:7], v[196:199], 0
    ds_read_b64_tr_b16 a[154:155], v38 offset:34816
    s_mul_i32 s32, s32, 4608
    v_mfma_f32_16x16x32_bf16 v[48:51], a[132:135], v[188:191], v[48:51]
    ds_read_b64_tr_b16 a[156:157], v39 offset:32768
    s_mov_b32 s45, 0
    v_mfma_f32_16x16x32_bf16 v[80:83], a[132:135], v[192:195], v[80:83]
    ds_read_b64_tr_b16 a[158:159], v39 offset:34816
    v_mfma_f32_16x16x32_bf16 v[52:55], a[136:139], v[188:191], v[52:55]
    ds_read_b64_tr_b16 a[160:161], v32 offset:33024
    v_mfma_f32_16x16x32_bf16 v[84:87], a[136:139], v[192:195], v[84:87]
    v_cvt_pk_bf16_f32 v196, v28, v29
    v_cvt_pk_bf16_f32 v197, v30, v31
    v_mfma_f32_16x16x32_bf16 v[56:59], a[140:143], v[188:191], v[56:59]
    ds_read_b64_tr_b16 a[162:163], v32 offset:35072
    v_cvt_pk_bf16_f32 v198, v40, v41
    v_mfma_f32_16x16x32_bf16 v[88:91], a[140:143], v[192:195], v[88:91]
    s_waitcnt lgkmcnt(2)
    v_cvt_pk_bf16_f32 v199, v42, v43
    v_mfma_f32_16x16x32_bf16 v[60:63], a[144:147], v[188:191], v[60:63]
    ds_read_b64_tr_b16 a[164:165], v33 offset:33024
    buffer_load_dwordx4 v23, s[8:11], s42 offen offset:3072 nt lds
    v_mfma_f32_16x16x32_bf16 v[92:95], a[144:147], v[192:195], v[92:95]
    ds_read_b64_tr_b16 a[166:167], v33 offset:35072
    v_mfma_f32_16x16x32_bf16 v[28:31], a[248:251], v[196:199], v[12:15]
    ds_read_b64_tr_b16 a[168:169], v34 offset:33024
    v_mfma_f32_16x16x32_bf16 v[40:43], a[250:253], v[196:199], v[16:19]
    ds_read_b64_tr_b16 a[170:171], v34 offset:35072
    v_mfma_f32_16x16x32_bf16 v[64:67], a[148:151], v[188:191], v[64:67]
    ds_read_b64_tr_b16 a[172:173], v35 offset:33024
    v_mfma_f32_16x16x32_bf16 v[96:99], a[148:151], v[192:195], v[96:99]
    ds_read_b64_tr_b16 a[174:175], v35 offset:35072
    v_mfma_f32_16x16x32_bf16 v[68:71], a[152:155], v[188:191], v[68:71]
    ds_read_b64_tr_b16 a[176:177], v36 offset:33024
    v_mfma_f32_16x16x32_bf16 v[100:103], a[152:155], v[192:195], v[100:103]
    v_cvt_pk_bf16_f32 v196, v28, v29
    v_cvt_pk_bf16_f32 v197, v30, v31
    v_mfma_f32_16x16x32_bf16 v[72:75], a[156:159], v[188:191], v[72:75]
    ds_read_b64_tr_b16 a[178:179], v36 offset:35072
    v_cvt_pk_bf16_f32 v198, v40, v41
    v_mfma_f32_16x16x32_bf16 v[104:107], a[156:159], v[192:195], v[104:107]
    s_waitcnt lgkmcnt(2)
    v_cvt_pk_bf16_f32 v199, v42, v43
    v_mfma_f32_16x16x32_bf16 v[108:111], a[160:163], v[188:191], v[108:111]
    ds_read_b64_tr_b16 a[180:181], v37 offset:33024
    v_mfma_f32_16x16x32_bf16 v[140:143], a[160:163], v[192:195], v[140:143]
    ds_read_b64_tr_b16 a[182:183], v37 offset:35072
    v_mfma_f32_16x16x32_bf16 v[28:31], v[2:5], v[200:203], 0
    ds_read_b64_tr_b16 a[184:185], v38 offset:33024
    v_mfma_f32_16x16x32_bf16 v[40:43], v[4:7], v[200:203], 0
    ds_read_b64_tr_b16 a[186:187], v38 offset:35072
    v_mfma_f32_16x16x32_bf16 v[112:115], a[164:167], v[188:191], v[112:115]
    ds_read_b64_tr_b16 a[188:189], v39 offset:33024
    v_mfma_f32_16x16x32_bf16 v[144:147], a[164:167], v[192:195], v[144:147]
    ds_read_b64_tr_b16 a[190:191], v39 offset:35072
    v_mfma_f32_16x16x32_bf16 v[116:119], a[168:171], v[188:191], v[116:119]
    ds_read_b64_tr_b16 a[128:129], v32 offset:49152
    v_mfma_f32_16x16x32_bf16 v[148:151], a[168:171], v[192:195], v[148:151]
    v_cvt_pk_bf16_f32 v200, v28, v29
    v_cvt_pk_bf16_f32 v201, v30, v31
    v_mfma_f32_16x16x32_bf16 v[120:123], a[172:175], v[188:191], v[120:123]
    ds_read_b64_tr_b16 a[130:131], v32 offset:51200
    v_cvt_pk_bf16_f32 v202, v40, v41
    v_mfma_f32_16x16x32_bf16 v[152:155], a[172:175], v[192:195], v[152:155]
    s_waitcnt lgkmcnt(2)
    v_cvt_pk_bf16_f32 v203, v42, v43
    v_mfma_f32_16x16x32_bf16 v[124:127], a[176:179], v[188:191], v[124:127]
    ds_read_b64_tr_b16 a[132:133], v33 offset:49152
    v_mfma_f32_16x16x32_bf16 v[156:159], a[176:179], v[192:195], v[156:159]
    ds_read_b64_tr_b16 a[134:135], v33 offset:51200
    v_mfma_f32_16x16x32_bf16 v[28:31], a[248:251], v[200:203], v[12:15]
    ds_read_b64_tr_b16 a[136:137], v34 offset:49152
    v_mfma_f32_16x16x32_bf16 v[40:43], a[250:253], v[200:203], v[16:19]
    ds_read_b64_tr_b16 a[138:139], v34 offset:51200
    v_mfma_f32_16x16x32_bf16 v[128:131], a[180:183], v[188:191], v[128:131]
    ds_read_b64_tr_b16 a[140:141], v35 offset:49152
    v_mfma_f32_16x16x32_bf16 v[160:163], a[180:183], v[192:195], v[160:163]
    ds_read_b64_tr_b16 a[142:143], v35 offset:51200
    v_mfma_f32_16x16x32_bf16 v[132:135], a[184:187], v[188:191], v[132:135]
    ds_read_b64_tr_b16 a[144:145], v36 offset:49152
    v_mfma_f32_16x16x32_bf16 v[164:167], a[184:187], v[192:195], v[164:167]
    v_cvt_pk_bf16_f32 v200, v28, v29
    v_cvt_pk_bf16_f32 v201, v30, v31
    v_mfma_f32_16x16x32_bf16 v[136:139], a[188:191], v[188:191], v[136:139]
    v_cvt_pk_bf16_f32 v202, v40, v41
    v_cvt_pk_bf16_f32 v203, v42, v43
    v_mfma_f32_16x16x32_bf16 v[168:171], a[188:191], v[192:195], v[168:171]
    s_waitcnt lgkmcnt(1)
    ds_read_b64_tr_b16 a[146:147], v36 offset:51200
    v_mfma_f32_16x16x32_bf16 v[44:47], a[128:131], v[196:199], v[44:47]
    ds_read_b64_tr_b16 a[148:149], v37 offset:49152
    v_mfma_f32_16x16x32_bf16 v[76:79], a[128:131], v[200:203], v[76:79]
    ds_read_b64_tr_b16 a[150:151], v37 offset:51200
    v_mfma_f32_16x16x32_bf16 v[48:51], a[132:135], v[196:199], v[48:51]
    ds_read_b64_tr_b16 a[152:153], v38 offset:49152
    v_mfma_f32_16x16x32_bf16 v[80:83], a[132:135], v[200:203], v[80:83]
    ds_read_b64_tr_b16 a[154:155], v38 offset:51200
    v_mfma_f32_16x16x32_bf16 v[52:55], a[136:139], v[196:199], v[52:55]
    ds_read_b64_tr_b16 a[156:157], v39 offset:49152
    v_mfma_f32_16x16x32_bf16 v[84:87], a[136:139], v[200:203], v[84:87]
    ds_read_b64_tr_b16 a[158:159], v39 offset:51200
    v_mfma_f32_16x16x32_bf16 v[56:59], a[140:143], v[196:199], v[56:59]
    ds_read_b64_tr_b16 a[160:161], v32 offset:49408
    v_mfma_f32_16x16x32_bf16 v[88:91], a[140:143], v[200:203], v[88:91]
    s_waitcnt lgkmcnt(1)
    ds_read_b64_tr_b16 a[162:163], v32 offset:51456
    v_mfma_f32_16x16x32_bf16 v[60:63], a[144:147], v[196:199], v[60:63]
    ds_read_b64_tr_b16 a[164:165], v33 offset:49408
    v_mfma_f32_16x16x32_bf16 v[92:95], a[144:147], v[200:203], v[92:95]
    ds_read_b64_tr_b16 a[166:167], v33 offset:51456
    v_mfma_f32_16x16x32_bf16 v[64:67], a[148:151], v[196:199], v[64:67]
    ds_read_b64_tr_b16 a[168:169], v34 offset:49408
    v_mfma_f32_16x16x32_bf16 v[96:99], a[148:151], v[200:203], v[96:99]
    ds_read_b64_tr_b16 a[170:171], v34 offset:51456
    v_mfma_f32_16x16x32_bf16 v[68:71], a[152:155], v[196:199], v[68:71]
    ds_read_b64_tr_b16 a[172:173], v35 offset:49408
    v_mfma_f32_16x16x32_bf16 v[100:103], a[152:155], v[200:203], v[100:103]
    ds_read_b64_tr_b16 a[174:175], v35 offset:51456
    v_mfma_f32_16x16x32_bf16 v[72:75], a[156:159], v[196:199], v[72:75]
    ds_read_b64_tr_b16 a[176:177], v36 offset:49408
    v_mfma_f32_16x16x32_bf16 v[104:107], a[156:159], v[200:203], v[104:107]
    s_waitcnt lgkmcnt(1)
    ds_read_b64_tr_b16 a[178:179], v36 offset:51456
    v_mfma_f32_16x16x32_bf16 v[108:111], a[160:163], v[196:199], v[108:111]
    ds_read_b64_tr_b16 a[180:181], v37 offset:49408
    v_mfma_f32_16x16x32_bf16 v[140:143], a[160:163], v[200:203], v[140:143]
    ds_read_b64_tr_b16 a[182:183], v37 offset:51456
    v_mfma_f32_16x16x32_bf16 v[112:115], a[164:167], v[196:199], v[112:115]
    ds_read_b64_tr_b16 a[184:185], v38 offset:49408
    v_mfma_f32_16x16x32_bf16 v[144:147], a[164:167], v[200:203], v[144:147]
    ds_read_b64_tr_b16 a[186:187], v38 offset:51456
    v_mfma_f32_16x16x32_bf16 v[116:119], a[168:171], v[196:199], v[116:119]
    ds_read_b64_tr_b16 a[188:189], v39 offset:49408
    v_mfma_f32_16x16x32_bf16 v[148:151], a[168:171], v[200:203], v[148:151]
    ds_read_b64_tr_b16 a[190:191], v39 offset:51456
    s_waitcnt vmcnt(8)
    s_barrier
    v_mfma_f32_16x16x32_bf16 v[120:123], a[172:175], v[196:199], v[120:123]
    s_add_u32 m0, s38, 65536
    s_mov_b32 s42, 0x0
    v_mfma_f32_16x16x32_bf16 v[152:155], a[172:175], v[200:203], v[152:155]
    s_waitcnt lgkmcnt(0)
    buffer_load_dwordx4 v24, s[12:15], s42 offen offset:0 nt lds
    v_mfma_f32_16x16x32_bf16 v[124:127], a[176:179], v[196:199], v[124:127]
    buffer_load_dwordx4 v25, s[12:15], s42 offen offset:1024 nt lds
    v_mfma_f32_16x16x32_bf16 v[156:159], a[176:179], v[200:203], v[156:159]
    buffer_load_dwordx4 v24, s[12:15], s42 offen offset:2048 nt lds
    v_mfma_f32_16x16x32_bf16 v[128:131], a[180:183], v[196:199], v[128:131]
    buffer_load_dwordx4 v25, s[12:15], s42 offen offset:3072 nt lds
    s_add_u32 m0, s38, 81920
    v_mfma_f32_16x16x32_bf16 v[160:163], a[180:183], v[200:203], v[160:163]
    s_mov_b32 s42, 0x4000
    v_mfma_f32_16x16x32_bf16 v[132:135], a[184:187], v[196:199], v[132:135]
    buffer_load_dwordx4 v24, s[12:15], s42 offen offset:0 nt lds
    v_mfma_f32_16x16x32_bf16 v[164:167], a[184:187], v[200:203], v[164:167]
    buffer_load_dwordx4 v25, s[12:15], s42 offen offset:1024 nt lds
    v_mfma_f32_16x16x32_bf16 v[136:139], a[188:191], v[196:199], v[136:139]
    buffer_load_dwordx4 v24, s[12:15], s42 offen offset:2048 nt lds
    v_mfma_f32_16x16x32_bf16 v[168:171], a[188:191], v[200:203], v[168:171]
    buffer_load_dwordx4 v25, s[12:15], s42 offen offset:3072 nt lds
    v_accvgpr_read_b32 v8, a192
    v_accvgpr_read_b32 v12, a193
    v_xor_b32 v9, 64, v8
    v_xor_b32 v10, 128, v8
    v_xor_b32 v11, 192, v8
    v_xor_b32 v13, 32, v12
    v_xor_b32 v14, 64, v12
    v_xor_b32 v15, 96, v12
    v_cvt_pk_bf16_f32 v220, v108, v109
    v_cvt_pk_bf16_f32 v221, v110, v111
    v_cvt_pk_bf16_f32 v222, v112, v113
    v_cvt_pk_bf16_f32 v223, v114, v115
    s_nop 1
    v_mfma_f32_16x16x32_bf16 v[108:111], a[216:219], v[220:223], 0
    v_cvt_pk_bf16_f32 v224, v116, v117
    v_cvt_pk_bf16_f32 v225, v118, v119
    v_mfma_f32_16x16x32_bf16 v[112:115], a[220:223], v[220:223], 0
    v_cvt_pk_bf16_f32 v226, v120, v121
    v_cvt_pk_bf16_f32 v227, v122, v123
    v_mfma_f32_16x16x32_bf16 v[108:111], a[224:227], v[220:223], v[108:111]
    v_cvt_pk_bf16_f32 v228, v124, v125
    v_cvt_pk_bf16_f32 v229, v126, v127
    v_mfma_f32_16x16x32_bf16 v[112:115], a[228:231], v[220:223], v[112:115]
    v_cvt_pk_bf16_f32 v230, v128, v129
    v_cvt_pk_bf16_f32 v231, v130, v131
    v_mfma_f32_16x16x32_bf16 v[116:119], a[216:219], v[224:227], 0
    v_cvt_pk_bf16_f32 v232, v132, v133
    v_cvt_pk_bf16_f32 v233, v134, v135
    v_mfma_f32_16x16x32_bf16 v[120:123], a[220:223], v[224:227], 0
    v_cvt_pk_bf16_f32 v234, v136, v137
    v_cvt_pk_bf16_f32 v235, v138, v139
    v_mfma_f32_16x16x32_bf16 v[116:119], a[224:227], v[224:227], v[116:119]
    v_xor_b32 v16, 128, v12
    v_xor_b32 v17, 160, v12
    v_mfma_f32_16x16x32_bf16 v[120:123], a[228:231], v[224:227], v[120:123]
    v_cvt_pk_bf16_f32 v220, v108, v109
    v_cvt_pk_bf16_f32 v221, v110, v111
    v_mfma_f32_16x16x32_bf16 v[124:127], a[216:219], v[228:231], 0
    v_cvt_pk_bf16_f32 v222, v112, v113
    v_cvt_pk_bf16_f32 v223, v114, v115
    v_mfma_f32_16x16x32_bf16 v[128:131], a[220:223], v[228:231], 0
    v_xor_b32 v18, 192, v12
    v_cvt_pk_bf16_f32 v188, v44, v45
    v_mfma_f32_16x16x32_bf16 v[124:127], a[224:227], v[228:231], v[124:127]
    v_cvt_pk_bf16_f32 v189, v46, v47
    v_cvt_pk_bf16_f32 v190, v48, v49
    v_mfma_f32_16x16x32_bf16 v[128:131], a[228:231], v[228:231], v[128:131]
    v_cvt_pk_bf16_f32 v191, v50, v51
    v_xor_b32 v19, 224, v12
    v_mfma_f32_16x16x32_bf16 v[132:135], a[216:219], v[232:235], 0
    ds_read_b128 a[128:131], v8 offset:0
    ds_read_b128 a[132:135], v9 offset:0
    v_mfma_f32_16x16x32_bf16 v[136:139], a[220:223], v[232:235], 0
    v_cvt_pk_bf16_f32 v224, v116, v117
    v_cvt_pk_bf16_f32 v225, v118, v119
    v_mfma_f32_16x16x32_bf16 v[132:135], a[224:227], v[232:235], v[132:135]
    v_cvt_pk_bf16_f32 v226, v120, v121
    v_cvt_pk_bf16_f32 v227, v122, v123
    v_mfma_f32_16x16x32_bf16 v[136:139], a[228:231], v[232:235], v[136:139]
    ds_read_b128 a[136:139], v10 offset:0
    v_cvt_pk_bf16_f32 v192, v52, v53
    v_mfma_f32_16x16x32_bf16 v[44:47], a[216:219], v[188:191], 0
    v_cvt_pk_bf16_f32 v193, v54, v55
    v_cvt_pk_bf16_f32 v194, v56, v57
    v_mfma_f32_16x16x32_bf16 v[48:51], a[220:223], v[188:191], 0
    v_cvt_pk_bf16_f32 v195, v58, v59
    ds_read_b128 a[140:143], v11 offset:0
    v_mfma_f32_16x16x32_bf16 v[44:47], a[224:227], v[188:191], v[44:47]
    ds_read_b128 a[144:147], v8 offset:4096
    ds_read_b128 a[148:151], v9 offset:4096
    v_mfma_f32_16x16x32_bf16 v[48:51], a[228:231], v[188:191], v[48:51]
    v_cvt_pk_bf16_f32 v228, v124, v125
    v_cvt_pk_bf16_f32 v229, v126, v127
    v_mfma_f32_16x16x32_bf16 v[52:55], a[216:219], v[192:195], 0
    v_cvt_pk_bf16_f32 v230, v128, v129
    v_cvt_pk_bf16_f32 v231, v130, v131
    ds_read_b128 a[152:155], v10 offset:4096
    v_mfma_f32_16x16x32_bf16 v[56:59], a[220:223], v[192:195], 0
    v_cvt_pk_bf16_f32 v196, v60, v61
    v_cvt_pk_bf16_f32 v197, v62, v63
    v_cvt_pk_bf16_f32 v198, v64, v65
    v_cvt_pk_bf16_f32 v199, v66, v67
    ds_read_b128 a[156:159], v11 offset:4096
    v_mfma_f32_16x16x32_bf16 v[52:55], a[224:227], v[192:195], v[52:55]
    v_cvt_pk_bf16_f32 v232, v132, v133
    v_cvt_pk_bf16_f32 v233, v134, v135
    v_mfma_f32_16x16x32_bf16 v[56:59], a[228:231], v[192:195], v[56:59]
    v_cvt_pk_bf16_f32 v234, v136, v137
    v_cvt_pk_bf16_f32 v235, v138, v139
    v_mfma_f32_16x16x32_bf16 v[60:63], a[216:219], v[196:199], 0
    v_cvt_pk_bf16_f32 v200, v68, v69
    v_cvt_pk_bf16_f32 v201, v70, v71
    v_mfma_f32_16x16x32_bf16 v[64:67], a[220:223], v[196:199], 0
    v_cvt_pk_bf16_f32 v202, v72, v73
    v_cvt_pk_bf16_f32 v203, v74, v75
    v_mfma_f32_16x16x32_bf16 v[60:63], a[224:227], v[196:199], v[60:63]
    v_cvt_pk_bf16_f32 v188, v44, v45
    v_cvt_pk_bf16_f32 v189, v46, v47
    v_mfma_f32_16x16x32_bf16 v[64:67], a[228:231], v[196:199], v[64:67]
    v_cvt_pk_bf16_f32 v190, v48, v49
    v_cvt_pk_bf16_f32 v191, v50, v51
    v_mfma_f32_16x16x32_bf16 v[68:71], a[216:219], v[200:203], 0
    v_cvt_pk_bf16_f32 v192, v52, v53
    v_cvt_pk_bf16_f32 v193, v54, v55
    v_mfma_f32_16x16x32_bf16 v[72:75], a[220:223], v[200:203], 0
    v_cvt_pk_bf16_f32 v194, v56, v57
    v_cvt_pk_bf16_f32 v195, v58, v59
    v_mfma_f32_16x16x32_bf16 v[68:71], a[224:227], v[200:203], v[68:71]
    v_mov_b32 v28, 0xff800000
    v_mov_b32 v29, 0xff800000
    v_mfma_f32_16x16x32_bf16 v[72:75], a[228:231], v[200:203], v[72:75]
    v_cvt_pk_bf16_f32 v196, v60, v61
    v_cvt_pk_bf16_f32 v197, v62, v63
    s_waitcnt lgkmcnt(7)
    v_mfma_f32_16x16x32_bf16 v[124:127], a[128:131], v[220:223], 0
    v_cvt_pk_bf16_f32 v198, v64, v65
    v_cvt_pk_bf16_f32 v199, v66, v67
    s_waitcnt lgkmcnt(6)
    v_mfma_f32_16x16x32_bf16 v[124:127], a[132:135], v[224:227], v[124:127]
    v_cvt_pk_bf16_f32 v204, v76, v77
    v_cvt_pk_bf16_f32 v205, v78, v79
    s_waitcnt lgkmcnt(5)
    v_mfma_f32_16x16x32_bf16 v[124:127], a[136:139], v[228:231], v[124:127]
    v_cvt_pk_bf16_f32 v206, v80, v81
    v_cvt_pk_bf16_f32 v207, v82, v83
    s_waitcnt lgkmcnt(4)
    v_mfma_f32_16x16x32_bf16 v[124:127], a[140:143], v[232:235], v[124:127]
    v_cvt_pk_bf16_f32 v200, v68, v69
    v_cvt_pk_bf16_f32 v201, v70, v71
    s_waitcnt lgkmcnt(3)
    v_mfma_f32_16x16x32_bf16 v[128:131], a[144:147], v[220:223], 0
    v_cvt_pk_bf16_f32 v202, v72, v73
    v_cvt_pk_bf16_f32 v203, v74, v75
    s_waitcnt lgkmcnt(2)
    v_mfma_f32_16x16x32_bf16 v[128:131], a[148:151], v[224:227], v[128:131]
    v_cvt_pk_bf16_f32 v208, v84, v85
    v_cvt_pk_bf16_f32 v209, v86, v87
    s_waitcnt lgkmcnt(1)
    v_mfma_f32_16x16x32_bf16 v[128:131], a[152:155], v[228:231], v[128:131]
    v_cvt_pk_bf16_f32 v210, v88, v89
    v_cvt_pk_bf16_f32 v211, v90, v91
    s_waitcnt lgkmcnt(0)
    v_mfma_f32_16x16x32_bf16 v[128:131], a[156:159], v[232:235], v[128:131]
    v_mov_b32 v30, 0xff800000
    v_mov_b32 v31, 0xff800000
    v_mfma_f32_16x16x32_bf16 v[76:79], a[216:219], v[204:207], 0
    v_cvt_pk_bf16_f32 v212, v92, v93
    v_cvt_pk_bf16_f32 v213, v94, v95
    v_mfma_f32_16x16x32_bf16 v[80:83], a[220:223], v[204:207], 0
    v_cvt_pk_bf16_f32 v214, v96, v97
    v_cvt_pk_bf16_f32 v215, v98, v99
    v_mfma_f32_16x16x32_bf16 v[76:79], a[224:227], v[204:207], v[76:79]
    v_lshrrev_b32 v4, 3, v255
    v_lshrrev_b32 v5, 4, v4
    v_mfma_f32_16x16x32_bf16 v[80:83], a[228:231], v[204:207], v[80:83]
    v_add_u32 v5, s28, v5
    v_mul_u32_u24 v3, 165888, v5
    v_mfma_f32_16x16x32_bf16 v[84:87], a[216:219], v[208:211], 0
    v_cvt_pk_bf16_f32 v216, v100, v101
    v_cvt_pk_bf16_f32 v217, v102, v103
    v_mfma_f32_16x16x32_bf16 v[88:91], a[220:223], v[208:211], 0
    v_cvt_pk_bf16_f32 v218, v104, v105
    v_cvt_pk_bf16_f32 v219, v106, v107
    v_mfma_f32_16x16x32_bf16 v[84:87], a[224:227], v[208:211], v[84:87]
    v_and_b32 v5, 15, v4
    v_lshl_add_u32 v3, v5, 4, v3
    v_mfma_f32_16x16x32_bf16 v[88:91], a[228:231], v[208:211], v[88:91]
    v_cvt_pk_bf16_f32 v204, v76, v77
    v_cvt_pk_bf16_f32 v205, v78, v79
    v_mfma_f32_16x16x32_bf16 v[92:95], a[216:219], v[212:215], 0
    v_cvt_pk_bf16_f32 v206, v80, v81
    v_cvt_pk_bf16_f32 v207, v82, v83
    v_mfma_f32_16x16x32_bf16 v[96:99], a[220:223], v[212:215], 0
    v_mov_b32 v4, -1
    v_mov_b32 v5, -1
    v_mfma_f32_16x16x32_bf16 v[92:95], a[224:227], v[212:215], v[92:95]
    v_mov_b32 v6, -1
    v_mov_b32 v7, -1
    v_mfma_f32_16x16x32_bf16 v[96:99], a[228:231], v[212:215], v[96:99]
    v_cvt_pk_bf16_f32 v208, v84, v85
    v_cvt_pk_bf16_f32 v209, v86, v87
    v_mfma_f32_16x16x32_bf16 v[100:103], a[216:219], v[216:219], 0
    v_cvt_pk_bf16_f32 v210, v88, v89
    v_cvt_pk_bf16_f32 v211, v90, v91
    v_mfma_f32_16x16x32_bf16 v[104:107], a[220:223], v[216:219], 0
    v_accvgpr_read_b32 v0, a205
    v_accvgpr_read_b32 v2, a206
    v_mfma_f32_16x16x32_bf16 v[100:103], a[224:227], v[216:219], v[100:103]
    v_accvgpr_read_b32 v180, a208
    v_accvgpr_read_b32 v1, a209
    v_mfma_f32_16x16x32_bf16 v[104:107], a[228:231], v[216:219], v[104:107]
    v_cvt_pk_bf16_f32 v212, v92, v93
    v_cvt_pk_bf16_f32 v213, v94, v95
    v_mfma_f32_16x16x32_bf16 v[108:111], a[128:131], v[188:191], 0
    v_cvt_pk_bf16_f32 v214, v96, v97
    v_cvt_pk_bf16_f32 v215, v98, v99
    v_mfma_f32_16x16x32_bf16 v[108:111], a[132:135], v[192:195], v[108:111]
    v_cvt_pk_bf16_f32 v236, v140, v141
    v_cvt_pk_bf16_f32 v237, v142, v143
    v_mfma_f32_16x16x32_bf16 v[108:111], a[136:139], v[196:199], v[108:111]
    v_cvt_pk_bf16_f32 v238, v144, v145
    v_cvt_pk_bf16_f32 v239, v146, v147
    v_mfma_f32_16x16x32_bf16 v[108:111], a[140:143], v[200:203], v[108:111]
    v_cvt_pk_bf16_f32 v216, v100, v101
    v_cvt_pk_bf16_f32 v217, v102, v103
    v_mfma_f32_16x16x32_bf16 v[112:115], a[144:147], v[188:191], 0
    v_cvt_pk_bf16_f32 v218, v104, v105
    v_cvt_pk_bf16_f32 v219, v106, v107
    v_mfma_f32_16x16x32_bf16 v[112:115], a[148:151], v[192:195], v[112:115]
    v_cvt_pk_bf16_f32 v240, v148, v149
    v_cvt_pk_bf16_f32 v241, v150, v151
    v_mfma_f32_16x16x32_bf16 v[112:115], a[152:155], v[196:199], v[112:115]
    v_cvt_pk_bf16_f32 v242, v152, v153
    v_cvt_pk_bf16_f32 v243, v154, v155
    v_mfma_f32_16x16x32_bf16 v[112:115], a[156:159], v[200:203], v[112:115]
    v_add_u32 v181, 8192, v180
    v_add_u32 v182, 16384, v180
    v_mfma_f32_16x16x32_bf16 v[140:143], a[216:219], v[236:239], 0
    v_cvt_pk_bf16_f32 v244, v156, v157
    v_cvt_pk_bf16_f32 v245, v158, v159
    v_mfma_f32_16x16x32_bf16 v[144:147], a[220:223], v[236:239], 0
    v_cvt_pk_bf16_f32 v246, v160, v161
    v_cvt_pk_bf16_f32 v247, v162, v163
    v_mfma_f32_16x16x32_bf16 v[140:143], a[224:227], v[236:239], v[140:143]
    v_add_u32 v183, 24576, v180
    v_mfma_f32_16x16x32_bf16 v[144:147], a[228:231], v[236:239], v[144:147]
    v_mfma_f32_16x16x32_bf16 v[148:151], a[216:219], v[240:243], 0
    v_cvt_pk_bf16_f32 v248, v164, v165
    v_cvt_pk_bf16_f32 v249, v166, v167
    v_mfma_f32_16x16x32_bf16 v[152:155], a[220:223], v[240:243], 0
    v_cvt_pk_bf16_f32 v250, v168, v169
    v_cvt_pk_bf16_f32 v251, v170, v171
    v_mfma_f32_16x16x32_bf16 v[148:151], a[224:227], v[240:243], v[148:151]
    v_mfma_f32_16x16x32_bf16 v[152:155], a[228:231], v[240:243], v[152:155]
    v_cvt_pk_bf16_f32 v236, v140, v141
    v_cvt_pk_bf16_f32 v237, v142, v143
    v_mfma_f32_16x16x32_bf16 v[156:159], a[216:219], v[244:247], 0
    v_cvt_pk_bf16_f32 v238, v144, v145
    v_cvt_pk_bf16_f32 v239, v146, v147
    v_mfma_f32_16x16x32_bf16 v[160:163], a[220:223], v[244:247], 0
    v_mfma_f32_16x16x32_bf16 v[156:159], a[224:227], v[244:247], v[156:159]
    v_mfma_f32_16x16x32_bf16 v[160:163], a[228:231], v[244:247], v[160:163]
    v_cvt_pk_bf16_f32 v240, v148, v149
    v_cvt_pk_bf16_f32 v241, v150, v151
    v_mfma_f32_16x16x32_bf16 v[164:167], a[216:219], v[248:251], 0
    v_cvt_pk_bf16_f32 v242, v152, v153
    v_cvt_pk_bf16_f32 v243, v154, v155
    v_mfma_f32_16x16x32_bf16 v[168:171], a[220:223], v[248:251], 0
    v_mfma_f32_16x16x32_bf16 v[164:167], a[224:227], v[248:251], v[164:167]
    v_mfma_f32_16x16x32_bf16 v[168:171], a[228:231], v[248:251], v[168:171]
    v_cvt_pk_bf16_f32 v244, v156, v157
    v_cvt_pk_bf16_f32 v245, v158, v159
    v_mfma_f32_16x16x32_bf16 v[116:119], a[128:131], v[204:207], 0
    v_cvt_pk_bf16_f32 v246, v160, v161
    v_cvt_pk_bf16_f32 v247, v162, v163
    v_mfma_f32_16x16x32_bf16 v[116:119], a[132:135], v[208:211], v[116:119]
    v_max3_f32 v34, v124, v125, v30
    v_max3_f32 v34, v126, v127, v34
    v_mfma_f32_16x16x32_bf16 v[116:119], a[136:139], v[212:215], v[116:119]
    v_max3_f32 v34, v128, v129, v34
    v_max3_f32 v34, v130, v131, v34
    v_mfma_f32_16x16x32_bf16 v[116:119], a[140:143], v[216:219], v[116:119]
    v_cvt_pk_bf16_f32 v248, v164, v165
    v_cvt_pk_bf16_f32 v249, v166, v167
    v_mfma_f32_16x16x32_bf16 v[120:123], a[144:147], v[204:207], 0
    v_cvt_pk_bf16_f32 v250, v168, v169
    v_cvt_pk_bf16_f32 v251, v170, v171
    v_mfma_f32_16x16x32_bf16 v[120:123], a[148:151], v[208:211], v[120:123]
    v_max3_f32 v32, v108, v109, v28
    v_max3_f32 v32, v110, v111, v32
    v_mfma_f32_16x16x32_bf16 v[120:123], a[152:155], v[212:215], v[120:123]
    v_max3_f32 v32, v112, v113, v32
    v_max3_f32 v32, v114, v115, v32
    v_mfma_f32_16x16x32_bf16 v[120:123], a[156:159], v[216:219], v[120:123]
    v_mfma_f32_16x16x32_bf16 v[132:135], a[128:131], v[236:239], 0
    v_mfma_f32_16x16x32_bf16 v[132:135], a[132:135], v[240:243], v[132:135]
    v_mfma_f32_16x16x32_bf16 v[132:135], a[136:139], v[244:247], v[132:135]
    v_mfma_f32_16x16x32_bf16 v[132:135], a[140:143], v[248:251], v[132:135]
    v_mfma_f32_16x16x32_bf16 v[136:139], a[144:147], v[236:239], 0
    v_mfma_f32_16x16x32_bf16 v[136:139], a[148:151], v[240:243], v[136:139]
    v_max3_f32 v33, v116, v117, v29
    v_max3_f32 v33, v118, v119, v33
    v_mfma_f32_16x16x32_bf16 v[136:139], a[152:155], v[244:247], v[136:139]
    v_max3_f32 v33, v120, v121, v33
    v_max3_f32 v33, v122, v123, v33
    v_mfma_f32_16x16x32_bf16 v[136:139], a[156:159], v[248:251], v[136:139]
    s_load_dwordx2 s[20:21], s[0:1], 48
    s_lshl_b32 s3, s35, 4
    s_add_u32 s3, s3, s54
    s_mul_i32 s3, s3, 9216
    s_add_u32 s3, s3, 0x488000
    s_add_u32 s16, s30, s3
    s_addc_u32 s17, s31, 0
    s_mov_b32 s18, 0x2400
    s_mov_b32 s19, 0x20000
    s_mov_b32 s44, s36
    s_branch L_attn_go
L_attn_entry:
    ds_read_b128 a[128:131], v8 offset:0
    ds_read_b128 a[132:135], v9 offset:0
    ds_read_b128 a[136:139], v10 offset:0
    ds_read_b128 a[140:143], v11 offset:0
    ds_read_b128 a[144:147], v8 offset:4096
    ds_read_b128 a[148:151], v9 offset:4096
    ds_read_b128 a[152:155], v10 offset:4096
    ds_read_b128 a[156:159], v11 offset:4096
    s_waitcnt lgkmcnt(7)
    v_mfma_f32_16x16x32_bf16 v[124:127], a[128:131], v[220:223], 0
    s_waitcnt lgkmcnt(6)
    v_mfma_f32_16x16x32_bf16 v[124:127], a[132:135], v[224:227], v[124:127]
    s_waitcnt lgkmcnt(5)
    v_mfma_f32_16x16x32_bf16 v[124:127], a[136:139], v[228:231], v[124:127]
    s_waitcnt lgkmcnt(4)
    v_mfma_f32_16x16x32_bf16 v[124:127], a[140:143], v[232:235], v[124:127]
    s_waitcnt lgkmcnt(3)
    v_mfma_f32_16x16x32_bf16 v[128:131], a[144:147], v[220:223], 0
    s_waitcnt lgkmcnt(2)
    v_mfma_f32_16x16x32_bf16 v[128:131], a[148:151], v[224:227], v[128:131]
    s_waitcnt lgkmcnt(1)
    v_mfma_f32_16x16x32_bf16 v[128:131], a[152:155], v[228:231], v[128:131]
    s_waitcnt lgkmcnt(0)
    v_mfma_f32_16x16x32_bf16 v[128:131], a[156:159], v[232:235], v[128:131]
    v_mfma_f32_16x16x32_bf16 v[108:111], a[128:131], v[188:191], 0
    v_mfma_f32_16x16x32_bf16 v[108:111], a[132:135], v[192:195], v[108:111]
    v_mfma_f32_16x16x32_bf16 v[108:111], a[136:139], v[196:199], v[108:111]
    v_mfma_f32_16x16x32_bf16 v[108:111], a[140:143], v[200:203], v[108:111]
    v_mfma_f32_16x16x32_bf16 v[112:115], a[144:147], v[188:191], 0
    v_mfma_f32_16x16x32_bf16 v[112:115], a[148:151], v[192:195], v[112:115]
    v_mfma_f32_16x16x32_bf16 v[112:115], a[152:155], v[196:199], v[112:115]
    v_mfma_f32_16x16x32_bf16 v[112:115], a[156:159], v[200:203], v[112:115]
    v_mfma_f32_16x16x32_bf16 v[116:119], a[128:131], v[204:207], 0
    v_mfma_f32_16x16x32_bf16 v[116:119], a[132:135], v[208:211], v[116:119]
    v_mfma_f32_16x16x32_bf16 v[116:119], a[136:139], v[212:215], v[116:119]
    v_mfma_f32_16x16x32_bf16 v[116:119], a[140:143], v[216:219], v[116:119]
    v_mfma_f32_16x16x32_bf16 v[120:123], a[144:147], v[204:207], 0
    v_mfma_f32_16x16x32_bf16 v[120:123], a[148:151], v[208:211], v[120:123]
    v_mfma_f32_16x16x32_bf16 v[120:123], a[152:155], v[212:215], v[120:123]
    v_mfma_f32_16x16x32_bf16 v[120:123], a[156:159], v[216:219], v[120:123]
    v_mfma_f32_16x16x32_bf16 v[132:135], a[128:131], v[236:239], 0
    v_mfma_f32_16x16x32_bf16 v[132:135], a[132:135], v[240:243], v[132:135]
    v_mfma_f32_16x16x32_bf16 v[132:135], a[136:139], v[244:247], v[132:135]
    v_mfma_f32_16x16x32_bf16 v[132:135], a[140:143], v[248:251], v[132:135]
    v_mfma_f32_16x16x32_bf16 v[136:139], a[144:147], v[236:239], 0
    v_mfma_f32_16x16x32_bf16 v[136:139], a[148:151], v[240:243], v[136:139]
    v_mfma_f32_16x16x32_bf16 v[136:139], a[152:155], v[244:247], v[136:139]
    v_mfma_f32_16x16x32_bf16 v[136:139], a[156:159], v[248:251], v[136:139]
    v_max3_f32 v34, v124, v125, v30
    v_max3_f32 v34, v126, v127, v34
    v_max3_f32 v34, v128, v129, v34
    v_max3_f32 v34, v130, v131, v34
    v_max3_f32 v32, v108, v109, v28
    v_max3_f32 v32, v110, v111, v32
    v_max3_f32 v32, v112, v113, v32
    v_max3_f32 v32, v114, v115, v32
    v_max3_f32 v33, v116, v117, v29
    v_max3_f32 v33, v118, v119, v33
    v_max3_f32 v33, v120, v121, v33
    v_max3_f32 v33, v122, v123, v33
L_attn_go:
    ds_read_b128 a[128:131], v8 offset:8192
    ds_read_b128 a[132:135], v9 offset:8192
    ds_read_b128 a[136:139], v10 offset:8192
    ds_read_b128 a[140:143], v11 offset:8192
    s_nop 3
    v_max3_f32 v35, v132, v133, v31
    v_max3_f32 v35, v134, v135, v35
    v_max3_f32 v35, v136, v137, v35
    v_max3_f32 v35, v138, v139, v35
    v_mov_b32 v36, v32
    v_mov_b32 v37, v33
    v_mov_b32 v38, v34
    v_mov_b32 v39, v35
    s_nop 0
    v_permlane16_swap_b32 v32, v36
    v_permlane16_swap_b32 v33, v37
    v_permlane16_swap_b32 v34, v38
    v_permlane16_swap_b32 v35, v39
    v_max_f32 v32, v32, v36
    v_max_f32 v33, v33, v37
    v_max_f32 v34, v34, v38
    v_max_f32 v35, v35, v39
    v_mov_b32 v36, v32
    v_mov_b32 v37, v33
    v_mov_b32 v38, v34
    v_mov_b32 v39, v35
    s_nop 0
    v_permlane32_swap_b32 v32, v36
    v_permlane32_swap_b32 v33, v37
    v_permlane32_swap_b32 v34, v38
    v_permlane32_swap_b32 v35, v39
    v_max_f32 v32, v32, v36
    v_max_f32 v33, v33, v37
    v_max_f32 v34, v34, v38
    v_max_f32 v35, v35, v39
    v_sub_f32 v44, 0, v32
    v_sub_f32 v45, 0, v32
    v_sub_f32 v46, 0, v32
    v_sub_f32 v47, 0, v32
    v_sub_f32 v48, 0, v33
    v_sub_f32 v49, 0, v33
    v_sub_f32 v50, 0, v33
    v_sub_f32 v51, 0, v33
    v_sub_f32 v52, 0, v34
    v_sub_f32 v53, 0, v34
    v_sub_f32 v54, 0, v34
    v_sub_f32 v55, 0, v34
    v_sub_f32 v56, 0, v35
    v_sub_f32 v57, 0, v35
    v_sub_f32 v58, 0, v35
    v_sub_f32 v59, 0, v35
    v_sub_f32 v108, v108, v32
    v_sub_f32 v109, v109, v32
    v_sub_f32 v110, v110, v32
    v_sub_f32 v111, v111, v32
    v_sub_f32 v116, v116, v33
    v_sub_f32 v117, v117, v33
    v_sub_f32 v118, v118, v33
    v_sub_f32 v119, v119, v33
    v_sub_f32 v124, v124, v34
    v_sub_f32 v125, v125, v34
    v_sub_f32 v126, v126, v34
    v_sub_f32 v127, v127, v34
    v_sub_f32 v132, v132, v35
    v_sub_f32 v133, v133, v35
    v_sub_f32 v134, v134, v35
    v_sub_f32 v135, v135, v35
    v_sub_f32 v112, v112, v32
    v_sub_f32 v113, v113, v32
    v_sub_f32 v114, v114, v32
    v_sub_f32 v115, v115, v32
    v_sub_f32 v120, v120, v33
    v_sub_f32 v121, v121, v33
    v_sub_f32 v122, v122, v33
    v_sub_f32 v123, v123, v33
    v_sub_f32 v128, v128, v34
    v_sub_f32 v129, v129, v34
    v_sub_f32 v130, v130, v34
    v_sub_f32 v131, v131, v34
    v_sub_f32 v136, v136, v35
    v_sub_f32 v137, v137, v35
    v_sub_f32 v138, v138, v35
    v_sub_f32 v139, v139, v35
    s_mov_b32 s40, 7
    s_mov_b32 s41, 0x8000
    s_waitcnt lgkmcnt(3)
    v_mfma_f32_16x16x32_bf16 v[140:143], a[128:131], v[188:191], v[44:47]
    v_exp_f32 v32, v108
    s_waitcnt lgkmcnt(2)
    v_mfma_f32_16x16x32_bf16 v[140:143], a[132:135], v[192:195], v[140:143]
    v_exp_f32 v33, v109
    v_mfma_f32_16x16x32_bf16 v[148:151], a[132:135], v[208:211], v[48:51]
    v_exp_f32 v34, v110
    v_mfma_f32_16x16x32_bf16 v[148:151], a[128:131], v[204:207], v[148:151]
    v_exp_f32 v35, v111
    ds_read_b128 a[144:147], v8 offset:12288
    v_mfma_f32_16x16x32_bf16 v[156:159], a[128:131], v[220:223], v[52:55]
    v_exp_f32 v36, v116
    v_mfma_f32_16x16x32_bf16 v[156:159], a[132:135], v[224:227], v[156:159]
    v_exp_f32 v37, v117
    v_mfma_f32_16x16x32_bf16 v[164:167], a[132:135], v[240:243], v[56:59]
    v_exp_f32 v38, v118
    v_cvt_pk_bf16_f32 v76, v32, v33
    v_mfma_f32_16x16x32_bf16 v[164:167], a[128:131], v[236:239], v[164:167]
    s_waitcnt lgkmcnt(1)
    v_exp_f32 v39, v119
    ds_read_b128 a[148:151], v9 offset:12288
    v_mfma_f32_16x16x32_bf16 v[140:143], a[136:139], v[196:199], v[140:143]
    v_exp_f32 v32, v124
    v_cvt_pk_bf16_f32 v77, v34, v35
    v_mfma_f32_16x16x32_bf16 v[140:143], a[140:143], v[200:203], v[140:143]
    v_exp_f32 v33, v125
    v_mfma_f32_16x16x32_bf16 v[148:151], a[140:143], v[216:219], v[148:151]
    v_exp_f32 v34, v126
    v_cvt_pk_bf16_f32 v80, v36, v37
    v_mfma_f32_16x16x32_bf16 v[148:151], a[136:139], v[212:215], v[148:151]
    v_exp_f32 v35, v127
    ds_read_b128 a[152:155], v10 offset:12288
    v_mfma_f32_16x16x32_bf16 v[156:159], a[136:139], v[228:231], v[156:159]
    v_exp_f32 v36, v132
    v_cvt_pk_bf16_f32 v81, v38, v39
    v_mfma_f32_16x16x32_bf16 v[156:159], a[140:143], v[232:235], v[156:159]
    v_exp_f32 v37, v133
    v_mfma_f32_16x16x32_bf16 v[164:167], a[140:143], v[248:251], v[164:167]
    v_exp_f32 v38, v134
    v_cvt_pk_bf16_f32 v84, v32, v33
    v_mfma_f32_16x16x32_bf16 v[164:167], a[136:139], v[244:247], v[164:167]
    s_waitcnt lgkmcnt(1)
    v_exp_f32 v39, v135
    ds_read_b128 a[156:159], v11 offset:12288
    v_mfma_f32_16x16x32_bf16 v[144:147], a[144:147], v[188:191], v[44:47]
    v_exp_f32 v32, v112
    v_exp_f32 v33, v113
    v_cvt_pk_bf16_f32 v85, v34, v35
    v_mfma_f32_16x16x32_bf16 v[144:147], a[148:151], v[192:195], v[144:147]
    v_exp_f32 v34, v114
    s_waitcnt vmcnt(4)
    s_barrier
    v_mfma_f32_16x16x32_bf16 v[152:155], a[148:151], v[208:211], v[48:51]
    v_exp_f32 v35, v115
    v_cvt_pk_bf16_f32 v88, v36, v37
    v_mfma_f32_16x16x32_bf16 v[152:155], a[144:147], v[204:207], v[152:155]
    v_exp_f32 v36, v120
    ds_read_b128 a[128:131], v8 offset:16384
    v_mfma_f32_16x16x32_bf16 v[160:163], a[144:147], v[220:223], v[52:55]
    v_exp_f32 v37, v121
    v_cvt_pk_bf16_f32 v89, v38, v39
    v_mfma_f32_16x16x32_bf16 v[160:163], a[148:151], v[224:227], v[160:163]
    v_exp_f32 v38, v122
    v_cvt_pk_bf16_f32 v78, v32, v33
    v_mfma_f32_16x16x32_bf16 v[168:171], a[148:151], v[240:243], v[56:59]
    v_exp_f32 v39, v123
    s_add_u32 m0, s38, 49152
    s_add_u32 s41, s41, 16384
    v_mfma_f32_16x16x32_bf16 v[168:171], a[144:147], v[236:239], v[168:171]
    buffer_load_dwordx4 v20, s[8:11], s41 offen offset:0 nt lds
    s_waitcnt lgkmcnt(1)
    v_exp_f32 v32, v128
    ds_read_b128 a[132:135], v9 offset:16384
    v_cvt_pk_bf16_f32 v79, v34, v35
    v_mfma_f32_16x16x32_bf16 v[144:147], a[152:155], v[196:199], v[144:147]
    v_exp_f32 v33, v129
    v_mfma_f32_16x16x32_bf16 v[144:147], a[156:159], v[200:203], v[144:147]
    v_exp_f32 v34, v130
    v_cvt_pk_bf16_f32 v82, v36, v37
    v_mfma_f32_16x16x32_bf16 v[152:155], a[156:159], v[216:219], v[152:155]
    v_exp_f32 v35, v131
    buffer_load_dwordx4 v21, s[8:11], s41 offen offset:1024 nt lds
    v_mfma_f32_16x16x32_bf16 v[152:155], a[152:155], v[212:215], v[152:155]
    v_exp_f32 v36, v136
    ds_read_b128 a[136:139], v10 offset:16384
    v_cvt_pk_bf16_f32 v83, v38, v39
    v_mfma_f32_16x16x32_bf16 v[160:163], a[152:155], v[228:231], v[160:163]
    v_exp_f32 v37, v137
    v_mfma_f32_16x16x32_bf16 v[160:163], a[156:159], v[232:235], v[160:163]
    v_exp_f32 v38, v138
    v_cvt_pk_bf16_f32 v86, v32, v33
    buffer_load_dwordx4 v22, s[8:11], s41 offen offset:2048 nt lds
    v_mfma_f32_16x16x32_bf16 v[168:171], a[156:159], v[248:251], v[168:171]
    v_exp_f32 v39, v139
    v_mfma_f32_16x16x32_bf16 v[168:171], a[152:155], v[244:247], v[168:171]
    s_waitcnt lgkmcnt(1)
    ds_read_b128 a[140:143], v11 offset:16384
    v_cvt_pk_bf16_f32 v87, v34, v35
    buffer_load_dwordx4 v23, s[8:11], s41 offen offset:3072 nt lds
    v_cvt_pk_bf16_f32 v90, v36, v37
    v_cvt_pk_bf16_f32 v91, v38, v39
    v_mfma_f32_16x16x32_bf16 v[108:111], a[128:131], v[188:191], v[44:47]
    v_exp_f32 v32, v140
    v_mfma_f32_16x16x32_bf16 v[108:111], a[132:135], v[192:195], v[108:111]
    v_exp_f32 v33, v141
    v_mfma_f32_16x16x32_bf16 v[116:119], a[132:135], v[208:211], v[48:51]
    v_exp_f32 v34, v142
    v_mfma_f32_16x16x32_bf16 v[116:119], a[128:131], v[204:207], v[116:119]
    v_exp_f32 v35, v143
    ds_read_b128 a[144:147], v8 offset:20480
    v_mfma_f32_16x16x32_bf16 v[124:127], a[128:131], v[220:223], v[52:55]
    v_exp_f32 v36, v148
    v_mfma_f32_16x16x32_bf16 v[124:127], a[132:135], v[224:227], v[124:127]
    v_exp_f32 v37, v149
    v_mfma_f32_16x16x32_bf16 v[132:135], a[132:135], v[240:243], v[56:59]
    v_exp_f32 v38, v150
    v_cvt_pk_bf16_f32 v92, v32, v33
    s_add_u32 m0, s38, 98304
    s_sub_u32 s42, s41, 16384
    v_mfma_f32_16x16x32_bf16 v[132:135], a[128:131], v[236:239], v[132:135]
    buffer_load_dwordx4 v24, s[12:15], s42 offen offset:0 nt lds
    s_waitcnt lgkmcnt(1)
    v_exp_f32 v39, v151
    ds_read_b128 a[148:151], v9 offset:20480
    v_mfma_f32_16x16x32_bf16 v[108:111], a[136:139], v[196:199], v[108:111]
    v_exp_f32 v32, v156
    v_cvt_pk_bf16_f32 v93, v34, v35
    v_mfma_f32_16x16x32_bf16 v[108:111], a[140:143], v[200:203], v[108:111]
    v_exp_f32 v33, v157
    v_mfma_f32_16x16x32_bf16 v[116:119], a[140:143], v[216:219], v[116:119]
    v_exp_f32 v34, v158
    v_cvt_pk_bf16_f32 v96, v36, v37
    v_mfma_f32_16x16x32_bf16 v[116:119], a[136:139], v[212:215], v[116:119]
    v_exp_f32 v35, v159
    ds_read_b128 a[152:155], v10 offset:20480
    buffer_load_dwordx4 v25, s[12:15], s42 offen offset:1024 nt lds
    v_mfma_f32_16x16x32_bf16 v[124:127], a[136:139], v[228:231], v[124:127]
    v_exp_f32 v36, v164
    v_cvt_pk_bf16_f32 v97, v38, v39
    v_mfma_f32_16x16x32_bf16 v[124:127], a[140:143], v[232:235], v[124:127]
    v_exp_f32 v37, v165
    v_mfma_f32_16x16x32_bf16 v[132:135], a[140:143], v[248:251], v[132:135]
    v_exp_f32 v38, v166
    v_cvt_pk_bf16_f32 v100, v32, v33
    v_mfma_f32_16x16x32_bf16 v[132:135], a[136:139], v[244:247], v[132:135]
    s_waitcnt lgkmcnt(1)
    v_exp_f32 v39, v167
    ds_read_b128 a[156:159], v11 offset:20480
    v_mfma_f32_16x16x32_bf16 v[112:115], a[144:147], v[188:191], v[44:47]
    v_exp_f32 v32, v144
    v_exp_f32 v33, v145
    ds_read_b128 a[128:131], v8 offset:24576
    v_cvt_pk_bf16_f32 v101, v34, v35
    buffer_load_dwordx4 v24, s[12:15], s42 offen offset:2048 nt lds
    v_mfma_f32_16x16x32_bf16 v[112:115], a[148:151], v[192:195], v[112:115]
    v_exp_f32 v34, v146
    ds_read_b64_tr_b16 a[160:161], v12 offset:0
    v_mfma_f32_16x16x32_bf16 v[120:123], a[148:151], v[208:211], v[48:51]
    v_exp_f32 v35, v147
    v_cvt_pk_bf16_f32 v104, v36, v37
    v_mfma_f32_16x16x32_bf16 v[120:123], a[144:147], v[204:207], v[120:123]
    v_exp_f32 v36, v152
    ds_read_b64_tr_b16 a[162:163], v12 offset:4096
    v_mfma_f32_16x16x32_bf16 v[128:131], a[144:147], v[220:223], v[52:55]
    v_exp_f32 v37, v153
    ds_read_b128 a[132:135], v9 offset:24576
    v_cvt_pk_bf16_f32 v105, v38, v39
    v_mfma_f32_16x16x32_bf16 v[128:131], a[148:151], v[224:227], v[128:131]
    v_exp_f32 v38, v154
    ds_read_b64_tr_b16 a[164:165], v12 offset:8192
    v_cvt_pk_bf16_f32 v94, v32, v33
    buffer_load_dwordx4 v25, s[12:15], s42 offen offset:3072 nt lds
    v_mfma_f32_16x16x32_bf16 v[136:139], a[148:151], v[240:243], v[56:59]
    v_exp_f32 v39, v155
    v_mfma_f32_16x16x32_bf16 v[136:139], a[144:147], v[236:239], v[136:139]
    s_waitcnt lgkmcnt(5)
    v_exp_f32 v32, v160
    ds_read_b64_tr_b16 a[166:167], v12 offset:12288
    v_cvt_pk_bf16_f32 v95, v34, v35
    v_mfma_f32_16x16x32_bf16 v[112:115], a[152:155], v[196:199], v[112:115]
    v_exp_f32 v33, v161
    ds_read_b128 a[136:139], v10 offset:24576
    v_mfma_f32_16x16x32_bf16 v[112:115], a[156:159], v[200:203], v[112:115]
    v_exp_f32 v34, v162
    ds_read_b64_tr_b16 a[168:169], v13 offset:0
    v_cvt_pk_bf16_f32 v98, v36, v37
    v_mfma_f32_16x16x32_bf16 v[120:123], a[156:159], v[216:219], v[120:123]
    v_exp_f32 v35, v163
    buffer_load_dwordx2 v[184:185], v255, s[56:59], s32 offen
    v_mfma_f32_16x16x32_bf16 v[120:123], a[152:155], v[212:215], v[120:123]
    v_exp_f32 v36, v168
    ds_read_b64_tr_b16 a[170:171], v13 offset:4096
    v_cvt_pk_bf16_f32 v99, v38, v39
    v_mfma_f32_16x16x32_bf16 v[128:131], a[152:155], v[228:231], v[128:131]
    v_exp_f32 v37, v169
    ds_read_b128 a[140:143], v11 offset:24576
    v_mfma_f32_16x16x32_bf16 v[128:131], a[156:159], v[232:235], v[128:131]
    v_exp_f32 v38, v170
    ds_read_b64_tr_b16 a[172:173], v13 offset:8192
    v_cvt_pk_bf16_f32 v102, v32, v33
    v_mfma_f32_16x16x32_bf16 v[136:139], a[156:159], v[248:251], v[136:139]
    v_exp_f32 v39, v171
    v_mfma_f32_16x16x32_bf16 v[136:139], a[152:155], v[244:247], v[136:139]
    s_waitcnt lgkmcnt(5)
    ds_read_b64_tr_b16 a[174:175], v13 offset:12288
    v_cvt_pk_bf16_f32 v103, v34, v35
    buffer_load_dwordx2 v[184:185], v255, s[56:59], s32 offen offset:512
    s_add_u32 s32, s32, 768
    v_cvt_pk_bf16_f32 v106, v36, v37
    v_cvt_pk_bf16_f32 v107, v38, v39
    v_mfma_f32_16x16x32_bf16 v[140:143], a[128:131], v[188:191], v[44:47]
    v_exp_f32 v32, v108
    v_mfma_f32_16x16x32_bf16 v[140:143], a[132:135], v[192:195], v[140:143]
    ds_read_b128 a[144:147], v8 offset:28672
    v_mfma_f32_16x16x32_bf16 v[148:151], a[132:135], v[208:211], v[48:51]
    v_exp_f32 v33, v109
    v_mfma_f32_16x16x32_bf16 v[148:151], a[128:131], v[204:207], v[148:151]
    v_exp_f32 v34, v110
    v_mfma_f32_16x16x32_bf16 v[156:159], a[128:131], v[220:223], v[52:55]
    ds_read_b64_tr_b16 a[176:177], v14 offset:0
    v_cvt_pk_bf16_f32 v60, v32, v33
    v_mfma_f32_16x16x32_bf16 v[156:159], a[132:135], v[224:227], v[156:159]
    v_exp_f32 v35, v111
    v_mfma_f32_16x16x32_bf16 v[164:167], a[132:135], v[240:243], v[56:59]
    ds_read_b64_tr_b16 a[178:179], v14 offset:4096
    v_cvt_pk_bf16_f32 v61, v34, v35
    v_mfma_f32_16x16x32_bf16 v[164:167], a[128:131], v[236:239], v[164:167]
    v_exp_f32 v36, v116
    v_mfma_f32_16x16x32_bf16 a[0:3], a[160:163], v[76:79], 0
    ds_read_b128 a[148:151], v9 offset:28672
    v_mfma_f32_16x16x32_bf16 a[0:3], a[164:167], v[92:95], a[0:3]
    v_exp_f32 v37, v117
    v_mfma_f32_16x16x32_bf16 a[232:235], a[196:199], v[92:95], 0
    ds_read_b64_tr_b16 a[180:181], v14 offset:8192
    v_cvt_pk_bf16_f32 v64, v36, v37
    v_mfma_f32_16x16x32_bf16 a[232:235], a[196:199], v[76:79], a[232:235]
    v_exp_f32 v38, v118
    v_mfma_f32_16x16x32_bf16 a[32:35], a[164:167], v[96:99], 0
    ds_read_b64_tr_b16 a[182:183], v14 offset:12288
    v_mfma_f32_16x16x32_bf16 a[32:35], a[160:163], v[80:83], a[32:35]
    v_exp_f32 v39, v119
    v_mfma_f32_16x16x32_bf16 a[64:67], a[160:163], v[84:87], 0
    v_cvt_pk_bf16_f32 v65, v38, v39
    v_mfma_f32_16x16x32_bf16 a[64:67], a[164:167], v[100:103], a[64:67]
    v_exp_f32 v32, v124
    v_mfma_f32_16x16x32_bf16 a[96:99], a[164:167], v[104:107], 0
    s_waitcnt lgkmcnt(6)
    ds_read_b128 a[152:155], v10 offset:28672
    v_mfma_f32_16x16x32_bf16 a[96:99], a[160:163], v[88:91], a[96:99]
    v_exp_f32 v33, v125
    v_mfma_f32_16x16x32_bf16 v[140:143], a[136:139], v[196:199], v[140:143]
    ds_read_b64_tr_b16 a[184:185], v15 offset:0
    v_cvt_pk_bf16_f32 v68, v32, v33
    v_mfma_f32_16x16x32_bf16 v[140:143], a[140:143], v[200:203], v[140:143]
    v_exp_f32 v34, v126
    v_mfma_f32_16x16x32_bf16 v[148:151], a[140:143], v[216:219], v[148:151]
    ds_read_b64_tr_b16 a[186:187], v15 offset:4096
    v_mfma_f32_16x16x32_bf16 v[148:151], a[136:139], v[212:215], v[148:151]
    v_exp_f32 v35, v127
    v_mfma_f32_16x16x32_bf16 v[156:159], a[136:139], v[228:231], v[156:159]
    v_cvt_pk_bf16_f32 v69, v34, v35
    v_mfma_f32_16x16x32_bf16 v[156:159], a[140:143], v[232:235], v[156:159]
    v_exp_f32 v36, v132
    v_mfma_f32_16x16x32_bf16 v[164:167], a[140:143], v[248:251], v[164:167]
    ds_read_b128 a[156:159], v11 offset:28672
    v_mfma_f32_16x16x32_bf16 v[164:167], a[136:139], v[244:247], v[164:167]
    v_exp_f32 v37, v133
    v_mfma_f32_16x16x32_bf16 a[4:7], a[168:171], v[76:79], 0
    ds_read_b64_tr_b16 a[188:189], v15 offset:8192
    v_cvt_pk_bf16_f32 v72, v36, v37
    v_mfma_f32_16x16x32_bf16 a[4:7], a[172:175], v[92:95], a[4:7]
    v_exp_f32 v38, v134
    v_mfma_f32_16x16x32_bf16 a[36:39], a[172:175], v[96:99], 0
    ds_read_b64_tr_b16 a[190:191], v15 offset:12288
    v_mfma_f32_16x16x32_bf16 a[36:39], a[168:171], v[80:83], a[36:39]
    v_exp_f32 v39, v135
    v_mfma_f32_16x16x32_bf16 a[68:71], a[168:171], v[84:87], 0
    v_cvt_pk_bf16_f32 v73, v38, v39
    v_mfma_f32_16x16x32_bf16 a[68:71], a[172:175], v[100:103], a[68:71]
    v_mfma_f32_16x16x32_bf16 a[100:103], a[172:175], v[104:107], 0
    s_waitcnt lgkmcnt(6)
    v_mfma_f32_16x16x32_bf16 a[100:103], a[168:171], v[88:91], a[100:103]
    v_exp_f32 v32, v112
    v_mfma_f32_16x16x32_bf16 v[144:147], a[144:147], v[188:191], v[44:47]
    s_waitcnt vmcnt(10)
    s_barrier
    v_mfma_f32_16x16x32_bf16 v[144:147], a[148:151], v[192:195], v[144:147]
    v_exp_f32 v33, v113
    v_mfma_f32_16x16x32_bf16 v[152:155], a[148:151], v[208:211], v[48:51]
    ds_read_b128 a[128:131], v8 offset:32768
    v_cvt_pk_bf16_f32 v62, v32, v33
    v_mfma_f32_16x16x32_bf16 v[152:155], a[144:147], v[204:207], v[152:155]
    v_exp_f32 v34, v114
    v_mfma_f32_16x16x32_bf16 v[160:163], a[144:147], v[220:223], v[52:55]
    ds_read_b64_tr_b16 a[160:161], v16 offset:0
    s_add_u32 m0, s38, 0
    v_mfma_f32_16x16x32_bf16 v[160:163], a[148:151], v[224:227], v[160:163]
    v_exp_f32 v35, v115
    v_mfma_f32_16x16x32_bf16 v[168:171], a[148:151], v[240:243], v[56:59]
    v_exp_f32 v36, v120
    v_mfma_f32_16x16x32_bf16 v[168:171], a[144:147], v[236:239], v[168:171]
    ds_read_b64_tr_b16 a[162:163], v16 offset:4096
    s_add_u32 s41, s41, 16384
    v_mfma_f32_16x16x32_bf16 a[8:11], a[176:179], v[76:79], 0
    buffer_store_dwordx4 v[4:7], v3, s[48:51], s53 offen sc1
    v_mfma_f32_16x16x32_bf16 a[8:11], a[180:183], v[92:95], a[8:11]
    v_exp_f32 v37, v121
    v_mfma_f32_16x16x32_bf16 a[40:43], a[180:183], v[96:99], 0
    ds_read_b128 a[132:135], v9 offset:32768
    v_cvt_pk_bf16_f32 v63, v34, v35
    v_mfma_f32_16x16x32_bf16 a[40:43], a[176:179], v[80:83], a[40:43]
    v_exp_f32 v38, v122
    v_mfma_f32_16x16x32_bf16 a[236:239], a[196:199], v[80:83], 0
    v_exp_f32 v39, v123
    v_mfma_f32_16x16x32_bf16 a[236:239], a[196:199], v[96:99], a[236:239]
    ds_read_b64_tr_b16 a[164:165], v16 offset:8192
    s_add_u32 s53, s53, 18432
    v_mfma_f32_16x16x32_bf16 a[72:75], a[176:179], v[84:87], 0
    buffer_load_dwordx4 v20, s[8:11], s41 offen offset:0 nt lds
    v_mfma_f32_16x16x32_bf16 a[72:75], a[180:183], v[100:103], a[72:75]
    v_cvt_pk_bf16_f32 v66, v36, v37
    ds_read_b64_tr_b16 a[166:167], v16 offset:12288
    v_mfma_f32_16x16x32_bf16 a[104:107], a[180:183], v[104:107], 0
    v_exp_f32 v32, v128
    v_mfma_f32_16x16x32_bf16 a[104:107], a[176:179], v[88:91], a[104:107]
    s_waitcnt lgkmcnt(6)
    ds_read_b128 a[136:139], v10 offset:32768
    v_mfma_f32_16x16x32_bf16 v[144:147], a[152:155], v[196:199], v[144:147]
    v_exp_f32 v33, v129
    v_mfma_f32_16x16x32_bf16 v[144:147], a[156:159], v[200:203], v[144:147]
    v_cvt_pk_bf16_f32 v67, v38, v39
    ds_read_b64_tr_b16 a[168:169], v17 offset:0
    v_mfma_f32_16x16x32_bf16 v[152:155], a[156:159], v[216:219], v[152:155]
    v_exp_f32 v34, v130
    v_mfma_f32_16x16x32_bf16 v[152:155], a[152:155], v[212:215], v[152:155]
    buffer_load_dwordx4 v21, s[8:11], s41 offen offset:1024 nt lds
    v_mfma_f32_16x16x32_bf16 v[160:163], a[152:155], v[228:231], v[160:163]
    v_exp_f32 v35, v131
    v_mfma_f32_16x16x32_bf16 v[160:163], a[156:159], v[232:235], v[160:163]
    v_cvt_pk_bf16_f32 v70, v32, v33
    ds_read_b64_tr_b16 a[170:171], v17 offset:4096
    v_mfma_f32_16x16x32_bf16 v[168:171], a[156:159], v[248:251], v[168:171]
    v_exp_f32 v36, v136
    v_mfma_f32_16x16x32_bf16 v[168:171], a[152:155], v[244:247], v[168:171]
    v_exp_f32 v37, v137
    v_mfma_f32_16x16x32_bf16 a[12:15], a[184:187], v[76:79], 0
    ds_read_b128 a[140:143], v11 offset:32768
    v_cvt_pk_bf16_f32 v71, v34, v35
    v_mfma_f32_16x16x32_bf16 a[12:15], a[188:191], v[92:95], a[12:15]
    buffer_load_dwordx4 v22, s[8:11], s41 offen offset:2048 nt lds
    v_mfma_f32_16x16x32_bf16 a[44:47], a[188:191], v[96:99], 0
    v_exp_f32 v38, v138
    v_mfma_f32_16x16x32_bf16 a[44:47], a[184:187], v[80:83], a[44:47]
    v_exp_f32 v39, v139
    v_mfma_f32_16x16x32_bf16 a[76:79], a[184:187], v[84:87], 0
    ds_read_b64_tr_b16 a[172:173], v17 offset:8192
    v_cvt_pk_bf16_f32 v74, v36, v37
    v_mfma_f32_16x16x32_bf16 a[76:79], a[188:191], v[100:103], a[76:79]
    ds_read_b64_tr_b16 a[174:175], v17 offset:12288
    v_cvt_pk_bf16_f32 v75, v38, v39
    v_mfma_f32_16x16x32_bf16 a[108:111], a[188:191], v[104:107], 0
    s_waitcnt lgkmcnt(6)
    v_mfma_f32_16x16x32_bf16 a[108:111], a[184:187], v[88:91], a[108:111]
    buffer_load_dwordx4 v23, s[8:11], s41 offen offset:3072 nt lds
    v_mfma_f32_16x16x32_bf16 v[108:111], a[128:131], v[188:191], v[44:47]
    v_exp_f32 v32, v140
    v_mfma_f32_16x16x32_bf16 v[108:111], a[132:135], v[192:195], v[108:111]
    ds_read_b128 a[144:147], v8 offset:36864
    s_add_u32 m0, s38, 114688
    v_mfma_f32_16x16x32_bf16 v[116:119], a[132:135], v[208:211], v[48:51]
    v_exp_f32 v33, v141
    v_mfma_f32_16x16x32_bf16 v[116:119], a[128:131], v[204:207], v[116:119]
    v_exp_f32 v34, v142
    v_mfma_f32_16x16x32_bf16 v[124:127], a[128:131], v[220:223], v[52:55]
    ds_read_b64_tr_b16 a[176:177], v18 offset:0
    v_cvt_pk_bf16_f32 v28, v32, v33
    v_mfma_f32_16x16x32_bf16 v[124:127], a[132:135], v[224:227], v[124:127]
    v_exp_f32 v35, v143
    v_mfma_f32_16x16x32_bf16 v[132:135], a[132:135], v[240:243], v[56:59]
    ds_read_b64_tr_b16 a[178:179], v18 offset:4096
    s_sub_u32 s42, s41, 16384
    v_mfma_f32_16x16x32_bf16 v[132:135], a[128:131], v[236:239], v[132:135]
    v_exp_f32 v36, v148
    v_mfma_f32_16x16x32_bf16 a[16:19], a[160:163], v[76:79], 0
    ds_read_b128 a[148:151], v9 offset:36864
    v_cvt_pk_bf16_f32 v29, v34, v35
    v_mfma_f32_16x16x32_bf16 a[16:19], a[164:167], v[92:95], a[16:19]
    v_exp_f32 v37, v149
    v_mfma_f32_16x16x32_bf16 a[48:51], a[164:167], v[96:99], 0
    buffer_load_dwordx4 v24, s[12:15], s42 offen offset:0 nt lds
    v_mfma_f32_16x16x32_bf16 a[48:51], a[160:163], v[80:83], a[48:51]
    v_exp_f32 v38, v150
    v_mfma_f32_16x16x32_bf16 a[80:83], a[160:163], v[84:87], 0
    ds_read_b64_tr_b16 a[180:181], v18 offset:8192
    v_cvt_pk_bf16_f32 v40, v36, v37
    v_mfma_f32_16x16x32_bf16 a[80:83], a[164:167], v[100:103], a[80:83]
    v_exp_f32 v39, v151
    v_mfma_f32_16x16x32_bf16 a[240:243], a[196:199], v[100:103], 0
    ds_read_b64_tr_b16 a[182:183], v18 offset:12288
    v_cvt_pk_bf16_f32 v41, v38, v39
    v_mfma_f32_16x16x32_bf16 a[240:243], a[196:199], v[84:87], a[240:243]
    v_exp_f32 v32, v156
    v_mfma_f32_16x16x32_bf16 a[112:115], a[164:167], v[104:107], 0
    s_waitcnt lgkmcnt(6)
    ds_read_b128 a[152:155], v10 offset:36864
    v_mfma_f32_16x16x32_bf16 a[112:115], a[160:163], v[88:91], a[112:115]
    v_exp_f32 v33, v157
    v_mfma_f32_16x16x32_bf16 v[108:111], a[136:139], v[196:199], v[108:111]
    ds_read_b64_tr_b16 a[184:185], v19 offset:0
    v_cvt_pk_bf16_f32 v172, v32, v33
    v_mfma_f32_16x16x32_bf16 v[108:111], a[140:143], v[200:203], v[108:111]
    v_exp_f32 v34, v158
    v_mfma_f32_16x16x32_bf16 v[116:119], a[140:143], v[216:219], v[116:119]
    buffer_load_dwordx4 v25, s[12:15], s42 offen offset:1024 nt lds
    v_mfma_f32_16x16x32_bf16 v[116:119], a[136:139], v[212:215], v[116:119]
    v_exp_f32 v35, v159
    v_mfma_f32_16x16x32_bf16 v[124:127], a[136:139], v[228:231], v[124:127]
    ds_read_b64_tr_b16 a[186:187], v19 offset:4096
    v_cvt_pk_bf16_f32 v173, v34, v35
    v_mfma_f32_16x16x32_bf16 v[124:127], a[140:143], v[232:235], v[124:127]
    v_exp_f32 v36, v164
    v_mfma_f32_16x16x32_bf16 v[132:135], a[140:143], v[248:251], v[132:135]
    ds_read_b128 a[156:159], v11 offset:36864
    v_mfma_f32_16x16x32_bf16 v[132:135], a[136:139], v[244:247], v[132:135]
    v_exp_f32 v37, v165
    v_mfma_f32_16x16x32_bf16 a[20:23], a[168:171], v[76:79], 0
    ds_read_b64_tr_b16 a[188:189], v19 offset:8192
    v_cvt_pk_bf16_f32 v176, v36, v37
    v_mfma_f32_16x16x32_bf16 a[20:23], a[172:175], v[92:95], a[20:23]
    v_exp_f32 v38, v166
    v_mfma_f32_16x16x32_bf16 a[52:55], a[172:175], v[96:99], 0
    ds_read_b64_tr_b16 a[190:191], v19 offset:12288
    v_mfma_f32_16x16x32_bf16 a[52:55], a[168:171], v[80:83], a[52:55]
    v_exp_f32 v39, v167
    v_mfma_f32_16x16x32_bf16 a[84:87], a[168:171], v[84:87], 0
    v_cvt_pk_bf16_f32 v177, v38, v39
    v_mfma_f32_16x16x32_bf16 a[84:87], a[172:175], v[100:103], a[84:87]
    buffer_load_dwordx4 v24, s[12:15], s42 offen offset:2048 nt lds
    v_mfma_f32_16x16x32_bf16 a[116:119], a[172:175], v[104:107], 0
    s_waitcnt lgkmcnt(6)
    ds_read_b128 a[128:131], v8 offset:40960
    v_mfma_f32_16x16x32_bf16 a[116:119], a[168:171], v[88:91], a[116:119]
    v_exp_f32 v32, v144
    v_mfma_f32_16x16x32_bf16 v[112:115], a[144:147], v[188:191], v[44:47]
    v_exp_f32 v33, v145
    v_mfma_f32_16x16x32_bf16 v[112:115], a[148:151], v[192:195], v[112:115]
    ds_read_b64_tr_b16 a[160:161], v12 offset:16384
    v_cvt_pk_bf16_f32 v30, v32, v33
    v_mfma_f32_16x16x32_bf16 v[120:123], a[148:151], v[208:211], v[48:51]
    v_exp_f32 v34, v146
    v_mfma_f32_16x16x32_bf16 v[120:123], a[144:147], v[204:207], v[120:123]
    ds_read_b64_tr_b16 a[162:163], v12 offset:20480
    v_mfma_f32_16x16x32_bf16 v[128:131], a[144:147], v[220:223], v[52:55]
    v_exp_f32 v35, v147
    v_mfma_f32_16x16x32_bf16 v[128:131], a[148:151], v[224:227], v[128:131]
    v_cvt_pk_bf16_f32 v31, v34, v35
    v_mfma_f32_16x16x32_bf16 v[136:139], a[148:151], v[240:243], v[56:59]
    v_exp_f32 v36, v152
    v_mfma_f32_16x16x32_bf16 v[136:139], a[144:147], v[236:239], v[136:139]
    ds_read_b128 a[132:135], v9 offset:40960
    v_mfma_f32_16x16x32_bf16 a[24:27], a[176:179], v[76:79], 0
    v_exp_f32 v37, v153
    v_mfma_f32_16x16x32_bf16 a[24:27], a[180:183], v[92:95], a[24:27]
    ds_read_b64_tr_b16 a[164:165], v12 offset:24576
    v_cvt_pk_bf16_f32 v42, v36, v37
    v_mfma_f32_16x16x32_bf16 a[56:59], a[180:183], v[96:99], 0
    v_exp_f32 v38, v154
    v_mfma_f32_16x16x32_bf16 a[56:59], a[176:179], v[80:83], a[56:59]
    ds_read_b64_tr_b16 a[166:167], v12 offset:28672
    v_mfma_f32_16x16x32_bf16 a[88:91], a[176:179], v[84:87], 0
    v_exp_f32 v39, v155
    v_mfma_f32_16x16x32_bf16 a[88:91], a[180:183], v[100:103], a[88:91]
    buffer_load_dwordx4 v25, s[12:15], s42 offen offset:3072 nt lds
    v_mfma_f32_16x16x32_bf16 a[120:123], a[180:183], v[104:107], 0
    v_exp_f32 v32, v160
    v_mfma_f32_16x16x32_bf16 a[120:123], a[176:179], v[88:91], a[120:123]
    v_cvt_pk_bf16_f32 v43, v38, v39
    v_mfma_f32_16x16x32_bf16 a[244:247], a[196:199], v[88:91], 0
    s_waitcnt lgkmcnt(6)
    ds_read_b128 a[136:139], v10 offset:40960
    v_mfma_f32_16x16x32_bf16 a[244:247], a[196:199], v[104:107], a[244:247]
    v_exp_f32 v33, v161
    v_mfma_f32_16x16x32_bf16 v[112:115], a[152:155], v[196:199], v[112:115]
    v_exp_f32 v34, v162
    v_mfma_f32_16x16x32_bf16 v[112:115], a[156:159], v[200:203], v[112:115]
    ds_read_b64_tr_b16 a[168:169], v13 offset:16384
    v_cvt_pk_bf16_f32 v174, v32, v33
    v_mfma_f32_16x16x32_bf16 v[120:123], a[156:159], v[216:219], v[120:123]
    v_exp_f32 v35, v163
    v_mfma_f32_16x16x32_bf16 v[120:123], a[152:155], v[212:215], v[120:123]
    ds_read_b64_tr_b16 a[170:171], v13 offset:20480
    v_cvt_pk_bf16_f32 v175, v34, v35
    v_mfma_f32_16x16x32_bf16 v[128:131], a[152:155], v[228:231], v[128:131]
    v_exp_f32 v36, v168
    v_mfma_f32_16x16x32_bf16 v[128:131], a[156:159], v[232:235], v[128:131]
    v_mfma_f32_16x16x32_bf16 v[136:139], a[156:159], v[248:251], v[136:139]
    v_exp_f32 v37, v169
    v_mfma_f32_16x16x32_bf16 v[136:139], a[152:155], v[244:247], v[136:139]
    ds_read_b128 a[140:143], v11 offset:40960
    v_cvt_pk_bf16_f32 v178, v36, v37
    v_mfma_f32_16x16x32_bf16 a[28:31], a[184:187], v[76:79], 0
    v_exp_f32 v38, v170
    v_mfma_f32_16x16x32_bf16 a[28:31], a[188:191], v[92:95], a[28:31]
    ds_read_b64_tr_b16 a[172:173], v13 offset:24576
    v_mfma_f32_16x16x32_bf16 a[60:63], a[188:191], v[96:99], 0
    v_exp_f32 v39, v171
    v_mfma_f32_16x16x32_bf16 a[60:63], a[184:187], v[80:83], a[60:63]
    buffer_load_dword v184, v186, s[60:63], s39 offen
    v_mfma_f32_16x16x32_bf16 a[92:95], a[184:187], v[84:87], 0
    ds_read_b64_tr_b16 a[174:175], v13 offset:28672
    v_cvt_pk_bf16_f32 v179, v38, v39
    v_mfma_f32_16x16x32_bf16 a[92:95], a[188:191], v[100:103], a[92:95]
    v_mfma_f32_16x16x32_bf16 a[124:127], a[188:191], v[104:107], 0
    s_waitcnt lgkmcnt(6)
    v_mfma_f32_16x16x32_bf16 a[124:127], a[184:187], v[88:91], a[124:127]
    s_branch L_attn_mid
.p2align 6
L_attn_loop:
    v_mfma_f32_16x16x32_bf16 v[140:143], a[128:131], v[188:191], v[44:47]
    v_exp_f32 v32, v108
    v_mfma_f32_16x16x32_bf16 v[140:143], a[132:135], v[192:195], v[140:143]
    ds_read_b128 a[144:147], v8 offset:28672
    v_mfma_f32_16x16x32_bf16 v[148:151], a[132:135], v[208:211], v[48:51]
    v_exp_f32 v33, v109
    v_mfma_f32_16x16x32_bf16 v[148:151], a[128:131], v[204:207], v[148:151]
    v_exp_f32 v34, v110
    v_mfma_f32_16x16x32_bf16 v[156:159], a[128:131], v[220:223], v[52:55]
    ds_read_b64_tr_b16 a[176:177], v14 offset:0
    v_cvt_pk_bf16_f32 v60, v32, v33
    v_mfma_f32_16x16x32_bf16 v[156:159], a[132:135], v[224:227], v[156:159]
    v_exp_f32 v35, v111
    v_mfma_f32_16x16x32_bf16 v[164:167], a[132:135], v[240:243], v[56:59]
    ds_read_b64_tr_b16 a[178:179], v14 offset:4096
    v_cvt_pk_bf16_f32 v61, v34, v35
    v_mfma_f32_16x16x32_bf16 v[164:167], a[128:131], v[236:239], v[164:167]
    v_exp_f32 v36, v116
    v_mfma_f32_16x16x32_bf16 a[0:3], a[160:163], v[76:79], a[0:3]
    ds_read_b128 a[148:151], v9 offset:28672
    v_mfma_f32_16x16x32_bf16 a[0:3], a[164:167], v[92:95], a[0:3]
    v_exp_f32 v37, v117
    v_mfma_f32_16x16x32_bf16 a[232:235], a[196:199], v[92:95], a[232:235]
    ds_read_b64_tr_b16 a[180:181], v14 offset:8192
    v_cvt_pk_bf16_f32 v64, v36, v37
    v_mfma_f32_16x16x32_bf16 a[232:235], a[196:199], v[76:79], a[232:235]
    v_exp_f32 v38, v118
    v_mfma_f32_16x16x32_bf16 a[32:35], a[164:167], v[96:99], a[32:35]
    ds_read_b64_tr_b16 a[182:183], v14 offset:12288
    v_mfma_f32_16x16x32_bf16 a[32:35], a[160:163], v[80:83], a[32:35]
    v_exp_f32 v39, v119
    v_mfma_f32_16x16x32_bf16 a[64:67], a[160:163], v[84:87], a[64:67]
    v_cvt_pk_bf16_f32 v65, v38, v39
    v_mfma_f32_16x16x32_bf16 a[64:67], a[164:167], v[100:103], a[64:67]
    v_exp_f32 v32, v124
    v_mfma_f32_16x16x32_bf16 a[96:99], a[164:167], v[104:107], a[96:99]
    s_waitcnt lgkmcnt(6)
    ds_read_b128 a[152:155], v10 offset:28672
    v_mfma_f32_16x16x32_bf16 a[96:99], a[160:163], v[88:91], a[96:99]
    v_exp_f32 v33, v125
    v_mfma_f32_16x16x32_bf16 v[140:143], a[136:139], v[196:199], v[140:143]
    ds_read_b64_tr_b16 a[184:185], v15 offset:0
    v_cvt_pk_bf16_f32 v68, v32, v33
    v_mfma_f32_16x16x32_bf16 v[140:143], a[140:143], v[200:203], v[140:143]
    v_exp_f32 v34, v126
    v_mfma_f32_16x16x32_bf16 v[148:151], a[140:143], v[216:219], v[148:151]
    ds_read_b64_tr_b16 a[186:187], v15 offset:4096
    v_mfma_f32_16x16x32_bf16 v[148:151], a[136:139], v[212:215], v[148:151]
    v_exp_f32 v35, v127
    v_mfma_f32_16x16x32_bf16 v[156:159], a[136:139], v[228:231], v[156:159]
    v_cvt_pk_bf16_f32 v69, v34, v35
    v_mfma_f32_16x16x32_bf16 v[156:159], a[140:143], v[232:235], v[156:159]
    v_exp_f32 v36, v132
    v_mfma_f32_16x16x32_bf16 v[164:167], a[140:143], v[248:251], v[164:167]
    ds_read_b128 a[156:159], v11 offset:28672
    v_mfma_f32_16x16x32_bf16 v[164:167], a[136:139], v[244:247], v[164:167]
    v_exp_f32 v37, v133
    v_mfma_f32_16x16x32_bf16 a[4:7], a[168:171], v[76:79], a[4:7]
    ds_read_b64_tr_b16 a[188:189], v15 offset:8192
    v_cvt_pk_bf16_f32 v72, v36, v37
    v_mfma_f32_16x16x32_bf16 a[4:7], a[172:175], v[92:95], a[4:7]
    v_exp_f32 v38, v134
    v_mfma_f32_16x16x32_bf16 a[36:39], a[172:175], v[96:99], a[36:39]
    ds_read_b64_tr_b16 a[190:191], v15 offset:12288
    v_mfma_f32_16x16x32_bf16 a[36:39], a[168:171], v[80:83], a[36:39]
    v_exp_f32 v39, v135
    v_mfma_f32_16x16x32_bf16 a[68:71], a[168:171], v[84:87], a[68:71]
    v_cvt_pk_bf16_f32 v73, v38, v39
    v_mfma_f32_16x16x32_bf16 a[68:71], a[172:175], v[100:103], a[68:71]
    v_mfma_f32_16x16x32_bf16 a[100:103], a[172:175], v[104:107], a[100:103]
    s_waitcnt lgkmcnt(6)
    v_mfma_f32_16x16x32_bf16 a[100:103], a[168:171], v[88:91], a[100:103]
    v_exp_f32 v32, v112
    v_mfma_f32_16x16x32_bf16 v[144:147], a[144:147], v[188:191], v[44:47]
    s_waitcnt vmcnt(12)
    s_barrier
    v_mfma_f32_16x16x32_bf16 v[144:147], a[148:151], v[192:195], v[144:147]
    v_exp_f32 v33, v113
    v_mfma_f32_16x16x32_bf16 v[152:155], a[148:151], v[208:211], v[48:51]
    ds_read_b128 a[128:131], v8 offset:32768
    v_cvt_pk_bf16_f32 v62, v32, v33
    v_mfma_f32_16x16x32_bf16 v[152:155], a[144:147], v[204:207], v[152:155]
    v_exp_f32 v34, v114
    v_mfma_f32_16x16x32_bf16 v[160:163], a[144:147], v[220:223], v[52:55]
    ds_read_b64_tr_b16 a[160:161], v16 offset:0
    s_add_u32 m0, s38, 0
    v_mfma_f32_16x16x32_bf16 v[160:163], a[148:151], v[224:227], v[160:163]
    v_exp_f32 v35, v115
    v_mfma_f32_16x16x32_bf16 v[168:171], a[148:151], v[240:243], v[56:59]
    v_exp_f32 v36, v120
    v_mfma_f32_16x16x32_bf16 v[168:171], a[144:147], v[236:239], v[168:171]
    ds_read_b64_tr_b16 a[162:163], v16 offset:4096
    s_add_u32 s41, s41, 16384
    v_mfma_f32_16x16x32_bf16 a[8:11], a[176:179], v[76:79], a[8:11]
    buffer_store_dwordx4 v[4:7], v3, s[48:51], s53 offen sc1
    v_mfma_f32_16x16x32_bf16 a[8:11], a[180:183], v[92:95], a[8:11]
    v_exp_f32 v37, v121
    v_mfma_f32_16x16x32_bf16 a[40:43], a[180:183], v[96:99], a[40:43]
    ds_read_b128 a[132:135], v9 offset:32768
    v_cvt_pk_bf16_f32 v63, v34, v35
    v_mfma_f32_16x16x32_bf16 a[40:43], a[176:179], v[80:83], a[40:43]
    v_exp_f32 v38, v122
    v_mfma_f32_16x16x32_bf16 a[236:239], a[196:199], v[80:83], a[236:239]
    v_exp_f32 v39, v123
    v_mfma_f32_16x16x32_bf16 a[236:239], a[196:199], v[96:99], a[236:239]
    ds_read_b64_tr_b16 a[164:165], v16 offset:8192
    s_add_u32 s53, s53, 18432
    v_mfma_f32_16x16x32_bf16 a[72:75], a[176:179], v[84:87], a[72:75]
    buffer_load_dwordx4 v20, s[8:11], s41 offen offset:0 nt lds
    v_mfma_f32_16x16x32_bf16 a[72:75], a[180:183], v[100:103], a[72:75]
    v_cvt_pk_bf16_f32 v66, v36, v37
    ds_read_b64_tr_b16 a[166:167], v16 offset:12288
    v_mfma_f32_16x16x32_bf16 a[104:107], a[180:183], v[104:107], a[104:107]
    v_exp_f32 v32, v128
    v_mfma_f32_16x16x32_bf16 a[104:107], a[176:179], v[88:91], a[104:107]
    s_waitcnt lgkmcnt(6)
    ds_read_b128 a[136:139], v10 offset:32768
    v_mfma_f32_16x16x32_bf16 v[144:147], a[152:155], v[196:199], v[144:147]
    v_exp_f32 v33, v129
    v_mfma_f32_16x16x32_bf16 v[144:147], a[156:159], v[200:203], v[144:147]
    v_cvt_pk_bf16_f32 v67, v38, v39
    ds_read_b64_tr_b16 a[168:169], v17 offset:0
    v_mfma_f32_16x16x32_bf16 v[152:155], a[156:159], v[216:219], v[152:155]
    v_exp_f32 v34, v130
    v_mfma_f32_16x16x32_bf16 v[152:155], a[152:155], v[212:215], v[152:155]
    buffer_load_dwordx4 v21, s[8:11], s41 offen offset:1024 nt lds
    v_mfma_f32_16x16x32_bf16 v[160:163], a[152:155], v[228:231], v[160:163]
    v_exp_f32 v35, v131
    v_mfma_f32_16x16x32_bf16 v[160:163], a[156:159], v[232:235], v[160:163]
    v_cvt_pk_bf16_f32 v70, v32, v33
    ds_read_b64_tr_b16 a[170:171], v17 offset:4096
    v_mfma_f32_16x16x32_bf16 v[168:171], a[156:159], v[248:251], v[168:171]
    v_exp_f32 v36, v136
    v_mfma_f32_16x16x32_bf16 v[168:171], a[152:155], v[244:247], v[168:171]
    v_exp_f32 v37, v137
    v_mfma_f32_16x16x32_bf16 a[12:15], a[184:187], v[76:79], a[12:15]
    ds_read_b128 a[140:143], v11 offset:32768
    v_cvt_pk_bf16_f32 v71, v34, v35
    v_mfma_f32_16x16x32_bf16 a[12:15], a[188:191], v[92:95], a[12:15]
    buffer_load_dwordx4 v22, s[8:11], s41 offen offset:2048 nt lds
    v_mfma_f32_16x16x32_bf16 a[44:47], a[188:191], v[96:99], a[44:47]
    v_exp_f32 v38, v138
    v_mfma_f32_16x16x32_bf16 a[44:47], a[184:187], v[80:83], a[44:47]
    v_exp_f32 v39, v139
    v_mfma_f32_16x16x32_bf16 a[76:79], a[184:187], v[84:87], a[76:79]
    ds_read_b64_tr_b16 a[172:173], v17 offset:8192
    v_cvt_pk_bf16_f32 v74, v36, v37
    v_mfma_f32_16x16x32_bf16 a[76:79], a[188:191], v[100:103], a[76:79]
    ds_read_b64_tr_b16 a[174:175], v17 offset:12288
    v_cvt_pk_bf16_f32 v75, v38, v39
    v_mfma_f32_16x16x32_bf16 a[108:111], a[188:191], v[104:107], a[108:111]
    s_waitcnt lgkmcnt(6)
    v_mfma_f32_16x16x32_bf16 a[108:111], a[184:187], v[88:91], a[108:111]
    buffer_load_dwordx4 v23, s[8:11], s41 offen offset:3072 nt lds
    v_mfma_f32_16x16x32_bf16 v[108:111], a[128:131], v[188:191], v[44:47]
    v_exp_f32 v32, v140
    v_mfma_f32_16x16x32_bf16 v[108:111], a[132:135], v[192:195], v[108:111]
    ds_read_b128 a[144:147], v8 offset:36864
    s_add_u32 m0, s38, 114688
    v_mfma_f32_16x16x32_bf16 v[116:119], a[132:135], v[208:211], v[48:51]
    v_exp_f32 v33, v141
    v_mfma_f32_16x16x32_bf16 v[116:119], a[128:131], v[204:207], v[116:119]
    v_exp_f32 v34, v142
    v_mfma_f32_16x16x32_bf16 v[124:127], a[128:131], v[220:223], v[52:55]
    ds_read_b64_tr_b16 a[176:177], v18 offset:0
    v_cvt_pk_bf16_f32 v28, v32, v33
    v_mfma_f32_16x16x32_bf16 v[124:127], a[132:135], v[224:227], v[124:127]
    v_exp_f32 v35, v143
    v_mfma_f32_16x16x32_bf16 v[132:135], a[132:135], v[240:243], v[56:59]
    ds_read_b64_tr_b16 a[178:179], v18 offset:4096
    s_sub_u32 s42, s41, 16384
    v_mfma_f32_16x16x32_bf16 v[132:135], a[128:131], v[236:239], v[132:135]
    v_exp_f32 v36, v148
    v_mfma_f32_16x16x32_bf16 a[16:19], a[160:163], v[76:79], a[16:19]
    ds_read_b128 a[148:151], v9 offset:36864
    v_cvt_pk_bf16_f32 v29, v34, v35
    v_mfma_f32_16x16x32_bf16 a[16:19], a[164:167], v[92:95], a[16:19]
    v_exp_f32 v37, v149
    v_mfma_f32_16x16x32_bf16 a[48:51], a[164:167], v[96:99], a[48:51]
    buffer_load_dwordx4 v24, s[12:15], s42 offen offset:0 nt lds
    v_mfma_f32_16x16x32_bf16 a[48:51], a[160:163], v[80:83], a[48:51]
    v_exp_f32 v38, v150
    v_mfma_f32_16x16x32_bf16 a[80:83], a[160:163], v[84:87], a[80:83]
    ds_read_b64_tr_b16 a[180:181], v18 offset:8192
    v_cvt_pk_bf16_f32 v40, v36, v37
    v_mfma_f32_16x16x32_bf16 a[80:83], a[164:167], v[100:103], a[80:83]
    v_exp_f32 v39, v151
    v_mfma_f32_16x16x32_bf16 a[240:243], a[196:199], v[100:103], a[240:243]
    ds_read_b64_tr_b16 a[182:183], v18 offset:12288
    v_cvt_pk_bf16_f32 v41, v38, v39
    v_mfma_f32_16x16x32_bf16 a[240:243], a[196:199], v[84:87], a[240:243]
    v_exp_f32 v32, v156
    v_mfma_f32_16x16x32_bf16 a[112:115], a[164:167], v[104:107], a[112:115]
    s_waitcnt lgkmcnt(6)
    ds_read_b128 a[152:155], v10 offset:36864
    v_mfma_f32_16x16x32_bf16 a[112:115], a[160:163], v[88:91], a[112:115]
    v_exp_f32 v33, v157
    v_mfma_f32_16x16x32_bf16 v[108:111], a[136:139], v[196:199], v[108:111]
    ds_read_b64_tr_b16 a[184:185], v19 offset:0
    v_cvt_pk_bf16_f32 v172, v32, v33
    v_mfma_f32_16x16x32_bf16 v[108:111], a[140:143], v[200:203], v[108:111]
    v_exp_f32 v34, v158
    v_mfma_f32_16x16x32_bf16 v[116:119], a[140:143], v[216:219], v[116:119]
    buffer_load_dwordx4 v25, s[12:15], s42 offen offset:1024 nt lds
    v_mfma_f32_16x16x32_bf16 v[116:119], a[136:139], v[212:215], v[116:119]
    v_exp_f32 v35, v159
    v_mfma_f32_16x16x32_bf16 v[124:127], a[136:139], v[228:231], v[124:127]
    ds_read_b64_tr_b16 a[186:187], v19 offset:4096
    v_cvt_pk_bf16_f32 v173, v34, v35
    v_mfma_f32_16x16x32_bf16 v[124:127], a[140:143], v[232:235], v[124:127]
    v_exp_f32 v36, v164
    v_mfma_f32_16x16x32_bf16 v[132:135], a[140:143], v[248:251], v[132:135]
    ds_read_b128 a[156:159], v11 offset:36864
    v_mfma_f32_16x16x32_bf16 v[132:135], a[136:139], v[244:247], v[132:135]
    v_exp_f32 v37, v165
    v_mfma_f32_16x16x32_bf16 a[20:23], a[168:171], v[76:79], a[20:23]
    ds_read_b64_tr_b16 a[188:189], v19 offset:8192
    v_cvt_pk_bf16_f32 v176, v36, v37
    v_mfma_f32_16x16x32_bf16 a[20:23], a[172:175], v[92:95], a[20:23]
    v_exp_f32 v38, v166
    v_mfma_f32_16x16x32_bf16 a[52:55], a[172:175], v[96:99], a[52:55]
    ds_read_b64_tr_b16 a[190:191], v19 offset:12288
    v_mfma_f32_16x16x32_bf16 a[52:55], a[168:171], v[80:83], a[52:55]
    v_exp_f32 v39, v167
    v_mfma_f32_16x16x32_bf16 a[84:87], a[168:171], v[84:87], a[84:87]
    v_cvt_pk_bf16_f32 v177, v38, v39
    v_mfma_f32_16x16x32_bf16 a[84:87], a[172:175], v[100:103], a[84:87]
    buffer_load_dwordx4 v24, s[12:15], s42 offen offset:2048 nt lds
    v_mfma_f32_16x16x32_bf16 a[116:119], a[172:175], v[104:107], a[116:119]
    s_waitcnt lgkmcnt(6)
    ds_read_b128 a[128:131], v8 offset:40960
    v_mfma_f32_16x16x32_bf16 a[116:119], a[168:171], v[88:91], a[116:119]
    v_exp_f32 v32, v144
    v_mfma_f32_16x16x32_bf16 v[112:115], a[144:147], v[188:191], v[44:47]
    v_exp_f32 v33, v145
    v_mfma_f32_16x16x32_bf16 v[112:115], a[148:151], v[192:195], v[112:115]
    ds_read_b64_tr_b16 a[160:161], v12 offset:16384
    v_cvt_pk_bf16_f32 v30, v32, v33
    v_mfma_f32_16x16x32_bf16 v[120:123], a[148:151], v[208:211], v[48:51]
    v_exp_f32 v34, v146
    v_mfma_f32_16x16x32_bf16 v[120:123], a[144:147], v[204:207], v[120:123]
    ds_read_b64_tr_b16 a[162:163], v12 offset:20480
    v_mfma_f32_16x16x32_bf16 v[128:131], a[144:147], v[220:223], v[52:55]
    v_exp_f32 v35, v147
    v_mfma_f32_16x16x32_bf16 v[128:131], a[148:151], v[224:227], v[128:131]
    v_cvt_pk_bf16_f32 v31, v34, v35
    v_mfma_f32_16x16x32_bf16 v[136:139], a[148:151], v[240:243], v[56:59]
    v_exp_f32 v36, v152
    v_mfma_f32_16x16x32_bf16 v[136:139], a[144:147], v[236:239], v[136:139]
    ds_read_b128 a[132:135], v9 offset:40960
    v_mfma_f32_16x16x32_bf16 a[24:27], a[176:179], v[76:79], a[24:27]
    v_exp_f32 v37, v153
    v_mfma_f32_16x16x32_bf16 a[24:27], a[180:183], v[92:95], a[24:27]
    ds_read_b64_tr_b16 a[164:165], v12 offset:24576
    v_cvt_pk_bf16_f32 v42, v36, v37
    v_mfma_f32_16x16x32_bf16 a[56:59], a[180:183], v[96:99], a[56:59]
    v_exp_f32 v38, v154
    v_mfma_f32_16x16x32_bf16 a[56:59], a[176:179], v[80:83], a[56:59]
    ds_read_b64_tr_b16 a[166:167], v12 offset:28672
    v_mfma_f32_16x16x32_bf16 a[88:91], a[176:179], v[84:87], a[88:91]
    v_exp_f32 v39, v155
    v_mfma_f32_16x16x32_bf16 a[88:91], a[180:183], v[100:103], a[88:91]
    buffer_load_dwordx4 v25, s[12:15], s42 offen offset:3072 nt lds
    v_mfma_f32_16x16x32_bf16 a[120:123], a[180:183], v[104:107], a[120:123]
    v_exp_f32 v32, v160
    v_mfma_f32_16x16x32_bf16 a[120:123], a[176:179], v[88:91], a[120:123]
    v_cvt_pk_bf16_f32 v43, v38, v39
    v_mfma_f32_16x16x32_bf16 a[244:247], a[196:199], v[88:91], a[244:247]
    s_waitcnt lgkmcnt(6)
    ds_read_b128 a[136:139], v10 offset:40960
    v_mfma_f32_16x16x32_bf16 a[244:247], a[196:199], v[104:107], a[244:247]
    v_exp_f32 v33, v161
    v_mfma_f32_16x16x32_bf16 v[112:115], a[152:155], v[196:199], v[112:115]
    v_exp_f32 v34, v162
    v_mfma_f32_16x16x32_bf16 v[112:115], a[156:159], v[200:203], v[112:115]
    ds_read_b64_tr_b16 a[168:169], v13 offset:16384
    v_cvt_pk_bf16_f32 v174, v32, v33
    v_mfma_f32_16x16x32_bf16 v[120:123], a[156:159], v[216:219], v[120:123]
    v_exp_f32 v35, v163
    v_mfma_f32_16x16x32_bf16 v[120:123], a[152:155], v[212:215], v[120:123]
    ds_read_b64_tr_b16 a[170:171], v13 offset:20480
    v_cvt_pk_bf16_f32 v175, v34, v35
    v_mfma_f32_16x16x32_bf16 v[128:131], a[152:155], v[228:231], v[128:131]
    v_exp_f32 v36, v168
    v_mfma_f32_16x16x32_bf16 v[128:131], a[156:159], v[232:235], v[128:131]
    v_mfma_f32_16x16x32_bf16 v[136:139], a[156:159], v[248:251], v[136:139]
    v_exp_f32 v37, v169
    v_mfma_f32_16x16x32_bf16 v[136:139], a[152:155], v[244:247], v[136:139]
    ds_read_b128 a[140:143], v11 offset:40960
    v_cvt_pk_bf16_f32 v178, v36, v37
    v_mfma_f32_16x16x32_bf16 a[28:31], a[184:187], v[76:79], a[28:31]
    v_exp_f32 v38, v170
    v_mfma_f32_16x16x32_bf16 a[28:31], a[188:191], v[92:95], a[28:31]
    ds_read_b64_tr_b16 a[172:173], v13 offset:24576
    v_mfma_f32_16x16x32_bf16 a[60:63], a[188:191], v[96:99], a[60:63]
    v_exp_f32 v39, v171
    v_mfma_f32_16x16x32_bf16 a[60:63], a[184:187], v[80:83], a[60:63]
    buffer_load_dword v184, v186, s[60:63], s39 offen
    v_mfma_f32_16x16x32_bf16 a[92:95], a[184:187], v[84:87], a[92:95]
    ds_read_b64_tr_b16 a[174:175], v13 offset:28672
    v_cvt_pk_bf16_f32 v179, v38, v39
    v_mfma_f32_16x16x32_bf16 a[92:95], a[188:191], v[100:103], a[92:95]
    v_mfma_f32_16x16x32_bf16 a[124:127], a[188:191], v[104:107], a[124:127]
    s_waitcnt lgkmcnt(6)
    v_mfma_f32_16x16x32_bf16 a[124:127], a[184:187], v[88:91], a[124:127]
L_attn_mid:
    v_mfma_f32_16x16x32_bf16 v[140:143], a[128:131], v[188:191], v[44:47]
    v_exp_f32 v32, v108
    v_mfma_f32_16x16x32_bf16 v[140:143], a[132:135], v[192:195], v[140:143]
    ds_read_b128 a[144:147], v8 offset:45056
    v_mfma_f32_16x16x32_bf16 v[148:151], a[132:135], v[208:211], v[48:51]
    v_exp_f32 v33, v109
    v_mfma_f32_16x16x32_bf16 v[148:151], a[128:131], v[204:207], v[148:151]
    v_exp_f32 v34, v110
    v_mfma_f32_16x16x32_bf16 v[156:159], a[128:131], v[220:223], v[52:55]
    ds_read_b64_tr_b16 a[176:177], v14 offset:16384
    v_cvt_pk_bf16_f32 v76, v32, v33
    v_mfma_f32_16x16x32_bf16 v[156:159], a[132:135], v[224:227], v[156:159]
    v_exp_f32 v35, v111
    v_mfma_f32_16x16x32_bf16 v[164:167], a[132:135], v[240:243], v[56:59]
    ds_read_b64_tr_b16 a[178:179], v14 offset:20480
    v_cvt_pk_bf16_f32 v77, v34, v35
    v_mfma_f32_16x16x32_bf16 v[164:167], a[128:131], v[236:239], v[164:167]
    v_exp_f32 v36, v116
    v_mfma_f32_16x16x32_bf16 a[0:3], a[160:163], v[60:63], a[0:3]
    ds_read_b128 a[148:151], v9 offset:45056
    v_mfma_f32_16x16x32_bf16 a[0:3], a[164:167], v[28:31], a[0:3]
    v_exp_f32 v37, v117
    v_mfma_f32_16x16x32_bf16 a[232:235], a[196:199], v[28:31], a[232:235]
    buffer_load_dwordx2 v[184:185], v255, s[72:75], s37 offen
    v_mfma_f32_16x16x32_bf16 a[232:235], a[196:199], v[60:63], a[232:235]
    v_exp_f32 v38, v118
    v_mfma_f32_16x16x32_bf16 a[32:35], a[164:167], v[40:43], a[32:35]
    ds_read_b64_tr_b16 a[180:181], v14 offset:24576
    v_cvt_pk_bf16_f32 v80, v36, v37
    v_mfma_f32_16x16x32_bf16 a[32:35], a[160:163], v[64:67], a[32:35]
    v_exp_f32 v39, v119
    v_mfma_f32_16x16x32_bf16 a[64:67], a[160:163], v[68:71], a[64:67]
    ds_read_b64_tr_b16 a[182:183], v14 offset:28672
    v_cvt_pk_bf16_f32 v81, v38, v39
    v_mfma_f32_16x16x32_bf16 a[64:67], a[164:167], v[172:175], a[64:67]
    v_exp_f32 v32, v124
    v_mfma_f32_16x16x32_bf16 a[96:99], a[164:167], v[176:179], a[96:99]
    s_waitcnt lgkmcnt(6)
    ds_read_b128 a[152:155], v10 offset:45056
    v_mfma_f32_16x16x32_bf16 a[96:99], a[160:163], v[72:75], a[96:99]
    v_exp_f32 v33, v125
    v_mfma_f32_16x16x32_bf16 v[140:143], a[136:139], v[196:199], v[140:143]
    ds_read_b64_tr_b16 a[184:185], v15 offset:16384
    v_cvt_pk_bf16_f32 v84, v32, v33
    v_mfma_f32_16x16x32_bf16 v[140:143], a[140:143], v[200:203], v[140:143]
    v_exp_f32 v34, v126
    v_mfma_f32_16x16x32_bf16 v[148:151], a[140:143], v[216:219], v[148:151]
    ds_read_b64_tr_b16 a[186:187], v15 offset:20480
    v_mfma_f32_16x16x32_bf16 v[148:151], a[136:139], v[212:215], v[148:151]
    v_exp_f32 v35, v127
    v_mfma_f32_16x16x32_bf16 v[156:159], a[136:139], v[228:231], v[156:159]
    v_cvt_pk_bf16_f32 v85, v34, v35
    v_mfma_f32_16x16x32_bf16 v[156:159], a[140:143], v[232:235], v[156:159]
    v_exp_f32 v36, v132
    v_mfma_f32_16x16x32_bf16 v[164:167], a[140:143], v[248:251], v[164:167]
    ds_read_b128 a[156:159], v11 offset:45056
    v_mfma_f32_16x16x32_bf16 v[164:167], a[136:139], v[244:247], v[164:167]
    v_exp_f32 v37, v133
    v_mfma_f32_16x16x32_bf16 a[4:7], a[168:171], v[60:63], a[4:7]
    ds_read_b64_tr_b16 a[188:189], v15 offset:24576
    v_cvt_pk_bf16_f32 v88, v36, v37
    v_mfma_f32_16x16x32_bf16 a[4:7], a[172:175], v[28:31], a[4:7]
    v_exp_f32 v38, v134
    v_mfma_f32_16x16x32_bf16 a[36:39], a[172:175], v[40:43], a[36:39]
    ds_read_b64_tr_b16 a[190:191], v15 offset:28672
    v_mfma_f32_16x16x32_bf16 a[36:39], a[168:171], v[64:67], a[36:39]
    v_exp_f32 v39, v135
    v_mfma_f32_16x16x32_bf16 a[68:71], a[168:171], v[68:71], a[68:71]
    v_cvt_pk_bf16_f32 v89, v38, v39
    v_mfma_f32_16x16x32_bf16 a[68:71], a[172:175], v[172:175], a[68:71]
    v_mfma_f32_16x16x32_bf16 a[100:103], a[172:175], v[176:179], a[100:103]
    s_waitcnt lgkmcnt(6)
    v_mfma_f32_16x16x32_bf16 a[100:103], a[168:171], v[72:75], a[100:103]
    v_exp_f32 v32, v112
    v_mfma_f32_16x16x32_bf16 v[144:147], a[144:147], v[188:191], v[44:47]
    s_waitcnt vmcnt(12)
    s_barrier
    v_mfma_f32_16x16x32_bf16 v[144:147], a[148:151], v[192:195], v[144:147]
    v_exp_f32 v33, v113
    v_mfma_f32_16x16x32_bf16 v[152:155], a[148:151], v[208:211], v[48:51]
    ds_read_b128 a[128:131], v8 offset:49152
    v_cvt_pk_bf16_f32 v78, v32, v33
    v_mfma_f32_16x16x32_bf16 v[152:155], a[144:147], v[204:207], v[152:155]
    v_exp_f32 v34, v114
    v_mfma_f32_16x16x32_bf16 v[160:163], a[144:147], v[220:223], v[52:55]
    ds_read_b64_tr_b16 a[160:161], v16 offset:16384
    s_add_u32 m0, s38, 16384
    v_mfma_f32_16x16x32_bf16 v[160:163], a[148:151], v[224:227], v[160:163]
    v_exp_f32 v35, v115
    v_mfma_f32_16x16x32_bf16 v[168:171], a[148:151], v[240:243], v[56:59]
    v_exp_f32 v36, v120
    v_mfma_f32_16x16x32_bf16 v[168:171], a[144:147], v[236:239], v[168:171]
    ds_read_b64_tr_b16 a[162:163], v16 offset:20480
    s_add_u32 s41, s41, 16384
    v_mfma_f32_16x16x32_bf16 a[8:11], a[176:179], v[60:63], a[8:11]
    buffer_store_dwordx4 v[4:7], v26, s[16:19], s44 offen sc1
    v_mfma_f32_16x16x32_bf16 a[8:11], a[180:183], v[28:31], a[8:11]
    v_exp_f32 v37, v121
    v_mfma_f32_16x16x32_bf16 a[40:43], a[180:183], v[40:43], a[40:43]
    ds_read_b128 a[132:135], v9 offset:49152
    v_cvt_pk_bf16_f32 v79, v34, v35
    v_mfma_f32_16x16x32_bf16 a[40:43], a[176:179], v[64:67], a[40:43]
    v_exp_f32 v38, v122
    v_mfma_f32_16x16x32_bf16 a[236:239], a[196:199], v[64:67], a[236:239]
    v_exp_f32 v39, v123
    v_mfma_f32_16x16x32_bf16 a[236:239], a[196:199], v[40:43], a[236:239]
    ds_read_b64_tr_b16 a[164:165], v16 offset:24576
    s_add_u32 s44, s44, 4096
    v_mfma_f32_16x16x32_bf16 a[72:75], a[176:179], v[68:71], a[72:75]
    buffer_load_dwordx4 v20, s[8:11], s41 offen offset:0 nt lds
    v_mfma_f32_16x16x32_bf16 a[72:75], a[180:183], v[172:175], a[72:75]
    v_cvt_pk_bf16_f32 v82, v36, v37
    ds_read_b64_tr_b16 a[166:167], v16 offset:28672
    v_mfma_f32_16x16x32_bf16 a[104:107], a[180:183], v[176:179], a[104:107]
    v_exp_f32 v32, v128
    v_mfma_f32_16x16x32_bf16 a[104:107], a[176:179], v[72:75], a[104:107]
    s_waitcnt lgkmcnt(6)
    ds_read_b128 a[136:139], v10 offset:49152
    v_mfma_f32_16x16x32_bf16 v[144:147], a[152:155], v[196:199], v[144:147]
    v_exp_f32 v33, v129
    v_mfma_f32_16x16x32_bf16 v[144:147], a[156:159], v[200:203], v[144:147]
    v_cvt_pk_bf16_f32 v83, v38, v39
    ds_read_b64_tr_b16 a[168:169], v17 offset:16384
    v_mfma_f32_16x16x32_bf16 v[152:155], a[156:159], v[216:219], v[152:155]
    v_exp_f32 v34, v130
    v_mfma_f32_16x16x32_bf16 v[152:155], a[152:155], v[212:215], v[152:155]
    buffer_load_dwordx4 v21, s[8:11], s41 offen offset:1024 nt lds
    v_mfma_f32_16x16x32_bf16 v[160:163], a[152:155], v[228:231], v[160:163]
    v_exp_f32 v35, v131
    v_mfma_f32_16x16x32_bf16 v[160:163], a[156:159], v[232:235], v[160:163]
    v_cvt_pk_bf16_f32 v86, v32, v33
    ds_read_b64_tr_b16 a[170:171], v17 offset:20480
    v_mfma_f32_16x16x32_bf16 v[168:171], a[156:159], v[248:251], v[168:171]
    v_exp_f32 v36, v136
    v_mfma_f32_16x16x32_bf16 v[168:171], a[152:155], v[244:247], v[168:171]
    v_exp_f32 v37, v137
    v_mfma_f32_16x16x32_bf16 a[12:15], a[184:187], v[60:63], a[12:15]
    ds_read_b128 a[140:143], v11 offset:49152
    v_cvt_pk_bf16_f32 v87, v34, v35
    v_mfma_f32_16x16x32_bf16 a[12:15], a[188:191], v[28:31], a[12:15]
    buffer_load_dwordx4 v22, s[8:11], s41 offen offset:2048 nt lds
    v_mfma_f32_16x16x32_bf16 a[44:47], a[188:191], v[40:43], a[44:47]
    v_exp_f32 v38, v138
    v_mfma_f32_16x16x32_bf16 a[44:47], a[184:187], v[64:67], a[44:47]
    v_exp_f32 v39, v139
    v_mfma_f32_16x16x32_bf16 a[76:79], a[184:187], v[68:71], a[76:79]
    ds_read_b64_tr_b16 a[172:173], v17 offset:24576
    v_cvt_pk_bf16_f32 v90, v36, v37
    v_mfma_f32_16x16x32_bf16 a[76:79], a[188:191], v[172:175], a[76:79]
    ds_read_b64_tr_b16 a[174:175], v17 offset:28672
    v_cvt_pk_bf16_f32 v91, v38, v39
    v_mfma_f32_16x16x32_bf16 a[108:111], a[188:191], v[176:179], a[108:111]
    s_waitcnt lgkmcnt(6)
    v_mfma_f32_16x16x32_bf16 a[108:111], a[184:187], v[72:75], a[108:111]
    buffer_load_dwordx4 v23, s[8:11], s41 offen offset:3072 nt lds
    v_mfma_f32_16x16x32_bf16 v[108:111], a[128:131], v[188:191], v[44:47]
    v_exp_f32 v32, v140
    v_mfma_f32_16x16x32_bf16 v[108:111], a[132:135], v[192:195], v[108:111]
    ds_read_b128 a[144:147], v8 offset:53248
    s_add_u32 m0, s38, 65536
    v_mfma_f32_16x16x32_bf16 v[116:119], a[132:135], v[208:211], v[48:51]
    v_exp_f32 v33, v141
    v_mfma_f32_16x16x32_bf16 v[116:119], a[128:131], v[204:207], v[116:119]
    v_exp_f32 v34, v142
    v_mfma_f32_16x16x32_bf16 v[124:127], a[128:131], v[220:223], v[52:55]
    ds_read_b64_tr_b16 a[176:177], v18 offset:16384
    v_cvt_pk_bf16_f32 v92, v32, v33
    v_mfma_f32_16x16x32_bf16 v[124:127], a[132:135], v[224:227], v[124:127]
    v_exp_f32 v35, v143
    v_mfma_f32_16x16x32_bf16 v[132:135], a[132:135], v[240:243], v[56:59]
    ds_read_b64_tr_b16 a[178:179], v18 offset:20480
    s_sub_u32 s42, s41, 16384
    v_mfma_f32_16x16x32_bf16 v[132:135], a[128:131], v[236:239], v[132:135]
    v_exp_f32 v36, v148
    v_mfma_f32_16x16x32_bf16 a[16:19], a[160:163], v[60:63], a[16:19]
    ds_read_b128 a[148:151], v9 offset:53248
    v_cvt_pk_bf16_f32 v93, v34, v35
    v_mfma_f32_16x16x32_bf16 a[16:19], a[164:167], v[28:31], a[16:19]
    v_exp_f32 v37, v149
    v_mfma_f32_16x16x32_bf16 a[48:51], a[164:167], v[40:43], a[48:51]
    buffer_load_dwordx4 v24, s[12:15], s42 offen offset:0 nt lds
    v_mfma_f32_16x16x32_bf16 a[48:51], a[160:163], v[64:67], a[48:51]
    v_exp_f32 v38, v150
    v_mfma_f32_16x16x32_bf16 a[80:83], a[160:163], v[68:71], a[80:83]
    ds_read_b64_tr_b16 a[180:181], v18 offset:24576
    v_cvt_pk_bf16_f32 v96, v36, v37
    v_mfma_f32_16x16x32_bf16 a[80:83], a[164:167], v[172:175], a[80:83]
    v_exp_f32 v39, v151
    v_mfma_f32_16x16x32_bf16 a[240:243], a[196:199], v[172:175], a[240:243]
    ds_read_b64_tr_b16 a[182:183], v18 offset:28672
    v_cvt_pk_bf16_f32 v97, v38, v39
    v_mfma_f32_16x16x32_bf16 a[240:243], a[196:199], v[68:71], a[240:243]
    v_exp_f32 v32, v156
    v_mfma_f32_16x16x32_bf16 a[112:115], a[164:167], v[176:179], a[112:115]
    s_waitcnt lgkmcnt(6)
    ds_read_b128 a[152:155], v10 offset:53248
    v_mfma_f32_16x16x32_bf16 a[112:115], a[160:163], v[72:75], a[112:115]
    v_exp_f32 v33, v157
    v_mfma_f32_16x16x32_bf16 v[108:111], a[136:139], v[196:199], v[108:111]
    ds_read_b64_tr_b16 a[184:185], v19 offset:16384
    v_cvt_pk_bf16_f32 v100, v32, v33
    v_mfma_f32_16x16x32_bf16 v[108:111], a[140:143], v[200:203], v[108:111]
    v_exp_f32 v34, v158
    v_mfma_f32_16x16x32_bf16 v[116:119], a[140:143], v[216:219], v[116:119]
    buffer_load_dwordx4 v25, s[12:15], s42 offen offset:1024 nt lds
    v_mfma_f32_16x16x32_bf16 v[116:119], a[136:139], v[212:215], v[116:119]
    v_exp_f32 v35, v159
    v_mfma_f32_16x16x32_bf16 v[124:127], a[136:139], v[228:231], v[124:127]
    ds_read_b64_tr_b16 a[186:187], v19 offset:20480
    v_cvt_pk_bf16_f32 v101, v34, v35
    v_mfma_f32_16x16x32_bf16 v[124:127], a[140:143], v[232:235], v[124:127]
    v_exp_f32 v36, v164
    v_mfma_f32_16x16x32_bf16 v[132:135], a[140:143], v[248:251], v[132:135]
    ds_read_b128 a[156:159], v11 offset:53248
    v_mfma_f32_16x16x32_bf16 v[132:135], a[136:139], v[244:247], v[132:135]
    v_exp_f32 v37, v165
    v_mfma_f32_16x16x32_bf16 a[20:23], a[168:171], v[60:63], a[20:23]
    ds_read_b64_tr_b16 a[188:189], v19 offset:24576
    v_cvt_pk_bf16_f32 v104, v36, v37
    v_mfma_f32_16x16x32_bf16 a[20:23], a[172:175], v[28:31], a[20:23]
    v_exp_f32 v38, v166
    v_mfma_f32_16x16x32_bf16 a[52:55], a[172:175], v[40:43], a[52:55]
    ds_read_b64_tr_b16 a[190:191], v19 offset:28672
    v_mfma_f32_16x16x32_bf16 a[52:55], a[168:171], v[64:67], a[52:55]
    v_exp_f32 v39, v167
    v_mfma_f32_16x16x32_bf16 a[84:87], a[168:171], v[68:71], a[84:87]
    v_cvt_pk_bf16_f32 v105, v38, v39
    v_mfma_f32_16x16x32_bf16 a[84:87], a[172:175], v[172:175], a[84:87]
    buffer_load_dwordx4 v24, s[12:15], s42 offen offset:2048 nt lds
    v_mfma_f32_16x16x32_bf16 a[116:119], a[172:175], v[176:179], a[116:119]
    s_waitcnt lgkmcnt(6)
    ds_read_b128 a[128:131], v8 offset:57344
    v_mfma_f32_16x16x32_bf16 a[116:119], a[168:171], v[72:75], a[116:119]
    v_exp_f32 v32, v144
    v_mfma_f32_16x16x32_bf16 v[112:115], a[144:147], v[188:191], v[44:47]
    v_exp_f32 v33, v145
    v_mfma_f32_16x16x32_bf16 v[112:115], a[148:151], v[192:195], v[112:115]
    ds_read_b64_tr_b16 a[160:161], v12 offset:32768
    v_cvt_pk_bf16_f32 v94, v32, v33
    v_mfma_f32_16x16x32_bf16 v[120:123], a[148:151], v[208:211], v[48:51]
    v_exp_f32 v34, v146
    v_mfma_f32_16x16x32_bf16 v[120:123], a[144:147], v[204:207], v[120:123]
    ds_read_b64_tr_b16 a[162:163], v12 offset:36864
    v_mfma_f32_16x16x32_bf16 v[128:131], a[144:147], v[220:223], v[52:55]
    v_exp_f32 v35, v147
    v_mfma_f32_16x16x32_bf16 v[128:131], a[148:151], v[224:227], v[128:131]
    v_cvt_pk_bf16_f32 v95, v34, v35
    v_mfma_f32_16x16x32_bf16 v[136:139], a[148:151], v[240:243], v[56:59]
    v_exp_f32 v36, v152
    v_mfma_f32_16x16x32_bf16 v[136:139], a[144:147], v[236:239], v[136:139]
    ds_read_b128 a[132:135], v9 offset:57344
    v_mfma_f32_16x16x32_bf16 a[24:27], a[176:179], v[60:63], a[24:27]
    v_exp_f32 v37, v153
    v_mfma_f32_16x16x32_bf16 a[24:27], a[180:183], v[28:31], a[24:27]
    ds_read_b64_tr_b16 a[164:165], v12 offset:40960
    v_cvt_pk_bf16_f32 v98, v36, v37
    v_mfma_f32_16x16x32_bf16 a[56:59], a[180:183], v[40:43], a[56:59]
    v_exp_f32 v38, v154
    v_mfma_f32_16x16x32_bf16 a[56:59], a[176:179], v[64:67], a[56:59]
    ds_read_b64_tr_b16 a[166:167], v12 offset:45056
    v_mfma_f32_16x16x32_bf16 a[88:91], a[176:179], v[68:71], a[88:91]
    v_exp_f32 v39, v155
    v_mfma_f32_16x16x32_bf16 a[88:91], a[180:183], v[172:175], a[88:91]
    buffer_load_dwordx4 v25, s[12:15], s42 offen offset:3072 nt lds
    v_mfma_f32_16x16x32_bf16 a[120:123], a[180:183], v[176:179], a[120:123]
    v_exp_f32 v32, v160
    v_mfma_f32_16x16x32_bf16 a[120:123], a[176:179], v[72:75], a[120:123]
    v_cvt_pk_bf16_f32 v99, v38, v39
    v_mfma_f32_16x16x32_bf16 a[244:247], a[196:199], v[72:75], a[244:247]
    s_waitcnt lgkmcnt(6)
    ds_read_b128 a[136:139], v10 offset:57344
    v_mfma_f32_16x16x32_bf16 a[244:247], a[196:199], v[176:179], a[244:247]
    v_exp_f32 v33, v161
    v_mfma_f32_16x16x32_bf16 v[112:115], a[152:155], v[196:199], v[112:115]
    v_exp_f32 v34, v162
    v_mfma_f32_16x16x32_bf16 v[112:115], a[156:159], v[200:203], v[112:115]
    ds_read_b64_tr_b16 a[168:169], v13 offset:32768
    v_cvt_pk_bf16_f32 v102, v32, v33
    v_mfma_f32_16x16x32_bf16 v[120:123], a[156:159], v[216:219], v[120:123]
    v_exp_f32 v35, v163
    v_mfma_f32_16x16x32_bf16 v[120:123], a[152:155], v[212:215], v[120:123]
    ds_read_b64_tr_b16 a[170:171], v13 offset:36864
    v_cvt_pk_bf16_f32 v103, v34, v35
    v_mfma_f32_16x16x32_bf16 v[128:131], a[152:155], v[228:231], v[128:131]
    v_exp_f32 v36, v168
    v_mfma_f32_16x16x32_bf16 v[128:131], a[156:159], v[232:235], v[128:131]
    v_mfma_f32_16x16x32_bf16 v[136:139], a[156:159], v[248:251], v[136:139]
    v_exp_f32 v37, v169
    v_mfma_f32_16x16x32_bf16 v[136:139], a[152:155], v[244:247], v[136:139]
    ds_read_b128 a[140:143], v11 offset:57344
    v_cvt_pk_bf16_f32 v106, v36, v37
    v_mfma_f32_16x16x32_bf16 a[28:31], a[184:187], v[60:63], a[28:31]
    v_exp_f32 v38, v170
    v_mfma_f32_16x16x32_bf16 a[28:31], a[188:191], v[28:31], a[28:31]
    ds_read_b64_tr_b16 a[172:173], v13 offset:40960
    v_mfma_f32_16x16x32_bf16 a[60:63], a[188:191], v[40:43], a[60:63]
    v_exp_f32 v39, v171
    v_mfma_f32_16x16x32_bf16 a[60:63], a[184:187], v[64:67], a[60:63]
    buffer_load_dword v184, v186, s[64:67], s39 offen
    v_mfma_f32_16x16x32_bf16 a[92:95], a[184:187], v[68:71], a[92:95]
    ds_read_b64_tr_b16 a[174:175], v13 offset:45056
    v_cvt_pk_bf16_f32 v107, v38, v39
    v_mfma_f32_16x16x32_bf16 a[92:95], a[188:191], v[172:175], a[92:95]
    v_mfma_f32_16x16x32_bf16 a[124:127], a[188:191], v[176:179], a[124:127]
    s_waitcnt lgkmcnt(6)
    v_mfma_f32_16x16x32_bf16 a[124:127], a[184:187], v[72:75], a[124:127]
    v_mfma_f32_16x16x32_bf16 v[140:143], a[128:131], v[188:191], v[44:47]
    v_exp_f32 v32, v108
    v_mfma_f32_16x16x32_bf16 v[140:143], a[132:135], v[192:195], v[140:143]
    ds_read_b128 a[144:147], v8 offset:61440
    v_mfma_f32_16x16x32_bf16 v[148:151], a[132:135], v[208:211], v[48:51]
    v_exp_f32 v33, v109
    v_mfma_f32_16x16x32_bf16 v[148:151], a[128:131], v[204:207], v[148:151]
    v_exp_f32 v34, v110
    v_mfma_f32_16x16x32_bf16 v[156:159], a[128:131], v[220:223], v[52:55]
    ds_read_b64_tr_b16 a[176:177], v14 offset:32768
    v_cvt_pk_bf16_f32 v60, v32, v33
    v_mfma_f32_16x16x32_bf16 v[156:159], a[132:135], v[224:227], v[156:159]
    v_exp_f32 v35, v111
    v_mfma_f32_16x16x32_bf16 v[164:167], a[132:135], v[240:243], v[56:59]
    ds_read_b64_tr_b16 a[178:179], v14 offset:36864
    v_cvt_pk_bf16_f32 v61, v34, v35
    v_mfma_f32_16x16x32_bf16 v[164:167], a[128:131], v[236:239], v[164:167]
    v_exp_f32 v36, v116
    v_mfma_f32_16x16x32_bf16 a[0:3], a[160:163], v[76:79], a[0:3]
    ds_read_b128 a[148:151], v9 offset:61440
    s_add_u32 s37, s37, 384
    v_mfma_f32_16x16x32_bf16 a[0:3], a[164:167], v[92:95], a[0:3]
    v_exp_f32 v37, v117
    v_mfma_f32_16x16x32_bf16 a[232:235], a[196:199], v[92:95], a[232:235]
    ds_read_b64_tr_b16 a[180:181], v14 offset:40960
    v_cvt_pk_bf16_f32 v64, v36, v37
    v_mfma_f32_16x16x32_bf16 a[232:235], a[196:199], v[76:79], a[232:235]
    v_exp_f32 v38, v118
    v_mfma_f32_16x16x32_bf16 a[32:35], a[164:167], v[96:99], a[32:35]
    ds_read_b64_tr_b16 a[182:183], v14 offset:45056
    v_mfma_f32_16x16x32_bf16 a[32:35], a[160:163], v[80:83], a[32:35]
    v_exp_f32 v39, v119
    v_mfma_f32_16x16x32_bf16 a[64:67], a[160:163], v[84:87], a[64:67]
    v_cvt_pk_bf16_f32 v65, v38, v39
    v_mfma_f32_16x16x32_bf16 a[64:67], a[164:167], v[100:103], a[64:67]
    v_exp_f32 v32, v124
    v_mfma_f32_16x16x32_bf16 a[96:99], a[164:167], v[104:107], a[96:99]
    s_waitcnt lgkmcnt(6)
    ds_read_b128 a[152:155], v10 offset:61440
    v_mfma_f32_16x16x32_bf16 a[96:99], a[160:163], v[88:91], a[96:99]
    v_exp_f32 v33, v125
    v_mfma_f32_16x16x32_bf16 v[140:143], a[136:139], v[196:199], v[140:143]
    ds_read_b64_tr_b16 a[184:185], v15 offset:32768
    v_cvt_pk_bf16_f32 v68, v32, v33
    v_mfma_f32_16x16x32_bf16 v[140:143], a[140:143], v[200:203], v[140:143]
    v_exp_f32 v34, v126
    v_mfma_f32_16x16x32_bf16 v[148:151], a[140:143], v[216:219], v[148:151]
    ds_read_b64_tr_b16 a[186:187], v15 offset:36864
    v_mfma_f32_16x16x32_bf16 v[148:151], a[136:139], v[212:215], v[148:151]
    v_exp_f32 v35, v127
    v_mfma_f32_16x16x32_bf16 v[156:159], a[136:139], v[228:231], v[156:159]
    v_cvt_pk_bf16_f32 v69, v34, v35
    v_mfma_f32_16x16x32_bf16 v[156:159], a[140:143], v[232:235], v[156:159]
    v_exp_f32 v36, v132
    v_mfma_f32_16x16x32_bf16 v[164:167], a[140:143], v[248:251], v[164:167]
    ds_read_b128 a[156:159], v11 offset:61440
    v_mfma_f32_16x16x32_bf16 v[164:167], a[136:139], v[244:247], v[164:167]
    v_exp_f32 v37, v133
    v_mfma_f32_16x16x32_bf16 a[4:7], a[168:171], v[76:79], a[4:7]
    ds_read_b64_tr_b16 a[188:189], v15 offset:40960
    v_cvt_pk_bf16_f32 v72, v36, v37
    v_mfma_f32_16x16x32_bf16 a[4:7], a[172:175], v[92:95], a[4:7]
    v_exp_f32 v38, v134
    v_mfma_f32_16x16x32_bf16 a[36:39], a[172:175], v[96:99], a[36:39]
    ds_read_b64_tr_b16 a[190:191], v15 offset:45056
    v_mfma_f32_16x16x32_bf16 a[36:39], a[168:171], v[80:83], a[36:39]
    v_exp_f32 v39, v135
    v_mfma_f32_16x16x32_bf16 a[68:71], a[168:171], v[84:87], a[68:71]
    v_cvt_pk_bf16_f32 v73, v38, v39
    v_mfma_f32_16x16x32_bf16 a[68:71], a[172:175], v[100:103], a[68:71]
    v_mfma_f32_16x16x32_bf16 a[100:103], a[172:175], v[104:107], a[100:103]
    s_waitcnt lgkmcnt(6)
    v_mfma_f32_16x16x32_bf16 a[100:103], a[168:171], v[88:91], a[100:103]
    v_exp_f32 v32, v112
    v_mfma_f32_16x16x32_bf16 v[144:147], a[144:147], v[188:191], v[44:47]
    s_waitcnt vmcnt(11)
    s_barrier
    v_mfma_f32_16x16x32_bf16 v[144:147], a[148:151], v[192:195], v[144:147]
    v_exp_f32 v33, v113
    v_mfma_f32_16x16x32_bf16 v[152:155], a[148:151], v[208:211], v[48:51]
    ds_read_b128 a[128:131], v8 offset:0
    v_cvt_pk_bf16_f32 v62, v32, v33
    v_mfma_f32_16x16x32_bf16 v[152:155], a[144:147], v[204:207], v[152:155]
    v_exp_f32 v34, v114
    v_mfma_f32_16x16x32_bf16 v[160:163], a[144:147], v[220:223], v[52:55]
    ds_read_b64_tr_b16 a[160:161], v16 offset:32768
    s_add_u32 m0, s38, 32768
    v_mfma_f32_16x16x32_bf16 v[160:163], a[148:151], v[224:227], v[160:163]
    v_exp_f32 v35, v115
    v_mfma_f32_16x16x32_bf16 v[168:171], a[148:151], v[240:243], v[56:59]
    v_exp_f32 v36, v120
    v_mfma_f32_16x16x32_bf16 v[168:171], a[144:147], v[236:239], v[168:171]
    ds_read_b64_tr_b16 a[162:163], v16 offset:36864
    s_add_u32 s41, s41, 16384
    v_mfma_f32_16x16x32_bf16 a[8:11], a[176:179], v[76:79], a[8:11]
    buffer_store_dwordx4 v[4:7], v3, s[48:51], s53 offen sc1
    v_mfma_f32_16x16x32_bf16 a[8:11], a[180:183], v[92:95], a[8:11]
    v_exp_f32 v37, v121
    v_mfma_f32_16x16x32_bf16 a[40:43], a[180:183], v[96:99], a[40:43]
    ds_read_b128 a[132:135], v9 offset:0
    v_cvt_pk_bf16_f32 v63, v34, v35
    v_mfma_f32_16x16x32_bf16 a[40:43], a[176:179], v[80:83], a[40:43]
    v_exp_f32 v38, v122
    v_mfma_f32_16x16x32_bf16 a[236:239], a[196:199], v[80:83], a[236:239]
    v_exp_f32 v39, v123
    v_mfma_f32_16x16x32_bf16 a[236:239], a[196:199], v[96:99], a[236:239]
    ds_read_b64_tr_b16 a[164:165], v16 offset:40960
    s_add_u32 s53, s53, 18432
    v_mfma_f32_16x16x32_bf16 a[72:75], a[176:179], v[84:87], a[72:75]
    buffer_load_dwordx4 v20, s[8:11], s41 offen offset:0 nt lds
    v_mfma_f32_16x16x32_bf16 a[72:75], a[180:183], v[100:103], a[72:75]
    v_cvt_pk_bf16_f32 v66, v36, v37
    ds_read_b64_tr_b16 a[166:167], v16 offset:45056
    v_mfma_f32_16x16x32_bf16 a[104:107], a[180:183], v[104:107], a[104:107]
    v_exp_f32 v32, v128
    v_mfma_f32_16x16x32_bf16 a[104:107], a[176:179], v[88:91], a[104:107]
    s_waitcnt lgkmcnt(6)
    ds_read_b128 a[136:139], v10 offset:0
    v_mfma_f32_16x16x32_bf16 v[144:147], a[152:155], v[196:199], v[144:147]
    v_exp_f32 v33, v129
    v_mfma_f32_16x16x32_bf16 v[144:147], a[156:159], v[200:203], v[144:147]
    v_cvt_pk_bf16_f32 v67, v38, v39
    ds_read_b64_tr_b16 a[168:169], v17 offset:32768
    v_mfma_f32_16x16x32_bf16 v[152:155], a[156:159], v[216:219], v[152:155]
    v_exp_f32 v34, v130
    v_mfma_f32_16x16x32_bf16 v[152:155], a[152:155], v[212:215], v[152:155]
    buffer_load_dwordx4 v21, s[8:11], s41 offen offset:1024 nt lds
    v_mfma_f32_16x16x32_bf16 v[160:163], a[152:155], v[228:231], v[160:163]
    v_exp_f32 v35, v131
    v_mfma_f32_16x16x32_bf16 v[160:163], a[156:159], v[232:235], v[160:163]
    v_cvt_pk_bf16_f32 v70, v32, v33
    ds_read_b64_tr_b16 a[170:171], v17 offset:36864
    v_mfma_f32_16x16x32_bf16 v[168:171], a[156:159], v[248:251], v[168:171]
    v_exp_f32 v36, v136
    v_mfma_f32_16x16x32_bf16 v[168:171], a[152:155], v[244:247], v[168:171]
    v_exp_f32 v37, v137
    v_mfma_f32_16x16x32_bf16 a[12:15], a[184:187], v[76:79], a[12:15]
    ds_read_b128 a[140:143], v11 offset:0
    v_cvt_pk_bf16_f32 v71, v34, v35
    v_mfma_f32_16x16x32_bf16 a[12:15], a[188:191], v[92:95], a[12:15]
    buffer_load_dwordx4 v22, s[8:11], s41 offen offset:2048 nt lds
    v_mfma_f32_16x16x32_bf16 a[44:47], a[188:191], v[96:99], a[44:47]
    v_exp_f32 v38, v138
    v_mfma_f32_16x16x32_bf16 a[44:47], a[184:187], v[80:83], a[44:47]
    v_exp_f32 v39, v139
    v_mfma_f32_16x16x32_bf16 a[76:79], a[184:187], v[84:87], a[76:79]
    ds_read_b64_tr_b16 a[172:173], v17 offset:40960
    v_cvt_pk_bf16_f32 v74, v36, v37
    v_mfma_f32_16x16x32_bf16 a[76:79], a[188:191], v[100:103], a[76:79]
    ds_read_b64_tr_b16 a[174:175], v17 offset:45056
    v_cvt_pk_bf16_f32 v75, v38, v39
    v_mfma_f32_16x16x32_bf16 a[108:111], a[188:191], v[104:107], a[108:111]
    s_waitcnt lgkmcnt(6)
    v_mfma_f32_16x16x32_bf16 a[108:111], a[184:187], v[88:91], a[108:111]
    buffer_load_dwordx4 v23, s[8:11], s41 offen offset:3072 nt lds
    v_mfma_f32_16x16x32_bf16 v[108:111], a[128:131], v[188:191], v[44:47]
    v_exp_f32 v32, v140
    v_mfma_f32_16x16x32_bf16 v[108:111], a[132:135], v[192:195], v[108:111]
    ds_read_b128 a[144:147], v8 offset:4096
    s_add_u32 m0, s38, 81920
    v_mfma_f32_16x16x32_bf16 v[116:119], a[132:135], v[208:211], v[48:51]
    v_exp_f32 v33, v141
    v_mfma_f32_16x16x32_bf16 v[116:119], a[128:131], v[204:207], v[116:119]
    v_exp_f32 v34, v142
    v_mfma_f32_16x16x32_bf16 v[124:127], a[128:131], v[220:223], v[52:55]
    ds_read_b64_tr_b16 a[176:177], v18 offset:32768
    v_cvt_pk_bf16_f32 v28, v32, v33
    v_mfma_f32_16x16x32_bf16 v[124:127], a[132:135], v[224:227], v[124:127]
    v_exp_f32 v35, v143
    v_mfma_f32_16x16x32_bf16 v[132:135], a[132:135], v[240:243], v[56:59]
    ds_read_b64_tr_b16 a[178:179], v18 offset:36864
    s_sub_u32 s42, s41, 16384
    v_mfma_f32_16x16x32_bf16 v[132:135], a[128:131], v[236:239], v[132:135]
    v_exp_f32 v36, v148
    v_mfma_f32_16x16x32_bf16 a[16:19], a[160:163], v[76:79], a[16:19]
    ds_read_b128 a[148:151], v9 offset:4096
    v_cvt_pk_bf16_f32 v29, v34, v35
    v_mfma_f32_16x16x32_bf16 a[16:19], a[164:167], v[92:95], a[16:19]
    v_exp_f32 v37, v149
    v_mfma_f32_16x16x32_bf16 a[48:51], a[164:167], v[96:99], a[48:51]
    buffer_load_dwordx4 v24, s[12:15], s42 offen offset:0 nt lds
    v_mfma_f32_16x16x32_bf16 a[48:51], a[160:163], v[80:83], a[48:51]
    v_exp_f32 v38, v150
    v_mfma_f32_16x16x32_bf16 a[80:83], a[160:163], v[84:87], a[80:83]
    ds_read_b64_tr_b16 a[180:181], v18 offset:40960
    v_cvt_pk_bf16_f32 v40, v36, v37
    v_mfma_f32_16x16x32_bf16 a[80:83], a[164:167], v[100:103], a[80:83]
    v_exp_f32 v39, v151
    v_mfma_f32_16x16x32_bf16 a[240:243], a[196:199], v[100:103], a[240:243]
    ds_read_b64_tr_b16 a[182:183], v18 offset:45056
    v_cvt_pk_bf16_f32 v41, v38, v39
    v_mfma_f32_16x16x32_bf16 a[240:243], a[196:199], v[84:87], a[240:243]
    v_exp_f32 v32, v156
    v_mfma_f32_16x16x32_bf16 a[112:115], a[164:167], v[104:107], a[112:115]
    s_waitcnt lgkmcnt(6)
    ds_read_b128 a[152:155], v10 offset:4096
    v_mfma_f32_16x16x32_bf16 a[112:115], a[160:163], v[88:91], a[112:115]
    v_exp_f32 v33, v157
    v_mfma_f32_16x16x32_bf16 v[108:111], a[136:139], v[196:199], v[108:111]
    ds_read_b64_tr_b16 a[184:185], v19 offset:32768
    v_cvt_pk_bf16_f32 v172, v32, v33
    v_mfma_f32_16x16x32_bf16 v[108:111], a[140:143], v[200:203], v[108:111]
    v_exp_f32 v34, v158
    v_mfma_f32_16x16x32_bf16 v[116:119], a[140:143], v[216:219], v[116:119]
    buffer_load_dwordx4 v25, s[12:15], s42 offen offset:1024 nt lds
    v_mfma_f32_16x16x32_bf16 v[116:119], a[136:139], v[212:215], v[116:119]
    v_exp_f32 v35, v159
    v_mfma_f32_16x16x32_bf16 v[124:127], a[136:139], v[228:231], v[124:127]
    ds_read_b64_tr_b16 a[186:187], v19 offset:36864
    v_cvt_pk_bf16_f32 v173, v34, v35
    v_mfma_f32_16x16x32_bf16 v[124:127], a[140:143], v[232:235], v[124:127]
    v_exp_f32 v36, v164
    v_mfma_f32_16x16x32_bf16 v[132:135], a[140:143], v[248:251], v[132:135]
    ds_read_b128 a[156:159], v11 offset:4096
    v_mfma_f32_16x16x32_bf16 v[132:135], a[136:139], v[244:247], v[132:135]
    v_exp_f32 v37, v165
    v_mfma_f32_16x16x32_bf16 a[20:23], a[168:171], v[76:79], a[20:23]
    ds_read_b64_tr_b16 a[188:189], v19 offset:40960
    v_cvt_pk_bf16_f32 v176, v36, v37
    v_mfma_f32_16x16x32_bf16 a[20:23], a[172:175], v[92:95], a[20:23]
    v_exp_f32 v38, v166
    v_mfma_f32_16x16x32_bf16 a[52:55], a[172:175], v[96:99], a[52:55]
    ds_read_b64_tr_b16 a[190:191], v19 offset:45056
    v_mfma_f32_16x16x32_bf16 a[52:55], a[168:171], v[80:83], a[52:55]
    v_exp_f32 v39, v167
    v_mfma_f32_16x16x32_bf16 a[84:87], a[168:171], v[84:87], a[84:87]
    v_cvt_pk_bf16_f32 v177, v38, v39
    v_mfma_f32_16x16x32_bf16 a[84:87], a[172:175], v[100:103], a[84:87]
    buffer_load_dwordx4 v24, s[12:15], s42 offen offset:2048 nt lds
    v_mfma_f32_16x16x32_bf16 a[116:119], a[172:175], v[104:107], a[116:119]
    s_waitcnt lgkmcnt(6)
    ds_read_b128 a[128:131], v8 offset:8192
    v_mfma_f32_16x16x32_bf16 a[116:119], a[168:171], v[88:91], a[116:119]
    v_exp_f32 v32, v144
    v_mfma_f32_16x16x32_bf16 v[112:115], a[144:147], v[188:191], v[44:47]
    v_exp_f32 v33, v145
    v_mfma_f32_16x16x32_bf16 v[112:115], a[148:151], v[192:195], v[112:115]
    ds_read_b64_tr_b16 a[160:161], v12 offset:49152
    v_cvt_pk_bf16_f32 v30, v32, v33
    v_mfma_f32_16x16x32_bf16 v[120:123], a[148:151], v[208:211], v[48:51]
    v_exp_f32 v34, v146
    v_mfma_f32_16x16x32_bf16 v[120:123], a[144:147], v[204:207], v[120:123]
    ds_read_b64_tr_b16 a[162:163], v12 offset:53248
    v_mfma_f32_16x16x32_bf16 v[128:131], a[144:147], v[220:223], v[52:55]
    v_exp_f32 v35, v147
    v_mfma_f32_16x16x32_bf16 v[128:131], a[148:151], v[224:227], v[128:131]
    v_cvt_pk_bf16_f32 v31, v34, v35
    v_mfma_f32_16x16x32_bf16 v[136:139], a[148:151], v[240:243], v[56:59]
    v_exp_f32 v36, v152
    v_mfma_f32_16x16x32_bf16 v[136:139], a[144:147], v[236:239], v[136:139]
    ds_read_b128 a[132:135], v9 offset:8192
    v_mfma_f32_16x16x32_bf16 a[24:27], a[176:179], v[76:79], a[24:27]
    v_exp_f32 v37, v153
    v_mfma_f32_16x16x32_bf16 a[24:27], a[180:183], v[92:95], a[24:27]
    ds_read_b64_tr_b16 a[164:165], v12 offset:57344
    v_cvt_pk_bf16_f32 v42, v36, v37
    v_mfma_f32_16x16x32_bf16 a[56:59], a[180:183], v[96:99], a[56:59]
    v_exp_f32 v38, v154
    v_mfma_f32_16x16x32_bf16 a[56:59], a[176:179], v[80:83], a[56:59]
    ds_read_b64_tr_b16 a[166:167], v12 offset:61440
    v_mfma_f32_16x16x32_bf16 a[88:91], a[176:179], v[84:87], a[88:91]
    v_exp_f32 v39, v155
    v_mfma_f32_16x16x32_bf16 a[88:91], a[180:183], v[100:103], a[88:91]
    buffer_load_dwordx4 v25, s[12:15], s42 offen offset:3072 nt lds
    v_mfma_f32_16x16x32_bf16 a[120:123], a[180:183], v[104:107], a[120:123]
    v_exp_f32 v32, v160
    v_mfma_f32_16x16x32_bf16 a[120:123], a[176:179], v[88:91], a[120:123]
    v_cvt_pk_bf16_f32 v43, v38, v39
    v_mfma_f32_16x16x32_bf16 a[244:247], a[196:199], v[88:91], a[244:247]
    s_waitcnt lgkmcnt(6)
    ds_read_b128 a[136:139], v10 offset:8192
    v_mfma_f32_16x16x32_bf16 a[244:247], a[196:199], v[104:107], a[244:247]
    v_exp_f32 v33, v161
    v_mfma_f32_16x16x32_bf16 v[112:115], a[152:155], v[196:199], v[112:115]
    v_exp_f32 v34, v162
    v_mfma_f32_16x16x32_bf16 v[112:115], a[156:159], v[200:203], v[112:115]
    ds_read_b64_tr_b16 a[168:169], v13 offset:49152
    v_cvt_pk_bf16_f32 v174, v32, v33
    v_mfma_f32_16x16x32_bf16 v[120:123], a[156:159], v[216:219], v[120:123]
    v_exp_f32 v35, v163
    v_mfma_f32_16x16x32_bf16 v[120:123], a[152:155], v[212:215], v[120:123]
    ds_read_b64_tr_b16 a[170:171], v13 offset:53248
    v_cvt_pk_bf16_f32 v175, v34, v35
    v_mfma_f32_16x16x32_bf16 v[128:131], a[152:155], v[228:231], v[128:131]
    v_exp_f32 v36, v168
    v_mfma_f32_16x16x32_bf16 v[128:131], a[156:159], v[232:235], v[128:131]
    v_mfma_f32_16x16x32_bf16 v[136:139], a[156:159], v[248:251], v[136:139]
    v_exp_f32 v37, v169
    v_mfma_f32_16x16x32_bf16 v[136:139], a[152:155], v[244:247], v[136:139]
    ds_read_b128 a[140:143], v11 offset:8192
    v_cvt_pk_bf16_f32 v178, v36, v37
    v_mfma_f32_16x16x32_bf16 a[28:31], a[184:187], v[76:79], a[28:31]
    v_exp_f32 v38, v170
    v_mfma_f32_16x16x32_bf16 a[28:31], a[188:191], v[92:95], a[28:31]
    ds_read_b64_tr_b16 a[172:173], v13 offset:57344
    v_mfma_f32_16x16x32_bf16 a[60:63], a[188:191], v[96:99], a[60:63]
    v_exp_f32 v39, v171
    v_mfma_f32_16x16x32_bf16 a[60:63], a[184:187], v[80:83], a[60:63]
    buffer_load_dword v184, v187, s[68:71], s34 offen
    v_mfma_f32_16x16x32_bf16 a[92:95], a[184:187], v[84:87], a[92:95]
    ds_read_b64_tr_b16 a[174:175], v13 offset:61440
    s_add_u32 s39, s39, 884736
    v_mfma_f32_16x16x32_bf16 a[92:95], a[188:191], v[100:103], a[92:95]
    s_add_u32 s34, s34, 12288
    v_cvt_pk_bf16_f32 v179, v38, v39
    v_mfma_f32_16x16x32_bf16 a[124:127], a[188:191], v[104:107], a[124:127]
    s_waitcnt lgkmcnt(6)
    v_mfma_f32_16x16x32_bf16 a[124:127], a[184:187], v[88:91], a[124:127]
    v_mfma_f32_16x16x32_bf16 v[140:143], a[128:131], v[188:191], v[44:47]
    v_exp_f32 v32, v108
    v_mfma_f32_16x16x32_bf16 v[140:143], a[132:135], v[192:195], v[140:143]
    ds_read_b128 a[144:147], v8 offset:12288
    v_mfma_f32_16x16x32_bf16 v[148:151], a[132:135], v[208:211], v[48:51]
    v_exp_f32 v33, v109
    v_mfma_f32_16x16x32_bf16 v[148:151], a[128:131], v[204:207], v[148:151]
    v_exp_f32 v34, v110
    v_mfma_f32_16x16x32_bf16 v[156:159], a[128:131], v[220:223], v[52:55]
    ds_read_b64_tr_b16 a[176:177], v14 offset:49152
    v_cvt_pk_bf16_f32 v76, v32, v33
    v_mfma_f32_16x16x32_bf16 v[156:159], a[132:135], v[224:227], v[156:159]
    v_exp_f32 v35, v111
    v_mfma_f32_16x16x32_bf16 v[164:167], a[132:135], v[240:243], v[56:59]
    ds_read_b64_tr_b16 a[178:179], v14 offset:53248
    v_cvt_pk_bf16_f32 v77, v34, v35
    v_mfma_f32_16x16x32_bf16 v[164:167], a[128:131], v[236:239], v[164:167]
    v_exp_f32 v36, v116
    v_mfma_f32_16x16x32_bf16 a[0:3], a[160:163], v[60:63], a[0:3]
    ds_read_b128 a[148:151], v9 offset:12288
    v_mfma_f32_16x16x32_bf16 a[0:3], a[164:167], v[28:31], a[0:3]
    v_exp_f32 v37, v117
    v_mfma_f32_16x16x32_bf16 a[232:235], a[196:199], v[28:31], a[232:235]
    buffer_load_dword v184, v254, s[4:7], s52 offen
    v_mfma_f32_16x16x32_bf16 a[232:235], a[196:199], v[60:63], a[232:235]
    v_exp_f32 v38, v118
    v_mfma_f32_16x16x32_bf16 a[32:35], a[164:167], v[40:43], a[32:35]
    ds_read_b64_tr_b16 a[180:181], v14 offset:57344
    v_cvt_pk_bf16_f32 v80, v36, v37
    v_mfma_f32_16x16x32_bf16 a[32:35], a[160:163], v[64:67], a[32:35]
    v_exp_f32 v39, v119
    v_mfma_f32_16x16x32_bf16 a[64:67], a[160:163], v[68:71], a[64:67]
    ds_read_b64_tr_b16 a[182:183], v14 offset:61440
    v_cvt_pk_bf16_f32 v81, v38, v39
    v_mfma_f32_16x16x32_bf16 a[64:67], a[164:167], v[172:175], a[64:67]
    v_exp_f32 v32, v124
    v_mfma_f32_16x16x32_bf16 a[96:99], a[164:167], v[176:179], a[96:99]
    s_waitcnt lgkmcnt(6)
    ds_read_b128 a[152:155], v10 offset:12288
    v_mfma_f32_16x16x32_bf16 a[96:99], a[160:163], v[72:75], a[96:99]
    v_exp_f32 v33, v125
    v_mfma_f32_16x16x32_bf16 v[140:143], a[136:139], v[196:199], v[140:143]
    ds_read_b64_tr_b16 a[184:185], v15 offset:49152
    v_cvt_pk_bf16_f32 v84, v32, v33
    v_mfma_f32_16x16x32_bf16 v[140:143], a[140:143], v[200:203], v[140:143]
    v_exp_f32 v34, v126
    v_mfma_f32_16x16x32_bf16 v[148:151], a[140:143], v[216:219], v[148:151]
    ds_read_b64_tr_b16 a[186:187], v15 offset:53248
    v_mfma_f32_16x16x32_bf16 v[148:151], a[136:139], v[212:215], v[148:151]
    v_exp_f32 v35, v127
    v_mfma_f32_16x16x32_bf16 v[156:159], a[136:139], v[228:231], v[156:159]
    v_cvt_pk_bf16_f32 v85, v34, v35
    v_mfma_f32_16x16x32_bf16 v[156:159], a[140:143], v[232:235], v[156:159]
    v_exp_f32 v36, v132
    v_mfma_f32_16x16x32_bf16 v[164:167], a[140:143], v[248:251], v[164:167]
    ds_read_b128 a[156:159], v11 offset:12288
    v_mfma_f32_16x16x32_bf16 v[164:167], a[136:139], v[244:247], v[164:167]
    v_exp_f32 v37, v133
    v_mfma_f32_16x16x32_bf16 a[4:7], a[168:171], v[60:63], a[4:7]
    ds_read_b64_tr_b16 a[188:189], v15 offset:57344
    v_cvt_pk_bf16_f32 v88, v36, v37
    v_mfma_f32_16x16x32_bf16 a[4:7], a[172:175], v[28:31], a[4:7]
    v_exp_f32 v38, v134
    v_mfma_f32_16x16x32_bf16 a[36:39], a[172:175], v[40:43], a[36:39]
    ds_read_b64_tr_b16 a[190:191], v15 offset:61440
    v_mfma_f32_16x16x32_bf16 a[36:39], a[168:171], v[64:67], a[36:39]
    v_exp_f32 v39, v135
    v_mfma_f32_16x16x32_bf16 a[68:71], a[168:171], v[68:71], a[68:71]
    v_cvt_pk_bf16_f32 v89, v38, v39
    v_mfma_f32_16x16x32_bf16 a[68:71], a[172:175], v[172:175], a[68:71]
    v_mfma_f32_16x16x32_bf16 a[100:103], a[172:175], v[176:179], a[100:103]
    s_waitcnt lgkmcnt(6)
    v_mfma_f32_16x16x32_bf16 a[100:103], a[168:171], v[72:75], a[100:103]
    v_exp_f32 v32, v112
    v_mfma_f32_16x16x32_bf16 v[144:147], a[144:147], v[188:191], v[44:47]
    s_waitcnt vmcnt(11)
    s_barrier
    v_mfma_f32_16x16x32_bf16 v[144:147], a[148:151], v[192:195], v[144:147]
    v_exp_f32 v33, v113
    v_mfma_f32_16x16x32_bf16 v[152:155], a[148:151], v[208:211], v[48:51]
    ds_read_b128 a[128:131], v8 offset:16384
    v_cvt_pk_bf16_f32 v78, v32, v33
    v_mfma_f32_16x16x32_bf16 v[152:155], a[144:147], v[204:207], v[152:155]
    v_exp_f32 v34, v114
    v_mfma_f32_16x16x32_bf16 v[160:163], a[144:147], v[220:223], v[52:55]
    ds_read_b64_tr_b16 a[160:161], v16 offset:49152
    s_add_u32 m0, s38, 49152
    v_mfma_f32_16x16x32_bf16 v[160:163], a[148:151], v[224:227], v[160:163]
    v_exp_f32 v35, v115
    v_mfma_f32_16x16x32_bf16 v[168:171], a[148:151], v[240:243], v[56:59]
    v_exp_f32 v36, v120
    v_mfma_f32_16x16x32_bf16 v[168:171], a[144:147], v[236:239], v[168:171]
    ds_read_b64_tr_b16 a[162:163], v16 offset:53248
    s_add_u32 s41, s41, 16384
    v_mfma_f32_16x16x32_bf16 a[8:11], a[176:179], v[60:63], a[8:11]
    buffer_load_dwordx4 v20, s[8:11], s41 offen offset:0 nt lds
    v_mfma_f32_16x16x32_bf16 a[8:11], a[180:183], v[28:31], a[8:11]
    v_exp_f32 v37, v121
    v_mfma_f32_16x16x32_bf16 a[40:43], a[180:183], v[40:43], a[40:43]
    ds_read_b128 a[132:135], v9 offset:16384
    v_cvt_pk_bf16_f32 v79, v34, v35
    v_mfma_f32_16x16x32_bf16 a[40:43], a[176:179], v[64:67], a[40:43]
    v_exp_f32 v38, v122
    v_mfma_f32_16x16x32_bf16 a[236:239], a[196:199], v[64:67], a[236:239]
    v_exp_f32 v39, v123
    v_mfma_f32_16x16x32_bf16 a[236:239], a[196:199], v[40:43], a[236:239]
    ds_read_b64_tr_b16 a[164:165], v16 offset:57344
    v_cvt_pk_bf16_f32 v82, v36, v37
    v_mfma_f32_16x16x32_bf16 a[72:75], a[176:179], v[68:71], a[72:75]
    v_exp_f32 v32, v128
    v_mfma_f32_16x16x32_bf16 a[72:75], a[180:183], v[172:175], a[72:75]
    ds_read_b64_tr_b16 a[166:167], v16 offset:61440
    v_cvt_pk_bf16_f32 v83, v38, v39
    v_mfma_f32_16x16x32_bf16 a[104:107], a[180:183], v[176:179], a[104:107]
    s_waitcnt lgkmcnt(6)
    ds_read_b128 a[136:139], v10 offset:16384
    v_mfma_f32_16x16x32_bf16 a[104:107], a[176:179], v[72:75], a[104:107]
    buffer_load_dwordx4 v21, s[8:11], s41 offen offset:1024 nt lds
    v_mfma_f32_16x16x32_bf16 v[144:147], a[152:155], v[196:199], v[144:147]
    v_exp_f32 v33, v129
    v_mfma_f32_16x16x32_bf16 v[144:147], a[156:159], v[200:203], v[144:147]
    v_exp_f32 v34, v130
    v_mfma_f32_16x16x32_bf16 v[152:155], a[156:159], v[216:219], v[152:155]
    v_exp_f32 v35, v131
    v_mfma_f32_16x16x32_bf16 v[152:155], a[152:155], v[212:215], v[152:155]
    ds_read_b64_tr_b16 a[168:169], v17 offset:49152
    v_cvt_pk_bf16_f32 v86, v32, v33
    v_mfma_f32_16x16x32_bf16 v[160:163], a[152:155], v[228:231], v[160:163]
    v_exp_f32 v36, v136
    v_mfma_f32_16x16x32_bf16 v[160:163], a[156:159], v[232:235], v[160:163]
    ds_read_b64_tr_b16 a[170:171], v17 offset:53248
    v_cvt_pk_bf16_f32 v87, v34, v35
    v_mfma_f32_16x16x32_bf16 v[168:171], a[156:159], v[248:251], v[168:171]
    buffer_load_dwordx4 v22, s[8:11], s41 offen offset:2048 nt lds
    v_mfma_f32_16x16x32_bf16 v[168:171], a[152:155], v[244:247], v[168:171]
    v_exp_f32 v37, v137
    v_mfma_f32_16x16x32_bf16 a[12:15], a[184:187], v[60:63], a[12:15]
    ds_read_b128 a[140:143], v11 offset:16384
    v_cvt_pk_bf16_f32 v90, v36, v37
    v_mfma_f32_16x16x32_bf16 a[12:15], a[188:191], v[28:31], a[12:15]
    v_exp_f32 v38, v138
    v_mfma_f32_16x16x32_bf16 a[44:47], a[188:191], v[40:43], a[44:47]
    v_exp_f32 v39, v139
    v_mfma_f32_16x16x32_bf16 a[44:47], a[184:187], v[64:67], a[44:47]
    ds_read_b64_tr_b16 a[172:173], v17 offset:57344
    v_cvt_pk_bf16_f32 v91, v38, v39
    v_mfma_f32_16x16x32_bf16 a[76:79], a[184:187], v[68:71], a[76:79]
    buffer_load_dwordx4 v23, s[8:11], s41 offen offset:3072 nt lds
    v_mfma_f32_16x16x32_bf16 a[76:79], a[188:191], v[172:175], a[76:79]
    ds_read_b64_tr_b16 a[174:175], v17 offset:61440
    v_mfma_f32_16x16x32_bf16 a[108:111], a[188:191], v[176:179], a[108:111]
    s_waitcnt lgkmcnt(6)
    v_mfma_f32_16x16x32_bf16 a[108:111], a[184:187], v[72:75], a[108:111]
    v_mfma_f32_16x16x32_bf16 v[108:111], a[128:131], v[188:191], v[44:47]
    v_exp_f32 v32, v140
    v_mfma_f32_16x16x32_bf16 v[108:111], a[132:135], v[192:195], v[108:111]
    ds_read_b128 a[144:147], v8 offset:20480
    s_add_u32 m0, s38, 98304
    v_mfma_f32_16x16x32_bf16 v[116:119], a[132:135], v[208:211], v[48:51]
    v_exp_f32 v33, v141
    v_mfma_f32_16x16x32_bf16 v[116:119], a[128:131], v[204:207], v[116:119]
    v_exp_f32 v34, v142
    v_mfma_f32_16x16x32_bf16 v[124:127], a[128:131], v[220:223], v[52:55]
    ds_read_b64_tr_b16 a[176:177], v18 offset:49152
    v_cvt_pk_bf16_f32 v92, v32, v33
    v_mfma_f32_16x16x32_bf16 v[124:127], a[132:135], v[224:227], v[124:127]
    v_exp_f32 v35, v143
    v_mfma_f32_16x16x32_bf16 v[132:135], a[132:135], v[240:243], v[56:59]
    ds_read_b64_tr_b16 a[178:179], v18 offset:53248
    s_sub_u32 s42, s41, 16384
    v_mfma_f32_16x16x32_bf16 v[132:135], a[128:131], v[236:239], v[132:135]
    v_exp_f32 v36, v148
    v_mfma_f32_16x16x32_bf16 a[16:19], a[160:163], v[60:63], a[16:19]
    buffer_load_dwordx4 v24, s[12:15], s42 offen offset:0 nt lds
    v_mfma_f32_16x16x32_bf16 a[16:19], a[164:167], v[28:31], a[16:19]
    v_exp_f32 v37, v149
    v_mfma_f32_16x16x32_bf16 a[48:51], a[164:167], v[40:43], a[48:51]
    ds_read_b128 a[148:151], v9 offset:20480
    v_cvt_pk_bf16_f32 v93, v34, v35
    v_mfma_f32_16x16x32_bf16 a[48:51], a[160:163], v[64:67], a[48:51]
    v_exp_f32 v38, v150
    v_mfma_f32_16x16x32_bf16 a[80:83], a[160:163], v[68:71], a[80:83]
    ds_read_b64_tr_b16 a[180:181], v18 offset:57344
    v_cvt_pk_bf16_f32 v96, v36, v37
    v_mfma_f32_16x16x32_bf16 a[80:83], a[164:167], v[172:175], a[80:83]
    v_exp_f32 v39, v151
    v_mfma_f32_16x16x32_bf16 a[240:243], a[196:199], v[172:175], a[240:243]
    ds_read_b64_tr_b16 a[182:183], v18 offset:61440
    v_cvt_pk_bf16_f32 v97, v38, v39
    v_mfma_f32_16x16x32_bf16 a[240:243], a[196:199], v[68:71], a[240:243]
    v_exp_f32 v32, v156
    v_mfma_f32_16x16x32_bf16 a[112:115], a[164:167], v[176:179], a[112:115]
    s_waitcnt lgkmcnt(6)
    ds_read_b128 a[152:155], v10 offset:20480
    v_mfma_f32_16x16x32_bf16 a[112:115], a[160:163], v[72:75], a[112:115]
    v_exp_f32 v33, v157
    v_mfma_f32_16x16x32_bf16 v[108:111], a[136:139], v[196:199], v[108:111]
    buffer_load_dwordx4 v25, s[12:15], s42 offen offset:1024 nt lds
    v_mfma_f32_16x16x32_bf16 v[108:111], a[140:143], v[200:203], v[108:111]
    v_exp_f32 v34, v158
    v_mfma_f32_16x16x32_bf16 v[116:119], a[140:143], v[216:219], v[116:119]
    ds_read_b64_tr_b16 a[184:185], v19 offset:49152
    v_cvt_pk_bf16_f32 v100, v32, v33
    v_mfma_f32_16x16x32_bf16 v[116:119], a[136:139], v[212:215], v[116:119]
    v_exp_f32 v35, v159
    v_mfma_f32_16x16x32_bf16 v[124:127], a[136:139], v[228:231], v[124:127]
    ds_read_b64_tr_b16 a[186:187], v19 offset:53248
    v_cvt_pk_bf16_f32 v101, v34, v35
    v_mfma_f32_16x16x32_bf16 v[124:127], a[140:143], v[232:235], v[124:127]
    v_exp_f32 v36, v164
    v_mfma_f32_16x16x32_bf16 v[132:135], a[140:143], v[248:251], v[132:135]
    ds_read_b128 a[156:159], v11 offset:20480
    v_mfma_f32_16x16x32_bf16 v[132:135], a[136:139], v[244:247], v[132:135]
    v_exp_f32 v37, v165
    v_mfma_f32_16x16x32_bf16 a[20:23], a[168:171], v[60:63], a[20:23]
    ds_read_b64_tr_b16 a[188:189], v19 offset:57344
    v_cvt_pk_bf16_f32 v104, v36, v37
    v_mfma_f32_16x16x32_bf16 a[20:23], a[172:175], v[28:31], a[20:23]
    v_exp_f32 v38, v166
    v_mfma_f32_16x16x32_bf16 a[52:55], a[172:175], v[40:43], a[52:55]
    buffer_load_dwordx4 v24, s[12:15], s42 offen offset:2048 nt lds
    v_mfma_f32_16x16x32_bf16 a[52:55], a[168:171], v[64:67], a[52:55]
    v_exp_f32 v39, v167
    v_mfma_f32_16x16x32_bf16 a[84:87], a[168:171], v[68:71], a[84:87]
    ds_read_b64_tr_b16 a[190:191], v19 offset:61440
    v_cvt_pk_bf16_f32 v105, v38, v39
    v_mfma_f32_16x16x32_bf16 a[84:87], a[172:175], v[172:175], a[84:87]
    v_mfma_f32_16x16x32_bf16 a[116:119], a[172:175], v[176:179], a[116:119]
    s_waitcnt lgkmcnt(6)
    ds_read_b128 a[128:131], v8 offset:24576
    v_mfma_f32_16x16x32_bf16 a[116:119], a[168:171], v[72:75], a[116:119]
    v_exp_f32 v32, v144
    v_mfma_f32_16x16x32_bf16 v[112:115], a[144:147], v[188:191], v[44:47]
    v_exp_f32 v33, v145
    v_mfma_f32_16x16x32_bf16 v[112:115], a[148:151], v[192:195], v[112:115]
    ds_read_b64_tr_b16 a[160:161], v12 offset:0
    v_cvt_pk_bf16_f32 v94, v32, v33
    v_mfma_f32_16x16x32_bf16 v[120:123], a[148:151], v[208:211], v[48:51]
    v_exp_f32 v34, v146
    v_mfma_f32_16x16x32_bf16 v[120:123], a[144:147], v[204:207], v[120:123]
    ds_read_b64_tr_b16 a[162:163], v12 offset:4096
    v_mfma_f32_16x16x32_bf16 v[128:131], a[144:147], v[220:223], v[52:55]
    v_exp_f32 v35, v147
    v_mfma_f32_16x16x32_bf16 v[128:131], a[148:151], v[224:227], v[128:131]
    buffer_load_dwordx4 v25, s[12:15], s42 offen offset:3072 nt lds
    v_mfma_f32_16x16x32_bf16 v[136:139], a[148:151], v[240:243], v[56:59]
    v_exp_f32 v36, v152
    v_mfma_f32_16x16x32_bf16 v[136:139], a[144:147], v[236:239], v[136:139]
    ds_read_b128 a[132:135], v9 offset:24576
    v_cvt_pk_bf16_f32 v95, v34, v35
    v_mfma_f32_16x16x32_bf16 a[24:27], a[176:179], v[60:63], a[24:27]
    v_exp_f32 v37, v153
    v_mfma_f32_16x16x32_bf16 a[24:27], a[180:183], v[28:31], a[24:27]
    ds_read_b64_tr_b16 a[164:165], v12 offset:8192
    v_cvt_pk_bf16_f32 v98, v36, v37
    v_mfma_f32_16x16x32_bf16 a[56:59], a[180:183], v[40:43], a[56:59]
    v_exp_f32 v38, v154
    v_mfma_f32_16x16x32_bf16 a[56:59], a[176:179], v[64:67], a[56:59]
    ds_read_b64_tr_b16 a[166:167], v12 offset:12288
    v_mfma_f32_16x16x32_bf16 a[88:91], a[176:179], v[68:71], a[88:91]
    v_exp_f32 v39, v155
    v_mfma_f32_16x16x32_bf16 a[88:91], a[180:183], v[172:175], a[88:91]
    v_cvt_pk_bf16_f32 v99, v38, v39
    v_mfma_f32_16x16x32_bf16 a[120:123], a[180:183], v[176:179], a[120:123]
    v_exp_f32 v32, v160
    v_mfma_f32_16x16x32_bf16 a[120:123], a[176:179], v[72:75], a[120:123]
    buffer_load_dwordx2 v[184:185], v255, s[56:59], s32 offen
    v_mfma_f32_16x16x32_bf16 a[244:247], a[196:199], v[72:75], a[244:247]
    s_waitcnt lgkmcnt(6)
    ds_read_b128 a[136:139], v10 offset:24576
    v_mfma_f32_16x16x32_bf16 a[244:247], a[196:199], v[176:179], a[244:247]
    v_exp_f32 v33, v161
    v_mfma_f32_16x16x32_bf16 v[112:115], a[152:155], v[196:199], v[112:115]
    v_exp_f32 v34, v162
    v_mfma_f32_16x16x32_bf16 v[112:115], a[156:159], v[200:203], v[112:115]
    ds_read_b64_tr_b16 a[168:169], v13 offset:0
    v_cvt_pk_bf16_f32 v102, v32, v33
    v_mfma_f32_16x16x32_bf16 v[120:123], a[156:159], v[216:219], v[120:123]
    v_exp_f32 v35, v163
    v_mfma_f32_16x16x32_bf16 v[120:123], a[152:155], v[212:215], v[120:123]
    ds_read_b64_tr_b16 a[170:171], v13 offset:4096
    v_cvt_pk_bf16_f32 v103, v34, v35
    v_mfma_f32_16x16x32_bf16 v[128:131], a[152:155], v[228:231], v[128:131]
    v_exp_f32 v36, v168
    v_mfma_f32_16x16x32_bf16 v[128:131], a[156:159], v[232:235], v[128:131]
    v_mfma_f32_16x16x32_bf16 v[136:139], a[156:159], v[248:251], v[136:139]
    v_exp_f32 v37, v169
    v_mfma_f32_16x16x32_bf16 v[136:139], a[152:155], v[244:247], v[136:139]
    ds_read_b128 a[140:143], v11 offset:24576
    v_cvt_pk_bf16_f32 v106, v36, v37
    v_mfma_f32_16x16x32_bf16 a[28:31], a[184:187], v[60:63], a[28:31]
    v_exp_f32 v38, v170
    v_mfma_f32_16x16x32_bf16 a[28:31], a[188:191], v[28:31], a[28:31]
    ds_read_b64_tr_b16 a[172:173], v13 offset:8192
    v_mfma_f32_16x16x32_bf16 a[60:63], a[188:191], v[40:43], a[60:63]
    v_exp_f32 v39, v171
    v_mfma_f32_16x16x32_bf16 a[60:63], a[184:187], v[64:67], a[60:63]
    buffer_load_dwordx2 v[184:185], v255, s[56:59], s32 offen offset:512
    v_mfma_f32_16x16x32_bf16 a[92:95], a[184:187], v[68:71], a[92:95]
    ds_read_b64_tr_b16 a[174:175], v13 offset:12288
    s_add_u32 s32, s32, 768
    v_mfma_f32_16x16x32_bf16 a[92:95], a[188:191], v[172:175], a[92:95]
    v_cvt_pk_bf16_f32 v107, v38, v39
    v_mfma_f32_16x16x32_bf16 a[124:127], a[188:191], v[176:179], a[124:127]
    s_waitcnt lgkmcnt(6)
    v_mfma_f32_16x16x32_bf16 a[124:127], a[184:187], v[72:75], a[124:127]
    s_sub_u32 s40, s40, 1
    s_cmp_lg_u32 s40, 0
    s_cbranch_scc1 L_attn_loop
L_attn_tail:
    v_mfma_f32_16x16x32_bf16 v[140:143], a[128:131], v[188:191], v[44:47]
    v_exp_f32 v32, v108
    v_mfma_f32_16x16x32_bf16 v[140:143], a[132:135], v[192:195], v[140:143]
    ds_read_b128 a[144:147], v8 offset:28672
    s_add_u32 m0, s36, 132096
    v_mfma_f32_16x16x32_bf16 v[148:151], a[132:135], v[208:211], v[48:51]
    v_exp_f32 v33, v109
    v_mfma_f32_16x16x32_bf16 v[148:151], a[128:131], v[204:207], v[148:151]
    v_exp_f32 v34, v110
    v_mfma_f32_16x16x32_bf16 v[156:159], a[128:131], v[220:223], v[52:55]
    ds_read_b64_tr_b16 a[176:177], v14 offset:0
    v_cvt_pk_bf16_f32 v60, v32, v33
    v_mfma_f32_16x16x32_bf16 v[156:159], a[132:135], v[224:227], v[156:159]
    v_exp_f32 v35, v111
    v_mfma_f32_16x16x32_bf16 v[164:167], a[132:135], v[240:243], v[56:59]
    ds_read_b64_tr_b16 a[178:179], v14 offset:4096
    s_mov_b32 s39, 0
    v_mfma_f32_16x16x32_bf16 v[164:167], a[128:131], v[236:239], v[164:167]
    v_exp_f32 v36, v116
    v_mfma_f32_16x16x32_bf16 a[0:3], a[160:163], v[76:79], a[0:3]
    s_mov_b32 s42, 4718592
    ds_read_b128 a[148:151], v9 offset:28672
    v_mfma_f32_16x16x32_bf16 a[0:3], a[164:167], v[92:95], a[0:3]
    v_exp_f32 v37, v117
    v_mfma_f32_16x16x32_bf16 a[232:235], a[196:199], v[92:95], a[232:235]
    v_cvt_pk_bf16_f32 v61, v34, v35
    ds_read_b64_tr_b16 a[180:181], v14 offset:8192
    v_mfma_f32_16x16x32_bf16 a[232:235], a[196:199], v[76:79], a[232:235]
    v_exp_f32 v38, v118
    v_mfma_f32_16x16x32_bf16 a[32:35], a[164:167], v[96:99], a[32:35]
    v_cvt_pk_bf16_f32 v64, v36, v37
    ds_read_b64_tr_b16 a[182:183], v14 offset:12288
    v_mfma_f32_16x16x32_bf16 a[32:35], a[160:163], v[80:83], a[32:35]
    v_exp_f32 v39, v119
    v_mfma_f32_16x16x32_bf16 a[64:67], a[160:163], v[84:87], a[64:67]
    buffer_load_dwordx4 v0, s[60:63], s42 offen lds
    v_mfma_f32_16x16x32_bf16 a[64:67], a[164:167], v[100:103], a[64:67]
    v_exp_f32 v32, v124
    v_mfma_f32_16x16x32_bf16 a[96:99], a[164:167], v[104:107], a[96:99]
    s_waitcnt lgkmcnt(6)
    ds_read_b128 a[152:155], v10 offset:28672
    v_mfma_f32_16x16x32_bf16 a[96:99], a[160:163], v[88:91], a[96:99]
    v_exp_f32 v33, v125
    v_mfma_f32_16x16x32_bf16 v[140:143], a[136:139], v[196:199], v[140:143]
    v_cvt_pk_bf16_f32 v65, v38, v39
    s_add_u32 m0, s36, 136192
    v_mfma_f32_16x16x32_bf16 v[140:143], a[140:143], v[200:203], v[140:143]
    v_exp_f32 v34, v126
    v_mfma_f32_16x16x32_bf16 v[148:151], a[140:143], v[216:219], v[148:151]
    ds_read_b64_tr_b16 a[184:185], v15 offset:0
    v_cvt_pk_bf16_f32 v68, v32, v33
    v_mfma_f32_16x16x32_bf16 v[148:151], a[136:139], v[212:215], v[148:151]
    v_exp_f32 v35, v127
    v_mfma_f32_16x16x32_bf16 v[156:159], a[136:139], v[228:231], v[156:159]
    ds_read_b64_tr_b16 a[186:187], v15 offset:4096
    v_cvt_pk_bf16_f32 v69, v34, v35
    v_mfma_f32_16x16x32_bf16 v[156:159], a[140:143], v[232:235], v[156:159]
    v_exp_f32 v36, v132
    v_mfma_f32_16x16x32_bf16 v[164:167], a[140:143], v[248:251], v[164:167]
    ds_read_b128 a[156:159], v11 offset:28672
    v_mfma_f32_16x16x32_bf16 v[164:167], a[136:139], v[244:247], v[164:167]
    v_exp_f32 v37, v133
    v_mfma_f32_16x16x32_bf16 a[4:7], a[168:171], v[76:79], a[4:7]
    buffer_load_dwordx4 v0, s[64:67], s42 offen lds
    v_mfma_f32_16x16x32_bf16 a[4:7], a[172:175], v[92:95], a[4:7]
    buffer_load_dwordx4 a[200:203], v0, s[60:63], s39 offen
    v_mfma_f32_16x16x32_bf16 a[36:39], a[172:175], v[96:99], a[36:39]
    v_exp_f32 v38, v134
    v_mfma_f32_16x16x32_bf16 a[36:39], a[168:171], v[80:83], a[36:39]
    ds_read_b64_tr_b16 a[188:189], v15 offset:8192
    v_cvt_pk_bf16_f32 v72, v36, v37
    v_mfma_f32_16x16x32_bf16 a[68:71], a[168:171], v[84:87], a[68:71]
    v_exp_f32 v39, v135
    v_mfma_f32_16x16x32_bf16 a[68:71], a[172:175], v[100:103], a[68:71]
    ds_read_b64_tr_b16 a[190:191], v15 offset:12288
    v_cvt_pk_bf16_f32 v73, v38, v39
    v_mfma_f32_16x16x32_bf16 a[100:103], a[172:175], v[104:107], a[100:103]
    s_waitcnt lgkmcnt(6)
    v_mfma_f32_16x16x32_bf16 a[100:103], a[168:171], v[88:91], a[100:103]
    v_exp_f32 v32, v112
    v_mfma_f32_16x16x32_bf16 v[144:147], a[144:147], v[188:191], v[44:47]
    s_waitcnt vmcnt(15)
    s_barrier
    v_mfma_f32_16x16x32_bf16 v[144:147], a[148:151], v[192:195], v[144:147]
    v_exp_f32 v33, v113
    v_mfma_f32_16x16x32_bf16 v[152:155], a[148:151], v[208:211], v[48:51]
    ds_read_b128 a[128:131], v8 offset:32768
    v_cvt_pk_bf16_f32 v62, v32, v33
    v_mfma_f32_16x16x32_bf16 v[152:155], a[144:147], v[204:207], v[152:155]
    v_exp_f32 v34, v114
    v_mfma_f32_16x16x32_bf16 v[160:163], a[144:147], v[220:223], v[52:55]
    ds_read_b64_tr_b16 a[160:161], v16 offset:0
    s_add_u32 m0, s38, 0
    v_mfma_f32_16x16x32_bf16 v[160:163], a[148:151], v[224:227], v[160:163]
    v_exp_f32 v35, v115
    v_mfma_f32_16x16x32_bf16 v[168:171], a[148:151], v[240:243], v[56:59]
    v_exp_f32 v36, v120
    v_mfma_f32_16x16x32_bf16 v[168:171], a[144:147], v[236:239], v[168:171]
    ds_read_b64_tr_b16 a[162:163], v16 offset:4096
    s_mov_b32 s42, 0x0
    v_mfma_f32_16x16x32_bf16 a[8:11], a[176:179], v[76:79], a[8:11]
    buffer_load_dwordx4 v180, s[56:59], s42 offen offset:0  lds
    v_mfma_f32_16x16x32_bf16 a[8:11], a[180:183], v[92:95], a[8:11]
    v_exp_f32 v37, v121
    v_mfma_f32_16x16x32_bf16 a[40:43], a[180:183], v[96:99], a[40:43]
    ds_read_b128 a[132:135], v9 offset:32768
    v_cvt_pk_bf16_f32 v63, v34, v35
    v_mfma_f32_16x16x32_bf16 a[40:43], a[176:179], v[80:83], a[40:43]
    v_exp_f32 v38, v122
    v_mfma_f32_16x16x32_bf16 a[236:239], a[196:199], v[80:83], a[236:239]
    buffer_load_dwordx4 a[204:207], v0, s[64:67], s39 offen
    v_mfma_f32_16x16x32_bf16 a[236:239], a[196:199], v[96:99], a[236:239]
    v_exp_f32 v39, v123
    v_mfma_f32_16x16x32_bf16 a[72:75], a[176:179], v[84:87], a[72:75]
    ds_read_b64_tr_b16 a[164:165], v16 offset:8192
    v_cvt_pk_bf16_f32 v66, v36, v37
    v_mfma_f32_16x16x32_bf16 a[72:75], a[180:183], v[100:103], a[72:75]
    v_exp_f32 v32, v128
    v_mfma_f32_16x16x32_bf16 a[104:107], a[180:183], v[104:107], a[104:107]
    s_waitcnt lgkmcnt(5)
    ds_read_b64_tr_b16 a[166:167], v16 offset:12288
    v_mfma_f32_16x16x32_bf16 a[104:107], a[176:179], v[88:91], a[104:107]
    buffer_load_dwordx4 v181, s[56:59], s42 offen offset:1024  lds
    v_mfma_f32_16x16x32_bf16 v[144:147], a[152:155], v[196:199], v[144:147]
    v_exp_f32 v33, v129
    v_mfma_f32_16x16x32_bf16 v[144:147], a[156:159], v[200:203], v[144:147]
    ds_read_b128 a[136:139], v10 offset:32768
    v_cvt_pk_bf16_f32 v67, v38, v39
    v_mfma_f32_16x16x32_bf16 v[152:155], a[156:159], v[216:219], v[152:155]
    v_exp_f32 v34, v130
    v_mfma_f32_16x16x32_bf16 v[152:155], a[152:155], v[212:215], v[152:155]
    v_exp_f32 v35, v131
    v_mfma_f32_16x16x32_bf16 v[160:163], a[152:155], v[228:231], v[160:163]
    ds_read_b64_tr_b16 a[168:169], v17 offset:0
    v_cvt_pk_bf16_f32 v70, v32, v33
    v_mfma_f32_16x16x32_bf16 v[160:163], a[156:159], v[232:235], v[160:163]
    v_exp_f32 v36, v136
    v_mfma_f32_16x16x32_bf16 v[168:171], a[156:159], v[248:251], v[168:171]
    ds_read_b64_tr_b16 a[170:171], v17 offset:4096
    v_cvt_pk_bf16_f32 v71, v34, v35
    v_mfma_f32_16x16x32_bf16 v[168:171], a[152:155], v[244:247], v[168:171]
    buffer_load_dwordx4 v182, s[56:59], s42 offen offset:2048  lds
    v_mfma_f32_16x16x32_bf16 a[12:15], a[184:187], v[76:79], a[12:15]
    v_exp_f32 v37, v137
    v_mfma_f32_16x16x32_bf16 a[12:15], a[188:191], v[92:95], a[12:15]
    ds_read_b128 a[140:143], v11 offset:32768
    v_cvt_pk_bf16_f32 v74, v36, v37
    v_mfma_f32_16x16x32_bf16 a[44:47], a[188:191], v[96:99], a[44:47]
    v_exp_f32 v38, v138
    v_mfma_f32_16x16x32_bf16 a[44:47], a[184:187], v[80:83], a[44:47]
    v_exp_f32 v39, v139
    v_mfma_f32_16x16x32_bf16 a[76:79], a[184:187], v[84:87], a[76:79]
    ds_read_b64_tr_b16 a[172:173], v17 offset:8192
    v_cvt_pk_bf16_f32 v75, v38, v39
    v_mfma_f32_16x16x32_bf16 a[76:79], a[188:191], v[100:103], a[76:79]
    buffer_load_dwordx4 v183, s[56:59], s42 offen offset:3072  lds
    v_mfma_f32_16x16x32_bf16 a[108:111], a[188:191], v[104:107], a[108:111]
    s_waitcnt lgkmcnt(5)
    ds_read_b64_tr_b16 a[174:175], v17 offset:12288
    v_mfma_f32_16x16x32_bf16 a[108:111], a[184:187], v[88:91], a[108:111]
    v_mfma_f32_16x16x32_bf16 v[108:111], a[128:131], v[188:191], v[44:47]
    v_exp_f32 v32, v140
    v_mfma_f32_16x16x32_bf16 v[108:111], a[132:135], v[192:195], v[108:111]
    ds_read_b128 a[144:147], v8 offset:36864
    s_mov_b32 s39, 589824
    v_mfma_f32_16x16x32_bf16 v[116:119], a[132:135], v[208:211], v[48:51]
    v_exp_f32 v33, v141
    v_mfma_f32_16x16x32_bf16 v[116:119], a[128:131], v[204:207], v[116:119]
    v_exp_f32 v34, v142
    v_mfma_f32_16x16x32_bf16 v[124:127], a[128:131], v[220:223], v[52:55]
    ds_read_b64_tr_b16 a[176:177], v18 offset:0
    v_cvt_pk_bf16_f32 v28, v32, v33
    v_mfma_f32_16x16x32_bf16 v[124:127], a[132:135], v[224:227], v[124:127]
    v_exp_f32 v35, v143
    v_mfma_f32_16x16x32_bf16 v[132:135], a[132:135], v[240:243], v[56:59]
    ds_read_b64_tr_b16 a[178:179], v18 offset:4096
    v_cvt_pk_bf16_f32 v29, v34, v35
    v_mfma_f32_16x16x32_bf16 v[132:135], a[128:131], v[236:239], v[132:135]
    v_exp_f32 v36, v148
    v_mfma_f32_16x16x32_bf16 a[16:19], a[160:163], v[76:79], a[16:19]
    ds_read_b128 a[148:151], v9 offset:36864
    s_add_u32 m0, s38, 114688
    v_mfma_f32_16x16x32_bf16 a[16:19], a[164:167], v[92:95], a[16:19]
    v_exp_f32 v37, v149
    v_mfma_f32_16x16x32_bf16 a[48:51], a[164:167], v[96:99], a[48:51]
    s_sub_u32 s42, s41, 0
    ds_read_b64_tr_b16 a[180:181], v18 offset:8192
    v_mfma_f32_16x16x32_bf16 a[48:51], a[160:163], v[80:83], a[48:51]
    v_exp_f32 v38, v150
    v_mfma_f32_16x16x32_bf16 a[80:83], a[160:163], v[84:87], a[80:83]
    buffer_load_dwordx4 v24, s[12:15], s42 offen offset:0 nt lds
    v_mfma_f32_16x16x32_bf16 a[80:83], a[164:167], v[100:103], a[80:83]
    v_exp_f32 v39, v151
    v_mfma_f32_16x16x32_bf16 a[240:243], a[196:199], v[100:103], a[240:243]
    v_cvt_pk_bf16_f32 v40, v36, v37
    ds_read_b64_tr_b16 a[182:183], v18 offset:12288
    v_mfma_f32_16x16x32_bf16 a[240:243], a[196:199], v[84:87], a[240:243]
    v_exp_f32 v32, v156
    v_mfma_f32_16x16x32_bf16 a[112:115], a[164:167], v[104:107], a[112:115]
    s_waitcnt lgkmcnt(6)
    ds_read_b128 a[152:155], v10 offset:36864
    v_mfma_f32_16x16x32_bf16 a[112:115], a[160:163], v[88:91], a[112:115]
    v_exp_f32 v33, v157
    v_mfma_f32_16x16x32_bf16 v[108:111], a[136:139], v[196:199], v[108:111]
    v_cvt_pk_bf16_f32 v41, v38, v39
    ds_read_b64_tr_b16 a[184:185], v19 offset:0
    v_mfma_f32_16x16x32_bf16 v[108:111], a[140:143], v[200:203], v[108:111]
    v_exp_f32 v34, v158
    v_mfma_f32_16x16x32_bf16 v[116:119], a[140:143], v[216:219], v[116:119]
    v_cvt_pk_bf16_f32 v172, v32, v33
    ds_read_b64_tr_b16 a[186:187], v19 offset:4096
    v_mfma_f32_16x16x32_bf16 v[116:119], a[136:139], v[212:215], v[116:119]
    v_exp_f32 v35, v159
    v_mfma_f32_16x16x32_bf16 v[124:127], a[136:139], v[228:231], v[124:127]
    buffer_load_dwordx4 a[208:211], v0, s[60:63], s39 offen
    v_mfma_f32_16x16x32_bf16 v[124:127], a[140:143], v[232:235], v[124:127]
    v_exp_f32 v36, v164
    v_mfma_f32_16x16x32_bf16 v[132:135], a[140:143], v[248:251], v[132:135]
    ds_read_b128 a[156:159], v11 offset:36864
    v_cvt_pk_bf16_f32 v173, v34, v35
    v_mfma_f32_16x16x32_bf16 v[132:135], a[136:139], v[244:247], v[132:135]
    v_exp_f32 v37, v165
    v_mfma_f32_16x16x32_bf16 a[20:23], a[168:171], v[76:79], a[20:23]
    buffer_load_dwordx4 v25, s[12:15], s42 offen offset:1024 nt lds
    v_mfma_f32_16x16x32_bf16 a[20:23], a[172:175], v[92:95], a[20:23]
    v_exp_f32 v38, v166
    v_mfma_f32_16x16x32_bf16 a[52:55], a[172:175], v[96:99], a[52:55]
    ds_read_b64_tr_b16 a[188:189], v19 offset:8192
    v_cvt_pk_bf16_f32 v176, v36, v37
    v_mfma_f32_16x16x32_bf16 a[52:55], a[168:171], v[80:83], a[52:55]
    v_exp_f32 v39, v167
    v_mfma_f32_16x16x32_bf16 a[84:87], a[168:171], v[84:87], a[84:87]
    ds_read_b64_tr_b16 a[190:191], v19 offset:12288
    v_cvt_pk_bf16_f32 v177, v38, v39
    v_mfma_f32_16x16x32_bf16 a[84:87], a[172:175], v[100:103], a[84:87]
    v_mfma_f32_16x16x32_bf16 a[116:119], a[172:175], v[104:107], a[116:119]
    s_waitcnt lgkmcnt(6)
    ds_read_b128 a[128:131], v8 offset:40960
    v_mfma_f32_16x16x32_bf16 a[116:119], a[168:171], v[88:91], a[116:119]
    v_exp_f32 v32, v144
    v_mfma_f32_16x16x32_bf16 v[112:115], a[144:147], v[188:191], v[44:47]
    v_exp_f32 v33, v145
    v_mfma_f32_16x16x32_bf16 v[112:115], a[148:151], v[192:195], v[112:115]
    ds_read_b64_tr_b16 a[160:161], v12 offset:16384
    v_cvt_pk_bf16_f32 v30, v32, v33
    v_mfma_f32_16x16x32_bf16 v[120:123], a[148:151], v[208:211], v[48:51]
    v_exp_f32 v34, v146
    v_mfma_f32_16x16x32_bf16 v[120:123], a[144:147], v[204:207], v[120:123]
    ds_read_b64_tr_b16 a[162:163], v12 offset:20480
    v_mfma_f32_16x16x32_bf16 v[128:131], a[144:147], v[220:223], v[52:55]
    v_exp_f32 v35, v147
    v_mfma_f32_16x16x32_bf16 v[128:131], a[148:151], v[224:227], v[128:131]
    v_cvt_pk_bf16_f32 v31, v34, v35
    v_mfma_f32_16x16x32_bf16 v[136:139], a[148:151], v[240:243], v[56:59]
    v_exp_f32 v36, v152
    v_mfma_f32_16x16x32_bf16 v[136:139], a[144:147], v[236:239], v[136:139]
    ds_read_b128 a[132:135], v9 offset:40960
    v_mfma_f32_16x16x32_bf16 a[24:27], a[176:179], v[76:79], a[24:27]
    v_exp_f32 v37, v153
    v_mfma_f32_16x16x32_bf16 a[24:27], a[180:183], v[92:95], a[24:27]
    buffer_load_dwordx4 v24, s[12:15], s42 offen offset:2048 nt lds
    v_mfma_f32_16x16x32_bf16 a[56:59], a[180:183], v[96:99], a[56:59]
    v_exp_f32 v38, v154
    v_mfma_f32_16x16x32_bf16 a[56:59], a[176:179], v[80:83], a[56:59]
    buffer_load_dwordx4 a[212:215], v0, s[64:67], s39 offen
    v_mfma_f32_16x16x32_bf16 a[88:91], a[176:179], v[84:87], a[88:91]
    v_exp_f32 v39, v155
    v_mfma_f32_16x16x32_bf16 a[88:91], a[180:183], v[100:103], a[88:91]
    ds_read_b64_tr_b16 a[164:165], v12 offset:24576
    v_cvt_pk_bf16_f32 v42, v36, v37
    v_mfma_f32_16x16x32_bf16 a[120:123], a[180:183], v[104:107], a[120:123]
    v_exp_f32 v32, v160
    v_mfma_f32_16x16x32_bf16 a[120:123], a[176:179], v[88:91], a[120:123]
    ds_read_b64_tr_b16 a[166:167], v12 offset:28672
    v_cvt_pk_bf16_f32 v43, v38, v39
    v_mfma_f32_16x16x32_bf16 a[244:247], a[196:199], v[88:91], a[244:247]
    s_waitcnt lgkmcnt(6)
    ds_read_b128 a[136:139], v10 offset:40960
    v_mfma_f32_16x16x32_bf16 a[244:247], a[196:199], v[104:107], a[244:247]
    v_exp_f32 v33, v161
    v_mfma_f32_16x16x32_bf16 v[112:115], a[152:155], v[196:199], v[112:115]
    v_exp_f32 v34, v162
    v_mfma_f32_16x16x32_bf16 v[112:115], a[156:159], v[200:203], v[112:115]
    ds_read_b64_tr_b16 a[168:169], v13 offset:16384
    v_cvt_pk_bf16_f32 v174, v32, v33
    v_mfma_f32_16x16x32_bf16 v[120:123], a[156:159], v[216:219], v[120:123]
    v_exp_f32 v35, v163
    v_mfma_f32_16x16x32_bf16 v[120:123], a[152:155], v[212:215], v[120:123]
    ds_read_b64_tr_b16 a[170:171], v13 offset:20480
    v_cvt_pk_bf16_f32 v175, v34, v35
    v_mfma_f32_16x16x32_bf16 v[128:131], a[152:155], v[228:231], v[128:131]
    v_exp_f32 v36, v168
    v_mfma_f32_16x16x32_bf16 v[128:131], a[156:159], v[232:235], v[128:131]
    buffer_load_dwordx4 v25, s[12:15], s42 offen offset:3072 nt lds
    v_mfma_f32_16x16x32_bf16 v[136:139], a[156:159], v[248:251], v[136:139]
    v_exp_f32 v37, v169
    v_mfma_f32_16x16x32_bf16 v[136:139], a[152:155], v[244:247], v[136:139]
    ds_read_b128 a[140:143], v11 offset:40960
    v_cvt_pk_bf16_f32 v178, v36, v37
    v_mfma_f32_16x16x32_bf16 a[28:31], a[184:187], v[76:79], a[28:31]
    v_exp_f32 v38, v170
    v_mfma_f32_16x16x32_bf16 a[28:31], a[188:191], v[92:95], a[28:31]
    ds_read_b64_tr_b16 a[172:173], v13 offset:24576
    v_mfma_f32_16x16x32_bf16 a[60:63], a[188:191], v[96:99], a[60:63]
    v_exp_f32 v39, v171
    v_mfma_f32_16x16x32_bf16 a[60:63], a[184:187], v[80:83], a[60:63]
    ds_read_b64_tr_b16 a[174:175], v13 offset:28672
    v_cvt_pk_bf16_f32 v179, v38, v39
    v_mfma_f32_16x16x32_bf16 a[92:95], a[184:187], v[84:87], a[92:95]
    v_mfma_f32_16x16x32_bf16 a[92:95], a[188:191], v[100:103], a[92:95]
    v_mfma_f32_16x16x32_bf16 a[124:127], a[188:191], v[104:107], a[124:127]
    s_waitcnt lgkmcnt(6)
    v_mfma_f32_16x16x32_bf16 a[124:127], a[184:187], v[88:91], a[124:127]
    v_mfma_f32_16x16x32_bf16 v[140:143], a[128:131], v[188:191], v[44:47]
    v_exp_f32 v32, v108
    v_mfma_f32_16x16x32_bf16 v[140:143], a[132:135], v[192:195], v[140:143]
    ds_read_b128 a[144:147], v8 offset:45056
    s_add_u32 m0, s36, 140288
    v_mfma_f32_16x16x32_bf16 v[148:151], a[132:135], v[208:211], v[48:51]
    v_exp_f32 v33, v109
    v_mfma_f32_16x16x32_bf16 v[148:151], a[128:131], v[204:207], v[148:151]
    v_exp_f32 v34, v110
    v_mfma_f32_16x16x32_bf16 v[156:159], a[128:131], v[220:223], v[52:55]
    ds_read_b64_tr_b16 a[176:177], v14 offset:16384
    v_cvt_pk_bf16_f32 v76, v32, v33
    v_mfma_f32_16x16x32_bf16 v[156:159], a[132:135], v[224:227], v[156:159]
    v_exp_f32 v35, v111
    v_mfma_f32_16x16x32_bf16 v[164:167], a[132:135], v[240:243], v[56:59]
    ds_read_b64_tr_b16 a[178:179], v14 offset:20480
    s_movk_i32 s42, 768
    v_mfma_f32_16x16x32_bf16 v[164:167], a[128:131], v[236:239], v[164:167]
    v_exp_f32 v36, v116
    v_mfma_f32_16x16x32_bf16 a[0:3], a[160:163], v[60:63], a[0:3]
    ds_read_b128 a[148:151], v9 offset:45056
    v_cvt_pk_bf16_f32 v77, v34, v35
    v_mfma_f32_16x16x32_bf16 a[0:3], a[164:167], v[28:31], a[0:3]
    v_exp_f32 v37, v117
    v_mfma_f32_16x16x32_bf16 a[232:235], a[196:199], v[28:31], a[232:235]
    ds_read_b64_tr_b16 a[180:181], v14 offset:24576
    v_cvt_pk_bf16_f32 v80, v36, v37
    v_mfma_f32_16x16x32_bf16 a[232:235], a[196:199], v[60:63], a[232:235]
    v_exp_f32 v38, v118
    v_mfma_f32_16x16x32_bf16 a[32:35], a[164:167], v[40:43], a[32:35]
    buffer_load_dwordx4 v2, s[68:71], s42 offen lds
    v_mfma_f32_16x16x32_bf16 a[32:35], a[160:163], v[64:67], a[32:35]
    v_exp_f32 v39, v119
    v_mfma_f32_16x16x32_bf16 a[64:67], a[160:163], v[68:71], a[64:67]
    ds_read_b64_tr_b16 a[182:183], v14 offset:28672
    s_add_u32 m0, s36, 144384
    v_mfma_f32_16x16x32_bf16 a[64:67], a[164:167], v[172:175], a[64:67]
    v_exp_f32 v32, v124
    v_mfma_f32_16x16x32_bf16 a[96:99], a[164:167], v[176:179], a[96:99]
    s_waitcnt lgkmcnt(6)
    ds_read_b128 a[152:155], v10 offset:45056
    v_mfma_f32_16x16x32_bf16 a[96:99], a[160:163], v[72:75], a[96:99]
    v_exp_f32 v33, v125
    v_mfma_f32_16x16x32_bf16 v[140:143], a[136:139], v[196:199], v[140:143]
    v_cvt_pk_bf16_f32 v81, v38, v39
    ds_read_b64_tr_b16 a[184:185], v15 offset:16384
    v_mfma_f32_16x16x32_bf16 v[140:143], a[140:143], v[200:203], v[140:143]
    v_exp_f32 v34, v126
    v_mfma_f32_16x16x32_bf16 v[148:151], a[140:143], v[216:219], v[148:151]
    s_movk_i32 s42, 896
    v_cvt_pk_bf16_f32 v84, v32, v33
    v_mfma_f32_16x16x32_bf16 v[148:151], a[136:139], v[212:215], v[148:151]
    v_exp_f32 v35, v127
    v_mfma_f32_16x16x32_bf16 v[156:159], a[136:139], v[228:231], v[156:159]
    ds_read_b64_tr_b16 a[186:187], v15 offset:20480
    v_cvt_pk_bf16_f32 v85, v34, v35
    v_mfma_f32_16x16x32_bf16 v[156:159], a[140:143], v[232:235], v[156:159]
    v_exp_f32 v36, v132
    v_mfma_f32_16x16x32_bf16 v[164:167], a[140:143], v[248:251], v[164:167]
    ds_read_b128 a[156:159], v11 offset:45056
    v_mfma_f32_16x16x32_bf16 v[164:167], a[136:139], v[244:247], v[164:167]
    v_exp_f32 v37, v133
    v_mfma_f32_16x16x32_bf16 a[4:7], a[168:171], v[60:63], a[4:7]
    buffer_load_dwordx4 v2, s[68:71], s42 offen lds
    v_mfma_f32_16x16x32_bf16 a[4:7], a[172:175], v[28:31], a[4:7]
    v_exp_f32 v38, v134
    v_mfma_f32_16x16x32_bf16 a[36:39], a[172:175], v[40:43], a[36:39]
    ds_read_b64_tr_b16 a[188:189], v15 offset:24576
    v_cvt_pk_bf16_f32 v88, v36, v37
    v_mfma_f32_16x16x32_bf16 a[36:39], a[168:171], v[64:67], a[36:39]
    v_exp_f32 v39, v135
    v_mfma_f32_16x16x32_bf16 a[68:71], a[168:171], v[68:71], a[68:71]
    ds_read_b64_tr_b16 a[190:191], v15 offset:28672
    v_cvt_pk_bf16_f32 v89, v38, v39
    v_mfma_f32_16x16x32_bf16 a[68:71], a[172:175], v[172:175], a[68:71]
    v_mfma_f32_16x16x32_bf16 a[100:103], a[172:175], v[176:179], a[100:103]
    s_waitcnt lgkmcnt(6)
    v_mfma_f32_16x16x32_bf16 a[100:103], a[168:171], v[72:75], a[100:103]
    v_exp_f32 v32, v112
    v_mfma_f32_16x16x32_bf16 v[144:147], a[144:147], v[188:191], v[44:47]
    s_waitcnt vmcnt(18)
    s_barrier
    v_mfma_f32_16x16x32_bf16 v[144:147], a[148:151], v[192:195], v[144:147]
    v_exp_f32 v33, v113
    v_mfma_f32_16x16x32_bf16 v[152:155], a[148:151], v[208:211], v[48:51]
    ds_read_b128 a[128:131], v8 offset:49152
    v_cvt_pk_bf16_f32 v78, v32, v33
    v_mfma_f32_16x16x32_bf16 v[152:155], a[144:147], v[204:207], v[152:155]
    v_exp_f32 v34, v114
    v_mfma_f32_16x16x32_bf16 v[160:163], a[144:147], v[220:223], v[52:55]
    ds_read_b64_tr_b16 a[160:161], v16 offset:16384
    s_add_u32 m0, s38, 16384
    v_mfma_f32_16x16x32_bf16 v[160:163], a[148:151], v[224:227], v[160:163]
    v_exp_f32 v35, v115
    v_mfma_f32_16x16x32_bf16 v[168:171], a[148:151], v[240:243], v[56:59]
    v_exp_f32 v36, v120
    v_mfma_f32_16x16x32_bf16 v[168:171], a[144:147], v[236:239], v[168:171]
    ds_read_b64_tr_b16 a[162:163], v16 offset:20480
    s_mov_b32 s42, 0x24000
    v_mfma_f32_16x16x32_bf16 a[8:11], a[176:179], v[60:63], a[8:11]
    buffer_load_dwordx4 v180, s[56:59], s42 offen offset:0  lds
    v_mfma_f32_16x16x32_bf16 a[8:11], a[180:183], v[28:31], a[8:11]
    v_exp_f32 v37, v121
    v_mfma_f32_16x16x32_bf16 a[40:43], a[180:183], v[40:43], a[40:43]
    ds_read_b128 a[132:135], v9 offset:49152
    v_cvt_pk_bf16_f32 v79, v34, v35
    v_mfma_f32_16x16x32_bf16 a[40:43], a[176:179], v[64:67], a[40:43]
    v_exp_f32 v38, v122
    v_mfma_f32_16x16x32_bf16 a[236:239], a[196:199], v[64:67], a[236:239]
    v_exp_f32 v39, v123
    v_mfma_f32_16x16x32_bf16 a[236:239], a[196:199], v[40:43], a[236:239]
    ds_read_b64_tr_b16 a[164:165], v16 offset:24576
    v_cvt_pk_bf16_f32 v82, v36, v37
    v_mfma_f32_16x16x32_bf16 a[72:75], a[176:179], v[68:71], a[72:75]
    v_exp_f32 v32, v128
    v_mfma_f32_16x16x32_bf16 a[72:75], a[180:183], v[172:175], a[72:75]
    ds_read_b64_tr_b16 a[166:167], v16 offset:28672
    v_cvt_pk_bf16_f32 v83, v38, v39
    v_mfma_f32_16x16x32_bf16 a[104:107], a[180:183], v[176:179], a[104:107]
    s_waitcnt lgkmcnt(6)
    ds_read_b128 a[136:139], v10 offset:49152
    v_mfma_f32_16x16x32_bf16 a[104:107], a[176:179], v[72:75], a[104:107]
    buffer_load_dwordx4 v181, s[56:59], s42 offen offset:1024  lds
    v_mfma_f32_16x16x32_bf16 v[144:147], a[152:155], v[196:199], v[144:147]
    v_exp_f32 v33, v129
    v_mfma_f32_16x16x32_bf16 v[144:147], a[156:159], v[200:203], v[144:147]
    v_exp_f32 v34, v130
    v_mfma_f32_16x16x32_bf16 v[152:155], a[156:159], v[216:219], v[152:155]
    v_exp_f32 v35, v131
    v_mfma_f32_16x16x32_bf16 v[152:155], a[152:155], v[212:215], v[152:155]
    ds_read_b64_tr_b16 a[168:169], v17 offset:16384
    v_cvt_pk_bf16_f32 v86, v32, v33
    v_mfma_f32_16x16x32_bf16 v[160:163], a[152:155], v[228:231], v[160:163]
    v_exp_f32 v36, v136
    v_mfma_f32_16x16x32_bf16 v[160:163], a[156:159], v[232:235], v[160:163]
    ds_read_b64_tr_b16 a[170:171], v17 offset:20480
    v_cvt_pk_bf16_f32 v87, v34, v35
    v_mfma_f32_16x16x32_bf16 v[168:171], a[156:159], v[248:251], v[168:171]
    buffer_load_dwordx4 v182, s[56:59], s42 offen offset:2048  lds
    v_mfma_f32_16x16x32_bf16 v[168:171], a[152:155], v[244:247], v[168:171]
    v_exp_f32 v37, v137
    v_mfma_f32_16x16x32_bf16 a[12:15], a[184:187], v[60:63], a[12:15]
    ds_read_b128 a[140:143], v11 offset:49152
    v_cvt_pk_bf16_f32 v90, v36, v37
    v_mfma_f32_16x16x32_bf16 a[12:15], a[188:191], v[28:31], a[12:15]
    v_exp_f32 v38, v138
    v_mfma_f32_16x16x32_bf16 a[44:47], a[188:191], v[40:43], a[44:47]
    v_exp_f32 v39, v139
    v_mfma_f32_16x16x32_bf16 a[44:47], a[184:187], v[64:67], a[44:47]
    ds_read_b64_tr_b16 a[172:173], v17 offset:24576
    v_cvt_pk_bf16_f32 v91, v38, v39
    v_mfma_f32_16x16x32_bf16 a[76:79], a[184:187], v[68:71], a[76:79]
    buffer_load_dwordx4 v183, s[56:59], s42 offen offset:3072  lds
    v_mfma_f32_16x16x32_bf16 a[76:79], a[188:191], v[172:175], a[76:79]
    ds_read_b64_tr_b16 a[174:175], v17 offset:28672
    v_mfma_f32_16x16x32_bf16 a[108:111], a[188:191], v[176:179], a[108:111]
    s_waitcnt lgkmcnt(6)
    v_mfma_f32_16x16x32_bf16 a[108:111], a[184:187], v[72:75], a[108:111]
    v_mfma_f32_16x16x32_bf16 v[108:111], a[128:131], v[188:191], v[44:47]
    v_exp_f32 v32, v140
    v_mfma_f32_16x16x32_bf16 v[108:111], a[132:135], v[192:195], v[108:111]
    ds_read_b128 a[144:147], v8 offset:53248
    s_mov_b32 s39, 1179648
    v_mfma_f32_16x16x32_bf16 v[116:119], a[132:135], v[208:211], v[48:51]
    v_exp_f32 v33, v141
    v_mfma_f32_16x16x32_bf16 v[116:119], a[128:131], v[204:207], v[116:119]
    v_exp_f32 v34, v142
    v_mfma_f32_16x16x32_bf16 v[124:127], a[128:131], v[220:223], v[52:55]
    ds_read_b64_tr_b16 a[176:177], v18 offset:16384
    v_cvt_pk_bf16_f32 v92, v32, v33
    v_mfma_f32_16x16x32_bf16 v[124:127], a[132:135], v[224:227], v[124:127]
    v_exp_f32 v35, v143
    v_mfma_f32_16x16x32_bf16 v[132:135], a[132:135], v[240:243], v[56:59]
    ds_read_b64_tr_b16 a[178:179], v18 offset:20480
    v_cvt_pk_bf16_f32 v93, v34, v35
    v_mfma_f32_16x16x32_bf16 v[132:135], a[128:131], v[236:239], v[132:135]
    v_exp_f32 v36, v148
    v_mfma_f32_16x16x32_bf16 a[16:19], a[160:163], v[60:63], a[16:19]
    ds_read_b128 a[148:151], v9 offset:53248
    s_add_u32 m0, s38, 65536
    v_mfma_f32_16x16x32_bf16 a[16:19], a[164:167], v[28:31], a[16:19]
    v_exp_f32 v37, v149
    v_mfma_f32_16x16x32_bf16 a[48:51], a[164:167], v[40:43], a[48:51]
    s_mov_b32 s42, 0x80
    ds_read_b64_tr_b16 a[180:181], v18 offset:24576
    v_mfma_f32_16x16x32_bf16 a[48:51], a[160:163], v[64:67], a[48:51]
    v_exp_f32 v38, v150
    v_mfma_f32_16x16x32_bf16 a[80:83], a[160:163], v[68:71], a[80:83]
    buffer_load_dwordx4 v180, s[56:59], s42 offen offset:0  lds
    v_mfma_f32_16x16x32_bf16 a[80:83], a[164:167], v[172:175], a[80:83]
    v_exp_f32 v39, v151
    v_mfma_f32_16x16x32_bf16 a[240:243], a[196:199], v[172:175], a[240:243]
    v_cvt_pk_bf16_f32 v96, v36, v37
    ds_read_b64_tr_b16 a[182:183], v18 offset:28672
    v_mfma_f32_16x16x32_bf16 a[240:243], a[196:199], v[68:71], a[240:243]
    v_exp_f32 v32, v156
    v_mfma_f32_16x16x32_bf16 a[112:115], a[164:167], v[176:179], a[112:115]
    s_waitcnt lgkmcnt(6)
    ds_read_b128 a[152:155], v10 offset:53248
    v_mfma_f32_16x16x32_bf16 a[112:115], a[160:163], v[72:75], a[112:115]
    v_exp_f32 v33, v157
    v_mfma_f32_16x16x32_bf16 v[108:111], a[136:139], v[196:199], v[108:111]
    v_cvt_pk_bf16_f32 v97, v38, v39
    ds_read_b64_tr_b16 a[184:185], v19 offset:16384
    v_mfma_f32_16x16x32_bf16 v[108:111], a[140:143], v[200:203], v[108:111]
    v_exp_f32 v34, v158
    v_mfma_f32_16x16x32_bf16 v[116:119], a[140:143], v[216:219], v[116:119]
    v_cvt_pk_bf16_f32 v100, v32, v33
    ds_read_b64_tr_b16 a[186:187], v19 offset:20480
    v_mfma_f32_16x16x32_bf16 v[116:119], a[136:139], v[212:215], v[116:119]
    v_exp_f32 v35, v159
    v_mfma_f32_16x16x32_bf16 v[124:127], a[136:139], v[228:231], v[124:127]
    buffer_load_dwordx4 a[216:219], v0, s[60:63], s39 offen
    v_mfma_f32_16x16x32_bf16 v[124:127], a[140:143], v[232:235], v[124:127]
    v_exp_f32 v36, v164
    v_mfma_f32_16x16x32_bf16 v[132:135], a[140:143], v[248:251], v[132:135]
    ds_read_b128 a[156:159], v11 offset:53248
    v_cvt_pk_bf16_f32 v101, v34, v35
    v_mfma_f32_16x16x32_bf16 v[132:135], a[136:139], v[244:247], v[132:135]
    v_exp_f32 v37, v165
    v_mfma_f32_16x16x32_bf16 a[20:23], a[168:171], v[60:63], a[20:23]
    buffer_load_dwordx4 v181, s[56:59], s42 offen offset:1024  lds
    v_mfma_f32_16x16x32_bf16 a[20:23], a[172:175], v[28:31], a[20:23]
    v_exp_f32 v38, v166
    v_mfma_f32_16x16x32_bf16 a[52:55], a[172:175], v[40:43], a[52:55]
    ds_read_b64_tr_b16 a[188:189], v19 offset:24576
    v_cvt_pk_bf16_f32 v104, v36, v37
    v_mfma_f32_16x16x32_bf16 a[52:55], a[168:171], v[64:67], a[52:55]
    v_exp_f32 v39, v167
    v_mfma_f32_16x16x32_bf16 a[84:87], a[168:171], v[68:71], a[84:87]
    ds_read_b64_tr_b16 a[190:191], v19 offset:28672
    v_cvt_pk_bf16_f32 v105, v38, v39
    v_mfma_f32_16x16x32_bf16 a[84:87], a[172:175], v[172:175], a[84:87]
    v_mfma_f32_16x16x32_bf16 a[116:119], a[172:175], v[176:179], a[116:119]
    s_waitcnt lgkmcnt(6)
    ds_read_b128 a[128:131], v8 offset:57344
    v_mfma_f32_16x16x32_bf16 a[116:119], a[168:171], v[72:75], a[116:119]
    v_exp_f32 v32, v144
    v_mfma_f32_16x16x32_bf16 v[112:115], a[144:147], v[188:191], v[44:47]
    v_exp_f32 v33, v145
    v_mfma_f32_16x16x32_bf16 v[112:115], a[148:151], v[192:195], v[112:115]
    ds_read_b64_tr_b16 a[160:161], v12 offset:32768
    v_cvt_pk_bf16_f32 v94, v32, v33
    v_mfma_f32_16x16x32_bf16 v[120:123], a[148:151], v[208:211], v[48:51]
    v_exp_f32 v34, v146
    v_mfma_f32_16x16x32_bf16 v[120:123], a[144:147], v[204:207], v[120:123]
    ds_read_b64_tr_b16 a[162:163], v12 offset:36864
    v_mfma_f32_16x16x32_bf16 v[128:131], a[144:147], v[220:223], v[52:55]
    v_exp_f32 v35, v147
    v_mfma_f32_16x16x32_bf16 v[128:131], a[148:151], v[224:227], v[128:131]
    v_cvt_pk_bf16_f32 v95, v34, v35
    v_mfma_f32_16x16x32_bf16 v[136:139], a[148:151], v[240:243], v[56:59]
    v_exp_f32 v36, v152
    v_mfma_f32_16x16x32_bf16 v[136:139], a[144:147], v[236:239], v[136:139]
    ds_read_b128 a[132:135], v9 offset:57344
    v_mfma_f32_16x16x32_bf16 a[24:27], a[176:179], v[60:63], a[24:27]
    v_exp_f32 v37, v153
    v_mfma_f32_16x16x32_bf16 a[24:27], a[180:183], v[28:31], a[24:27]
    buffer_load_dwordx4 v182, s[56:59], s42 offen offset:2048  lds
    v_mfma_f32_16x16x32_bf16 a[56:59], a[180:183], v[40:43], a[56:59]
    v_exp_f32 v38, v154
    v_mfma_f32_16x16x32_bf16 a[56:59], a[176:179], v[64:67], a[56:59]
    buffer_load_dwordx4 a[220:223], v0, s[64:67], s39 offen
    v_mfma_f32_16x16x32_bf16 a[88:91], a[176:179], v[68:71], a[88:91]
    v_exp_f32 v39, v155
    v_mfma_f32_16x16x32_bf16 a[88:91], a[180:183], v[172:175], a[88:91]
    ds_read_b64_tr_b16 a[164:165], v12 offset:40960
    v_cvt_pk_bf16_f32 v98, v36, v37
    v_mfma_f32_16x16x32_bf16 a[120:123], a[180:183], v[176:179], a[120:123]
    v_exp_f32 v32, v160
    v_mfma_f32_16x16x32_bf16 a[120:123], a[176:179], v[72:75], a[120:123]
    ds_read_b64_tr_b16 a[166:167], v12 offset:45056
    v_cvt_pk_bf16_f32 v99, v38, v39
    v_mfma_f32_16x16x32_bf16 a[244:247], a[196:199], v[72:75], a[244:247]
    s_waitcnt lgkmcnt(6)
    ds_read_b128 a[136:139], v10 offset:57344
    v_mfma_f32_16x16x32_bf16 a[244:247], a[196:199], v[176:179], a[244:247]
    v_exp_f32 v33, v161
    v_mfma_f32_16x16x32_bf16 v[112:115], a[152:155], v[196:199], v[112:115]
    v_exp_f32 v34, v162
    v_mfma_f32_16x16x32_bf16 v[112:115], a[156:159], v[200:203], v[112:115]
    ds_read_b64_tr_b16 a[168:169], v13 offset:32768
    v_cvt_pk_bf16_f32 v102, v32, v33
    v_mfma_f32_16x16x32_bf16 v[120:123], a[156:159], v[216:219], v[120:123]
    v_exp_f32 v35, v163
    v_mfma_f32_16x16x32_bf16 v[120:123], a[152:155], v[212:215], v[120:123]
    ds_read_b64_tr_b16 a[170:171], v13 offset:36864
    v_cvt_pk_bf16_f32 v103, v34, v35
    v_mfma_f32_16x16x32_bf16 v[128:131], a[152:155], v[228:231], v[128:131]
    v_exp_f32 v36, v168
    v_mfma_f32_16x16x32_bf16 v[128:131], a[156:159], v[232:235], v[128:131]
    buffer_load_dwordx4 v183, s[56:59], s42 offen offset:3072  lds
    v_mfma_f32_16x16x32_bf16 v[136:139], a[156:159], v[248:251], v[136:139]
    v_exp_f32 v37, v169
    v_mfma_f32_16x16x32_bf16 v[136:139], a[152:155], v[244:247], v[136:139]
    ds_read_b128 a[140:143], v11 offset:57344
    v_cvt_pk_bf16_f32 v106, v36, v37
    v_mfma_f32_16x16x32_bf16 a[28:31], a[184:187], v[60:63], a[28:31]
    v_exp_f32 v38, v170
    v_mfma_f32_16x16x32_bf16 a[28:31], a[188:191], v[28:31], a[28:31]
    ds_read_b64_tr_b16 a[172:173], v13 offset:40960
    v_mfma_f32_16x16x32_bf16 a[60:63], a[188:191], v[40:43], a[60:63]
    v_exp_f32 v39, v171
    v_mfma_f32_16x16x32_bf16 a[60:63], a[184:187], v[64:67], a[60:63]
    ds_read_b64_tr_b16 a[174:175], v13 offset:45056
    v_cvt_pk_bf16_f32 v107, v38, v39
    v_mfma_f32_16x16x32_bf16 a[92:95], a[184:187], v[68:71], a[92:95]
    v_mfma_f32_16x16x32_bf16 a[92:95], a[188:191], v[172:175], a[92:95]
    v_mfma_f32_16x16x32_bf16 a[124:127], a[188:191], v[176:179], a[124:127]
    s_waitcnt lgkmcnt(6)
    v_mfma_f32_16x16x32_bf16 a[124:127], a[184:187], v[72:75], a[124:127]
    v_mfma_f32_16x16x32_bf16 v[140:143], a[128:131], v[188:191], v[44:47]
    v_exp_f32 v32, v108
    v_mfma_f32_16x16x32_bf16 v[140:143], a[132:135], v[192:195], v[140:143]
    ds_read_b128 a[144:147], v8 offset:61440
    s_add_u32 m0, s36, 148480
    v_mfma_f32_16x16x32_bf16 v[148:151], a[132:135], v[208:211], v[48:51]
    v_exp_f32 v33, v109
    v_mfma_f32_16x16x32_bf16 v[148:151], a[128:131], v[204:207], v[148:151]
    v_exp_f32 v34, v110
    v_mfma_f32_16x16x32_bf16 v[156:159], a[128:131], v[220:223], v[52:55]
    ds_read_b64_tr_b16 a[176:177], v14 offset:32768
    v_cvt_pk_bf16_f32 v60, v32, v33
    v_mfma_f32_16x16x32_bf16 v[156:159], a[132:135], v[224:227], v[156:159]
    v_exp_f32 v35, v111
    v_mfma_f32_16x16x32_bf16 v[164:167], a[132:135], v[240:243], v[56:59]
    ds_read_b64_tr_b16 a[178:179], v14 offset:36864
    s_mov_b32 s39, 1769472
    v_mfma_f32_16x16x32_bf16 v[164:167], a[128:131], v[236:239], v[164:167]
    v_exp_f32 v36, v116
    v_mfma_f32_16x16x32_bf16 a[0:3], a[160:163], v[76:79], a[0:3]
    ds_read_b128 a[148:151], v9 offset:61440
    v_cvt_pk_bf16_f32 v61, v34, v35
    v_mfma_f32_16x16x32_bf16 a[0:3], a[164:167], v[92:95], a[0:3]
    v_exp_f32 v37, v117
    v_mfma_f32_16x16x32_bf16 a[232:235], a[196:199], v[92:95], a[232:235]
    ds_read_b64_tr_b16 a[180:181], v14 offset:40960
    s_movk_i32 s42, 1024
    v_mfma_f32_16x16x32_bf16 a[232:235], a[196:199], v[76:79], a[232:235]
    v_exp_f32 v38, v118
    v_mfma_f32_16x16x32_bf16 a[32:35], a[164:167], v[96:99], a[32:35]
    v_cvt_pk_bf16_f32 v64, v36, v37
    ds_read_b64_tr_b16 a[182:183], v14 offset:45056
    v_mfma_f32_16x16x32_bf16 a[32:35], a[160:163], v[80:83], a[32:35]
    v_exp_f32 v39, v119
    v_mfma_f32_16x16x32_bf16 a[64:67], a[160:163], v[84:87], a[64:67]
    v_cvt_pk_bf16_f32 v65, v38, v39
    v_mfma_f32_16x16x32_bf16 a[64:67], a[164:167], v[100:103], a[64:67]
    v_exp_f32 v32, v124
    v_mfma_f32_16x16x32_bf16 a[96:99], a[164:167], v[104:107], a[96:99]
    s_waitcnt lgkmcnt(6)
    ds_read_b128 a[152:155], v10 offset:61440
    v_mfma_f32_16x16x32_bf16 a[96:99], a[160:163], v[88:91], a[96:99]
    v_exp_f32 v33, v125
    v_mfma_f32_16x16x32_bf16 v[140:143], a[136:139], v[196:199], v[140:143]
    ds_read_b64_tr_b16 a[184:185], v15 offset:32768
    v_cvt_pk_bf16_f32 v68, v32, v33
    v_mfma_f32_16x16x32_bf16 v[140:143], a[140:143], v[200:203], v[140:143]
    v_exp_f32 v34, v126
    v_mfma_f32_16x16x32_bf16 v[148:151], a[140:143], v[216:219], v[148:151]
    buffer_load_dwordx4 v2, s[68:71], s42 offen lds
    v_mfma_f32_16x16x32_bf16 v[148:151], a[136:139], v[212:215], v[148:151]
    v_exp_f32 v35, v127
    v_mfma_f32_16x16x32_bf16 v[156:159], a[136:139], v[228:231], v[156:159]
    ds_read_b64_tr_b16 a[186:187], v15 offset:36864
    v_cvt_pk_bf16_f32 v69, v34, v35
    v_mfma_f32_16x16x32_bf16 v[156:159], a[140:143], v[232:235], v[156:159]
    v_exp_f32 v36, v132
    v_mfma_f32_16x16x32_bf16 v[164:167], a[140:143], v[248:251], v[164:167]
    ds_read_b128 a[156:159], v11 offset:61440
    v_mfma_f32_16x16x32_bf16 v[164:167], a[136:139], v[244:247], v[164:167]
    v_exp_f32 v37, v133
    v_mfma_f32_16x16x32_bf16 a[4:7], a[168:171], v[76:79], a[4:7]
    buffer_load_dwordx4 a[224:227], v0, s[60:63], s39 offen
    v_mfma_f32_16x16x32_bf16 a[4:7], a[172:175], v[92:95], a[4:7]
    v_exp_f32 v38, v134
    v_mfma_f32_16x16x32_bf16 a[36:39], a[172:175], v[96:99], a[36:39]
    ds_read_b64_tr_b16 a[188:189], v15 offset:40960
    v_cvt_pk_bf16_f32 v72, v36, v37
    v_mfma_f32_16x16x32_bf16 a[36:39], a[168:171], v[80:83], a[36:39]
    v_exp_f32 v39, v135
    v_mfma_f32_16x16x32_bf16 a[68:71], a[168:171], v[84:87], a[68:71]
    ds_read_b64_tr_b16 a[190:191], v15 offset:45056
    v_cvt_pk_bf16_f32 v73, v38, v39
    v_mfma_f32_16x16x32_bf16 a[68:71], a[172:175], v[100:103], a[68:71]
    v_mfma_f32_16x16x32_bf16 a[100:103], a[172:175], v[104:107], a[100:103]
    s_waitcnt lgkmcnt(6)
    v_mfma_f32_16x16x32_bf16 a[100:103], a[168:171], v[88:91], a[100:103]
    v_exp_f32 v32, v112
    v_mfma_f32_16x16x32_bf16 v[144:147], a[144:147], v[188:191], v[44:47]
    s_waitcnt vmcnt(14)
    s_barrier
    v_mfma_f32_16x16x32_bf16 v[144:147], a[148:151], v[192:195], v[144:147]
    v_exp_f32 v33, v113
    v_mfma_f32_16x16x32_bf16 v[152:155], a[148:151], v[208:211], v[48:51]
    ds_read_b64_tr_b16 a[160:161], v16 offset:32768
    v_cvt_pk_bf16_f32 v62, v32, v33
    v_mfma_f32_16x16x32_bf16 v[152:155], a[144:147], v[204:207], v[152:155]
    v_exp_f32 v34, v114
    v_mfma_f32_16x16x32_bf16 v[160:163], a[144:147], v[220:223], v[52:55]
    v_exp_f32 v35, v115
    v_mfma_f32_16x16x32_bf16 v[160:163], a[148:151], v[224:227], v[160:163]
    ds_read_b64_tr_b16 a[162:163], v16 offset:36864
    s_add_u32 m0, s38, 32768
    v_mfma_f32_16x16x32_bf16 v[168:171], a[148:151], v[240:243], v[56:59]
    v_exp_f32 v36, v120
    v_mfma_f32_16x16x32_bf16 v[168:171], a[144:147], v[236:239], v[168:171]
    s_mov_b32 s42, 0x24080
    v_cvt_pk_bf16_f32 v63, v34, v35
    v_mfma_f32_16x16x32_bf16 a[8:11], a[176:179], v[76:79], a[8:11]
    buffer_load_dwordx4 v180, s[56:59], s42 offen offset:0  lds
    v_mfma_f32_16x16x32_bf16 a[8:11], a[180:183], v[92:95], a[8:11]
    v_exp_f32 v37, v121
    v_mfma_f32_16x16x32_bf16 a[40:43], a[180:183], v[96:99], a[40:43]
    v_exp_f32 v38, v122
    v_mfma_f32_16x16x32_bf16 a[40:43], a[176:179], v[80:83], a[40:43]
    ds_read_b64_tr_b16 a[164:165], v16 offset:40960
    v_cvt_pk_bf16_f32 v66, v36, v37
    v_mfma_f32_16x16x32_bf16 a[236:239], a[196:199], v[80:83], a[236:239]
    buffer_load_dwordx4 a[228:231], v0, s[64:67], s39 offen
    v_mfma_f32_16x16x32_bf16 a[236:239], a[196:199], v[96:99], a[236:239]
    v_exp_f32 v39, v123
    v_mfma_f32_16x16x32_bf16 a[72:75], a[176:179], v[84:87], a[72:75]
    v_exp_f32 v32, v128
    v_mfma_f32_16x16x32_bf16 a[72:75], a[180:183], v[100:103], a[72:75]
    ds_read_b64_tr_b16 a[166:167], v16 offset:45056
    v_cvt_pk_bf16_f32 v67, v38, v39
    v_mfma_f32_16x16x32_bf16 a[104:107], a[180:183], v[104:107], a[104:107]
    s_waitcnt lgkmcnt(4)
    ds_read_b64_tr_b16 a[168:169], v17 offset:32768
    v_mfma_f32_16x16x32_bf16 a[104:107], a[176:179], v[88:91], a[104:107]
    buffer_load_dwordx4 v181, s[56:59], s42 offen offset:1024  lds
    v_mfma_f32_16x16x32_bf16 v[144:147], a[152:155], v[196:199], v[144:147]
    v_exp_f32 v33, v129
    v_mfma_f32_16x16x32_bf16 v[144:147], a[156:159], v[200:203], v[144:147]
    v_exp_f32 v34, v130
    v_mfma_f32_16x16x32_bf16 v[152:155], a[156:159], v[216:219], v[152:155]
    v_exp_f32 v35, v131
    v_mfma_f32_16x16x32_bf16 v[152:155], a[152:155], v[212:215], v[152:155]
    v_cvt_pk_bf16_f32 v70, v32, v33
    ds_read_b64_tr_b16 a[170:171], v17 offset:36864
    v_mfma_f32_16x16x32_bf16 v[160:163], a[152:155], v[228:231], v[160:163]
    v_exp_f32 v36, v136
    v_mfma_f32_16x16x32_bf16 v[160:163], a[156:159], v[232:235], v[160:163]
    buffer_load_dwordx4 v182, s[56:59], s42 offen offset:2048  lds
    v_mfma_f32_16x16x32_bf16 v[168:171], a[156:159], v[248:251], v[168:171]
    v_exp_f32 v37, v137
    v_mfma_f32_16x16x32_bf16 v[168:171], a[152:155], v[244:247], v[168:171]
    v_cvt_pk_bf16_f32 v71, v34, v35
    ds_read_b64_tr_b16 a[172:173], v17 offset:40960
    v_mfma_f32_16x16x32_bf16 a[12:15], a[184:187], v[76:79], a[12:15]
    v_exp_f32 v38, v138
    v_mfma_f32_16x16x32_bf16 a[12:15], a[188:191], v[92:95], a[12:15]
    v_cvt_pk_bf16_f32 v74, v36, v37
    ds_read_b64_tr_b16 a[174:175], v17 offset:45056
    v_mfma_f32_16x16x32_bf16 a[44:47], a[188:191], v[96:99], a[44:47]
    v_exp_f32 v39, v139
    v_mfma_f32_16x16x32_bf16 a[44:47], a[184:187], v[80:83], a[44:47]
    buffer_load_dwordx4 v183, s[56:59], s42 offen offset:3072  lds
    v_mfma_f32_16x16x32_bf16 a[76:79], a[184:187], v[84:87], a[76:79]
    v_cvt_pk_bf16_f32 v75, v38, v39
    v_mfma_f32_16x16x32_bf16 a[76:79], a[188:191], v[100:103], a[76:79]
    v_mfma_f32_16x16x32_bf16 a[108:111], a[188:191], v[104:107], a[108:111]
    s_waitcnt lgkmcnt(4)
    v_mfma_f32_16x16x32_bf16 a[108:111], a[184:187], v[88:91], a[108:111]
    v_mfma_f32_16x16x32_bf16 a[16:19], a[160:163], v[76:79], a[16:19]
    v_exp_f32 v32, v140
    v_mfma_f32_16x16x32_bf16 a[16:19], a[164:167], v[92:95], a[16:19]
    ds_read_b64_tr_b16 a[176:177], v18 offset:32768
    s_add_u32 m0, s38, 81920
    v_mfma_f32_16x16x32_bf16 a[48:51], a[164:167], v[96:99], a[48:51]
    v_exp_f32 v33, v141
    v_mfma_f32_16x16x32_bf16 a[48:51], a[160:163], v[80:83], a[48:51]
    v_exp_f32 v34, v142
    v_mfma_f32_16x16x32_bf16 a[80:83], a[160:163], v[84:87], a[80:83]
    v_exp_f32 v35, v143
    ds_read_b64_tr_b16 a[178:179], v18 offset:36864
    v_mfma_f32_16x16x32_bf16 a[80:83], a[164:167], v[100:103], a[80:83]
    v_exp_f32 v36, v148
    v_mfma_f32_16x16x32_bf16 a[240:243], a[196:199], v[100:103], a[240:243]
    v_exp_f32 v37, v149
    ds_read_b64_tr_b16 a[180:181], v18 offset:40960
    v_mfma_f32_16x16x32_bf16 a[240:243], a[196:199], v[84:87], a[240:243]
    v_exp_f32 v38, v150
    v_cvt_pk_bf16_f32 v28, v32, v33
    v_mfma_f32_16x16x32_bf16 a[112:115], a[164:167], v[104:107], a[112:115]
    v_exp_f32 v39, v151
    s_mov_b32 s42, 0x100
    v_mfma_f32_16x16x32_bf16 a[112:115], a[160:163], v[88:91], a[112:115]
    buffer_load_dwordx4 v180, s[56:59], s42 offen offset:0  lds
    s_waitcnt lgkmcnt(3)
    v_exp_f32 v32, v156
    ds_read_b64_tr_b16 a[182:183], v18 offset:45056
    v_cvt_pk_bf16_f32 v29, v34, v35
    v_mfma_f32_16x16x32_bf16 a[20:23], a[168:171], v[76:79], a[20:23]
    v_exp_f32 v33, v157
    v_mfma_f32_16x16x32_bf16 a[20:23], a[172:175], v[92:95], a[20:23]
    v_exp_f32 v34, v158
    ds_read_b64_tr_b16 a[184:185], v19 offset:32768
    v_cvt_pk_bf16_f32 v40, v36, v37
    v_mfma_f32_16x16x32_bf16 a[52:55], a[172:175], v[96:99], a[52:55]
    v_exp_f32 v35, v159
    v_mfma_f32_16x16x32_bf16 a[52:55], a[168:171], v[80:83], a[52:55]
    v_exp_f32 v36, v164
    ds_read_b64_tr_b16 a[186:187], v19 offset:36864
    v_cvt_pk_bf16_f32 v41, v38, v39
    v_mfma_f32_16x16x32_bf16 a[84:87], a[168:171], v[84:87], a[84:87]
    v_exp_f32 v37, v165
    v_mfma_f32_16x16x32_bf16 a[84:87], a[172:175], v[100:103], a[84:87]
    v_exp_f32 v38, v166
    ds_read_b64_tr_b16 a[188:189], v19 offset:40960
    v_cvt_pk_bf16_f32 v172, v32, v33
    v_mfma_f32_16x16x32_bf16 a[116:119], a[172:175], v[104:107], a[116:119]
    v_exp_f32 v39, v167
    v_mfma_f32_16x16x32_bf16 a[116:119], a[168:171], v[88:91], a[116:119]
    s_waitcnt lgkmcnt(3)
    ds_read_b64_tr_b16 a[190:191], v19 offset:45056
    v_cvt_pk_bf16_f32 v173, v34, v35
    buffer_load_dwordx4 v181, s[56:59], s42 offen offset:1024  lds
    v_mfma_f32_16x16x32_bf16 a[24:27], a[176:179], v[76:79], a[24:27]
    v_exp_f32 v32, v144
    v_mfma_f32_16x16x32_bf16 a[24:27], a[180:183], v[92:95], a[24:27]
    v_exp_f32 v33, v145
    ds_read_b64_tr_b16 a[160:161], v12 offset:49152
    v_cvt_pk_bf16_f32 v176, v36, v37
    v_mfma_f32_16x16x32_bf16 a[56:59], a[180:183], v[96:99], a[56:59]
    v_exp_f32 v34, v146
    v_mfma_f32_16x16x32_bf16 a[56:59], a[176:179], v[80:83], a[56:59]
    v_exp_f32 v35, v147
    v_cvt_pk_bf16_f32 v177, v38, v39
    v_mfma_f32_16x16x32_bf16 a[88:91], a[176:179], v[84:87], a[88:91]
    v_exp_f32 v36, v152
    ds_read_b64_tr_b16 a[162:163], v12 offset:53248
    v_mfma_f32_16x16x32_bf16 a[88:91], a[180:183], v[100:103], a[88:91]
    v_exp_f32 v37, v153
    v_mfma_f32_16x16x32_bf16 a[120:123], a[180:183], v[104:107], a[120:123]
    v_exp_f32 v38, v154
    ds_read_b64_tr_b16 a[164:165], v12 offset:57344
    v_cvt_pk_bf16_f32 v30, v32, v33
    v_mfma_f32_16x16x32_bf16 a[120:123], a[176:179], v[88:91], a[120:123]
    v_exp_f32 v39, v155
    buffer_load_dwordx4 v182, s[56:59], s42 offen offset:2048  lds
    v_mfma_f32_16x16x32_bf16 a[244:247], a[196:199], v[88:91], a[244:247]
    v_exp_f32 v32, v160
    v_cvt_pk_bf16_f32 v31, v34, v35
    v_mfma_f32_16x16x32_bf16 a[244:247], a[196:199], v[104:107], a[244:247]
    s_waitcnt lgkmcnt(3)
    v_exp_f32 v33, v161
    ds_read_b64_tr_b16 a[166:167], v12 offset:61440
    v_mfma_f32_16x16x32_bf16 a[28:31], a[184:187], v[76:79], a[28:31]
    v_exp_f32 v34, v162
    v_cvt_pk_bf16_f32 v42, v36, v37
    v_mfma_f32_16x16x32_bf16 a[28:31], a[188:191], v[92:95], a[28:31]
    v_exp_f32 v35, v163
    ds_read_b64_tr_b16 a[168:169], v13 offset:49152
    v_mfma_f32_16x16x32_bf16 a[60:63], a[188:191], v[96:99], a[60:63]
    v_exp_f32 v36, v168
    v_cvt_pk_bf16_f32 v43, v38, v39
    v_mfma_f32_16x16x32_bf16 a[60:63], a[184:187], v[80:83], a[60:63]
    v_exp_f32 v37, v169
    ds_read_b64_tr_b16 a[170:171], v13 offset:53248
    v_mfma_f32_16x16x32_bf16 a[92:95], a[184:187], v[84:87], a[92:95]
    v_exp_f32 v38, v170
    v_cvt_pk_bf16_f32 v174, v32, v33
    v_mfma_f32_16x16x32_bf16 a[92:95], a[188:191], v[100:103], a[92:95]
    v_exp_f32 v39, v171
    ds_read_b64_tr_b16 a[172:173], v13 offset:57344
    v_mfma_f32_16x16x32_bf16 a[124:127], a[188:191], v[104:107], a[124:127]
    v_cvt_pk_bf16_f32 v175, v34, v35
    buffer_load_dwordx4 v183, s[56:59], s42 offen offset:3072  lds
    v_mfma_f32_16x16x32_bf16 a[124:127], a[184:187], v[88:91], a[124:127]
    s_waitcnt lgkmcnt(3)
    ds_read_b64_tr_b16 a[174:175], v13 offset:61440
    v_cvt_pk_bf16_f32 v178, v36, v37
    v_cvt_pk_bf16_f32 v179, v38, v39
    s_nop 1
    v_mfma_f32_16x16x32_bf16 a[232:235], a[196:199], v[60:63], a[232:235]
    ds_read_b64_tr_b16 a[176:177], v14 offset:49152
    v_mfma_f32_16x16x32_bf16 a[232:235], a[196:199], v[28:31], a[232:235]
    ds_read_b64_tr_b16 a[178:179], v14 offset:53248
    v_mfma_f32_16x16x32_bf16 a[236:239], a[196:199], v[64:67], a[236:239]
    v_mfma_f32_16x16x32_bf16 a[236:239], a[196:199], v[40:43], a[236:239]
    v_mfma_f32_16x16x32_bf16 a[240:243], a[196:199], v[68:71], a[240:243]
    v_mfma_f32_16x16x32_bf16 a[240:243], a[196:199], v[172:175], a[240:243]
    v_mfma_f32_16x16x32_bf16 a[244:247], a[196:199], v[72:75], a[244:247]
    ds_read_b64_tr_b16 a[180:181], v14 offset:57344
    v_mfma_f32_16x16x32_bf16 a[244:247], a[196:199], v[176:179], a[244:247]
    ds_read_b64_tr_b16 a[182:183], v14 offset:61440
    v_mfma_f32_16x16x32_bf16 a[0:3], a[160:163], v[60:63], a[0:3]
    v_mfma_f32_16x16x32_bf16 a[0:3], a[164:167], v[28:31], a[0:3]
    v_mfma_f32_16x16x32_bf16 a[32:35], a[164:167], v[40:43], a[32:35]
    v_mfma_f32_16x16x32_bf16 a[32:35], a[160:163], v[64:67], a[32:35]
    v_mfma_f32_16x16x32_bf16 a[64:67], a[160:163], v[68:71], a[64:67]
    v_mfma_f32_16x16x32_bf16 a[64:67], a[164:167], v[172:175], a[64:67]
    v_mfma_f32_16x16x32_bf16 a[96:99], a[164:167], v[176:179], a[96:99]
    s_waitcnt lgkmcnt(4)
    ds_read_b64_tr_b16 a[184:185], v15 offset:49152
    v_mfma_f32_16x16x32_bf16 a[96:99], a[160:163], v[72:75], a[96:99]
    ds_read_b64_tr_b16 a[186:187], v15 offset:53248
    v_accvgpr_read_b32 v36, a232
    v_mfma_f32_16x16x32_bf16 a[4:7], a[168:171], v[60:63], a[4:7]
    v_accvgpr_read_b32 v37, a236
    v_accvgpr_read_b32 v38, a240
    v_mfma_f32_16x16x32_bf16 a[4:7], a[172:175], v[28:31], a[4:7]
    v_accvgpr_read_b32 v39, a244
    v_mfma_f32_16x16x32_bf16 a[36:39], a[172:175], v[40:43], a[36:39]
    ds_read_b64_tr_b16 a[188:189], v15 offset:57344
    v_mfma_f32_16x16x32_bf16 a[36:39], a[168:171], v[64:67], a[36:39]
    ds_read_b64_tr_b16 a[190:191], v15 offset:61440
    v_mfma_f32_16x16x32_bf16 a[68:71], a[168:171], v[68:71], a[68:71]
    v_rcp_f32 v32, v36
    v_mfma_f32_16x16x32_bf16 a[68:71], a[172:175], v[172:175], a[68:71]
    v_rcp_f32 v33, v37
    v_mfma_f32_16x16x32_bf16 a[100:103], a[172:175], v[176:179], a[100:103]
    s_waitcnt lgkmcnt(4)
    ds_read_b64_tr_b16 a[160:161], v16 offset:49152
    v_mfma_f32_16x16x32_bf16 a[100:103], a[168:171], v[72:75], a[100:103]
    ds_read_b64_tr_b16 a[162:163], v16 offset:53248
    v_mfma_f32_16x16x32_bf16 a[8:11], a[176:179], v[60:63], a[8:11]
    v_rcp_f32 v34, v38
    v_mfma_f32_16x16x32_bf16 a[8:11], a[180:183], v[28:31], a[8:11]
    v_rcp_f32 v35, v39
    v_mfma_f32_16x16x32_bf16 a[40:43], a[180:183], v[40:43], a[40:43]
    ds_read_b64_tr_b16 a[164:165], v16 offset:57344
    v_max3_f32 v36, v36, v37, v38
    v_mfma_f32_16x16x32_bf16 a[40:43], a[176:179], v[64:67], a[40:43]
    ds_read_b64_tr_b16 a[166:167], v16 offset:61440
    v_max_f32 v36, v36, v39
    v_mfma_f32_16x16x32_bf16 a[72:75], a[176:179], v[68:71], a[72:75]
    v_accvgpr_read_b32 v4, a0
    v_accvgpr_read_b32 v5, a1
    v_mfma_f32_16x16x32_bf16 a[72:75], a[180:183], v[172:175], a[72:75]
    v_accvgpr_read_b32 v6, a2
    v_accvgpr_read_b32 v7, a3
    v_mfma_f32_16x16x32_bf16 a[104:107], a[180:183], v[176:179], a[104:107]
    s_waitcnt lgkmcnt(4)
    ds_read_b64_tr_b16 a[168:169], v17 offset:49152
    v_mfma_f32_16x16x32_bf16 a[104:107], a[176:179], v[72:75], a[104:107]
    ds_read_b64_tr_b16 a[170:171], v17 offset:53248
    v_accvgpr_read_b32 v252, a32
    v_mfma_f32_16x16x32_bf16 a[12:15], a[184:187], v[60:63], a[12:15]
    v_accvgpr_read_b32 v253, a33
    v_accvgpr_read_b32 v184, a34
    v_mfma_f32_16x16x32_bf16 a[12:15], a[188:191], v[28:31], a[12:15]
    v_accvgpr_read_b32 v185, a35
    v_mul_f32 v4, v4, v32
    v_mfma_f32_16x16x32_bf16 a[44:47], a[188:191], v[40:43], a[44:47]
    ds_read_b64_tr_b16 a[172:173], v17 offset:57344
    v_mul_f32 v5, v5, v32
    v_mfma_f32_16x16x32_bf16 a[44:47], a[184:187], v[64:67], a[44:47]
    ds_read_b64_tr_b16 a[174:175], v17 offset:61440
    v_mul_f32 v6, v6, v32
    v_mfma_f32_16x16x32_bf16 a[76:79], a[184:187], v[68:71], a[76:79]
    v_mul_f32 v7, v7, v32
    v_mul_f32 v252, v252, v33
    v_mfma_f32_16x16x32_bf16 a[76:79], a[188:191], v[172:175], a[76:79]
    v_mul_f32 v253, v253, v33
    v_mul_f32 v184, v184, v33
    v_mfma_f32_16x16x32_bf16 a[108:111], a[188:191], v[176:179], a[108:111]
    s_waitcnt lgkmcnt(4)
    v_mul_f32 v185, v185, v33
    v_mfma_f32_16x16x32_bf16 a[108:111], a[184:187], v[72:75], a[108:111]
    v_cvt_pk_bf16_f32 v108, v4, v5
    v_cvt_pk_bf16_f32 v109, v6, v7
    v_cvt_pk_bf16_f32 v124, v252, v253
    v_cvt_pk_bf16_f32 v125, v184, v185
    v_mfma_f32_16x16x32_bf16 a[16:19], a[160:163], v[60:63], a[16:19]
    ds_read_b64_tr_b16 a[176:177], v18 offset:49152
    v_accvgpr_read_b32 v4, a64
    v_mfma_f32_16x16x32_bf16 a[16:19], a[164:167], v[28:31], a[16:19]
    ds_read_b64_tr_b16 a[178:179], v18 offset:53248
    v_accvgpr_read_b32 v5, a65
    v_mfma_f32_16x16x32_bf16 a[48:51], a[164:167], v[40:43], a[48:51]
    ds_read_b64_tr_b16 a[180:181], v18 offset:57344
    v_accvgpr_read_b32 v6, a66
    v_mfma_f32_16x16x32_bf16 a[48:51], a[160:163], v[64:67], a[48:51]
    ds_read_b64_tr_b16 a[182:183], v18 offset:61440
    v_accvgpr_read_b32 v7, a67
    v_mfma_f32_16x16x32_bf16 a[80:83], a[160:163], v[68:71], a[80:83]
    v_accvgpr_read_b32 v252, a96
    v_accvgpr_read_b32 v253, a97
    v_mfma_f32_16x16x32_bf16 a[80:83], a[164:167], v[172:175], a[80:83]
    v_accvgpr_read_b32 v184, a98
    v_accvgpr_read_b32 v185, a99
    v_mfma_f32_16x16x32_bf16 a[112:115], a[164:167], v[176:179], a[112:115]
    s_waitcnt lgkmcnt(4)
    ds_read_b64_tr_b16 a[184:185], v19 offset:49152
    v_mfma_f32_16x16x32_bf16 a[112:115], a[160:163], v[72:75], a[112:115]
    ds_read_b64_tr_b16 a[186:187], v19 offset:53248
    v_mul_f32 v4, v4, v34
    v_mfma_f32_16x16x32_bf16 a[20:23], a[168:171], v[60:63], a[20:23]
    v_mul_f32 v5, v5, v34
    v_mul_f32 v6, v6, v34
    v_mfma_f32_16x16x32_bf16 a[20:23], a[172:175], v[28:31], a[20:23]
    v_mul_f32 v7, v7, v34
    v_mul_f32 v252, v252, v35
    v_mfma_f32_16x16x32_bf16 a[52:55], a[172:175], v[40:43], a[52:55]
    ds_read_b64_tr_b16 a[188:189], v19 offset:57344
    v_mul_f32 v253, v253, v35
    v_mfma_f32_16x16x32_bf16 a[52:55], a[168:171], v[64:67], a[52:55]
    ds_read_b64_tr_b16 a[190:191], v19 offset:61440
    v_mul_f32 v184, v184, v35
    v_mfma_f32_16x16x32_bf16 a[84:87], a[168:171], v[68:71], a[84:87]
    v_mul_f32 v185, v185, v35
    v_cvt_pk_bf16_f32 v140, v4, v5
    v_mfma_f32_16x16x32_bf16 a[84:87], a[172:175], v[172:175], a[84:87]
    v_cvt_pk_bf16_f32 v141, v6, v7
    v_cvt_pk_bf16_f32 v156, v252, v253
    v_mfma_f32_16x16x32_bf16 a[116:119], a[172:175], v[176:179], a[116:119]
    s_waitcnt lgkmcnt(4)
    v_cvt_pk_bf16_f32 v157, v184, v185
    v_mfma_f32_16x16x32_bf16 a[116:119], a[168:171], v[72:75], a[116:119]
    v_accvgpr_read_b32 v4, a4
    v_accvgpr_read_b32 v5, a5
    v_mfma_f32_16x16x32_bf16 a[24:27], a[176:179], v[60:63], a[24:27]
    v_accvgpr_read_b32 v6, a6
    v_accvgpr_read_b32 v7, a7
    v_mfma_f32_16x16x32_bf16 a[24:27], a[180:183], v[28:31], a[24:27]
    v_accvgpr_read_b32 v252, a36
    v_accvgpr_read_b32 v253, a37
    v_mfma_f32_16x16x32_bf16 a[56:59], a[180:183], v[40:43], a[56:59]
    v_accvgpr_read_b32 v184, a38
    v_accvgpr_read_b32 v185, a39
    v_mfma_f32_16x16x32_bf16 a[56:59], a[176:179], v[64:67], a[56:59]
    v_mul_f32 v4, v4, v32
    v_mul_f32 v5, v5, v32
    v_mfma_f32_16x16x32_bf16 a[88:91], a[176:179], v[68:71], a[88:91]
    v_mul_f32 v6, v6, v32
    v_mul_f32 v7, v7, v32
    v_mfma_f32_16x16x32_bf16 a[88:91], a[180:183], v[172:175], a[88:91]
    v_mul_f32 v252, v252, v33
    v_mul_f32 v253, v253, v33
    v_mfma_f32_16x16x32_bf16 a[120:123], a[180:183], v[176:179], a[120:123]
    s_waitcnt lgkmcnt(0)
    v_mul_f32 v184, v184, v33
    v_mfma_f32_16x16x32_bf16 a[120:123], a[176:179], v[72:75], a[120:123]
    v_mul_f32 v185, v185, v33
    v_cvt_pk_bf16_f32 v110, v4, v5
    v_mfma_f32_16x16x32_bf16 a[28:31], a[184:187], v[60:63], a[28:31]
    v_cvt_pk_bf16_f32 v111, v6, v7
    v_cvt_pk_bf16_f32 v126, v252, v253
    v_mfma_f32_16x16x32_bf16 a[28:31], a[188:191], v[28:31], a[28:31]
    v_cvt_pk_bf16_f32 v127, v184, v185
    v_accvgpr_read_b32 v4, a68
    v_mfma_f32_16x16x32_bf16 a[60:63], a[188:191], v[40:43], a[60:63]
    v_accvgpr_read_b32 v5, a69
    v_accvgpr_read_b32 v6, a70
    v_mfma_f32_16x16x32_bf16 a[60:63], a[184:187], v[64:67], a[60:63]
    v_accvgpr_read_b32 v7, a71
    v_accvgpr_read_b32 v252, a100
    v_mfma_f32_16x16x32_bf16 a[92:95], a[184:187], v[68:71], a[92:95]
    v_accvgpr_read_b32 v253, a101
    v_accvgpr_read_b32 v184, a102
    v_mfma_f32_16x16x32_bf16 a[92:95], a[188:191], v[172:175], a[92:95]
    v_accvgpr_read_b32 v185, a103
    v_mul_f32 v4, v4, v34
    v_mfma_f32_16x16x32_bf16 a[124:127], a[188:191], v[176:179], a[124:127]
    v_mul_f32 v5, v5, v34
    v_mfma_f32_16x16x32_bf16 a[124:127], a[184:187], v[72:75], a[124:127]
    v_mul_f32 v6, v6, v34
    v_mul_f32 v7, v7, v34
    v_mul_f32 v252, v252, v35
    v_mul_f32 v253, v253, v35
    v_mul_f32 v184, v184, v35
    v_mul_f32 v185, v185, v35
    v_cvt_pk_bf16_f32 v142, v4, v5
    v_cvt_pk_bf16_f32 v143, v6, v7
    v_cvt_pk_bf16_f32 v158, v252, v253
    v_cvt_pk_bf16_f32 v159, v184, v185
    v_xor_b32 v172, 0, v1
    v_xor_b32 v176, 0, v1
    v_xor_b32 v68, 16384, v1
    v_xor_b32 v173, 32, v1
    v_xor_b32 v177, 32, v1
    v_xor_b32 v69, 16416, v1
    v_xor_b32 v174, 64, v1
    v_xor_b32 v178, 64, v1
    v_xor_b32 v70, 16448, v1
    v_xor_b32 v175, 96, v1
    v_xor_b32 v179, 96, v1
    v_xor_b32 v71, 16480, v1
    s_mov_b32 s46, 0
    s_mov_b32 s52, 65536
    s_mov_b32 s53, 32768
    s_waitcnt vmcnt(17)
    s_barrier
    v_accvgpr_read_b32 v4, a8
    v_accvgpr_read_b32 v5, a9
    v_accvgpr_read_b32 v6, a10
    v_accvgpr_read_b32 v7, a11
    v_accvgpr_read_b32 v252, a40
    s_add_u32 m0, s38, 49152
    v_accvgpr_read_b32 v253, a41
    v_accvgpr_read_b32 v184, a42
    v_accvgpr_read_b32 v185, a43
    v_pk_mul_f32 v[4:5], v[4:5], v[32:33] op_sel_hi:[1,0]
    v_pk_mul_f32 v[6:7], v[6:7], v[32:33] op_sel_hi:[1,0]
    s_mov_b32 s42, 0x24100
    v_pk_mul_f32 v[252:253], v[252:253], v[32:33] op_sel:[0,1]
    v_pk_mul_f32 v[184:185], v[184:185], v[32:33] op_sel:[0,1]
    v_cvt_pk_bf16_f32 v112, v4, v5
    v_cvt_pk_bf16_f32 v113, v6, v7
    v_cvt_pk_bf16_f32 v128, v252, v253
    buffer_load_dwordx4 v180, s[56:59], s42 offen offset:0  lds
    v_cvt_pk_bf16_f32 v129, v184, v185
    v_accvgpr_read_b32 v4, a72
    v_accvgpr_read_b32 v5, a73
    v_accvgpr_read_b32 v6, a74
    v_accvgpr_read_b32 v7, a75
    buffer_load_dwordx4 v181, s[56:59], s42 offen offset:1024  lds
    v_accvgpr_read_b32 v252, a104
    v_accvgpr_read_b32 v253, a105
    v_accvgpr_read_b32 v184, a106
    v_accvgpr_read_b32 v185, a107
    v_pk_mul_f32 v[4:5], v[4:5], v[34:35] op_sel_hi:[1,0]
    buffer_load_dwordx4 v182, s[56:59], s42 offen offset:2048  lds
    v_pk_mul_f32 v[6:7], v[6:7], v[34:35] op_sel_hi:[1,0]
    v_pk_mul_f32 v[252:253], v[252:253], v[34:35] op_sel:[0,1]
    v_pk_mul_f32 v[184:185], v[184:185], v[34:35] op_sel:[0,1]
    v_cvt_pk_bf16_f32 v144, v4, v5
    v_cvt_pk_bf16_f32 v145, v6, v7
    buffer_load_dwordx4 v183, s[56:59], s42 offen offset:3072  lds
    v_cvt_pk_bf16_f32 v160, v252, v253
    v_cvt_pk_bf16_f32 v161, v184, v185
    v_accvgpr_read_b32 v4, a12
    v_accvgpr_read_b32 v5, a13
    v_accvgpr_read_b32 v6, a14
    s_add_u32 m0, s38, 98304
    v_accvgpr_read_b32 v7, a15
    v_accvgpr_read_b32 v252, a44
    v_accvgpr_read_b32 v253, a45
    v_accvgpr_read_b32 v184, a46
    v_accvgpr_read_b32 v185, a47
    s_mov_b32 s42, 0x180
    v_pk_mul_f32 v[4:5], v[4:5], v[32:33] op_sel_hi:[1,0]
    v_pk_mul_f32 v[6:7], v[6:7], v[32:33] op_sel_hi:[1,0]
    v_pk_mul_f32 v[252:253], v[252:253], v[32:33] op_sel:[0,1]
    v_pk_mul_f32 v[184:185], v[184:185], v[32:33] op_sel:[0,1]
    v_cvt_pk_bf16_f32 v114, v4, v5
    buffer_load_dwordx4 v180, s[56:59], s42 offen offset:0  lds
    v_cvt_pk_bf16_f32 v115, v6, v7
    v_cvt_pk_bf16_f32 v130, v252, v253
    v_cvt_pk_bf16_f32 v131, v184, v185
    v_accvgpr_read_b32 v4, a76
    v_accvgpr_read_b32 v5, a77
    buffer_load_dwordx4 v181, s[56:59], s42 offen offset:1024  lds
    v_accvgpr_read_b32 v6, a78
    v_accvgpr_read_b32 v7, a79
    v_accvgpr_read_b32 v252, a108
    v_accvgpr_read_b32 v253, a109
    v_accvgpr_read_b32 v184, a110
    buffer_load_dwordx4 v182, s[56:59], s42 offen offset:2048  lds
    v_accvgpr_read_b32 v185, a111
    v_pk_mul_f32 v[4:5], v[4:5], v[34:35] op_sel_hi:[1,0]
    v_pk_mul_f32 v[6:7], v[6:7], v[34:35] op_sel_hi:[1,0]
    v_pk_mul_f32 v[252:253], v[252:253], v[34:35] op_sel:[0,1]
    v_pk_mul_f32 v[184:185], v[184:185], v[34:35] op_sel:[0,1]
    buffer_load_dwordx4 v183, s[56:59], s42 offen offset:3072  lds
    v_cvt_pk_bf16_f32 v146, v4, v5
    v_cvt_pk_bf16_f32 v147, v6, v7
    v_cvt_pk_bf16_f32 v162, v252, v253
    v_cvt_pk_bf16_f32 v163, v184, v185
    v_accvgpr_read_b32 v4, a16
    s_add_u32 m0, s38, 114688
    v_accvgpr_read_b32 v5, a17
    v_accvgpr_read_b32 v6, a18
    v_accvgpr_read_b32 v7, a19
    v_accvgpr_read_b32 v252, a48
    v_accvgpr_read_b32 v253, a49
    s_mov_b32 s42, 0x24180
    v_accvgpr_read_b32 v184, a50
    v_accvgpr_read_b32 v185, a51
    v_pk_mul_f32 v[4:5], v[4:5], v[32:33] op_sel_hi:[1,0]
    v_pk_mul_f32 v[6:7], v[6:7], v[32:33] op_sel_hi:[1,0]
    v_pk_mul_f32 v[252:253], v[252:253], v[32:33] op_sel:[0,1]
    buffer_load_dwordx4 v180, s[56:59], s42 offen offset:0  lds
    v_pk_mul_f32 v[184:185], v[184:185], v[32:33] op_sel:[0,1]
    v_cvt_pk_bf16_f32 v116, v4, v5
    v_cvt_pk_bf16_f32 v117, v6, v7
    v_cvt_pk_bf16_f32 v132, v252, v253
    v_cvt_pk_bf16_f32 v133, v184, v185
    buffer_load_dwordx4 v181, s[56:59], s42 offen offset:1024  lds
    v_accvgpr_read_b32 v4, a80
    v_accvgpr_read_b32 v5, a81
    v_accvgpr_read_b32 v6, a82
    v_accvgpr_read_b32 v7, a83
    v_accvgpr_read_b32 v252, a112
    buffer_load_dwordx4 v182, s[56:59], s42 offen offset:2048  lds
    v_accvgpr_read_b32 v253, a113
    v_accvgpr_read_b32 v184, a114
    v_accvgpr_read_b32 v185, a115
    v_pk_mul_f32 v[4:5], v[4:5], v[34:35] op_sel_hi:[1,0]
    v_pk_mul_f32 v[6:7], v[6:7], v[34:35] op_sel_hi:[1,0]
    buffer_load_dwordx4 v183, s[56:59], s42 offen offset:3072  lds
    v_pk_mul_f32 v[252:253], v[252:253], v[34:35] op_sel:[0,1]
    v_pk_mul_f32 v[184:185], v[184:185], v[34:35] op_sel:[0,1]
    v_cvt_pk_bf16_f32 v148, v4, v5
    v_cvt_pk_bf16_f32 v149, v6, v7
    v_cvt_pk_bf16_f32 v164, v252, v253
    ds_read_b64_tr_b16 a[128:129], v176 offset:0
    v_cvt_pk_bf16_f32 v165, v184, v185
    v_accvgpr_read_b32 v4, a20
    v_accvgpr_read_b32 v5, a21
    v_accvgpr_read_b32 v6, a22
    v_accvgpr_read_b32 v7, a23
    ds_read_b64_tr_b16 a[130:131], v176 offset:2048
    v_accvgpr_read_b32 v252, a52
    v_accvgpr_read_b32 v253, a53
    v_accvgpr_read_b32 v184, a54
    v_accvgpr_read_b32 v185, a55
    v_pk_mul_f32 v[4:5], v[4:5], v[32:33] op_sel_hi:[1,0]
    ds_read_b64_tr_b16 a[132:133], v176 offset:4096
    v_pk_mul_f32 v[6:7], v[6:7], v[32:33] op_sel_hi:[1,0]
    v_pk_mul_f32 v[252:253], v[252:253], v[32:33] op_sel:[0,1]
    v_pk_mul_f32 v[184:185], v[184:185], v[32:33] op_sel:[0,1]
    v_cvt_pk_bf16_f32 v118, v4, v5
    v_cvt_pk_bf16_f32 v119, v6, v7
    ds_read_b64_tr_b16 a[134:135], v176 offset:6144
    v_cvt_pk_bf16_f32 v134, v252, v253
    v_cvt_pk_bf16_f32 v135, v184, v185
    v_accvgpr_read_b32 v4, a84
    v_accvgpr_read_b32 v5, a85
    v_accvgpr_read_b32 v6, a86
    ds_read_b64_tr_b16 a[136:137], v176 offset:8192
    v_accvgpr_read_b32 v7, a87
    v_accvgpr_read_b32 v252, a116
    v_accvgpr_read_b32 v253, a117
    v_accvgpr_read_b32 v184, a118
    v_accvgpr_read_b32 v185, a119
    ds_read_b64_tr_b16 a[138:139], v176 offset:10240
    v_pk_mul_f32 v[4:5], v[4:5], v[34:35] op_sel_hi:[1,0]
    v_pk_mul_f32 v[6:7], v[6:7], v[34:35] op_sel_hi:[1,0]
    v_pk_mul_f32 v[252:253], v[252:253], v[34:35] op_sel:[0,1]
    v_pk_mul_f32 v[184:185], v[184:185], v[34:35] op_sel:[0,1]
    v_cvt_pk_bf16_f32 v150, v4, v5
    ds_read_b64_tr_b16 a[140:141], v176 offset:12288
    v_cvt_pk_bf16_f32 v151, v6, v7
    v_cvt_pk_bf16_f32 v166, v252, v253
    v_cvt_pk_bf16_f32 v167, v184, v185
    v_accvgpr_read_b32 v4, a24
    v_accvgpr_read_b32 v5, a25
    ds_read_b64_tr_b16 a[142:143], v176 offset:14336
    v_accvgpr_read_b32 v6, a26
    v_accvgpr_read_b32 v7, a27
    v_accvgpr_read_b32 v252, a56
    v_accvgpr_read_b32 v253, a57
    v_accvgpr_read_b32 v184, a58
    ds_read_b64_tr_b16 a[144:145], v68 offset:0
    v_accvgpr_read_b32 v185, a59
    v_pk_mul_f32 v[4:5], v[4:5], v[32:33] op_sel_hi:[1,0]
    v_pk_mul_f32 v[6:7], v[6:7], v[32:33] op_sel_hi:[1,0]
    v_pk_mul_f32 v[252:253], v[252:253], v[32:33] op_sel:[0,1]
    v_pk_mul_f32 v[184:185], v[184:185], v[32:33] op_sel:[0,1]
    ds_read_b64_tr_b16 a[146:147], v68 offset:2048
    v_cvt_pk_bf16_f32 v120, v4, v5
    v_cvt_pk_bf16_f32 v121, v6, v7
    v_cvt_pk_bf16_f32 v136, v252, v253
    v_cvt_pk_bf16_f32 v137, v184, v185
    v_accvgpr_read_b32 v4, a88
    ds_read_b64_tr_b16 a[148:149], v68 offset:4096
    v_accvgpr_read_b32 v5, a89
    v_accvgpr_read_b32 v6, a90
    v_accvgpr_read_b32 v7, a91
    v_accvgpr_read_b32 v252, a120
    v_accvgpr_read_b32 v253, a121
    ds_read_b64_tr_b16 a[150:151], v68 offset:6144
    v_accvgpr_read_b32 v184, a122
    v_accvgpr_read_b32 v185, a123
    v_pk_mul_f32 v[4:5], v[4:5], v[34:35] op_sel_hi:[1,0]
    v_pk_mul_f32 v[6:7], v[6:7], v[34:35] op_sel_hi:[1,0]
    v_pk_mul_f32 v[252:253], v[252:253], v[34:35] op_sel:[0,1]
    ds_read_b64_tr_b16 a[152:153], v68 offset:8192
    v_pk_mul_f32 v[184:185], v[184:185], v[34:35] op_sel:[0,1]
    v_cvt_pk_bf16_f32 v152, v4, v5
    v_cvt_pk_bf16_f32 v153, v6, v7
    v_cvt_pk_bf16_f32 v168, v252, v253
    v_cvt_pk_bf16_f32 v169, v184, v185
    ds_read_b64_tr_b16 a[154:155], v68 offset:10240
    v_accvgpr_read_b32 v4, a28
    v_accvgpr_read_b32 v5, a29
    v_accvgpr_read_b32 v6, a30
    v_accvgpr_read_b32 v7, a31
    v_accvgpr_read_b32 v252, a60
    v_accvgpr_read_b32 v253, a61
    v_accvgpr_read_b32 v184, a62
    v_accvgpr_read_b32 v185, a63
    v_pk_mul_f32 v[4:5], v[4:5], v[32:33] op_sel_hi:[1,0]
    v_pk_mul_f32 v[6:7], v[6:7], v[32:33] op_sel_hi:[1,0]
    v_pk_mul_f32 v[252:253], v[252:253], v[32:33] op_sel:[0,1]
    v_pk_mul_f32 v[184:185], v[184:185], v[32:33] op_sel:[0,1]
    v_cvt_pk_bf16_f32 v122, v4, v5
    v_cvt_pk_bf16_f32 v123, v6, v7
    v_cvt_pk_bf16_f32 v138, v252, v253
    v_cvt_pk_bf16_f32 v139, v184, v185
    v_accvgpr_read_b32 v4, a92
    v_accvgpr_read_b32 v5, a93
    v_accvgpr_read_b32 v6, a94
    v_accvgpr_read_b32 v7, a95
    v_accvgpr_read_b32 v252, a124
    v_accvgpr_read_b32 v253, a125
    v_accvgpr_read_b32 v184, a126
    v_accvgpr_read_b32 v185, a127
    v_pk_mul_f32 v[4:5], v[4:5], v[34:35] op_sel_hi:[1,0]
    v_pk_mul_f32 v[6:7], v[6:7], v[34:35] op_sel_hi:[1,0]
    v_pk_mul_f32 v[252:253], v[252:253], v[34:35] op_sel:[0,1]
    v_pk_mul_f32 v[184:185], v[184:185], v[34:35] op_sel:[0,1]
    v_cvt_pk_bf16_f32 v154, v4, v5
    v_cvt_pk_bf16_f32 v155, v6, v7
    v_cvt_pk_bf16_f32 v170, v252, v253
    v_cvt_pk_bf16_f32 v171, v184, v185
    s_waitcnt lgkmcnt(6)
    s_nop 0
    v_mfma_f32_16x16x32_bf16 v[76:79], a[128:131], v[108:111], 0
    ds_read_b64_tr_b16 a[156:157], v68 offset:12288
    s_lshl_b32 s3, s33, 2
    v_mfma_f32_16x16x32_bf16 v[76:79], a[132:135], v[112:115], v[76:79]
    ds_read_b64_tr_b16 a[158:159], v68 offset:14336
    s_sub_u32 s3, s54, s3
    v_mfma_f32_16x16x32_bf16 v[80:83], a[128:131], v[124:127], 0
    ds_read_b64_tr_b16 a[160:161], v177 offset:0
    v_bfe_u32 v4, v26, 7, 1
    v_mfma_f32_16x16x32_bf16 v[80:83], a[132:135], v[128:131], v[80:83]
    ds_read_b64_tr_b16 a[162:163], v177 offset:2048
    v_or_b32 v5, 2, v4
    v_mfma_f32_16x16x32_bf16 v[76:79], a[136:139], v[116:119], v[76:79]
    ds_read_b64_tr_b16 a[164:165], v177 offset:4096
    v_cmp_eq_u32 vcc, s3, v4
    v_mfma_f32_16x16x32_bf16 v[76:79], a[140:143], v[120:123], v[76:79]
    ds_read_b64_tr_b16 a[166:167], v177 offset:6144
    v_cmp_eq_u32 s[28:29], s3, v5
    v_mfma_f32_16x16x32_bf16 v[80:83], a[136:139], v[132:135], v[80:83]
    ds_read_b64_tr_b16 a[168:169], v177 offset:8192
    v_lshrrev_b32 v4, 8, v26
    v_mfma_f32_16x16x32_bf16 v[80:83], a[140:143], v[136:139], v[80:83]
    s_waitcnt lgkmcnt(5)
    ds_read_b64_tr_b16 a[170:171], v177 offset:10240
    v_mfma_f32_16x16x32_bf16 v[76:79], a[144:147], v[140:143], v[76:79]
    ds_read_b64_tr_b16 a[172:173], v177 offset:12288
    v_and_b32 v5, 0x70, v26
    v_mfma_f32_16x16x32_bf16 v[76:79], a[148:151], v[144:147], v[76:79]
    ds_read_b64_tr_b16 a[174:175], v177 offset:14336
    v_lshl_add_u32 v4, v4, 7, v5
    v_mfma_f32_16x16x32_bf16 v[80:83], a[144:147], v[156:159], v[80:83]
    ds_read_b64_tr_b16 a[176:177], v69 offset:0
    v_add_u32 v4, 152576, v4
    v_mfma_f32_16x16x32_bf16 v[80:83], a[148:151], v[160:163], v[80:83]
    ds_read_b64_tr_b16 a[178:179], v69 offset:2048
    v_mov_b32 v5, 0x1000000
    v_mfma_f32_16x16x32_bf16 v[76:79], a[152:155], v[148:151], v[76:79]
    ds_read_b64_tr_b16 a[180:181], v69 offset:4096
    v_cndmask_b32 v72, v26, v5, vcc
    v_mfma_f32_16x16x32_bf16 v[76:79], a[156:159], v[152:155], v[76:79]
    ds_read_b64_tr_b16 a[182:183], v69 offset:6144
    v_cndmask_b32 v73, v27, v5, s[28:29]
    v_mfma_f32_16x16x32_bf16 v[80:83], a[152:155], v[164:167], v[80:83]
    ds_read_b64_tr_b16 a[184:185], v69 offset:8192
    v_mov_b32 v5, 0x30000
    v_mfma_f32_16x16x32_bf16 v[80:83], a[156:159], v[168:171], v[80:83]
    s_waitcnt lgkmcnt(5)
    ds_read_b64_tr_b16 a[186:187], v69 offset:10240
    v_mfma_f32_16x16x32_bf16 v[84:87], a[160:163], v[108:111], 0
    ds_read_b64_tr_b16 a[188:189], v69 offset:12288
    v_cndmask_b32 v74, v5, v4, vcc
    v_mfma_f32_16x16x32_bf16 v[84:87], a[164:167], v[112:115], v[84:87]
    ds_read_b64_tr_b16 a[190:191], v69 offset:14336
    v_cndmask_b32 v75, v5, v4, s[28:29]
    v_mfma_f32_16x16x32_bf16 v[88:91], a[160:163], v[124:127], 0
    ds_read_b64_tr_b16 a[128:129], v178 offset:0
    v_add_u32 v176, s52, v172
    v_mfma_f32_16x16x32_bf16 v[88:91], a[164:167], v[128:131], v[88:91]
    ds_read_b64_tr_b16 a[130:131], v178 offset:2048
    s_add_u32 s43, s46, 1024
    v_mfma_f32_16x16x32_bf16 v[84:87], a[168:171], v[116:119], v[84:87]
    ds_read_b64_tr_b16 a[132:133], v178 offset:4096
    v_add_u32 v68, s53, v172
    v_mfma_f32_16x16x32_bf16 v[84:87], a[172:175], v[120:123], v[84:87]
    ds_read_b64_tr_b16 a[134:135], v178 offset:6144
    v_add_u32 v177, s52, v173
    v_mfma_f32_16x16x32_bf16 v[88:91], a[168:171], v[132:135], v[88:91]
    ds_read_b64_tr_b16 a[136:137], v178 offset:8192
    v_add_u32 v69, s53, v173
    v_mfma_f32_16x16x32_bf16 v[88:91], a[172:175], v[136:139], v[88:91]
    s_waitcnt lgkmcnt(5)
    ds_read_b64_tr_b16 a[138:139], v178 offset:10240
    v_mfma_f32_16x16x32_bf16 v[84:87], a[176:179], v[140:143], v[84:87]
    ds_read_b64_tr_b16 a[140:141], v178 offset:12288
    v_mov_b32 v60, 0
    v_mfma_f32_16x16x32_bf16 v[84:87], a[180:183], v[144:147], v[84:87]
    ds_read_b64_tr_b16 a[142:143], v178 offset:14336
    v_mov_b32 v61, 0
    v_mfma_f32_16x16x32_bf16 v[88:91], a[176:179], v[156:159], v[88:91]
    ds_read_b64_tr_b16 a[144:145], v70 offset:0
    v_add_u32 v178, s52, v174
    v_mfma_f32_16x16x32_bf16 v[88:91], a[180:183], v[160:163], v[88:91]
    ds_read_b64_tr_b16 a[146:147], v70 offset:2048
    v_mov_b32 v62, 0
    v_mfma_f32_16x16x32_bf16 v[84:87], a[184:187], v[148:151], v[84:87]
    ds_read_b64_tr_b16 a[148:149], v70 offset:4096
    v_mov_b32 v63, 0
    v_mfma_f32_16x16x32_bf16 v[84:87], a[188:191], v[152:155], v[84:87]
    ds_read_b64_tr_b16 a[150:151], v70 offset:6144
    s_mov_b32 s50, 0x76352410
    v_mfma_f32_16x16x32_bf16 v[88:91], a[184:187], v[164:167], v[88:91]
    ds_read_b64_tr_b16 a[152:153], v70 offset:8192
    s_mov_b32 s51, 0x76352410
    v_mfma_f32_16x16x32_bf16 v[88:91], a[188:191], v[168:171], v[88:91]
    s_waitcnt lgkmcnt(5)
    ds_read_b64_tr_b16 a[154:155], v70 offset:10240
    v_mfma_f32_16x16x32_bf16 v[92:95], a[128:131], v[108:111], 0
    ds_read_b64_tr_b16 a[156:157], v70 offset:12288
    s_movk_i32 s41, 0x200
    v_mfma_f32_16x16x32_bf16 v[92:95], a[132:135], v[112:115], v[92:95]
    ds_read_b64_tr_b16 a[158:159], v70 offset:14336
    s_mov_b32 s3, 0x71800000
    v_mfma_f32_16x16x32_bf16 v[96:99], a[128:131], v[124:127], 0
    ds_read_b64_tr_b16 a[160:161], v179 offset:0
    v_add_u32 v70, s53, v174
    v_mfma_f32_16x16x32_bf16 v[96:99], a[132:135], v[128:131], v[96:99]
    ds_read_b64_tr_b16 a[162:163], v179 offset:2048
    v_cmp_ngt_f32 vcc, s3, v36
    v_mfma_f32_16x16x32_bf16 v[92:95], a[136:139], v[116:119], v[92:95]
    ds_read_b64_tr_b16 a[164:165], v179 offset:4096
    s_lshl_b32 s3, s33, 2
    v_mfma_f32_16x16x32_bf16 v[92:95], a[140:143], v[120:123], v[92:95]
    ds_read_b64_tr_b16 a[166:167], v179 offset:6144
    v_cvt_pk_bf16_f32 v44, v76, v77
    v_mfma_f32_16x16x32_bf16 v[96:99], a[136:139], v[132:135], v[96:99]
    ds_read_b64_tr_b16 a[168:169], v179 offset:8192
    v_cvt_pk_bf16_f32 v45, v78, v79
    v_mfma_f32_16x16x32_bf16 v[96:99], a[140:143], v[136:139], v[96:99]
    s_waitcnt lgkmcnt(5)
    ds_read_b64_tr_b16 a[170:171], v179 offset:10240
    v_mfma_f32_16x16x32_bf16 v[92:95], a[144:147], v[140:143], v[92:95]
    ds_read_b64_tr_b16 a[172:173], v179 offset:12288
    v_cvt_pk_bf16_f32 v46, v84, v85
    v_mfma_f32_16x16x32_bf16 v[92:95], a[148:151], v[144:147], v[92:95]
    ds_read_b64_tr_b16 a[174:175], v179 offset:14336
    v_cvt_pk_bf16_f32 v47, v86, v87
    v_mfma_f32_16x16x32_bf16 v[96:99], a[144:147], v[156:159], v[96:99]
    ds_read_b64_tr_b16 a[176:177], v71 offset:0
    v_add_u32 v179, s52, v175
    v_mfma_f32_16x16x32_bf16 v[96:99], a[148:151], v[160:163], v[96:99]
    ds_read_b64_tr_b16 a[178:179], v71 offset:2048
    s_add_u32 s3, s3, 0x20000
    v_mfma_f32_16x16x32_bf16 v[92:95], a[152:155], v[148:151], v[92:95]
    ds_read_b64_tr_b16 a[180:181], v71 offset:4096
    v_mov_b32 v3, s3
    v_mfma_f32_16x16x32_bf16 v[92:95], a[156:159], v[152:155], v[92:95]
    ds_read_b64_tr_b16 a[182:183], v71 offset:6144
    buffer_store_dwordx4 v[44:47], v72, s[24:27], s46 offen sc1
    v_mfma_f32_16x16x32_bf16 v[96:99], a[152:155], v[164:167], v[96:99]
    ds_read_b64_tr_b16 a[184:185], v71 offset:8192
    ds_write_b128 v74, v[44:47] offset:512
    v_mfma_f32_16x16x32_bf16 v[96:99], a[156:159], v[168:171], v[96:99]
    s_waitcnt lgkmcnt(6)
    ds_read_b64_tr_b16 a[186:187], v71 offset:10240
    v_mfma_f32_16x16x32_bf16 v[100:103], a[160:163], v[108:111], 0
    ds_read_b64_tr_b16 a[188:189], v71 offset:12288
    v_add_u32 v74, 1024, v74
    v_mfma_f32_16x16x32_bf16 v[100:103], a[164:167], v[112:115], v[100:103]
    ds_read_b64_tr_b16 a[190:191], v71 offset:14336
    s_waitcnt vmcnt(17)
    v_mfma_f32_16x16x32_bf16 v[104:107], a[160:163], v[124:127], 0
    s_barrier
    ds_read_b64_tr_b16 a[128:129], v176 offset:0
    v_mfma_f32_16x16x32_bf16 v[104:107], a[164:167], v[128:131], v[104:107]
    ds_read_b64_tr_b16 a[130:131], v176 offset:2048
    v_cvt_pk_bf16_f32 v48, v80, v81
    v_mfma_f32_16x16x32_bf16 v[100:103], a[168:171], v[116:119], v[100:103]
    ds_read_b64_tr_b16 a[132:133], v176 offset:4096
    v_cvt_pk_bf16_f32 v49, v82, v83
    v_mfma_f32_16x16x32_bf16 v[100:103], a[172:175], v[120:123], v[100:103]
    ds_read_b64_tr_b16 a[134:135], v176 offset:6144
    v_cvt_pk_bf16_f32 v50, v88, v89
    v_mfma_f32_16x16x32_bf16 v[104:107], a[168:171], v[132:135], v[104:107]
    ds_read_b64_tr_b16 a[136:137], v176 offset:8192
    v_cvt_pk_bf16_f32 v51, v90, v91
    v_mfma_f32_16x16x32_bf16 v[104:107], a[172:175], v[136:139], v[104:107]
    s_waitcnt lgkmcnt(5)
    ds_read_b64_tr_b16 a[138:139], v176 offset:10240
    v_mfma_f32_16x16x32_bf16 v[100:103], a[176:179], v[140:143], v[100:103]
    ds_read_b64_tr_b16 a[140:141], v176 offset:12288
    v_add_u32 v71, s53, v175
    v_mfma_f32_16x16x32_bf16 v[100:103], a[180:183], v[144:147], v[100:103]
    ds_read_b64_tr_b16 a[142:143], v176 offset:14336
    s_add_u32 s3, s36, 0x8000
    v_mfma_f32_16x16x32_bf16 v[104:107], a[176:179], v[156:159], v[104:107]
    ds_read_b64_tr_b16 a[144:145], v68 offset:0
    v_add_u32 v252, s3, v26
    v_mfma_f32_16x16x32_bf16 v[104:107], a[180:183], v[160:163], v[104:107]
    ds_read_b64_tr_b16 a[146:147], v68 offset:2048
    s_mov_b32 s52, 81920
    v_mfma_f32_16x16x32_bf16 v[100:103], a[184:187], v[148:151], v[100:103]
    ds_read_b64_tr_b16 a[148:149], v68 offset:4096
    s_mov_b32 s53, 49152
    v_mfma_f32_16x16x32_bf16 v[100:103], a[188:191], v[152:155], v[100:103]
    ds_read_b64_tr_b16 a[150:151], v68 offset:6144
    buffer_store_dwordx4 v[48:51], v73, s[24:27], s46 offen sc1
    v_mfma_f32_16x16x32_bf16 v[104:107], a[184:187], v[164:167], v[104:107]
    ds_read_b64_tr_b16 a[152:153], v68 offset:8192
    ds_write_b128 v75, v[48:51] offset:512
    v_mfma_f32_16x16x32_bf16 v[104:107], a[188:191], v[168:171], v[104:107]
    s_waitcnt lgkmcnt(6)
    ds_read_b64_tr_b16 a[154:155], v68 offset:10240
    v_add_u32 v75, 1024, v75
    s_add_u32 s46, s46, 2048
    v_add_u32 v253, 0x10000, v252
    v_mfma_f32_16x16x32_bf16 v[76:79], a[128:131], v[108:111], 0
    ds_read_b64_tr_b16 a[156:157], v68 offset:12288
    v_add_u32 v176, s52, v172
    v_mfma_f32_16x16x32_bf16 v[76:79], a[132:135], v[112:115], v[76:79]
    ds_read_b64_tr_b16 a[158:159], v68 offset:14336
    v_mfma_f32_16x16x32_bf16 v[80:83], a[128:131], v[124:127], 0
    ds_read_b64_tr_b16 a[160:161], v177 offset:0
    v_add_u32 v68, s53, v172
    v_mfma_f32_16x16x32_bf16 v[80:83], a[132:135], v[128:131], v[80:83]
    ds_read_b64_tr_b16 a[162:163], v177 offset:2048
    v_mfma_f32_16x16x32_bf16 v[76:79], a[136:139], v[116:119], v[76:79]
    ds_read_b64_tr_b16 a[164:165], v177 offset:4096
    v_mfma_f32_16x16x32_bf16 v[76:79], a[140:143], v[120:123], v[76:79]
    ds_read_b64_tr_b16 a[166:167], v177 offset:6144
    v_cvt_pk_bf16_f32 v52, v92, v93
    v_mfma_f32_16x16x32_bf16 v[80:83], a[136:139], v[132:135], v[80:83]
    ds_read_b64_tr_b16 a[168:169], v177 offset:8192
    v_cvt_pk_bf16_f32 v53, v94, v95
    v_mfma_f32_16x16x32_bf16 v[80:83], a[140:143], v[136:139], v[80:83]
    s_waitcnt lgkmcnt(5)
    ds_read_b64_tr_b16 a[170:171], v177 offset:10240
    v_mfma_f32_16x16x32_bf16 v[76:79], a[144:147], v[140:143], v[76:79]
    ds_read_b64_tr_b16 a[172:173], v177 offset:12288
    v_cvt_pk_bf16_f32 v54, v100, v101
    v_mfma_f32_16x16x32_bf16 v[76:79], a[148:151], v[144:147], v[76:79]
    ds_read_b64_tr_b16 a[174:175], v177 offset:14336
    v_cvt_pk_bf16_f32 v55, v102, v103
    v_mfma_f32_16x16x32_bf16 v[80:83], a[144:147], v[156:159], v[80:83]
    ds_read_b64_tr_b16 a[176:177], v69 offset:0
    v_add_u32 v177, s52, v173
    v_mfma_f32_16x16x32_bf16 v[80:83], a[148:151], v[160:163], v[80:83]
    ds_read_b64_tr_b16 a[178:179], v69 offset:2048
    v_mfma_f32_16x16x32_bf16 v[76:79], a[152:155], v[148:151], v[76:79]
    ds_read_b64_tr_b16 a[180:181], v69 offset:4096
    v_mfma_f32_16x16x32_bf16 v[76:79], a[156:159], v[152:155], v[76:79]
    ds_read_b64_tr_b16 a[182:183], v69 offset:6144
    buffer_store_dwordx4 v[52:55], v72, s[24:27], s43 offen sc1
    v_mfma_f32_16x16x32_bf16 v[80:83], a[152:155], v[164:167], v[80:83]
    ds_read_b64_tr_b16 a[184:185], v69 offset:8192
    ds_write_b128 v74, v[52:55] offset:0
    v_mfma_f32_16x16x32_bf16 v[80:83], a[156:159], v[168:171], v[80:83]
    s_waitcnt lgkmcnt(6)
    ds_read_b64_tr_b16 a[186:187], v69 offset:10240
    v_mfma_f32_16x16x32_bf16 v[84:87], a[160:163], v[108:111], 0
    ds_read_b64_tr_b16 a[188:189], v69 offset:12288
    s_mov_b32 s39, 2359296
    v_mfma_f32_16x16x32_bf16 v[84:87], a[164:167], v[112:115], v[84:87]
    ds_read_b64_tr_b16 a[190:191], v69 offset:14336
    v_cvt_pk_bf16_f32 v56, v96, v97
    v_mfma_f32_16x16x32_bf16 v[88:91], a[160:163], v[124:127], 0
    ds_read_b64_tr_b16 a[128:129], v178 offset:0
    buffer_load_dwordx4 a[0:3], v0, s[60:63], s39 offen
    v_mfma_f32_16x16x32_bf16 v[88:91], a[164:167], v[128:131], v[88:91]
    ds_read_b64_tr_b16 a[130:131], v178 offset:2048
    v_cvt_pk_bf16_f32 v57, v98, v99
    v_mfma_f32_16x16x32_bf16 v[84:87], a[168:171], v[116:119], v[84:87]
    ds_read_b64_tr_b16 a[132:133], v178 offset:4096
    buffer_load_dwordx4 a[4:7], v0, s[64:67], s39 offen
    v_mfma_f32_16x16x32_bf16 v[84:87], a[172:175], v[120:123], v[84:87]
    ds_read_b64_tr_b16 a[134:135], v178 offset:6144
    v_cvt_pk_bf16_f32 v58, v104, v105
    v_mfma_f32_16x16x32_bf16 v[88:91], a[168:171], v[132:135], v[88:91]
    ds_read_b64_tr_b16 a[136:137], v178 offset:8192
    s_mov_b32 s39, 2949120
    v_mfma_f32_16x16x32_bf16 v[88:91], a[172:175], v[136:139], v[88:91]
    s_waitcnt lgkmcnt(5)
    ds_read_b64_tr_b16 a[138:139], v178 offset:10240
    v_mfma_f32_16x16x32_bf16 v[84:87], a[176:179], v[140:143], v[84:87]
    ds_read_b64_tr_b16 a[140:141], v178 offset:12288
    v_cvt_pk_bf16_f32 v59, v106, v107
    v_mfma_f32_16x16x32_bf16 v[84:87], a[180:183], v[144:147], v[84:87]
    ds_read_b64_tr_b16 a[142:143], v178 offset:14336
    buffer_load_dwordx4 a[8:11], v0, s[60:63], s39 offen
    v_mfma_f32_16x16x32_bf16 v[88:91], a[176:179], v[156:159], v[88:91]
    ds_read_b64_tr_b16 a[144:145], v70 offset:0
    buffer_load_dwordx4 a[12:15], v0, s[64:67], s39 offen
    v_mfma_f32_16x16x32_bf16 v[88:91], a[180:183], v[160:163], v[88:91]
    ds_read_b64_tr_b16 a[146:147], v70 offset:2048
    v_add_u32 v69, s53, v173
    v_mfma_f32_16x16x32_bf16 v[84:87], a[184:187], v[148:151], v[84:87]
    ds_read_b64_tr_b16 a[148:149], v70 offset:4096
    s_mov_b32 s39, 3538944
    v_mfma_f32_16x16x32_bf16 v[84:87], a[188:191], v[152:155], v[84:87]
    ds_read_b64_tr_b16 a[150:151], v70 offset:6144
    buffer_store_dwordx4 v[56:59], v73, s[24:27], s43 offen sc1
    v_mfma_f32_16x16x32_bf16 v[88:91], a[184:187], v[164:167], v[88:91]
    ds_read_b64_tr_b16 a[152:153], v70 offset:8192
    buffer_load_dwordx4 a[16:19], v0, s[60:63], s39 offen
    v_mfma_f32_16x16x32_bf16 v[88:91], a[188:191], v[168:171], v[88:91]
    s_waitcnt lgkmcnt(5)
    ds_read_b64_tr_b16 a[154:155], v70 offset:10240
    v_mfma_f32_16x16x32_bf16 v[64:67], v[60:63], v[108:111], 0
    buffer_load_dwordx4 a[20:23], v0, s[64:67], s39 offen
    ds_read_b64_tr_b16 a[156:157], v70 offset:12288
    v_mfma_f32_16x16x32_bf16 v[64:67], v[60:63], v[112:115], v[64:67]
    ds_write_b128 v75, v[56:59] offset:0
    s_add_u32 s43, s46, 1024
    v_mfma_f32_16x16x32_bf16 v[64:67], v[60:63], v[116:119], v[64:67]
    s_mov_b32 s39, 4128768
    v_add_u32 v178, s52, v174
    v_mfma_f32_16x16x32_bf16 v[64:67], v[60:63], v[120:123], v[64:67]
    v_mfma_f32_16x16x32_bf16 v[64:67], v[60:63], v[124:127], v[64:67]
    buffer_load_dwordx4 a[24:27], v0, s[60:63], s39 offen
    v_mfma_f32_16x16x32_bf16 v[64:67], v[60:63], v[128:131], v[64:67]
    v_mfma_f32_16x16x32_bf16 v[64:67], v[60:63], v[132:135], v[64:67]
    buffer_load_dwordx4 a[28:31], v0, s[64:67], s39 offen
    v_mfma_f32_16x16x32_bf16 v[64:67], v[60:63], v[136:139], v[64:67]
    v_mfma_f32_16x16x32_bf16 v[64:67], v[60:63], v[140:143], v[64:67]
    buffer_load_dwordx4 a[32:35], v2, s[68:71], 0 offen offset:0
    v_mfma_f32_16x16x32_bf16 v[64:67], v[60:63], v[144:147], v[64:67]
    v_mfma_f32_16x16x32_bf16 v[64:67], v[60:63], v[148:151], v[64:67]
    buffer_load_dwordx4 a[36:39], v2, s[68:71], 0 offen offset:128
    v_mfma_f32_16x16x32_bf16 v[64:67], v[60:63], v[152:155], v[64:67]
    v_mfma_f32_16x16x32_bf16 v[64:67], v[60:63], v[156:159], v[64:67]
    buffer_load_dwordx4 a[40:43], v2, s[68:71], 0 offen offset:256
    v_mfma_f32_16x16x32_bf16 v[64:67], v[60:63], v[160:163], v[64:67]
    v_mfma_f32_16x16x32_bf16 v[64:67], v[60:63], v[164:167], v[64:67]
    buffer_load_dwordx4 a[44:47], v2, s[68:71], 0 offen offset:384
    v_mfma_f32_16x16x32_bf16 v[64:67], v[60:63], v[168:171], v[64:67]
    v_mfma_f32_16x16x32_bf16 v[92:95], a[128:131], v[108:111], 0
    ds_read_b64_tr_b16 a[158:159], v70 offset:14336
    buffer_load_dwordx4 a[48:51], v2, s[68:71], 0 offen offset:512
    v_mfma_f32_16x16x32_bf16 v[92:95], a[132:135], v[112:115], v[92:95]
    ds_read_b64_tr_b16 a[160:161], v179 offset:0
    v_mfma_f32_16x16x32_bf16 v[96:99], a[128:131], v[124:127], 0
    ds_read_b64_tr_b16 a[162:163], v179 offset:2048
    buffer_load_dwordx4 a[52:55], v2, s[68:71], 0 offen offset:640
    v_mfma_f32_16x16x32_bf16 v[96:99], a[132:135], v[128:131], v[96:99]
    ds_read_b64_tr_b16 a[164:165], v179 offset:4096
    v_add_u32 v70, s53, v174
    v_mfma_f32_16x16x32_bf16 v[92:95], a[136:139], v[116:119], v[92:95]
    ds_read_b64_tr_b16 a[166:167], v179 offset:6144
    v_mfma_f32_16x16x32_bf16 v[92:95], a[140:143], v[120:123], v[92:95]
    ds_read_b64_tr_b16 a[168:169], v179 offset:8192
    v_cvt_pk_bf16_f32 v44, v76, v77
    v_mfma_f32_16x16x32_bf16 v[96:99], a[136:139], v[132:135], v[96:99]
    ds_read_b64_tr_b16 a[170:171], v179 offset:10240
    v_cvt_pk_bf16_f32 v45, v78, v79
    v_mfma_f32_16x16x32_bf16 v[96:99], a[140:143], v[136:139], v[96:99]
    s_waitcnt lgkmcnt(6)
    ds_read_b64_tr_b16 a[172:173], v179 offset:12288
    v_mfma_f32_16x16x32_bf16 v[92:95], a[144:147], v[140:143], v[92:95]
    ds_read_b64_tr_b16 a[174:175], v179 offset:14336
    v_cvt_pk_bf16_f32 v46, v84, v85
    v_mfma_f32_16x16x32_bf16 v[92:95], a[148:151], v[144:147], v[92:95]
    ds_read_b64_tr_b16 a[176:177], v71 offset:0
    v_cvt_pk_bf16_f32 v47, v86, v87
    v_mfma_f32_16x16x32_bf16 v[96:99], a[144:147], v[156:159], v[96:99]
    ds_read_b64_tr_b16 a[178:179], v71 offset:2048
    v_cmp_u_f32 s[28:29], v64, v64
    v_mfma_f32_16x16x32_bf16 v[96:99], a[148:151], v[160:163], v[96:99]
    ds_read_b64_tr_b16 a[180:181], v71 offset:4096
    s_nop 0
    v_mfma_f32_16x16x32_bf16 v[92:95], a[152:155], v[148:151], v[92:95]
    ds_read_b64_tr_b16 a[182:183], v71 offset:6144
    s_or_b64 s[28:29], s[28:29], vcc
    s_cselect_b32 s3, 1, 0
    v_mfma_f32_16x16x32_bf16 v[92:95], a[156:159], v[152:155], v[92:95]
    ds_read_b64_tr_b16 a[184:185], v71 offset:8192
    buffer_store_dwordx4 v[44:47], v72, s[24:27], s46 offen sc1
    v_mfma_f32_16x16x32_bf16 v[96:99], a[152:155], v[164:167], v[96:99]
    ds_read_b64_tr_b16 a[186:187], v71 offset:10240
    ds_write_b128 v74, v[44:47] offset:512
    v_mfma_f32_16x16x32_bf16 v[96:99], a[156:159], v[168:171], v[96:99]
    s_waitcnt lgkmcnt(7)
    ds_read_b64_tr_b16 a[188:189], v71 offset:12288
    v_mfma_f32_16x16x32_bf16 v[100:103], a[160:163], v[108:111], 0
    ds_read_b64_tr_b16 a[190:191], v71 offset:14336
    s_waitcnt vmcnt(27)
    v_mfma_f32_16x16x32_bf16 v[100:103], a[164:167], v[112:115], v[100:103]
    s_barrier
    ds_read_b64_tr_b16 a[128:129], v176 offset:0
    v_mfma_f32_16x16x32_bf16 v[104:107], a[160:163], v[124:127], 0
    v_add_u32 v74, 1024, v74
    ds_read_b64_tr_b16 a[130:131], v176 offset:2048
    v_mfma_f32_16x16x32_bf16 v[104:107], a[164:167], v[128:131], v[104:107]
    ds_read_b64_tr_b16 a[132:133], v176 offset:4096
    v_mov_b32 v4, s3
    v_mfma_f32_16x16x32_bf16 v[100:103], a[168:171], v[116:119], v[100:103]
    ds_read_b64_tr_b16 a[134:135], v176 offset:6144
    ds_write_b32 v3, v4
    v_mfma_f32_16x16x32_bf16 v[100:103], a[172:175], v[120:123], v[100:103]
    ds_read_b64_tr_b16 a[136:137], v176 offset:8192
    v_mov_b32 v3, 0x20000
    v_mfma_f32_16x16x32_bf16 v[104:107], a[168:171], v[132:135], v[104:107]
    s_waitcnt lgkmcnt(12)
    ds_read_b64_tr_b16 a[138:139], v176 offset:10240
    v_add_u32 v179, s52, v175
    v_mfma_f32_16x16x32_bf16 v[104:107], a[172:175], v[136:139], v[104:107]
    s_waitcnt lgkmcnt(7)
    ds_read_b64_tr_b16 a[140:141], v176 offset:12288
    v_mfma_f32_16x16x32_bf16 v[100:103], a[176:179], v[140:143], v[100:103]
    ds_read_b64_tr_b16 a[142:143], v176 offset:14336
    v_cvt_pk_bf16_f32 v48, v80, v81
    v_mfma_f32_16x16x32_bf16 v[100:103], a[180:183], v[144:147], v[100:103]
    ds_read_b64_tr_b16 a[144:145], v68 offset:0
    v_cvt_pk_bf16_f32 v49, v82, v83
    v_mfma_f32_16x16x32_bf16 v[104:107], a[176:179], v[156:159], v[104:107]
    ds_read_b64_tr_b16 a[146:147], v68 offset:2048
    v_cvt_pk_bf16_f32 v50, v88, v89
    v_mfma_f32_16x16x32_bf16 v[104:107], a[180:183], v[160:163], v[104:107]
    ds_read_b64_tr_b16 a[148:149], v68 offset:4096
    v_cvt_pk_bf16_f32 v51, v90, v91
    v_mfma_f32_16x16x32_bf16 v[100:103], a[184:187], v[148:151], v[100:103]
    v_add_u32 v71, s53, v175
    ds_read_b64_tr_b16 a[150:151], v68 offset:6144
    v_mfma_f32_16x16x32_bf16 v[100:103], a[188:191], v[152:155], v[100:103]
    ds_read_b64_tr_b16 a[152:153], v68 offset:8192
    buffer_store_dwordx4 v[48:51], v73, s[24:27], s46 offen sc1
    v_mfma_f32_16x16x32_bf16 v[104:107], a[184:187], v[164:167], v[104:107]
    ds_read_b64_tr_b16 a[154:155], v68 offset:10240
    s_waitcnt lgkmcnt(12)
    ds_write_b128 v75, v[48:51] offset:512
    v_mfma_f32_16x16x32_bf16 v[104:107], a[188:191], v[168:171], v[104:107]
    s_waitcnt lgkmcnt(7)
    v_add_u32 v75, 1024, v75
    s_add_u32 s46, s46, 2048
    s_mov_b32 s52, 98304
    s_mov_b32 s53, 114688
.p2align 6
L_oproj_loop:
    v_mfma_f32_16x16x32_bf16 v[76:79], a[128:131], v[108:111], 0
    ds_read_b64_tr_b16 a[156:157], v68 offset:12288
    s_bfe_u32 s28, s50, 0x30000
    v_mfma_f32_16x16x32_bf16 v[76:79], a[132:135], v[112:115], v[76:79]
    ds_read_b64_tr_b16 a[158:159], v68 offset:14336
    s_lshl_b32 s28, s28, 14
    v_mfma_f32_16x16x32_bf16 v[80:83], a[128:131], v[124:127], 0
    ds_read_b64_tr_b16 a[160:161], v177 offset:0
    s_add_u32 m0, s28, s38
    v_mfma_f32_16x16x32_bf16 v[80:83], a[132:135], v[128:131], v[80:83]
    ds_read_b64_tr_b16 a[162:163], v177 offset:2048
    buffer_load_dwordx4 v180, s[56:59], s41 offen offset:0 lds
    v_mfma_f32_16x16x32_bf16 v[76:79], a[136:139], v[116:119], v[76:79]
    ds_read_b64_tr_b16 a[164:165], v177 offset:4096
    v_add_u32 v176, s52, v172
    v_mfma_f32_16x16x32_bf16 v[76:79], a[140:143], v[120:123], v[76:79]
    ds_read_b64_tr_b16 a[166:167], v177 offset:6144
    v_cvt_pk_bf16_f32 v52, v92, v93
    v_mfma_f32_16x16x32_bf16 v[80:83], a[136:139], v[132:135], v[80:83]
    ds_read_b64_tr_b16 a[168:169], v177 offset:8192
    v_cvt_pk_bf16_f32 v53, v94, v95
    v_mfma_f32_16x16x32_bf16 v[80:83], a[140:143], v[136:139], v[80:83]
    s_waitcnt lgkmcnt(5)
    ds_read_b64_tr_b16 a[170:171], v177 offset:10240
    v_mfma_f32_16x16x32_bf16 v[76:79], a[144:147], v[140:143], v[76:79]
    ds_read_b64_tr_b16 a[172:173], v177 offset:12288
    buffer_load_dwordx4 v181, s[56:59], s41 offen offset:1024 lds
    v_mfma_f32_16x16x32_bf16 v[76:79], a[148:151], v[144:147], v[76:79]
    ds_read_b64_tr_b16 a[174:175], v177 offset:14336
    v_cvt_pk_bf16_f32 v54, v100, v101
    v_mfma_f32_16x16x32_bf16 v[80:83], a[144:147], v[156:159], v[80:83]
    ds_read_b64_tr_b16 a[176:177], v69 offset:0
    v_cvt_pk_bf16_f32 v55, v102, v103
    v_mfma_f32_16x16x32_bf16 v[80:83], a[148:151], v[160:163], v[80:83]
    ds_read_b64_tr_b16 a[178:179], v69 offset:2048
    v_add_u32 v68, s53, v172
    v_mfma_f32_16x16x32_bf16 v[76:79], a[152:155], v[148:151], v[76:79]
    ds_read_b64_tr_b16 a[180:181], v69 offset:4096
    v_add_u32 v177, s52, v173
    v_mfma_f32_16x16x32_bf16 v[76:79], a[156:159], v[152:155], v[76:79]
    ds_read_b64_tr_b16 a[182:183], v69 offset:6144
    buffer_store_dwordx4 v[52:55], v72, s[24:27], s43 offen sc1
    v_mfma_f32_16x16x32_bf16 v[80:83], a[152:155], v[164:167], v[80:83]
    ds_read_b64_tr_b16 a[184:185], v69 offset:8192
    ds_write_b128 v74, v[52:55] offset:0
    v_mfma_f32_16x16x32_bf16 v[80:83], a[156:159], v[168:171], v[80:83]
    s_waitcnt lgkmcnt(6)
    ds_read_b64_tr_b16 a[186:187], v69 offset:10240
    v_mfma_f32_16x16x32_bf16 v[84:87], a[160:163], v[108:111], 0
    ds_read_b64_tr_b16 a[188:189], v69 offset:12288
    v_cvt_pk_bf16_f32 v56, v96, v97
    v_mfma_f32_16x16x32_bf16 v[84:87], a[164:167], v[112:115], v[84:87]
    ds_read_b64_tr_b16 a[190:191], v69 offset:14336
    v_cvt_pk_bf16_f32 v57, v98, v99
    v_mfma_f32_16x16x32_bf16 v[88:91], a[160:163], v[124:127], 0
    ds_read_b64_tr_b16 a[128:129], v178 offset:0
    v_cvt_pk_bf16_f32 v58, v104, v105
    v_mfma_f32_16x16x32_bf16 v[88:91], a[164:167], v[128:131], v[88:91]
    ds_read_b64_tr_b16 a[130:131], v178 offset:2048
    buffer_load_dwordx4 v182, s[56:59], s41 offen offset:2048 lds
    v_mfma_f32_16x16x32_bf16 v[84:87], a[168:171], v[116:119], v[84:87]
    ds_read_b64_tr_b16 a[132:133], v178 offset:4096
    v_cvt_pk_bf16_f32 v59, v106, v107
    v_mfma_f32_16x16x32_bf16 v[84:87], a[172:175], v[120:123], v[84:87]
    ds_read_b64_tr_b16 a[134:135], v178 offset:6144
    v_add_u32 v69, s53, v173
    v_mfma_f32_16x16x32_bf16 v[88:91], a[168:171], v[132:135], v[88:91]
    ds_read_b64_tr_b16 a[136:137], v178 offset:8192
    v_mfma_f32_16x16x32_bf16 v[88:91], a[172:175], v[136:139], v[88:91]
    s_waitcnt lgkmcnt(5)
    ds_read_b64_tr_b16 a[138:139], v178 offset:10240
    v_mfma_f32_16x16x32_bf16 v[84:87], a[176:179], v[140:143], v[84:87]
    ds_read_b64_tr_b16 a[140:141], v178 offset:12288
    buffer_load_dwordx4 v183, s[56:59], s41 offen offset:3072 lds
    v_mfma_f32_16x16x32_bf16 v[84:87], a[180:183], v[144:147], v[84:87]
    ds_read_b64_tr_b16 a[142:143], v178 offset:14336
    s_bfe_u32 s29, s50, 0x30004
    v_mfma_f32_16x16x32_bf16 v[88:91], a[176:179], v[156:159], v[88:91]
    ds_read_b64_tr_b16 a[144:145], v70 offset:0
    s_lshl_b32 s29, s29, 14
    v_mfma_f32_16x16x32_bf16 v[88:91], a[180:183], v[160:163], v[88:91]
    ds_read_b64_tr_b16 a[146:147], v70 offset:2048
    s_add_u32 m0, s29, s38
    v_mfma_f32_16x16x32_bf16 v[84:87], a[184:187], v[148:151], v[84:87]
    ds_read_b64_tr_b16 a[148:149], v70 offset:4096
    s_add_u32 s42, s41, 147456
    v_mfma_f32_16x16x32_bf16 v[84:87], a[188:191], v[152:155], v[84:87]
    ds_read_b64_tr_b16 a[150:151], v70 offset:6144
    buffer_store_dwordx4 v[56:59], v73, s[24:27], s43 offen sc1
    v_mfma_f32_16x16x32_bf16 v[88:91], a[184:187], v[164:167], v[88:91]
    ds_read_b64_tr_b16 a[152:153], v70 offset:8192
    ds_write_b128 v75, v[56:59] offset:0
    v_mfma_f32_16x16x32_bf16 v[88:91], a[188:191], v[168:171], v[88:91]
    s_waitcnt lgkmcnt(6)
    ds_read_b64_tr_b16 a[154:155], v70 offset:10240
    v_mfma_f32_16x16x32_bf16 v[92:95], a[128:131], v[108:111], 0
    ds_read_b64_tr_b16 a[156:157], v70 offset:12288
    s_add_u32 s43, s46, 1024
    v_mfma_f32_16x16x32_bf16 v[92:95], a[132:135], v[112:115], v[92:95]
    ds_read_b64_tr_b16 a[158:159], v70 offset:14336
    v_add_u32 v178, s52, v174
    v_mfma_f32_16x16x32_bf16 v[96:99], a[128:131], v[124:127], 0
    ds_read_b64_tr_b16 a[160:161], v179 offset:0
    v_add_u32 v70, s53, v174
    v_mfma_f32_16x16x32_bf16 v[96:99], a[132:135], v[128:131], v[96:99]
    ds_read_b64_tr_b16 a[162:163], v179 offset:2048
    buffer_load_dwordx4 v180, s[56:59], s42 offen offset:0 lds
    v_mfma_f32_16x16x32_bf16 v[92:95], a[136:139], v[116:119], v[92:95]
    ds_read_b64_tr_b16 a[164:165], v179 offset:4096
    s_lshr_b64 s[50:51], s[50:51], 8
    v_mfma_f32_16x16x32_bf16 v[92:95], a[140:143], v[120:123], v[92:95]
    ds_read_b64_tr_b16 a[166:167], v179 offset:6144
    v_cvt_pk_bf16_f32 v44, v76, v77
    v_mfma_f32_16x16x32_bf16 v[96:99], a[136:139], v[132:135], v[96:99]
    ds_read_b64_tr_b16 a[168:169], v179 offset:8192
    v_cvt_pk_bf16_f32 v45, v78, v79
    v_mfma_f32_16x16x32_bf16 v[96:99], a[140:143], v[136:139], v[96:99]
    s_waitcnt lgkmcnt(5)
    ds_read_b64_tr_b16 a[170:171], v179 offset:10240
    v_mfma_f32_16x16x32_bf16 v[92:95], a[144:147], v[140:143], v[92:95]
    ds_read_b64_tr_b16 a[172:173], v179 offset:12288
    buffer_load_dwordx4 v181, s[56:59], s42 offen offset:1024 lds
    v_mfma_f32_16x16x32_bf16 v[92:95], a[148:151], v[144:147], v[92:95]
    ds_read_b64_tr_b16 a[174:175], v179 offset:14336
    v_cvt_pk_bf16_f32 v46, v84, v85
    v_mfma_f32_16x16x32_bf16 v[96:99], a[144:147], v[156:159], v[96:99]
    ds_read_b64_tr_b16 a[176:177], v71 offset:0
    v_cvt_pk_bf16_f32 v47, v86, v87
    v_mfma_f32_16x16x32_bf16 v[96:99], a[148:151], v[160:163], v[96:99]
    ds_read_b64_tr_b16 a[178:179], v71 offset:2048
    v_add_u32 v179, s52, v175
    v_mfma_f32_16x16x32_bf16 v[92:95], a[152:155], v[148:151], v[92:95]
    ds_read_b64_tr_b16 a[180:181], v71 offset:4096
    s_add_u32 s41, s41, 128
    v_mfma_f32_16x16x32_bf16 v[92:95], a[156:159], v[152:155], v[92:95]
    ds_read_b64_tr_b16 a[182:183], v71 offset:6144
    buffer_store_dwordx4 v[44:47], v72, s[24:27], s46 offen sc1
    v_mfma_f32_16x16x32_bf16 v[96:99], a[152:155], v[164:167], v[96:99]
    ds_read_b64_tr_b16 a[184:185], v71 offset:8192
    ds_write_b128 v74, v[44:47] offset:512
    v_mfma_f32_16x16x32_bf16 v[96:99], a[156:159], v[168:171], v[96:99]
    s_waitcnt lgkmcnt(6)
    ds_read_b64_tr_b16 a[186:187], v71 offset:10240
    v_mfma_f32_16x16x32_bf16 v[100:103], a[160:163], v[108:111], 0
    ds_read_b64_tr_b16 a[188:189], v71 offset:12288
    v_add_u32 v74, 1024, v74
    v_mfma_f32_16x16x32_bf16 v[100:103], a[164:167], v[112:115], v[100:103]
    ds_read_b64_tr_b16 a[190:191], v71 offset:14336
    s_waitcnt vmcnt(10)
    v_mfma_f32_16x16x32_bf16 v[104:107], a[160:163], v[124:127], 0
    s_barrier
    ds_read_b64_tr_b16 a[128:129], v176 offset:0
    v_mfma_f32_16x16x32_bf16 v[104:107], a[164:167], v[128:131], v[104:107]
    ds_read_b64_tr_b16 a[130:131], v176 offset:2048
    buffer_load_dwordx4 v182, s[56:59], s42 offen offset:2048 lds
    v_mfma_f32_16x16x32_bf16 v[100:103], a[168:171], v[116:119], v[100:103]
    ds_read_b64_tr_b16 a[132:133], v176 offset:4096
    v_cvt_pk_bf16_f32 v48, v80, v81
    v_mfma_f32_16x16x32_bf16 v[100:103], a[172:175], v[120:123], v[100:103]
    ds_read_b64_tr_b16 a[134:135], v176 offset:6144
    v_cvt_pk_bf16_f32 v49, v82, v83
    v_mfma_f32_16x16x32_bf16 v[104:107], a[168:171], v[132:135], v[104:107]
    ds_read_b64_tr_b16 a[136:137], v176 offset:8192
    v_cvt_pk_bf16_f32 v50, v88, v89
    v_mfma_f32_16x16x32_bf16 v[104:107], a[172:175], v[136:139], v[104:107]
    s_waitcnt lgkmcnt(5)
    ds_read_b64_tr_b16 a[138:139], v176 offset:10240
    v_mfma_f32_16x16x32_bf16 v[100:103], a[176:179], v[140:143], v[100:103]
    ds_read_b64_tr_b16 a[140:141], v176 offset:12288
    buffer_load_dwordx4 v183, s[56:59], s42 offen offset:3072 lds
    v_mfma_f32_16x16x32_bf16 v[100:103], a[180:183], v[144:147], v[100:103]
    ds_read_b64_tr_b16 a[142:143], v176 offset:14336
    v_cvt_pk_bf16_f32 v51, v90, v91
    v_mfma_f32_16x16x32_bf16 v[104:107], a[176:179], v[156:159], v[104:107]
    ds_read_b64_tr_b16 a[144:145], v68 offset:0
    v_add_u32 v71, s53, v175
    v_mfma_f32_16x16x32_bf16 v[104:107], a[180:183], v[160:163], v[104:107]
    ds_read_b64_tr_b16 a[146:147], v68 offset:2048
    s_mov_b64 s[52:53], s[28:29]
    v_mfma_f32_16x16x32_bf16 v[100:103], a[184:187], v[148:151], v[100:103]
    ds_read_b64_tr_b16 a[148:149], v68 offset:4096
    v_mfma_f32_16x16x32_bf16 v[100:103], a[188:191], v[152:155], v[100:103]
    ds_read_b64_tr_b16 a[150:151], v68 offset:6144
    buffer_store_dwordx4 v[48:51], v73, s[24:27], s46 offen sc1
    v_mfma_f32_16x16x32_bf16 v[104:107], a[184:187], v[164:167], v[104:107]
    ds_read_b64_tr_b16 a[152:153], v68 offset:8192
    ds_write_b128 v75, v[48:51] offset:512
    v_mfma_f32_16x16x32_bf16 v[104:107], a[188:191], v[168:171], v[104:107]
    s_waitcnt lgkmcnt(6)
    ds_read_b64_tr_b16 a[154:155], v68 offset:10240
    v_add_u32 v75, 1024, v75
    s_add_u32 s46, s46, 2048
    s_cmp_lt_u32 s46, 14336
    s_cbranch_scc1 L_oproj_loop
    v_mfma_f32_16x16x32_bf16 v[76:79], a[128:131], v[108:111], 0
    ds_read_b64_tr_b16 a[156:157], v68 offset:12288
    ds_read_b128 v[4:7], v3
    v_mfma_f32_16x16x32_bf16 v[76:79], a[132:135], v[112:115], v[76:79]
    ds_read_b64_tr_b16 a[158:159], v68 offset:14336
    v_add_u32 v176, s52, v172
    v_mfma_f32_16x16x32_bf16 v[80:83], a[128:131], v[124:127], 0
    ds_read_b64_tr_b16 a[160:161], v177 offset:0
    v_add_u32 v68, s53, v172
    v_mfma_f32_16x16x32_bf16 v[80:83], a[132:135], v[128:131], v[80:83]
    ds_read_b64_tr_b16 a[162:163], v177 offset:2048
    v_mfma_f32_16x16x32_bf16 v[76:79], a[136:139], v[116:119], v[76:79]
    ds_read_b64_tr_b16 a[164:165], v177 offset:4096
    v_mfma_f32_16x16x32_bf16 v[76:79], a[140:143], v[120:123], v[76:79]
    ds_read_b64_tr_b16 a[166:167], v177 offset:6144
    v_cvt_pk_bf16_f32 v52, v92, v93
    v_mfma_f32_16x16x32_bf16 v[80:83], a[136:139], v[132:135], v[80:83]
    ds_read_b64_tr_b16 a[168:169], v177 offset:8192
    v_cvt_pk_bf16_f32 v53, v94, v95
    v_mfma_f32_16x16x32_bf16 v[80:83], a[140:143], v[136:139], v[80:83]
    s_waitcnt lgkmcnt(5)
    ds_read_b64_tr_b16 a[170:171], v177 offset:10240
    v_mfma_f32_16x16x32_bf16 v[76:79], a[144:147], v[140:143], v[76:79]
    ds_read_b64_tr_b16 a[172:173], v177 offset:12288
    v_or3_b32 v4, v4, v5, v6
    v_mfma_f32_16x16x32_bf16 v[76:79], a[148:151], v[144:147], v[76:79]
    ds_read_b64_tr_b16 a[174:175], v177 offset:14336
    v_or_b32 v4, v4, v7
    v_mfma_f32_16x16x32_bf16 v[80:83], a[144:147], v[156:159], v[80:83]
    ds_read_b64_tr_b16 a[176:177], v69 offset:0
    v_cvt_pk_bf16_f32 v54, v100, v101
    v_mfma_f32_16x16x32_bf16 v[80:83], a[148:151], v[160:163], v[80:83]
    ds_read_b64_tr_b16 a[178:179], v69 offset:2048
    v_cvt_pk_bf16_f32 v55, v102, v103
    v_mfma_f32_16x16x32_bf16 v[76:79], a[152:155], v[148:151], v[76:79]
    ds_read_b64_tr_b16 a[180:181], v69 offset:4096
    v_readfirstlane_b32 s47, v4
    v_mfma_f32_16x16x32_bf16 v[76:79], a[156:159], v[152:155], v[76:79]
    ds_read_b64_tr_b16 a[182:183], v69 offset:6144
    buffer_store_dwordx4 v[52:55], v72, s[24:27], s43 offen sc1
    v_mfma_f32_16x16x32_bf16 v[80:83], a[152:155], v[164:167], v[80:83]
    ds_read_b64_tr_b16 a[184:185], v69 offset:8192
    s_andn2_b32 s47, s47, s45
    s_cbranch_scc1 L_attn_retry
    v_mfma_f32_16x16x32_bf16 v[80:83], a[156:159], v[168:171], v[80:83]
    s_waitcnt lgkmcnt(5)
    ds_read_b64_tr_b16 a[186:187], v69 offset:10240
    v_mfma_f32_16x16x32_bf16 v[84:87], a[160:163], v[108:111], 0
    ds_read_b64_tr_b16 a[188:189], v69 offset:12288
    ds_write_b128 v74, v[52:55] offset:0
    s_lshl_b32 s32, s35, 4
    v_mfma_f32_16x16x32_bf16 v[84:87], a[164:167], v[112:115], v[84:87]
    ds_read_b64_tr_b16 a[190:191], v69 offset:14336
    s_add_u32 s32, s32, s54
    v_mfma_f32_16x16x32_bf16 v[88:91], a[160:163], v[124:127], 0
    ds_read_b64_tr_b16 a[128:129], v178 offset:0
    s_mov_b64 s[8:9], s[30:31]
    v_mfma_f32_16x16x32_bf16 v[88:91], a[164:167], v[128:131], v[88:91]
    ds_read_b64_tr_b16 a[130:131], v178 offset:2048
    s_mov_b32 s10, 0x8000
    v_mfma_f32_16x16x32_bf16 v[84:87], a[168:171], v[116:119], v[84:87]
    ds_read_b64_tr_b16 a[132:133], v178 offset:4096
    v_lshrrev_b32 v2, 3, v255
    v_mfma_f32_16x16x32_bf16 v[84:87], a[172:175], v[120:123], v[84:87]
    ds_read_b64_tr_b16 a[134:135], v178 offset:6144
    s_lshr_b32 s42, s32, 2
    v_mfma_f32_16x16x32_bf16 v[88:91], a[168:171], v[132:135], v[88:91]
    ds_read_b64_tr_b16 a[136:137], v178 offset:8192
    ds_write_b128 v252, a[200:203] offset:0
    v_mfma_f32_16x16x32_bf16 v[88:91], a[172:175], v[136:139], v[88:91]
    s_waitcnt lgkmcnt(6)
    ds_read_b64_tr_b16 a[138:139], v178 offset:10240
    v_mfma_f32_16x16x32_bf16 v[84:87], a[176:179], v[140:143], v[84:87]
    ds_read_b64_tr_b16 a[140:141], v178 offset:12288
    v_and_b32 v12, 15, v2
    v_mfma_f32_16x16x32_bf16 v[84:87], a[180:183], v[144:147], v[84:87]
    ds_read_b64_tr_b16 a[142:143], v178 offset:14336
    s_lshl_b32 s42, s42, 6
    v_mfma_f32_16x16x32_bf16 v[88:91], a[176:179], v[156:159], v[88:91]
    ds_read_b64_tr_b16 a[144:145], v70 offset:0
    v_cvt_pk_bf16_f32 v56, v96, v97
    v_mfma_f32_16x16x32_bf16 v[88:91], a[180:183], v[160:163], v[88:91]
    ds_read_b64_tr_b16 a[146:147], v70 offset:2048
    v_cvt_pk_bf16_f32 v57, v98, v99
    v_mfma_f32_16x16x32_bf16 v[84:87], a[184:187], v[148:151], v[84:87]
    ds_read_b64_tr_b16 a[148:149], v70 offset:4096
    v_cvt_pk_bf16_f32 v58, v104, v105
    v_cvt_pk_bf16_f32 v59, v106, v107
    ds_write_b128 v252, a[204:207] offset:32768
    v_mfma_f32_16x16x32_bf16 v[84:87], a[188:191], v[152:155], v[84:87]
    ds_read_b64_tr_b16 a[150:151], v70 offset:6144
    v_lshlrev_b32 v12, 2, v12
    v_mfma_f32_16x16x32_bf16 v[88:91], a[184:187], v[164:167], v[88:91]
    ds_read_b64_tr_b16 a[152:153], v70 offset:8192
    buffer_store_dwordx4 v[56:59], v73, s[24:27], s43 offen sc1
    s_add_u32 s42, s42, 24576
    v_mfma_f32_16x16x32_bf16 v[88:91], a[188:191], v[168:171], v[88:91]
    s_waitcnt lgkmcnt(6)
    ds_read_b64_tr_b16 a[154:155], v70 offset:10240
    v_mfma_f32_16x16x32_bf16 v[92:95], a[128:131], v[108:111], 0
    ds_read_b64_tr_b16 a[156:157], v70 offset:12288
    ds_write_b128 v75, v[56:59] offset:0
    v_and_b32 v1, 7, v2
    ds_write_b128 v252, a[208:211] offset:4096
    v_mfma_f32_16x16x32_bf16 v[92:95], a[132:135], v[112:115], v[92:95]
    ds_read_b64_tr_b16 a[158:159], v70 offset:14336
    v_lshrrev_b32 v3, 3, v2
    v_mfma_f32_16x16x32_bf16 v[96:99], a[128:131], v[124:127], 0
    ds_read_b64_tr_b16 a[160:161], v179 offset:0
    v_lshlrev_b32 v6, 8, v3
    v_mfma_f32_16x16x32_bf16 v[96:99], a[132:135], v[128:131], v[96:99]
    ds_read_b64_tr_b16 a[162:163], v179 offset:2048
    s_add_u32 s43, s46, 1024
    v_mfma_f32_16x16x32_bf16 v[92:95], a[136:139], v[116:119], v[92:95]
    ds_read_b64_tr_b16 a[164:165], v179 offset:4096
    ds_write_b128 v252, a[212:215] offset:36864
    v_mfma_f32_16x16x32_bf16 v[92:95], a[140:143], v[120:123], v[92:95]
    s_waitcnt lgkmcnt(12)
    ds_read_b64_tr_b16 a[166:167], v179 offset:6144
    v_lshl_add_u32 v6, v1, 4, v6
    v_mfma_f32_16x16x32_bf16 v[96:99], a[136:139], v[132:135], v[96:99]
    ds_read_b64_tr_b16 a[168:169], v179 offset:8192
    v_add_u32 v11, 4096, v6
    v_mfma_f32_16x16x32_bf16 v[96:99], a[140:143], v[136:139], v[96:99]
    s_waitcnt lgkmcnt(6)
    ds_read_b64_tr_b16 a[170:171], v179 offset:10240
    v_mfma_f32_16x16x32_bf16 v[92:95], a[144:147], v[140:143], v[92:95]
    ds_read_b64_tr_b16 a[172:173], v179 offset:12288
    s_add_u32 s16, s30, 0x6c8000
    s_addc_u32 s17, s31, 0
    ds_write_b128 v252, a[216:219] offset:8192
    v_mfma_f32_16x16x32_bf16 v[92:95], a[148:151], v[144:147], v[92:95]
    ds_read_b64_tr_b16 a[174:175], v179 offset:14336
    v_add_u32 v177, s52, v173
    v_mfma_f32_16x16x32_bf16 v[96:99], a[144:147], v[156:159], v[96:99]
    ds_read_b64_tr_b16 a[176:177], v71 offset:0
    s_mov_b32 s18, 0x2400000
    v_mfma_f32_16x16x32_bf16 v[96:99], a[148:151], v[160:163], v[96:99]
    ds_read_b64_tr_b16 a[178:179], v71 offset:2048
    v_cvt_pk_bf16_f32 v44, v76, v77
    v_mfma_f32_16x16x32_bf16 v[92:95], a[152:155], v[148:151], v[92:95]
    ds_read_b64_tr_b16 a[180:181], v71 offset:4096
    v_cvt_pk_bf16_f32 v45, v78, v79
    v_cvt_pk_bf16_f32 v46, v84, v85
    v_cvt_pk_bf16_f32 v47, v86, v87
    s_mov_b32 s19, 0x20000
    ds_write_b128 v252, a[220:223] offset:40960
    v_mfma_f32_16x16x32_bf16 v[92:95], a[156:159], v[152:155], v[92:95]
    ds_read_b64_tr_b16 a[182:183], v71 offset:6144
    s_lshr_b32 s41, s32, 1
    v_mfma_f32_16x16x32_bf16 v[96:99], a[152:155], v[164:167], v[96:99]
    s_waitcnt lgkmcnt(12)
    ds_read_b64_tr_b16 a[184:185], v71 offset:8192
    buffer_store_dwordx4 v[44:47], v72, s[24:27], s46 offen sc1
    v_add_u32 v69, s53, v173
    v_mfma_f32_16x16x32_bf16 v[96:99], a[156:159], v[168:171], v[96:99]
    s_waitcnt lgkmcnt(6)
    ds_read_b64_tr_b16 a[186:187], v71 offset:10240
    s_mul_i32 s41, s41, 18432
    v_mfma_f32_16x16x32_bf16 v[100:103], a[160:163], v[108:111], 0
    ds_read_b64_tr_b16 a[188:189], v71 offset:12288
    ds_write_b128 v74, v[44:47] offset:512
    ds_write_b128 v252, a[224:227] offset:12288
    v_mfma_f32_16x16x32_bf16 v[100:103], a[164:167], v[112:115], v[100:103]
    ds_read_b64_tr_b16 a[190:191], v71 offset:14336
    s_waitcnt vmcnt(4)
    s_and_b32 s3, s32, 1
    v_mfma_f32_16x16x32_bf16 v[104:107], a[160:163], v[124:127], 0
    s_barrier
    ds_read_b64_tr_b16 a[128:129], v176 offset:0
    v_add_u32 v74, 1024, v74
    v_add_u32 v178, s52, v174
    s_lshl_b32 s3, s3, 7
    v_mfma_f32_16x16x32_bf16 v[104:107], a[164:167], v[128:131], v[104:107]
    ds_read_b64_tr_b16 a[130:131], v176 offset:2048
    s_add_u32 s41, s41, s3
    v_mfma_f32_16x16x32_bf16 v[100:103], a[168:171], v[116:119], v[100:103]
    ds_read_b64_tr_b16 a[132:133], v176 offset:4096
    ds_write_b128 v252, a[228:231] offset:45056
    v_mfma_f32_16x16x32_bf16 v[100:103], a[172:175], v[120:123], v[100:103]
    s_waitcnt lgkmcnt(12)
    ds_read_b64_tr_b16 a[134:135], v176 offset:6144
    v_add_u32 v70, s53, v174
    v_mfma_f32_16x16x32_bf16 v[104:107], a[168:171], v[132:135], v[104:107]
    ds_read_b64_tr_b16 a[136:137], v176 offset:8192
    s_mul_i32 s3, s33, 6144
    v_mfma_f32_16x16x32_bf16 v[104:107], a[172:175], v[136:139], v[104:107]
    s_waitcnt lgkmcnt(6)
    ds_read_b64_tr_b16 a[138:139], v176 offset:10240
    s_add_u32 s41, s41, s3
    v_mfma_f32_16x16x32_bf16 v[100:103], a[176:179], v[140:143], v[100:103]
    ds_read_b64_tr_b16 a[140:141], v176 offset:12288
    s_lshl_b32 s44, 1, s54
    v_mfma_f32_16x16x32_bf16 v[100:103], a[180:183], v[144:147], v[100:103]
    ds_read_b64_tr_b16 a[142:143], v176 offset:14336
    v_add_u32 v179, s52, v175
    v_mfma_f32_16x16x32_bf16 v[104:107], a[176:179], v[156:159], v[104:107]
    ds_read_b64_tr_b16 a[144:145], v68 offset:0
    v_lshrrev_b32 v7, 5, v2
    v_mfma_f32_16x16x32_bf16 v[104:107], a[180:183], v[160:163], v[104:107]
    ds_read_b64_tr_b16 a[146:147], v68 offset:2048
    v_cvt_pk_bf16_f32 v48, v80, v81
    v_mfma_f32_16x16x32_bf16 v[100:103], a[184:187], v[148:151], v[100:103]
    ds_read_b64_tr_b16 a[148:149], v68 offset:4096
    v_cvt_pk_bf16_f32 v49, v82, v83
    v_cvt_pk_bf16_f32 v50, v88, v89
    v_cvt_pk_bf16_f32 v51, v90, v91
    v_add_u32 v71, s53, v175
    v_lshlrev_b32 v7, 6, v7
    v_mfma_f32_16x16x32_bf16 v[100:103], a[188:191], v[152:155], v[100:103]
    ds_read_b64_tr_b16 a[150:151], v68 offset:6144
    buffer_store_dwordx4 v[48:51], v73, s[24:27], s46 offen sc1
    v_mfma_f32_16x16x32_bf16 v[104:107], a[184:187], v[164:167], v[104:107]
    ds_read_b64_tr_b16 a[152:153], v68 offset:8192
    v_and_b32 v8, 1, v3
    v_mfma_f32_16x16x32_bf16 v[104:107], a[188:191], v[168:171], v[104:107]
    s_waitcnt lgkmcnt(5)
    ds_read_b64_tr_b16 a[154:155], v68 offset:10240
    ds_write_b128 v75, v[48:51] offset:512
    v_add_u32 v75, 1024, v75
    s_add_u32 s46, s46, 2048
    v_mfma_f32_16x16x32_bf16 v[76:79], a[128:131], v[108:111], 0
    ds_read_b64_tr_b16 a[156:157], v68 offset:12288
    v_lshl_add_u32 v7, v8, 5, v7
    v_mfma_f32_16x16x32_bf16 v[76:79], a[132:135], v[112:115], v[76:79]
    ds_read_b64_tr_b16 a[158:159], v68 offset:14336
    v_and_b32 v8, 2, v3
    v_mfma_f32_16x16x32_bf16 v[80:83], a[128:131], v[124:127], 0
    ds_read_b64_tr_b16 a[160:161], v177 offset:0
    v_lshl_add_u32 v7, v8, 3, v7
    v_mfma_f32_16x16x32_bf16 v[80:83], a[132:135], v[128:131], v[80:83]
    ds_read_b64_tr_b16 a[162:163], v177 offset:2048
    s_mul_i32 s28, s33, 5120
    v_mfma_f32_16x16x32_bf16 v[76:79], a[136:139], v[116:119], v[76:79]
    ds_read_b64_tr_b16 a[164:165], v177 offset:4096
    s_add_u32 s28, s28, 16384
    v_mfma_f32_16x16x32_bf16 v[76:79], a[140:143], v[120:123], v[76:79]
    ds_read_b64_tr_b16 a[166:167], v177 offset:6144
    v_lshl_add_u32 v8, v7, 1, s28
    v_mfma_f32_16x16x32_bf16 v[80:83], a[136:139], v[132:135], v[80:83]
    ds_read_b64_tr_b16 a[168:169], v177 offset:8192
    v_add_u32 v0, s28, v7
    v_mfma_f32_16x16x32_bf16 v[80:83], a[140:143], v[136:139], v[80:83]
    s_waitcnt lgkmcnt(5)
    ds_read_b64_tr_b16 a[170:171], v177 offset:10240
    v_mfma_f32_16x16x32_bf16 v[76:79], a[144:147], v[140:143], v[76:79]
    ds_read_b64_tr_b16 a[172:173], v177 offset:12288
    s_mul_i32 s29, s33, 384
    v_mfma_f32_16x16x32_bf16 v[76:79], a[148:151], v[144:147], v[76:79]
    ds_read_b64_tr_b16 a[174:175], v177 offset:14336
    v_cvt_pk_bf16_f32 v52, v92, v93
    v_mfma_f32_16x16x32_bf16 v[80:83], a[144:147], v[156:159], v[80:83]
    ds_read_b64_tr_b16 a[176:177], v69 offset:0
    v_cvt_pk_bf16_f32 v53, v94, v95
    v_mfma_f32_16x16x32_bf16 v[80:83], a[148:151], v[160:163], v[80:83]
    ds_read_b64_tr_b16 a[178:179], v69 offset:2048
    v_cvt_pk_bf16_f32 v54, v100, v101
    v_mfma_f32_16x16x32_bf16 v[76:79], a[152:155], v[148:151], v[76:79]
    ds_read_b64_tr_b16 a[180:181], v69 offset:4096
    v_cvt_pk_bf16_f32 v55, v102, v103
    v_mfma_f32_16x16x32_bf16 v[76:79], a[156:159], v[152:155], v[76:79]
    ds_read_b64_tr_b16 a[182:183], v69 offset:6144
    v_add_u32 v7, s29, v7
    v_mfma_f32_16x16x32_bf16 v[80:83], a[152:155], v[164:167], v[80:83]
    ds_read_b64_tr_b16 a[184:185], v69 offset:8192
    buffer_store_dwordx4 v[52:55], v72, s[24:27], s43 offen sc1
    ds_write_b128 v252, a[0:3] offset:16384
    v_mfma_f32_16x16x32_bf16 v[80:83], a[156:159], v[168:171], v[80:83]
    s_waitcnt lgkmcnt(6)
    ds_read_b64_tr_b16 a[186:187], v69 offset:10240
    s_lshl_b32 s38, s29, 1
    v_mfma_f32_16x16x32_bf16 v[84:87], a[160:163], v[108:111], 0
    ds_read_b64_tr_b16 a[188:189], v69 offset:12288
    ds_write_b128 v74, v[52:55] offset:0
    s_lshl_b32 s3, s32, 3
    v_mfma_f32_16x16x32_bf16 v[84:87], a[164:167], v[112:115], v[84:87]
    ds_read_b64_tr_b16 a[190:191], v69 offset:14336
    v_add_u32 v9, s3, v1
    v_mfma_f32_16x16x32_bf16 v[88:91], a[160:163], v[124:127], 0
    ds_read_b64_tr_b16 a[128:129], v178 offset:0
    v_mul_u32_u24 v10, 1152, v9
    v_mfma_f32_16x16x32_bf16 v[88:91], a[164:167], v[128:131], v[88:91]
    ds_read_b64_tr_b16 a[130:131], v178 offset:2048
    ds_write_b128 v252, a[4:7] offset:49152
    v_mfma_f32_16x16x32_bf16 v[84:87], a[168:171], v[116:119], v[84:87]
    ds_read_b64_tr_b16 a[132:133], v178 offset:4096
    v_add_u32 v10, v10, v7
    v_mfma_f32_16x16x32_bf16 v[84:87], a[172:175], v[120:123], v[84:87]
    ds_read_b64_tr_b16 a[134:135], v178 offset:6144
    v_mul_u32_u24 v14, 32, v1
    v_mfma_f32_16x16x32_bf16 v[88:91], a[168:171], v[132:135], v[88:91]
    s_waitcnt lgkmcnt(12)
    ds_read_b64_tr_b16 a[136:137], v178 offset:8192
    v_add_u32 v14, 162304, v14
    v_mfma_f32_16x16x32_bf16 v[88:91], a[172:175], v[136:139], v[88:91]
    s_waitcnt lgkmcnt(6)
    ds_read_b64_tr_b16 a[138:139], v178 offset:10240
    v_mfma_f32_16x16x32_bf16 v[84:87], a[176:179], v[140:143], v[84:87]
    ds_read_b64_tr_b16 a[140:141], v178 offset:12288
    s_lshl_b32 s3, s33, 3
    v_mfma_f32_16x16x32_bf16 v[84:87], a[180:183], v[144:147], v[84:87]
    ds_read_b64_tr_b16 a[142:143], v178 offset:14336
    ds_write_b128 v252, a[8:11] offset:20480
    v_mfma_f32_16x16x32_bf16 v[88:91], a[176:179], v[156:159], v[88:91]
    ds_read_b64_tr_b16 a[144:145], v70 offset:0
    v_cvt_pk_bf16_f32 v56, v96, v97
    v_mfma_f32_16x16x32_bf16 v[88:91], a[180:183], v[160:163], v[88:91]
    ds_read_b64_tr_b16 a[146:147], v70 offset:2048
    v_cvt_pk_bf16_f32 v57, v98, v99
    v_mfma_f32_16x16x32_bf16 v[84:87], a[184:187], v[148:151], v[84:87]
    ds_read_b64_tr_b16 a[148:149], v70 offset:4096
    v_cvt_pk_bf16_f32 v58, v104, v105
    v_cvt_pk_bf16_f32 v59, v106, v107
    v_add_u32 v15, s3, v14
    v_mfma_f32_16x16x32_bf16 v[84:87], a[188:191], v[152:155], v[84:87]
    ds_read_b64_tr_b16 a[150:151], v70 offset:6144
    buffer_store_dwordx4 v[56:59], v73, s[24:27], s43 offen sc1
    v_mfma_f32_16x16x32_bf16 v[88:91], a[184:187], v[164:167], v[88:91]
    ds_read_b64_tr_b16 a[152:153], v70 offset:8192
    s_lshl_b32 s34, s35, 2
    v_mfma_f32_16x16x32_bf16 v[88:91], a[188:191], v[168:171], v[88:91]
    s_waitcnt lgkmcnt(6)
    ds_read_b64_tr_b16 a[154:155], v70 offset:10240
    s_add_u32 s34, s34, s33
    v_mfma_f32_16x16x32_bf16 v[92:95], a[128:131], v[108:111], 0
    ds_read_b64_tr_b16 a[156:157], v70 offset:12288
    ds_write_b128 v75, v[56:59] offset:0
    ds_write_b128 v252, a[12:15] offset:53248
    v_mfma_f32_16x16x32_bf16 v[92:95], a[132:135], v[112:115], v[92:95]
    ds_read_b64_tr_b16 a[158:159], v70 offset:14336
    s_lshl_b32 s34, s34, 4
    v_mfma_f32_16x16x32_bf16 v[96:99], a[128:131], v[124:127], 0
    ds_read_b64_tr_b16 a[160:161], v179 offset:0
    s_add_u32 s34, s34, s54
    v_mfma_f32_16x16x32_bf16 v[96:99], a[132:135], v[128:131], v[96:99]
    ds_read_b64_tr_b16 a[162:163], v179 offset:2048
    s_add_u32 s43, s46, 1024
    v_mfma_f32_16x16x32_bf16 v[92:95], a[136:139], v[116:119], v[92:95]
    ds_read_b64_tr_b16 a[164:165], v179 offset:4096
    s_lshl_b32 s34, s34, 2
    v_mfma_f32_16x16x32_bf16 v[92:95], a[140:143], v[120:123], v[92:95]
    ds_read_b64_tr_b16 a[166:167], v179 offset:6144
    s_add_u32 s34, s34, 24576
    v_mfma_f32_16x16x32_bf16 v[96:99], a[136:139], v[132:135], v[96:99]
    s_waitcnt lgkmcnt(12)
    ds_read_b64_tr_b16 a[168:169], v179 offset:8192
    ds_write_b128 v252, a[16:19] offset:24576
    v_mfma_f32_16x16x32_bf16 v[96:99], a[140:143], v[136:139], v[96:99]
    s_waitcnt lgkmcnt(6)
    ds_read_b64_tr_b16 a[170:171], v179 offset:10240
    v_mfma_f32_16x16x32_bf16 v[92:95], a[144:147], v[140:143], v[92:95]
    ds_read_b64_tr_b16 a[172:173], v179 offset:12288
    v_mov_b32 v4, 0
    v_mfma_f32_16x16x32_bf16 v[92:95], a[148:151], v[144:147], v[92:95]
    ds_read_b64_tr_b16 a[174:175], v179 offset:14336
    v_mov_b32 v5, 1
    v_mfma_f32_16x16x32_bf16 v[96:99], a[144:147], v[156:159], v[96:99]
    ds_read_b64_tr_b16 a[176:177], v71 offset:0
    s_mul_i32 s3, s33, 3072
    v_mfma_f32_16x16x32_bf16 v[96:99], a[148:151], v[160:163], v[96:99]
    ds_read_b64_tr_b16 a[178:179], v71 offset:2048
    v_cvt_pk_bf16_f32 v44, v76, v77
    v_mfma_f32_16x16x32_bf16 v[92:95], a[152:155], v[148:151], v[92:95]
    ds_read_b64_tr_b16 a[180:181], v71 offset:4096
    v_cvt_pk_bf16_f32 v45, v78, v79
    v_cvt_pk_bf16_f32 v46, v84, v85
    v_cvt_pk_bf16_f32 v47, v86, v87
    ds_write_b128 v252, a[20:23] offset:57344
    v_mfma_f32_16x16x32_bf16 v[92:95], a[156:159], v[152:155], v[92:95]
    ds_read_b64_tr_b16 a[182:183], v71 offset:6144
    s_add_u32 s3, s3, 153088
    v_mfma_f32_16x16x32_bf16 v[96:99], a[152:155], v[164:167], v[96:99]
    ds_read_b64_tr_b16 a[184:185], v71 offset:8192
    buffer_store_dwordx4 v[44:47], v72, s[24:27], s46 offen sc1
    v_lshl_add_u32 v3, v2, 4, s3
    v_mfma_f32_16x16x32_bf16 v[96:99], a[156:159], v[168:171], v[96:99]
    s_waitcnt lgkmcnt(6)
    ds_read_b64_tr_b16 a[186:187], v71 offset:10240
    v_mfma_f32_16x16x32_bf16 v[100:103], a[160:163], v[108:111], 0
    ds_read_b64_tr_b16 a[188:189], v71 offset:12288
    ds_write_b128 v74, v[44:47] offset:512
    s_add_u32 s48, s30, 0x2ac8000
    s_addc_u32 s49, s31, 0
    v_mfma_f32_16x16x32_bf16 v[100:103], a[164:167], v[112:115], v[100:103]
    ds_read_b64_tr_b16 a[190:191], v71 offset:14336
    v_add_u32 v74, 1024, v74
    v_mfma_f32_16x16x32_bf16 v[104:107], a[160:163], v[124:127], 0
    s_mov_b32 s50, 0x288000
    ds_write_b128 v252, a[24:27] offset:28672
    v_mfma_f32_16x16x32_bf16 v[104:107], a[164:167], v[128:131], v[104:107]
    s_mov_b32 s51, 0x20000
    s_sub_u32 s37, s55, 144
    v_mfma_f32_16x16x32_bf16 v[100:103], a[168:171], v[116:119], v[100:103]
    s_mov_b32 s40, 32768
    s_mov_b32 s22, 1152
    v_mfma_f32_16x16x32_bf16 v[100:103], a[172:175], v[120:123], v[100:103]
    ds_write_b128 v252, a[28:31] offset:61440
    s_mov_b32 s23, 0x20000
    v_mfma_f32_16x16x32_bf16 v[104:107], a[168:171], v[132:135], v[104:107]
    v_cvt_pk_bf16_f32 v48, v80, v81
    v_cvt_pk_bf16_f32 v49, v82, v83
    v_mfma_f32_16x16x32_bf16 v[104:107], a[172:175], v[136:139], v[104:107]
    s_waitcnt lgkmcnt(2)
    v_cvt_pk_bf16_f32 v50, v88, v89
    v_mfma_f32_16x16x32_bf16 v[100:103], a[176:179], v[140:143], v[100:103]
    v_cvt_pk_bf16_f32 v51, v90, v91
    v_mfma_f32_16x16x32_bf16 v[100:103], a[180:183], v[144:147], v[100:103]
    v_mfma_f32_16x16x32_bf16 v[104:107], a[176:179], v[156:159], v[104:107]
    v_mfma_f32_16x16x32_bf16 v[104:107], a[180:183], v[160:163], v[104:107]
    v_mfma_f32_16x16x32_bf16 v[100:103], a[184:187], v[148:151], v[100:103]
    v_mfma_f32_16x16x32_bf16 v[100:103], a[188:191], v[152:155], v[100:103]
    buffer_store_dwordx4 v[48:51], v73, s[24:27], s46 offen sc1
    ds_write_b128 v75, v[48:51] offset:512
    v_mfma_f32_16x16x32_bf16 v[104:107], a[184:187], v[164:167], v[104:107]
    v_add_u32 v75, 1024, v75
    s_add_u32 s46, s46, 2048
    v_mfma_f32_16x16x32_bf16 v[104:107], a[188:191], v[168:171], v[104:107]
    s_nop 4
    v_cvt_pk_bf16_f32 v52, v92, v93
    v_cvt_pk_bf16_f32 v53, v94, v95
    v_cvt_pk_bf16_f32 v54, v100, v101
    v_cvt_pk_bf16_f32 v55, v102, v103
    buffer_store_dwordx4 v[52:55], v72, s[24:27], s43 offen sc1
    ds_write_b128 v74, v[52:55] offset:0
    v_cvt_pk_bf16_f32 v56, v96, v97
    v_cvt_pk_bf16_f32 v57, v98, v99
    v_cvt_pk_bf16_f32 v58, v104, v105
    v_cvt_pk_bf16_f32 v59, v106, v107
    buffer_store_dwordx4 v[56:59], v73, s[24:27], s43 offen sc1
    ds_write_b128 v75, v[56:59] offset:0
    s_add_u32 s24, s30, 0x248000
    s_addc_u32 s25, s31, 0
    s_mov_b32 s26, 0x480000
    s_mov_b32 s27, 0x20000
    s_waitcnt lgkmcnt(0)
    s_barrier
    s_cmp_eq_u32 s33, 3
    s_cbranch_scc1 L_tail_loader
    ds_read_b128 v[160:163], v3 offset:0
    ds_read_b128 v[164:167], v3 offset:1024
    ds_read_b128 v[168:171], v3 offset:2048
    ds_write_b128 v253, a[32:35] offset:0
    ds_write_b128 v253, a[36:39] offset:4096
    ds_write_b128 v253, a[40:43] offset:8192
    ds_write_b128 v253, a[44:47] offset:12288
    ds_write_b128 v253, a[48:51] offset:16384
    ds_write_b128 v253, a[52:55] offset:20480
    buffer_load_dword v13, v12, s[8:11], s42 offen sc1
    s_add_u32 m0, s28, 0
    s_add_u32 s3, s38, 4608
    buffer_load_dwordx4 v26, s[8:11], s3 offen lds
    s_add_u32 m0, s28, 1024
    s_add_u32 s3, s38, 6912
    buffer_load_dwordx4 v26, s[8:11], s3 offen lds
    s_add_u32 m0, s28, 2048
    s_add_u32 s3, s38, 9216
    buffer_load_dwordx4 v26, s[8:11], s3 offen lds
    s_add_u32 m0, s28, 3072
    s_add_u32 s3, s38, 11520
    buffer_load_dwordx4 v26, s[8:11], s3 offen lds
    s_add_u32 m0, s28, 4096
    s_nop 0
    buffer_load_dwordx4 v26, s[20:23], s29 offen lds
    buffer_load_dwordx4 v[16:19], v10, s[72:75], 0 offen offset:0
    buffer_load_dwordx4 v[20:23], v10, s[72:75], 0 offen offset:128
    buffer_load_dwordx4 v[24:27], v10, s[72:75], 0 offen offset:256
    s_waitcnt vmcnt(9) lgkmcnt(0)
    buffer_store_dword v5, v4, s[8:11], s34 offen sc1
    v_mfma_f32_16x16x32_bf16 v[136:139], a[248:251], v[160:163], 0
    v_mfma_f32_16x16x32_bf16 v[140:143], a[250:253], v[160:163], 0
    v_mfma_f32_16x16x32_bf16 v[144:147], a[248:251], v[164:167], 0
    v_mfma_f32_16x16x32_bf16 v[148:151], a[250:253], v[164:167], 0
    v_mfma_f32_16x16x32_bf16 v[152:155], a[248:251], v[168:171], 0
    v_mfma_f32_16x16x32_bf16 v[156:159], a[250:253], v[168:171], 0
    s_mov_b32 s45, 0
    s_waitcnt vmcnt(1)
L_part_round:
    v_cmp_ne_u32 vcc, 0, v13
    s_sub_u32 s40, s40, 1
    s_cselect_b32 s46, -1, vcc_lo
    s_and_b32 s46, s46, 0xffff
    s_andn2_b32 s46, s46, s44
    s_bcnt1_i32_b32 s52, s46
    s_min_u32 s53, s52, 5
    s_or_b32 s44, s44, s46
    s_cmp_eq_u32 s44, 0xffff
    s_cselect_b32 s52, s52, s53
    s_cmp_ge_u32 s52, 15
    s_cbranch_scc0 L_part_l0
    s_ff1_i32_b32 s3, s46
    s_bitset0_b32 s46, s3
    s_mul_i32 s3, s3, 2359296
    s_add_u32 s3, s3, s41
    buffer_load_dwordx4 a[0:3], v6, s[16:19], s3 offen offset:0 sc1
    buffer_load_dwordx4 a[4:7], v6, s[16:19], s3 offen offset:2048 sc1
    buffer_load_dwordx4 a[8:11], v11, s[16:19], s3 offen offset:0 sc1
L_part_l0:
    s_cmp_ge_u32 s52, 14
    s_cbranch_scc0 L_part_l1
    s_ff1_i32_b32 s3, s46
    s_bitset0_b32 s46, s3
    s_mul_i32 s3, s3, 2359296
    s_add_u32 s3, s3, s41
    buffer_load_dwordx4 a[12:15], v6, s[16:19], s3 offen offset:0 sc1
    buffer_load_dwordx4 a[16:19], v6, s[16:19], s3 offen offset:2048 sc1
    buffer_load_dwordx4 a[20:23], v11, s[16:19], s3 offen offset:0 sc1
L_part_l1:
    s_cmp_ge_u32 s52, 13
    s_cbranch_scc0 L_part_l2
    s_ff1_i32_b32 s3, s46
    s_bitset0_b32 s46, s3
    s_mul_i32 s3, s3, 2359296
    s_add_u32 s3, s3, s41
    buffer_load_dwordx4 a[24:27], v6, s[16:19], s3 offen offset:0 sc1
    buffer_load_dwordx4 a[28:31], v6, s[16:19], s3 offen offset:2048 sc1
    buffer_load_dwordx4 a[32:35], v11, s[16:19], s3 offen offset:0 sc1
L_part_l2:
    s_cmp_ge_u32 s52, 12
    s_cbranch_scc0 L_part_l3
    s_ff1_i32_b32 s3, s46
    s_bitset0_b32 s46, s3
    s_mul_i32 s3, s3, 2359296
    s_add_u32 s3, s3, s41
    buffer_load_dwordx4 a[36:39], v6, s[16:19], s3 offen offset:0 sc1
    buffer_load_dwordx4 a[40:43], v6, s[16:19], s3 offen offset:2048 sc1
    buffer_load_dwordx4 a[44:47], v11, s[16:19], s3 offen offset:0 sc1
L_part_l3:
    s_cmp_ge_u32 s52, 11
    s_cbranch_scc0 L_part_l4
    s_ff1_i32_b32 s3, s46
    s_bitset0_b32 s46, s3
    s_mul_i32 s3, s3, 2359296
    s_add_u32 s3, s3, s41
    buffer_load_dwordx4 a[48:51], v6, s[16:19], s3 offen offset:0 sc1
    buffer_load_dwordx4 a[52:55], v6, s[16:19], s3 offen offset:2048 sc1
    buffer_load_dwordx4 a[56:59], v11, s[16:19], s3 offen offset:0 sc1
L_part_l4:
    s_cmp_ge_u32 s52, 10
    s_cbranch_scc0 L_part_l5
    s_ff1_i32_b32 s3, s46
    s_bitset0_b32 s46, s3
    s_mul_i32 s3, s3, 2359296
    s_add_u32 s3, s3, s41
    buffer_load_dwordx4 a[60:63], v6, s[16:19], s3 offen offset:0 sc1
    buffer_load_dwordx4 a[64:67], v6, s[16:19], s3 offen offset:2048 sc1
    buffer_load_dwordx4 a[68:71], v11, s[16:19], s3 offen offset:0 sc1
L_part_l5:
    s_cmp_ge_u32 s52, 9
    s_cbranch_scc0 L_part_l6
    s_ff1_i32_b32 s3, s46
    s_bitset0_b32 s46, s3
    s_mul_i32 s3, s3, 2359296
    s_add_u32 s3, s3, s41
    buffer_load_dwordx4 a[72:75], v6, s[16:19], s3 offen offset:0 sc1
    buffer_load_dwordx4 a[76:79], v6, s[16:19], s3 offen offset:2048 sc1
    buffer_load_dwordx4 a[80:83], v11, s[16:19], s3 offen offset:0 sc1
L_part_l6:
    s_cmp_ge_u32 s52, 8
    s_cbranch_scc0 L_part_l7
    s_ff1_i32_b32 s3, s46
    s_bitset0_b32 s46, s3
    s_mul_i32 s3, s3, 2359296
    s_add_u32 s3, s3, s41
    buffer_load_dwordx4 a[84:87], v6, s[16:19], s3 offen offset:0 sc1
    buffer_load_dwordx4 a[88:91], v6, s[16:19], s3 offen offset:2048 sc1
    buffer_load_dwordx4 a[92:95], v11, s[16:19], s3 offen offset:0 sc1
L_part_l7:
    s_cmp_ge_u32 s52, 7
    s_cbranch_scc0 L_part_l8
    s_ff1_i32_b32 s3, s46
    s_bitset0_b32 s46, s3
    s_mul_i32 s3, s3, 2359296
    s_add_u32 s3, s3, s41
    buffer_load_dwordx4 a[96:99], v6, s[16:19], s3 offen offset:0 sc1
    buffer_load_dwordx4 a[100:103], v6, s[16:19], s3 offen offset:2048 sc1
    buffer_load_dwordx4 a[104:107], v11, s[16:19], s3 offen offset:0 sc1
L_part_l8:
    s_cmp_ge_u32 s52, 6
    s_cbranch_scc0 L_part_l9
    s_ff1_i32_b32 s3, s46
    s_bitset0_b32 s46, s3
    s_mul_i32 s3, s3, 2359296
    s_add_u32 s3, s3, s41
    buffer_load_dwordx4 a[108:111], v6, s[16:19], s3 offen offset:0 sc1
    buffer_load_dwordx4 a[112:115], v6, s[16:19], s3 offen offset:2048 sc1
    buffer_load_dwordx4 a[116:119], v11, s[16:19], s3 offen offset:0 sc1
L_part_l9:
    s_cmp_ge_u32 s52, 5
    s_cbranch_scc0 L_part_l10
    s_ff1_i32_b32 s3, s46
    s_bitset0_b32 s46, s3
    s_mul_i32 s3, s3, 2359296
    s_add_u32 s3, s3, s41
    buffer_load_dwordx4 a[120:123], v6, s[16:19], s3 offen offset:0 sc1
    buffer_load_dwordx4 a[124:127], v6, s[16:19], s3 offen offset:2048 sc1
    buffer_load_dwordx4 a[128:131], v11, s[16:19], s3 offen offset:0 sc1
L_part_l10:
    s_cmp_ge_u32 s52, 4
    s_cbranch_scc0 L_part_l11
    s_ff1_i32_b32 s3, s46
    s_bitset0_b32 s46, s3
    s_mul_i32 s3, s3, 2359296
    s_add_u32 s3, s3, s41
    buffer_load_dwordx4 a[132:135], v6, s[16:19], s3 offen offset:0 sc1
    buffer_load_dwordx4 a[136:139], v6, s[16:19], s3 offen offset:2048 sc1
    buffer_load_dwordx4 a[140:143], v11, s[16:19], s3 offen offset:0 sc1
L_part_l11:
    s_cmp_ge_u32 s52, 3
    s_cbranch_scc0 L_part_l12
    s_ff1_i32_b32 s3, s46
    s_bitset0_b32 s46, s3
    s_mul_i32 s3, s3, 2359296
    s_add_u32 s3, s3, s41
    buffer_load_dwordx4 a[144:147], v6, s[16:19], s3 offen offset:0 sc1
    buffer_load_dwordx4 a[148:151], v6, s[16:19], s3 offen offset:2048 sc1
    buffer_load_dwordx4 a[152:155], v11, s[16:19], s3 offen offset:0 sc1
L_part_l12:
    s_cmp_ge_u32 s52, 2
    s_cbranch_scc0 L_part_l13
    s_ff1_i32_b32 s3, s46
    s_bitset0_b32 s46, s3
    s_mul_i32 s3, s3, 2359296
    s_add_u32 s3, s3, s41
    buffer_load_dwordx4 a[156:159], v6, s[16:19], s3 offen offset:0 sc1
    buffer_load_dwordx4 a[160:163], v6, s[16:19], s3 offen offset:2048 sc1
    buffer_load_dwordx4 a[164:167], v11, s[16:19], s3 offen offset:0 sc1
L_part_l13:
    s_cmp_ge_u32 s52, 1
    s_cbranch_scc0 L_part_l14
    s_ff1_i32_b32 s3, s46
    s_bitset0_b32 s46, s3
    s_mul_i32 s3, s3, 2359296
    s_add_u32 s3, s3, s41
    buffer_load_dwordx4 a[168:171], v6, s[16:19], s3 offen offset:0 sc1
    buffer_load_dwordx4 a[172:175], v6, s[16:19], s3 offen offset:2048 sc1
    buffer_load_dwordx4 a[176:179], v11, s[16:19], s3 offen offset:0 sc1
L_part_l14:
    s_andn2_b32 s44, s44, s46
    buffer_load_dword v13, v12, s[8:11], s42 offen sc1
    s_cmp_lg_u32 s45, 0
    s_cbranch_scc1 L_part_sum
    s_mov_b32 s45, 1
    s_waitcnt lgkmcnt(2)
    ds_read_b128 v[28:31], v0 offset:4096
    ds_read_b128 v[32:35], v0 offset:4224
    ds_read_b128 v[36:39], v0 offset:4352
    ds_read_b128 v[40:43], v8 offset:0
    ds_read_b128 v[44:47], v8 offset:16
    ds_read_b128 v[48:51], v8 offset:256
    ds_read_b128 v[52:55], v8 offset:272
    ds_read_b128 v[56:59], v8 offset:512
    ds_read_b128 v[60:63], v8 offset:528
    s_waitcnt lgkmcnt(4)
    ds_read_b128 v[64:67], v8 offset:1024
    ds_read_b128 v[68:71], v8 offset:1040
    ds_read_b128 v[72:75], v8 offset:1280
    ds_read_b128 v[76:79], v8 offset:1296
    ds_read_b128 v[80:83], v8 offset:1536
    ds_read_b128 v[84:87], v8 offset:1552
    ds_read_b128 v[88:91], v8 offset:2048
    ds_read_b128 v[92:95], v8 offset:2064
    ds_read_b128 v[96:99], v8 offset:2304
    s_waitcnt lgkmcnt(4)
    ds_read_b128 v[100:103], v8 offset:2320
    ds_read_b128 v[104:107], v8 offset:2560
    ds_read_b128 v[108:111], v8 offset:2576
    ds_read_b128 v[112:115], v8 offset:3072
    ds_read_b128 v[116:119], v8 offset:3088
    ds_read_b128 v[120:123], v8 offset:3328
    ds_read_b128 v[124:127], v8 offset:3344
    ds_read_b128 v[128:131], v8 offset:3584
    ds_read_b128 v[132:135], v8 offset:3600
    s_waitcnt lgkmcnt(4)
    v_lshlrev_b32 v184, 16, v16
    v_and_b32 v185, 0xffff0000, v16
    v_lshlrev_b32 v186, 16, v17
    v_and_b32 v187, 0xffff0000, v17
    v_lshlrev_b32 v188, 16, v18
    v_and_b32 v189, 0xffff0000, v18
    v_lshlrev_b32 v190, 16, v19
    v_and_b32 v191, 0xffff0000, v19
    v_lshlrev_b32 v192, 16, v20
    v_and_b32 v193, 0xffff0000, v20
    v_lshlrev_b32 v194, 16, v21
    v_and_b32 v195, 0xffff0000, v21
    v_lshlrev_b32 v196, 16, v22
    v_and_b32 v197, 0xffff0000, v22
    v_lshlrev_b32 v198, 16, v23
    v_and_b32 v199, 0xffff0000, v23
    v_lshlrev_b32 v200, 16, v24
    v_and_b32 v201, 0xffff0000, v24
    v_lshlrev_b32 v202, 16, v25
    v_and_b32 v203, 0xffff0000, v25
    v_lshlrev_b32 v204, 16, v26
    v_and_b32 v205, 0xffff0000, v26
    v_lshlrev_b32 v206, 16, v27
    v_and_b32 v207, 0xffff0000, v27
    s_waitcnt lgkmcnt(0)
    v_lshlrev_b32 v232, 16, v28
    v_and_b32 v233, 0xffff0000, v28
    v_lshlrev_b32 v234, 16, v29
    v_and_b32 v235, 0xffff0000, v29
    v_lshlrev_b32 v236, 16, v30
    v_and_b32 v237, 0xffff0000, v30
    v_lshlrev_b32 v238, 16, v31
    v_and_b32 v239, 0xffff0000, v31
    v_lshlrev_b32 v240, 16, v32
    v_and_b32 v241, 0xffff0000, v32
    v_lshlrev_b32 v242, 16, v33
    v_and_b32 v243, 0xffff0000, v33
    v_lshlrev_b32 v244, 16, v34
    v_and_b32 v245, 0xffff0000, v34
    v_lshlrev_b32 v246, 16, v35
    v_and_b32 v247, 0xffff0000, v35
    v_lshlrev_b32 v248, 16, v36
    v_and_b32 v249, 0xffff0000, v36
    v_lshlrev_b32 v250, 16, v37
    v_and_b32 v251, 0xffff0000, v37
    v_lshlrev_b32 v252, 16, v38
    v_and_b32 v253, 0xffff0000, v38
    v_lshlrev_b32 v254, 16, v39
    v_and_b32 v255, 0xffff0000, v39
L_part_sum:
    s_cmp_ge_u32 s52, 15
    s_cbranch_scc0 L_part_s0
    s_waitcnt vmcnt(43)
    v_mfma_f32_16x16x32_bf16 v[136:139], a[248:251], a[0:3], v[136:139]
    v_mfma_f32_16x16x32_bf16 v[140:143], a[250:253], a[0:3], v[140:143]
    v_mfma_f32_16x16x32_bf16 v[144:147], a[248:251], a[4:7], v[144:147]
    v_mfma_f32_16x16x32_bf16 v[148:151], a[250:253], a[4:7], v[148:151]
    v_mfma_f32_16x16x32_bf16 v[152:155], a[248:251], a[8:11], v[152:155]
    v_mfma_f32_16x16x32_bf16 v[156:159], a[250:253], a[8:11], v[156:159]
L_part_s0:
    s_cmp_ge_u32 s52, 14
    s_cbranch_scc0 L_part_s1
    s_waitcnt vmcnt(40)
    v_mfma_f32_16x16x32_bf16 v[136:139], a[248:251], a[12:15], v[136:139]
    v_mfma_f32_16x16x32_bf16 v[140:143], a[250:253], a[12:15], v[140:143]
    v_mfma_f32_16x16x32_bf16 v[144:147], a[248:251], a[16:19], v[144:147]
    v_mfma_f32_16x16x32_bf16 v[148:151], a[250:253], a[16:19], v[148:151]
    v_mfma_f32_16x16x32_bf16 v[152:155], a[248:251], a[20:23], v[152:155]
    v_mfma_f32_16x16x32_bf16 v[156:159], a[250:253], a[20:23], v[156:159]
L_part_s1:
    s_cmp_ge_u32 s52, 13
    s_cbranch_scc0 L_part_s2
    s_waitcnt vmcnt(37)
    v_mfma_f32_16x16x32_bf16 v[136:139], a[248:251], a[24:27], v[136:139]
    v_mfma_f32_16x16x32_bf16 v[140:143], a[250:253], a[24:27], v[140:143]
    v_mfma_f32_16x16x32_bf16 v[144:147], a[248:251], a[28:31], v[144:147]
    v_mfma_f32_16x16x32_bf16 v[148:151], a[250:253], a[28:31], v[148:151]
    v_mfma_f32_16x16x32_bf16 v[152:155], a[248:251], a[32:35], v[152:155]
    v_mfma_f32_16x16x32_bf16 v[156:159], a[250:253], a[32:35], v[156:159]
L_part_s2:
    s_cmp_ge_u32 s52, 12
    s_cbranch_scc0 L_part_s3
    s_waitcnt vmcnt(34)
    v_mfma_f32_16x16x32_bf16 v[136:139], a[248:251], a[36:39], v[136:139]
    v_mfma_f32_16x16x32_bf16 v[140:143], a[250:253], a[36:39], v[140:143]
    v_mfma_f32_16x16x32_bf16 v[144:147], a[248:251], a[40:43], v[144:147]
    v_mfma_f32_16x16x32_bf16 v[148:151], a[250:253], a[40:43], v[148:151]
    v_mfma_f32_16x16x32_bf16 v[152:155], a[248:251], a[44:47], v[152:155]
    v_mfma_f32_16x16x32_bf16 v[156:159], a[250:253], a[44:47], v[156:159]
L_part_s3:
    s_cmp_ge_u32 s52, 11
    s_cbranch_scc0 L_part_s4
    s_waitcnt vmcnt(31)
    v_mfma_f32_16x16x32_bf16 v[136:139], a[248:251], a[48:51], v[136:139]
    v_mfma_f32_16x16x32_bf16 v[140:143], a[250:253], a[48:51], v[140:143]
    v_mfma_f32_16x16x32_bf16 v[144:147], a[248:251], a[52:55], v[144:147]
    v_mfma_f32_16x16x32_bf16 v[148:151], a[250:253], a[52:55], v[148:151]
    v_mfma_f32_16x16x32_bf16 v[152:155], a[248:251], a[56:59], v[152:155]
    v_mfma_f32_16x16x32_bf16 v[156:159], a[250:253], a[56:59], v[156:159]
L_part_s4:
    s_cmp_ge_u32 s52, 10
    s_cbranch_scc0 L_part_s5
    s_waitcnt vmcnt(28)
    v_mfma_f32_16x16x32_bf16 v[136:139], a[248:251], a[60:63], v[136:139]
    v_mfma_f32_16x16x32_bf16 v[140:143], a[250:253], a[60:63], v[140:143]
    v_mfma_f32_16x16x32_bf16 v[144:147], a[248:251], a[64:67], v[144:147]
    v_mfma_f32_16x16x32_bf16 v[148:151], a[250:253], a[64:67], v[148:151]
    v_mfma_f32_16x16x32_bf16 v[152:155], a[248:251], a[68:71], v[152:155]
    v_mfma_f32_16x16x32_bf16 v[156:159], a[250:253], a[68:71], v[156:159]
L_part_s5:
    s_cmp_ge_u32 s52, 9
    s_cbranch_scc0 L_part_s6
    s_waitcnt vmcnt(25)
    v_mfma_f32_16x16x32_bf16 v[136:139], a[248:251], a[72:75], v[136:139]
    v_mfma_f32_16x16x32_bf16 v[140:143], a[250:253], a[72:75], v[140:143]
    v_mfma_f32_16x16x32_bf16 v[144:147], a[248:251], a[76:79], v[144:147]
    v_mfma_f32_16x16x32_bf16 v[148:151], a[250:253], a[76:79], v[148:151]
    v_mfma_f32_16x16x32_bf16 v[152:155], a[248:251], a[80:83], v[152:155]
    v_mfma_f32_16x16x32_bf16 v[156:159], a[250:253], a[80:83], v[156:159]
L_part_s6:
    s_cmp_ge_u32 s52, 8
    s_cbranch_scc0 L_part_s7
    s_waitcnt vmcnt(22)
    v_mfma_f32_16x16x32_bf16 v[136:139], a[248:251], a[84:87], v[136:139]
    v_mfma_f32_16x16x32_bf16 v[140:143], a[250:253], a[84:87], v[140:143]
    v_mfma_f32_16x16x32_bf16 v[144:147], a[248:251], a[88:91], v[144:147]
    v_mfma_f32_16x16x32_bf16 v[148:151], a[250:253], a[88:91], v[148:151]
    v_mfma_f32_16x16x32_bf16 v[152:155], a[248:251], a[92:95], v[152:155]
    v_mfma_f32_16x16x32_bf16 v[156:159], a[250:253], a[92:95], v[156:159]
L_part_s7:
    s_cmp_ge_u32 s52, 7
    s_cbranch_scc0 L_part_s8
    s_waitcnt vmcnt(19)
    v_mfma_f32_16x16x32_bf16 v[136:139], a[248:251], a[96:99], v[136:139]
    v_mfma_f32_16x16x32_bf16 v[140:143], a[250:253], a[96:99], v[140:143]
    v_mfma_f32_16x16x32_bf16 v[144:147], a[248:251], a[100:103], v[144:147]
    v_mfma_f32_16x16x32_bf16 v[148:151], a[250:253], a[100:103], v[148:151]
    v_mfma_f32_16x16x32_bf16 v[152:155], a[248:251], a[104:107], v[152:155]
    v_mfma_f32_16x16x32_bf16 v[156:159], a[250:253], a[104:107], v[156:159]
L_part_s8:
    s_cmp_ge_u32 s52, 6
    s_cbranch_scc0 L_part_s9
    s_waitcnt vmcnt(16)
    v_mfma_f32_16x16x32_bf16 v[136:139], a[248:251], a[108:111], v[136:139]
    v_mfma_f32_16x16x32_bf16 v[140:143], a[250:253], a[108:111], v[140:143]
    v_mfma_f32_16x16x32_bf16 v[144:147], a[248:251], a[112:115], v[144:147]
    v_mfma_f32_16x16x32_bf16 v[148:151], a[250:253], a[112:115], v[148:151]
    v_mfma_f32_16x16x32_bf16 v[152:155], a[248:251], a[116:119], v[152:155]
    v_mfma_f32_16x16x32_bf16 v[156:159], a[250:253], a[116:119], v[156:159]
L_part_s9:
    s_cmp_ge_u32 s52, 5
    s_cbranch_scc0 L_part_s10
    s_waitcnt vmcnt(13)
    v_mfma_f32_16x16x32_bf16 v[136:139], a[248:251], a[120:123], v[136:139]
    v_mfma_f32_16x16x32_bf16 v[140:143], a[250:253], a[120:123], v[140:143]
    v_mfma_f32_16x16x32_bf16 v[144:147], a[248:251], a[124:127], v[144:147]
    v_mfma_f32_16x16x32_bf16 v[148:151], a[250:253], a[124:127], v[148:151]
    v_mfma_f32_16x16x32_bf16 v[152:155], a[248:251], a[128:131], v[152:155]
    v_mfma_f32_16x16x32_bf16 v[156:159], a[250:253], a[128:131], v[156:159]
L_part_s10:
    s_cmp_ge_u32 s52, 4
    s_cbranch_scc0 L_part_s11
    s_waitcnt vmcnt(10)
    v_mfma_f32_16x16x32_bf16 v[136:139], a[248:251], a[132:135], v[136:139]
    v_mfma_f32_16x16x32_bf16 v[140:143], a[250:253], a[132:135], v[140:143]
    v_mfma_f32_16x16x32_bf16 v[144:147], a[248:251], a[136:139], v[144:147]
    v_mfma_f32_16x16x32_bf16 v[148:151], a[250:253], a[136:139], v[148:151]
    v_mfma_f32_16x16x32_bf16 v[152:155], a[248:251], a[140:143], v[152:155]
    v_mfma_f32_16x16x32_bf16 v[156:159], a[250:253], a[140:143], v[156:159]
L_part_s11:
    s_cmp_ge_u32 s52, 3
    s_cbranch_scc0 L_part_s12
    s_waitcnt vmcnt(7)
    v_mfma_f32_16x16x32_bf16 v[136:139], a[248:251], a[144:147], v[136:139]
    v_mfma_f32_16x16x32_bf16 v[140:143], a[250:253], a[144:147], v[140:143]
    v_mfma_f32_16x16x32_bf16 v[144:147], a[248:251], a[148:151], v[144:147]
    v_mfma_f32_16x16x32_bf16 v[148:151], a[250:253], a[148:151], v[148:151]
    v_mfma_f32_16x16x32_bf16 v[152:155], a[248:251], a[152:155], v[152:155]
    v_mfma_f32_16x16x32_bf16 v[156:159], a[250:253], a[152:155], v[156:159]
L_part_s12:
    s_cmp_ge_u32 s52, 2
    s_cbranch_scc0 L_part_s13
    s_waitcnt vmcnt(4)
    v_mfma_f32_16x16x32_bf16 v[136:139], a[248:251], a[156:159], v[136:139]
    v_mfma_f32_16x16x32_bf16 v[140:143], a[250:253], a[156:159], v[140:143]
    v_mfma_f32_16x16x32_bf16 v[144:147], a[248:251], a[160:163], v[144:147]
    v_mfma_f32_16x16x32_bf16 v[148:151], a[250:253], a[160:163], v[148:151]
    v_mfma_f32_16x16x32_bf16 v[152:155], a[248:251], a[164:167], v[152:155]
    v_mfma_f32_16x16x32_bf16 v[156:159], a[250:253], a[164:167], v[156:159]
L_part_s13:
    s_cmp_ge_u32 s52, 1
    s_cbranch_scc0 L_part_s14
    s_waitcnt vmcnt(1)
    v_mfma_f32_16x16x32_bf16 v[136:139], a[248:251], a[168:171], v[136:139]
    v_mfma_f32_16x16x32_bf16 v[140:143], a[250:253], a[168:171], v[140:143]
    v_mfma_f32_16x16x32_bf16 v[144:147], a[248:251], a[172:175], v[144:147]
    v_mfma_f32_16x16x32_bf16 v[148:151], a[250:253], a[172:175], v[148:151]
    v_mfma_f32_16x16x32_bf16 v[152:155], a[248:251], a[176:179], v[152:155]
    v_mfma_f32_16x16x32_bf16 v[156:159], a[250:253], a[176:179], v[156:159]
L_part_s14:
    s_waitcnt vmcnt(0)
    s_cmp_lg_u32 s44, 0xffff
    s_cbranch_scc1 L_part_round
L_part_done:
    s_nop 4
    s_mov_b32 s47, 0xffff0000
    v_cvt_pk_bf16_f32 v208, v136, v137
    v_cvt_pk_bf16_f32 v209, v138, v139
    v_cvt_pk_bf16_f32 v210, v140, v141
    v_cvt_pk_bf16_f32 v211, v142, v143
    v_cvt_pk_bf16_f32 v216, v144, v145
    v_cvt_pk_bf16_f32 v217, v146, v147
    v_cvt_pk_bf16_f32 v218, v148, v149
    v_cvt_pk_bf16_f32 v219, v150, v151
    v_cvt_pk_bf16_f32 v224, v152, v153
    v_cvt_pk_bf16_f32 v225, v154, v155
    v_cvt_pk_bf16_f32 v226, v156, v157
    v_cvt_pk_bf16_f32 v227, v158, v159
    v_mov_b32 v212, v210
    v_mov_b32 v213, v211
    v_mov_b32 v220, v218
    v_mov_b32 v221, v219
    v_mov_b32 v228, v226
    v_mov_b32 v229, v227
    v_mov_b32_dpp v210, v208 row_ror:8 row_mask:0xf bank_mask:0x3
    v_mov_b32_dpp v211, v209 row_ror:8 row_mask:0xf bank_mask:0x3
    v_mov_b32_dpp v218, v216 row_ror:8 row_mask:0xf bank_mask:0x3
    v_mov_b32_dpp v219, v217 row_ror:8 row_mask:0xf bank_mask:0x3
    v_mov_b32_dpp v226, v224 row_ror:8 row_mask:0xf bank_mask:0x3
    v_mov_b32_dpp v227, v225 row_ror:8 row_mask:0xf bank_mask:0x3
    v_mov_b32_dpp v208, v212 row_ror:8 row_mask:0xf bank_mask:0xc
    v_mov_b32_dpp v209, v213 row_ror:8 row_mask:0xf bank_mask:0xc
    v_mov_b32_dpp v216, v220 row_ror:8 row_mask:0xf bank_mask:0xc
    v_mov_b32_dpp v217, v221 row_ror:8 row_mask:0xf bank_mask:0xc
    v_mov_b32_dpp v224, v228 row_ror:8 row_mask:0xf bank_mask:0xc
    v_mov_b32_dpp v225, v229 row_ror:8 row_mask:0xf bank_mask:0xc
    v_lshlrev_b32 v136, 16, v208
    v_and_b32 v137, s47, v208
    v_lshlrev_b32 v138, 16, v209
    v_and_b32 v139, s47, v209
    v_lshlrev_b32 v140, 16, v210
    v_and_b32 v141, s47, v210
    v_lshlrev_b32 v142, 16, v211
    v_and_b32 v143, s47, v211
    v_lshlrev_b32 v144, 16, v216
    v_and_b32 v145, s47, v216
    v_lshlrev_b32 v146, 16, v217
    v_and_b32 v147, s47, v217
    v_lshlrev_b32 v148, 16, v218
    v_and_b32 v149, s47, v218
    v_lshlrev_b32 v150, 16, v219
    v_and_b32 v151, s47, v219
    v_lshlrev_b32 v152, 16, v224
    v_and_b32 v153, s47, v224
    v_lshlrev_b32 v154, 16, v225
    v_and_b32 v155, s47, v225
    v_lshlrev_b32 v156, 16, v226
    v_and_b32 v157, s47, v226
    v_lshlrev_b32 v158, 16, v227
    v_and_b32 v159, s47, v227
    v_pk_mul_f32 v[136:137], v[136:137], v[40:41]
    v_pk_mul_f32 v[138:139], v[138:139], v[42:43]
    v_pk_mul_f32 v[140:141], v[140:141], v[44:45]
    v_pk_mul_f32 v[142:143], v[142:143], v[46:47]
    v_pk_mul_f32 v[144:145], v[144:145], v[48:49]
    v_pk_mul_f32 v[146:147], v[146:147], v[50:51]
    v_pk_mul_f32 v[148:149], v[148:149], v[52:53]
    v_pk_mul_f32 v[150:151], v[150:151], v[54:55]
    v_pk_mul_f32 v[152:153], v[152:153], v[56:57]
    v_pk_mul_f32 v[154:155], v[154:155], v[58:59]
    v_pk_mul_f32 v[156:157], v[156:157], v[60:61]
    v_pk_mul_f32 v[158:159], v[158:159], v[62:63]
    v_cvt_pk_bf16_f32 v208, v136, v137
    v_cvt_pk_bf16_f32 v209, v138, v139
    v_cvt_pk_bf16_f32 v210, v140, v141
    v_cvt_pk_bf16_f32 v211, v142, v143
    v_cvt_pk_bf16_f32 v216, v144, v145
    v_cvt_pk_bf16_f32 v217, v146, v147
    v_cvt_pk_bf16_f32 v218, v148, v149
    v_cvt_pk_bf16_f32 v219, v150, v151
    v_cvt_pk_bf16_f32 v224, v152, v153
    v_cvt_pk_bf16_f32 v225, v154, v155
    v_cvt_pk_bf16_f32 v226, v156, v157
    v_cvt_pk_bf16_f32 v227, v158, v159
    v_lshlrev_b32 v136, 16, v208
    v_and_b32 v137, s47, v208
    v_lshlrev_b32 v138, 16, v209
    v_and_b32 v139, s47, v209
    v_lshlrev_b32 v140, 16, v210
    v_and_b32 v141, s47, v210
    v_lshlrev_b32 v142, 16, v211
    v_and_b32 v143, s47, v211
    v_lshlrev_b32 v144, 16, v216
    v_and_b32 v145, s47, v216
    v_lshlrev_b32 v146, 16, v217
    v_and_b32 v147, s47, v217
    v_lshlrev_b32 v148, 16, v218
    v_and_b32 v149, s47, v218
    v_lshlrev_b32 v150, 16, v219
    v_and_b32 v151, s47, v219
    v_lshlrev_b32 v152, 16, v224
    v_and_b32 v153, s47, v224
    v_lshlrev_b32 v154, 16, v225
    v_and_b32 v155, s47, v225
    v_lshlrev_b32 v156, 16, v226
    v_and_b32 v157, s47, v226
    v_lshlrev_b32 v158, 16, v227
    v_and_b32 v159, s47, v227
    v_pk_add_f32 v[160:161], v[184:185], v[136:137]
    v_pk_add_f32 v[162:163], v[186:187], v[138:139]
    v_pk_add_f32 v[164:165], v[188:189], v[140:141]
    v_pk_add_f32 v[166:167], v[190:191], v[142:143]
    v_pk_add_f32 v[168:169], v[192:193], v[144:145]
    v_pk_add_f32 v[170:171], v[194:195], v[146:147]
    v_pk_add_f32 v[172:173], v[196:197], v[148:149]
    v_pk_add_f32 v[174:175], v[198:199], v[150:151]
    v_pk_add_f32 v[176:177], v[200:201], v[152:153]
    v_pk_add_f32 v[178:179], v[202:203], v[154:155]
    v_pk_add_f32 v[180:181], v[204:205], v[156:157]
    v_pk_add_f32 v[182:183], v[206:207], v[158:159]
    v_cvt_pk_bf16_f32 v16, v160, v161
    v_cvt_pk_bf16_f32 v17, v162, v163
    v_cvt_pk_bf16_f32 v18, v164, v165
    v_cvt_pk_bf16_f32 v19, v166, v167
    v_cvt_pk_bf16_f32 v20, v168, v169
    v_cvt_pk_bf16_f32 v21, v170, v171
    v_cvt_pk_bf16_f32 v22, v172, v173
    v_cvt_pk_bf16_f32 v23, v174, v175
    v_cvt_pk_bf16_f32 v24, v176, v177
    v_cvt_pk_bf16_f32 v25, v178, v179
    v_cvt_pk_bf16_f32 v26, v180, v181
    v_cvt_pk_bf16_f32 v27, v182, v183
    v_lshlrev_b32 v160, 16, v16
    v_and_b32 v161, s47, v16
    v_lshlrev_b32 v162, 16, v17
    v_and_b32 v163, s47, v17
    v_lshlrev_b32 v164, 16, v18
    v_and_b32 v165, s47, v18
    v_lshlrev_b32 v166, 16, v19
    v_and_b32 v167, s47, v19
    v_lshlrev_b32 v168, 16, v20
    v_and_b32 v169, s47, v20
    v_lshlrev_b32 v170, 16, v21
    v_and_b32 v171, s47, v21
    v_lshlrev_b32 v172, 16, v22
    v_and_b32 v173, s47, v22
    v_lshlrev_b32 v174, 16, v23
    v_and_b32 v175, s47, v23
    v_lshlrev_b32 v176, 16, v24
    v_and_b32 v177, s47, v24
    v_lshlrev_b32 v178, 16, v25
    v_and_b32 v179, s47, v25
    v_lshlrev_b32 v180, 16, v26
    v_and_b32 v181, s47, v26
    v_lshlrev_b32 v182, 16, v27
    v_and_b32 v183, s47, v27
    v_pk_add_f32 v[208:209], v[160:161], v[168:169]
    v_pk_add_f32 v[210:211], v[162:163], v[170:171]
    v_pk_add_f32 v[212:213], v[164:165], v[172:173]
    v_pk_add_f32 v[214:215], v[166:167], v[174:175]
    v_pk_add_f32 v[208:209], v[208:209], v[176:177]
    v_pk_add_f32 v[210:211], v[210:211], v[178:179]
    v_pk_add_f32 v[212:213], v[212:213], v[180:181]
    v_pk_add_f32 v[214:215], v[214:215], v[182:183]
    v_pk_add_f32 v[208:209], v[208:209], v[210:211]
    v_pk_add_f32 v[212:213], v[212:213], v[214:215]
    v_pk_add_f32 v[208:209], v[208:209], v[212:213]
    v_add_f32 v4, v208, v209
    s_nop 1
    v_add_f32_dpp v4, v4, v4 row_ror:8 row_mask:0xf bank_mask:0xf
    v_mov_b32 v208, v4
    s_nop 1
    v_permlane16_swap_b32 v4, v208
    v_add_f32 v4, v4, v208
    v_mov_b32 v208, v4
    s_nop 1
    v_permlane32_swap_b32 v4, v208
    v_add_f32 v4, v4, v208
    v_mul_f32 v4, 0x3baaaaab, v4
    v_pk_add_f32 v[184:185], v[160:161], v[4:5] op_sel_hi:[1,0] neg_lo:[0,1] neg_hi:[0,1]
    v_pk_add_f32 v[186:187], v[162:163], v[4:5] op_sel_hi:[1,0] neg_lo:[0,1] neg_hi:[0,1]
    v_pk_add_f32 v[188:189], v[164:165], v[4:5] op_sel_hi:[1,0] neg_lo:[0,1] neg_hi:[0,1]
    v_pk_add_f32 v[190:191], v[166:167], v[4:5] op_sel_hi:[1,0] neg_lo:[0,1] neg_hi:[0,1]
    v_pk_add_f32 v[192:193], v[168:169], v[4:5] op_sel_hi:[1,0] neg_lo:[0,1] neg_hi:[0,1]
    v_pk_add_f32 v[194:195], v[170:171], v[4:5] op_sel_hi:[1,0] neg_lo:[0,1] neg_hi:[0,1]
    v_pk_add_f32 v[196:197], v[172:173], v[4:5] op_sel_hi:[1,0] neg_lo:[0,1] neg_hi:[0,1]
    v_pk_add_f32 v[198:199], v[174:175], v[4:5] op_sel_hi:[1,0] neg_lo:[0,1] neg_hi:[0,1]
    v_pk_add_f32 v[200:201], v[176:177], v[4:5] op_sel_hi:[1,0] neg_lo:[0,1] neg_hi:[0,1]
    v_pk_add_f32 v[202:203], v[178:179], v[4:5] op_sel_hi:[1,0] neg_lo:[0,1] neg_hi:[0,1]
    v_pk_add_f32 v[204:205], v[180:181], v[4:5] op_sel_hi:[1,0] neg_lo:[0,1] neg_hi:[0,1]
    v_pk_add_f32 v[206:207], v[182:183], v[4:5] op_sel_hi:[1,0] neg_lo:[0,1] neg_hi:[0,1]
    v_pk_mul_f32 v[208:209], v[184:185], v[184:185]
    v_pk_mul_f32 v[210:211], v[186:187], v[186:187]
    v_pk_mul_f32 v[212:213], v[188:189], v[188:189]
    v_pk_mul_f32 v[214:215], v[190:191], v[190:191]
    v_pk_fma_f32 v[208:209], v[192:193], v[192:193], v[208:209]
    v_pk_fma_f32 v[210:211], v[194:195], v[194:195], v[210:211]
    v_pk_fma_f32 v[212:213], v[196:197], v[196:197], v[212:213]
    v_pk_fma_f32 v[214:215], v[198:199], v[198:199], v[214:215]
    v_pk_fma_f32 v[208:209], v[200:201], v[200:201], v[208:209]
    v_pk_fma_f32 v[210:211], v[202:203], v[202:203], v[210:211]
    v_pk_fma_f32 v[212:213], v[204:205], v[204:205], v[212:213]
    v_pk_fma_f32 v[214:215], v[206:207], v[206:207], v[214:215]
    v_pk_add_f32 v[208:209], v[208:209], v[210:211]
    v_pk_add_f32 v[212:213], v[212:213], v[214:215]
    v_pk_add_f32 v[208:209], v[208:209], v[212:213]
    v_add_f32 v5, v208, v209
    s_nop 1
    v_add_f32_dpp v5, v5, v5 row_ror:8 row_mask:0xf bank_mask:0xf
    v_mov_b32 v208, v5
    s_nop 1
    v_permlane16_swap_b32 v5, v208
    v_add_f32 v5, v5, v208
    v_mov_b32 v208, v5
    s_nop 1
    v_permlane32_swap_b32 v5, v208
    v_add_f32 v5, v5, v208
    ds_write_b64 v15, v[4:5]
    s_waitcnt lgkmcnt(0)
    s_barrier
    ds_read_b128 v[216:219], v14
    ds_read_b64 v[220:221], v14 offset:16
    s_waitcnt lgkmcnt(0)
    v_pk_add_f32 v[4:5], v[216:217], v[218:219]
    v_pk_add_f32 v[4:5], v[4:5], v[220:221]
    v_mul_f32 v4, 0x3eaaaaab, v4
    v_sub_f32 v216, v216, v4
    v_sub_f32 v218, v218, v4
    v_sub_f32 v220, v220, v4
    v_mul_f32 v208, v216, v216
    v_fmac_f32 v208, v218, v218
    v_fmac_f32 v208, v220, v220
    v_fmac_f32 v5, 0x43400000, v208
    v_mul_f32 v5, 0x3ae38e39, v5
    v_cvt_pk_bf16_f32 v208, v4, v5
    v_lshlrev_b32 v4, 16, v208
    v_and_b32 v5, 0xffff0000, v208
    v_add_f32 v6, 0x3727c5ac, v5
    v_cvt_pk_bf16_f32 v6, v6, v6
    v_and_b32 v6, 0xffff0000, v6
    v_sqrt_f32 v6, v6
    v_pk_add_f32 v[184:185], v[160:161], v[4:5] op_sel_hi:[1,0] neg_lo:[0,1] neg_hi:[0,1]
    v_pk_add_f32 v[186:187], v[162:163], v[4:5] op_sel_hi:[1,0] neg_lo:[0,1] neg_hi:[0,1]
    v_pk_add_f32 v[188:189], v[164:165], v[4:5] op_sel_hi:[1,0] neg_lo:[0,1] neg_hi:[0,1]
    v_pk_add_f32 v[190:191], v[166:167], v[4:5] op_sel_hi:[1,0] neg_lo:[0,1] neg_hi:[0,1]
    v_pk_add_f32 v[192:193], v[168:169], v[4:5] op_sel_hi:[1,0] neg_lo:[0,1] neg_hi:[0,1]
    v_pk_add_f32 v[194:195], v[170:171], v[4:5] op_sel_hi:[1,0] neg_lo:[0,1] neg_hi:[0,1]
    v_pk_add_f32 v[196:197], v[172:173], v[4:5] op_sel_hi:[1,0] neg_lo:[0,1] neg_hi:[0,1]
    v_pk_add_f32 v[198:199], v[174:175], v[4:5] op_sel_hi:[1,0] neg_lo:[0,1] neg_hi:[0,1]
    v_pk_add_f32 v[200:201], v[176:177], v[4:5] op_sel_hi:[1,0] neg_lo:[0,1] neg_hi:[0,1]
    v_pk_add_f32 v[202:203], v[178:179], v[4:5] op_sel_hi:[1,0] neg_lo:[0,1] neg_hi:[0,1]
    v_pk_add_f32 v[204:205], v[180:181], v[4:5] op_sel_hi:[1,0] neg_lo:[0,1] neg_hi:[0,1]
    v_pk_add_f32 v[206:207], v[182:183], v[4:5] op_sel_hi:[1,0] neg_lo:[0,1] neg_hi:[0,1]
    v_cvt_pk_bf16_f32 v6, v6, v6
    v_and_b32 v6, 0xffff0000, v6
    v_rcp_f32 v5, v6
    v_cvt_pk_bf16_f32 v208, v184, v185
    v_cvt_pk_bf16_f32 v209, v186, v187
    v_cvt_pk_bf16_f32 v210, v188, v189
    v_cvt_pk_bf16_f32 v211, v190, v191
    v_cvt_pk_bf16_f32 v216, v192, v193
    v_cvt_pk_bf16_f32 v217, v194, v195
    v_cvt_pk_bf16_f32 v218, v196, v197
    v_cvt_pk_bf16_f32 v219, v198, v199
    v_cvt_pk_bf16_f32 v224, v200, v201
    v_cvt_pk_bf16_f32 v225, v202, v203
    v_cvt_pk_bf16_f32 v226, v204, v205
    v_cvt_pk_bf16_f32 v227, v206, v207
    v_lshlrev_b32 v184, 16, v208
    v_and_b32 v185, s47, v208
    v_lshlrev_b32 v186, 16, v209
    v_and_b32 v187, s47, v209
    v_lshlrev_b32 v188, 16, v210
    v_and_b32 v189, s47, v210
    v_lshlrev_b32 v190, 16, v211
    v_and_b32 v191, s47, v211
    v_lshlrev_b32 v192, 16, v216
    v_and_b32 v193, s47, v216
    v_lshlrev_b32 v194, 16, v217
    v_and_b32 v195, s47, v217
    v_lshlrev_b32 v196, 16, v218
    v_and_b32 v197, s47, v218
    v_lshlrev_b32 v198, 16, v219
    v_and_b32 v199, s47, v219
    v_lshlrev_b32 v200, 16, v224
    v_and_b32 v201, s47, v224
    v_lshlrev_b32 v202, 16, v225
    v_and_b32 v203, s47, v225
    v_lshlrev_b32 v204, 16, v226
    v_and_b32 v205, s47, v226
    v_lshlrev_b32 v206, 16, v227
    v_and_b32 v207, s47, v227
    v_pk_mul_f32 v[184:185], v[184:185], v[4:5] op_sel:[0,1]
    v_pk_mul_f32 v[186:187], v[186:187], v[4:5] op_sel:[0,1]
    v_pk_mul_f32 v[188:189], v[188:189], v[4:5] op_sel:[0,1]
    v_pk_mul_f32 v[190:191], v[190:191], v[4:5] op_sel:[0,1]
    v_pk_mul_f32 v[192:193], v[192:193], v[4:5] op_sel:[0,1]
    v_pk_mul_f32 v[194:195], v[194:195], v[4:5] op_sel:[0,1]
    v_pk_mul_f32 v[196:197], v[196:197], v[4:5] op_sel:[0,1]
    v_pk_mul_f32 v[198:199], v[198:199], v[4:5] op_sel:[0,1]
    v_pk_mul_f32 v[200:201], v[200:201], v[4:5] op_sel:[0,1]
    v_pk_mul_f32 v[202:203], v[202:203], v[4:5] op_sel:[0,1]
    v_pk_mul_f32 v[204:205], v[204:205], v[4:5] op_sel:[0,1]
    v_pk_mul_f32 v[206:207], v[206:207], v[4:5] op_sel:[0,1]
    v_cvt_pk_bf16_f32 v208, v184, v185
    v_cvt_pk_bf16_f32 v209, v186, v187
    v_cvt_pk_bf16_f32 v210, v188, v189
    v_cvt_pk_bf16_f32 v211, v190, v191
    v_cvt_pk_bf16_f32 v216, v192, v193
    v_cvt_pk_bf16_f32 v217, v194, v195
    v_cvt_pk_bf16_f32 v218, v196, v197
    v_cvt_pk_bf16_f32 v219, v198, v199
    v_cvt_pk_bf16_f32 v224, v200, v201
    v_cvt_pk_bf16_f32 v225, v202, v203
    v_cvt_pk_bf16_f32 v226, v204, v205
    v_cvt_pk_bf16_f32 v227, v206, v207
    v_lshlrev_b32 v184, 16, v208
    v_and_b32 v185, s47, v208
    v_lshlrev_b32 v186, 16, v209
    v_and_b32 v187, s47, v209
    v_lshlrev_b32 v188, 16, v210
    v_and_b32 v189, s47, v210
    v_lshlrev_b32 v190, 16, v211
    v_and_b32 v191, s47, v211
    v_lshlrev_b32 v192, 16, v216
    v_and_b32 v193, s47, v216
    v_lshlrev_b32 v194, 16, v217
    v_and_b32 v195, s47, v217
    v_lshlrev_b32 v196, 16, v218
    v_and_b32 v197, s47, v218
    v_lshlrev_b32 v198, 16, v219
    v_and_b32 v199, s47, v219
    v_lshlrev_b32 v200, 16, v224
    v_and_b32 v201, s47, v224
    v_lshlrev_b32 v202, 16, v225
    v_and_b32 v203, s47, v225
    v_lshlrev_b32 v204, 16, v226
    v_and_b32 v205, s47, v226
    v_lshlrev_b32 v206, 16, v227
    v_and_b32 v207, s47, v227
    v_pk_mul_f32 v[184:185], v[184:185], v[88:89]
    v_pk_mul_f32 v[186:187], v[186:187], v[90:91]
    v_pk_mul_f32 v[188:189], v[188:189], v[92:93]
    v_pk_mul_f32 v[190:191], v[190:191], v[94:95]
    v_pk_mul_f32 v[192:193], v[192:193], v[96:97]
    v_pk_mul_f32 v[194:195], v[194:195], v[98:99]
    v_pk_mul_f32 v[196:197], v[196:197], v[100:101]
    v_pk_mul_f32 v[198:199], v[198:199], v[102:103]
    v_pk_mul_f32 v[200:201], v[200:201], v[104:105]
    v_pk_mul_f32 v[202:203], v[202:203], v[106:107]
    v_pk_mul_f32 v[204:205], v[204:205], v[108:109]
    v_pk_mul_f32 v[206:207], v[206:207], v[110:111]
    v_cvt_pk_bf16_f32 v208, v184, v185
    v_cvt_pk_bf16_f32 v209, v186, v187
    v_cvt_pk_bf16_f32 v210, v188, v189
    v_cvt_pk_bf16_f32 v211, v190, v191
    v_cvt_pk_bf16_f32 v216, v192, v193
    v_cvt_pk_bf16_f32 v217, v194, v195
    v_cvt_pk_bf16_f32 v218, v196, v197
    v_cvt_pk_bf16_f32 v219, v198, v199
    v_cvt_pk_bf16_f32 v224, v200, v201
    v_cvt_pk_bf16_f32 v225, v202, v203
    v_cvt_pk_bf16_f32 v226, v204, v205
    v_cvt_pk_bf16_f32 v227, v206, v207
    v_lshlrev_b32 v184, 16, v208
    v_and_b32 v185, s47, v208
    v_lshlrev_b32 v186, 16, v209
    v_and_b32 v187, s47, v209
    v_lshlrev_b32 v188, 16, v210
    v_and_b32 v189, s47, v210
    v_lshlrev_b32 v190, 16, v211
    v_and_b32 v191, s47, v211
    v_lshlrev_b32 v192, 16, v216
    v_and_b32 v193, s47, v216
    v_lshlrev_b32 v194, 16, v217
    v_and_b32 v195, s47, v217
    v_lshlrev_b32 v196, 16, v218
    v_and_b32 v197, s47, v218
    v_lshlrev_b32 v198, 16, v219
    v_and_b32 v199, s47, v219
    v_lshlrev_b32 v200, 16, v224
    v_and_b32 v201, s47, v224
    v_lshlrev_b32 v202, 16, v225
    v_and_b32 v203, s47, v225
    v_lshlrev_b32 v204, 16, v226
    v_and_b32 v205, s47, v226
    v_lshlrev_b32 v206, 16, v227
    v_and_b32 v207, s47, v227
    v_pk_add_f32 v[184:185], v[184:185], v[64:65]
    v_pk_add_f32 v[186:187], v[186:187], v[66:67]
    v_pk_add_f32 v[188:189], v[188:189], v[68:69]
    v_pk_add_f32 v[190:191], v[190:191], v[70:71]
    v_pk_add_f32 v[192:193], v[192:193], v[72:73]
    v_pk_add_f32 v[194:195], v[194:195], v[74:75]
    v_pk_add_f32 v[196:197], v[196:197], v[76:77]
    v_pk_add_f32 v[198:199], v[198:199], v[78:79]
    v_pk_add_f32 v[200:201], v[200:201], v[80:81]
    v_pk_add_f32 v[202:203], v[202:203], v[82:83]
    v_pk_add_f32 v[204:205], v[204:205], v[84:85]
    v_pk_add_f32 v[206:207], v[206:207], v[86:87]
    v_cvt_pk_bf16_f32 v28, v184, v185
    v_cvt_pk_bf16_f32 v29, v186, v187
    v_cvt_pk_bf16_f32 v30, v188, v189
    v_cvt_pk_bf16_f32 v31, v190, v191
    v_cvt_pk_bf16_f32 v32, v192, v193
    v_cvt_pk_bf16_f32 v33, v194, v195
    v_cvt_pk_bf16_f32 v34, v196, v197
    v_cvt_pk_bf16_f32 v35, v198, v199
    v_cvt_pk_bf16_f32 v36, v200, v201
    v_cvt_pk_bf16_f32 v37, v202, v203
    v_cvt_pk_bf16_f32 v38, v204, v205
    v_cvt_pk_bf16_f32 v39, v206, v207
    v_lshlrev_b32 v184, 16, v28
    v_and_b32 v185, s47, v28
    v_lshlrev_b32 v186, 16, v29
    v_and_b32 v187, s47, v29
    v_lshlrev_b32 v188, 16, v30
    v_and_b32 v189, s47, v30
    v_lshlrev_b32 v190, 16, v31
    v_and_b32 v191, s47, v31
    v_lshlrev_b32 v192, 16, v32
    v_and_b32 v193, s47, v32
    v_lshlrev_b32 v194, 16, v33
    v_and_b32 v195, s47, v33
    v_lshlrev_b32 v196, 16, v34
    v_and_b32 v197, s47, v34
    v_lshlrev_b32 v198, 16, v35
    v_and_b32 v199, s47, v35
    v_lshlrev_b32 v200, 16, v36
    v_and_b32 v201, s47, v36
    v_lshlrev_b32 v202, 16, v37
    v_and_b32 v203, s47, v37
    v_lshlrev_b32 v204, 16, v38
    v_and_b32 v205, s47, v38
    v_lshlrev_b32 v206, 16, v39
    v_and_b32 v207, s47, v39
    v_pk_mul_f32 v[208:209], v[184:185], v[232:233]
    v_pk_mul_f32 v[210:211], v[186:187], v[234:235]
    v_pk_mul_f32 v[212:213], v[188:189], v[236:237]
    v_pk_mul_f32 v[214:215], v[190:191], v[238:239]
    v_pk_fma_f32 v[208:209], v[192:193], v[240:241], v[208:209]
    v_pk_fma_f32 v[210:211], v[194:195], v[242:243], v[210:211]
    v_pk_fma_f32 v[212:213], v[196:197], v[244:245], v[212:213]
    v_pk_fma_f32 v[214:215], v[198:199], v[246:247], v[214:215]
    v_pk_fma_f32 v[208:209], v[200:201], v[248:249], v[208:209]
    v_pk_fma_f32 v[210:211], v[202:203], v[250:251], v[210:211]
    v_pk_fma_f32 v[212:213], v[204:205], v[252:253], v[212:213]
    v_pk_fma_f32 v[214:215], v[206:207], v[254:255], v[214:215]
    v_pk_add_f32 v[208:209], v[208:209], v[210:211]
    v_pk_add_f32 v[212:213], v[212:213], v[214:215]
    v_pk_add_f32 v[208:209], v[208:209], v[212:213]
    v_add_f32 v4, v208, v209
    s_nop 1
    v_add_f32_dpp v4, v4, v4 row_ror:8 row_mask:0xf bank_mask:0xf
    v_mov_b32 v208, v4
    s_nop 1
    v_permlane16_swap_b32 v4, v208
    v_add_f32 v4, v4, v208
    v_mov_b32 v208, v4
    s_nop 1
    v_permlane32_swap_b32 v4, v208
    v_add_f32 v4, v4, v208
    ds_write_b32 v15, v4 offset:256
    s_waitcnt lgkmcnt(0)
    s_barrier
    ds_read_b128 v[216:219], v14 offset:256
    ds_read_b32 v220, v14 offset:272
    v_lshlrev_b32 v6, 2, v9
    s_mov_b32 s3, 0xfffff800
    s_lshl_b32 s41, s33, 16
    s_add_u32 s41, s41, 16384
    s_waitcnt lgkmcnt(0)
    v_add_f32 v4, v216, v218
    v_add_f32 v4, v4, v220
    v_ashrrev_i32 v5, 31, v4
    v_or_b32 v5, 0x80000000, v5
    v_xor_b32 v4, v4, v5
    v_max_u32 v4, 0x800, v4
    v_and_or_b32 v4, v4, s3, v9
    buffer_store_dword v4, v6, s[8:11], s41 offen sc1
    v_mov_b32 v103, v4
    v_mov_b32 v100, v9
    v_mov_b32 v101, v10
    v_mov_b32 v102, v7
    s_branch L_tail_moe
L_tail_loader:
    ds_write_b128 v253, a[32:35] offset:0
    ds_write_b128 v253, a[36:39] offset:4096
    ds_write_b128 v253, a[40:43] offset:8192
    ds_write_b128 v253, a[44:47] offset:12288
    ds_write_b128 v253, a[48:51] offset:16384
    ds_write_b128 v253, a[52:55] offset:20480
    s_waitcnt vmcnt(0) lgkmcnt(0)
    buffer_store_dword v5, v4, s[8:11], s34 offen sc1
    s_mul_i32 s3, s55, 18432
    buffer_load_dword v13, v4, s[48:51], s3 offen sc1
    s_waitcnt vmcnt(0) lgkmcnt(0)
    v_lshlrev_b32 v3, 7, v2
    s_mov_b32 s3, L_part_done-L_attn_pc-0x3000
    buffer_load_dword v103, v3, s[4:7], s3 offen
    s_barrier
    s_mov_b32 s3, L_tail_moe-L_attn_pc-0x3000
    buffer_load_dword v103, v3, s[4:7], s3 offen sc1
    s_barrier
L_tail_moe:
    s_mov_b32 s32, s55
    v_mov_b32 v1, s33
    v_lshrrev_b32 v13, 4, v2
    v_lshlrev_b32 v5, 4, v2
    v_and_b32 v10, 7, v2
    s_add_u32 s24, s30, 0x248000
    s_addc_u32 s25, s31, 0
    s_mov_b32 s26, 0x480000
    s_mov_b32 s27, 0x20000
    s_cmp_ge_u32 s32, 144
    s_cbranch_scc1 L_tail_fprep
    v_bfe_u32 v3, v2, 2, 2
    v_lshl_add_u32 v3, v13, 3, v3
    v_lshlrev_b32 v3, 6, v3
    v_and_b32 v9, 3, v2
    v_lshl_add_u32 v3, v9, 3, v3
    v_xor_b32 v4, v13, v1
    v_and_b32 v4, 1, v4
    v_lshl_add_u32 v3, v4, 5, v3
    s_lshr_b32 s3, s33, 1
    s_lshl_b32 s41, s3, 12
    s_add_u32 s41, s41, 132096
    v_add_u32 v8, s41, v3
    s_lshl_b32 s3, s3, 15
    s_add_u32 s3, s3, 32768
    v_add_u32 v3, s3, v3
    v_lshrrev_b32 v14, 2, v2
    v_lshlrev_b32 v14, 7, v14
    v_lshl_add_u32 v14, v9, 3, v14
    v_bfe_u32 v4, v2, 3, 2
    v_xor_b32 v4, v4, v1
    v_lshl_add_u32 v14, v4, 5, v14
    v_add_u32 v14, 98304, v14
    s_mul_i32 s3, s32, 18432
    s_add_u32 s3, s3, 44859392
    s_add_u32 s16, s30, s3
    s_addc_u32 s17, s31, 0
    s_mov_b32 s18, 0x4800
    s_mov_b32 s19, 0x20000
    v_lshlrev_b32 v15, 4, v10
    v_lshl_add_u32 v15, v13, 7, v15
    v_lshl_add_u32 v15, v1, 9, v15
    v_and_b32 v4, 8, v2
    v_lshl_add_u32 v15, v4, 20, v15
    v_lshlrev_b32 v12, 3, v4
    v_lshl_add_u32 v12, v13, 4, v12
    s_branch L_tail_select
L_tail_fprep:
    v_lshrrev_b32 v3, 4, v2
    s_lshl_b32 s3, s33, 2
    v_add_u32 v3, s3, v3
    v_mul_u32_u24 v0, 165888, v3
    v_and_b32 v3, 15, v2
    v_lshl_add_u32 v0, v3, 4, v0
    s_lshl_b32 s3, s37, 8
    v_add_u32 v0, s3, v0
    v_and_b32 v12, 8, v2
    v_lshlrev_b32 v15, 1, v12
    v_and_b32 v14, 15, v2
    v_lshlrev_b32 v14, 4, v14
    v_lshl_add_u32 v13, v1, 8, v14
L_tail_select:
    s_lshl_b32 s41, s33, 11
    s_add_u32 s41, s41, 16384
    v_lshlrev_b32 v60, 5, v2
    v_lshlrev_b32 v6, 2, v10
    v_lshl_add_u32 v61, v1, 6, v6
    v_add_u32 v61, 162944, v61
    v_lshl_add_u32 v6, v1, 5, v6
    v_add_u32 v6, 162816, v6
    v_and_b32 v62, 31, v2
    v_lshlrev_b32 v62, 2, v62
    v_add_u32 v62, 162816, v62
    v_mov_b32 v63, 162816
    s_lshl_b32 s38, s33, 6
    s_add_u32 s38, s38, 162944
    v_lshrrev_b32 v44, 4, v2
    v_lshl_add_u32 v44, v1, 2, v44
    v_lshlrev_b32 v44, 2, v44
    v_add_u32 v44, 163200, v44
    v_and_b32 v45, 15, v2
    v_lshlrev_b32 v45, 2, v45
    v_add_u32 v45, 163200, v45
    v_lshlrev_b32 v46, 5, v1
    v_add_u32 v46, 162816, v46
    v_mov_b32 v47, 163264
    v_mov_b32 v11, 0
    s_mov_b32 s40, 32768
    buffer_load_dwordx4 v[16:19], v60, s[8:11], s41 offen sc1
    buffer_load_dwordx4 v[20:23], v60, s[8:11], s41 offen offset:16 sc1
    s_cmp_ge_u32 s32, 144
    s_cbranch_scc1 L_tail_nofrag
    ds_read_b64_tr_b16 a[0:1], v3 offset:0
    ds_read_b64_tr_b16 a[2:3], v3 offset:256
    ds_read_b64_tr_b16 a[4:5], v3 offset:2048
    ds_read_b64_tr_b16 a[6:7], v3 offset:2304
    ds_read_b64_tr_b16 a[8:9], v3 offset:4096
    ds_read_b64_tr_b16 a[10:11], v3 offset:4352
    ds_read_b64_tr_b16 a[12:13], v3 offset:6144
    ds_read_b64_tr_b16 a[14:15], v3 offset:6400
    ds_read_b64_tr_b16 a[16:17], v3 offset:8192
    ds_read_b64_tr_b16 a[18:19], v3 offset:8448
    ds_read_b64_tr_b16 a[20:21], v3 offset:10240
    ds_read_b64_tr_b16 a[22:23], v3 offset:10496
    s_waitcnt lgkmcnt(8)
    ds_read_b64_tr_b16 a[24:25], v3 offset:12288
    ds_read_b64_tr_b16 a[26:27], v3 offset:12544
    ds_read_b64_tr_b16 a[28:29], v3 offset:14336
    ds_read_b64_tr_b16 a[30:31], v3 offset:14592
    ds_read_b64_tr_b16 a[32:33], v3 offset:16384
    ds_read_b64_tr_b16 a[34:35], v3 offset:16640
    s_waitcnt lgkmcnt(8)
    ds_read_b64_tr_b16 a[36:37], v3 offset:18432
    ds_read_b64_tr_b16 a[38:39], v3 offset:18688
    ds_read_b64_tr_b16 a[40:41], v3 offset:20480
    ds_read_b64_tr_b16 a[42:43], v3 offset:20736
    ds_read_b64_tr_b16 a[44:45], v3 offset:22528
    ds_read_b64_tr_b16 a[46:47], v3 offset:22784
    s_waitcnt lgkmcnt(8)
    ds_read_b64_tr_b16 a[48:49], v3 offset:24576
    ds_read_b64_tr_b16 a[50:51], v3 offset:24832
    ds_read_b64_tr_b16 a[52:53], v3 offset:26624
    ds_read_b64_tr_b16 a[54:55], v3 offset:26880
    ds_read_b64_tr_b16 a[56:57], v3 offset:28672
    ds_read_b64_tr_b16 a[58:59], v3 offset:28928
    s_waitcnt lgkmcnt(8)
    ds_read_b64_tr_b16 a[60:61], v3 offset:30720
    ds_read_b64_tr_b16 a[62:63], v3 offset:30976
    ds_read_b64_tr_b16 a[64:65], v8 offset:0
    ds_read_b64_tr_b16 a[66:67], v8 offset:256
    ds_read_b64_tr_b16 a[68:69], v8 offset:2048
    ds_read_b64_tr_b16 a[70:71], v8 offset:2304
    s_waitcnt lgkmcnt(8)
    ds_read_b64_tr_b16 a[72:73], v14 offset:0
    ds_read_b64_tr_b16 a[74:75], v14 offset:2048
    ds_read_b64_tr_b16 a[76:77], v14 offset:4096
    ds_read_b64_tr_b16 a[78:79], v14 offset:6144
    ds_read_b64_tr_b16 a[80:81], v14 offset:8192
    ds_read_b64_tr_b16 a[82:83], v14 offset:10240
    s_waitcnt lgkmcnt(8)
    ds_read_b64_tr_b16 a[84:85], v14 offset:12288
    ds_read_b64_tr_b16 a[86:87], v14 offset:14336
    ds_read_b64_tr_b16 a[88:89], v14 offset:16384
    ds_read_b64_tr_b16 a[90:91], v14 offset:18432
    ds_read_b64_tr_b16 a[92:93], v14 offset:20480
    ds_read_b64_tr_b16 a[94:95], v14 offset:22528
    s_waitcnt lgkmcnt(8)
    ds_read_b64_tr_b16 a[96:97], v14 offset:41984
    ds_read_b64_tr_b16 a[98:99], v14 offset:44032
    ds_read_b64_tr_b16 a[100:101], v14 offset:46080
    ds_read_b64_tr_b16 a[102:103], v14 offset:48128
    ds_read_b64_tr_b16 a[104:105], v14 offset:50176
    ds_read_b64_tr_b16 a[106:107], v14 offset:52224
    s_waitcnt lgkmcnt(8)
L_tail_nofrag:
    s_waitcnt vmcnt(0)
    s_branch L_keys_chk
L_poll_keys:
    s_mov_b64 exec, vcc
    buffer_load_dwordx4 v[16:19], v60, s[8:11], s41 offen sc1
    buffer_load_dwordx4 v[20:23], v60, s[8:11], s41 offen offset:16 sc1
    s_waitcnt vmcnt(0)
L_keys_chk:
    v_min3_u32 v3, v16, v17, v18
    v_min3_u32 v4, v19, v20, v21
    v_min3_u32 v3, v3, v22, v23
    v_min_u32 v3, v3, v4
    v_cmp_eq_u32 vcc, 0, v3
    s_sub_u32 s40, s40, 1
    s_cselect_b64 vcc, 0, vcc
    s_bcnt1_i32_b64 s3, vcc
    s_cmp_gt_u32 s3, 12
    s_cbranch_scc1 L_poll_keys
    s_mov_b64 exec, -1
    v_max3_u32 v8, v16, v17, v18
    v_max3_u32 v9, v19, v20, v21
    v_max3_u32 v8, v8, v22, v23
    v_max_u32 v8, v8, v9
    s_mov_b32 s34, s41
    s_mov_b64 s[28:29], vcc
    s_cbranch_vccz L_keys_all
    s_mov_b64 exec, vcc
    buffer_load_dwordx4 v[16:19], v60, s[8:11], s41 offen sc1
    buffer_load_dwordx4 v[20:23], v60, s[8:11], s41 offen offset:16 sc1
    s_mov_b64 exec, -1
L_keys_all:
    s_nop 1
    v_max_u32_dpp v8, v8, v8 row_ror:1 row_mask:0xf bank_mask:0xf
    s_nop 1
    v_max_u32_dpp v8, v8, v8 row_ror:2 row_mask:0xf bank_mask:0xf
    s_nop 1
    v_max_u32_dpp v8, v8, v8 row_ror:4 row_mask:0xf bank_mask:0xf
    s_nop 1
    v_max_u32_dpp v8, v8, v8 row_ror:8 row_mask:0xf bank_mask:0xf
    ds_write_b32 v44, v8
    ds_write_b32 v6, v11
    s_waitcnt lgkmcnt(0)
    s_barrier
    ds_read_b32 v9, v45
    ds_read_b128 v[24:27], v63 offset:384
    ds_read_b128 v[28:31], v63 offset:400
    ds_read_b128 v[32:35], v63 offset:416
    ds_read_b128 v[36:39], v63 offset:432
    v_mov_b32 v7, 0
    v_mov_b32 v8, 0
    s_waitcnt lgkmcnt(3)
    v_cmp_gt_u32 s[40:41], v24, v9
    v_cmp_gt_u32 s[42:43], v25, v9
    v_cmp_gt_u32 s[44:45], v26, v9
    v_cmp_gt_u32 s[46:47], v27, v9
    v_addc_co_u32 v7, vcc, 0, v7, s[40:41]
    v_addc_co_u32 v8, vcc, 0, v8, s[42:43]
    v_addc_co_u32 v7, vcc, 0, v7, s[44:45]
    v_addc_co_u32 v8, vcc, 0, v8, s[46:47]
    s_waitcnt lgkmcnt(2)
    v_cmp_gt_u32 s[40:41], v28, v9
    v_cmp_gt_u32 s[42:43], v29, v9
    v_cmp_gt_u32 s[44:45], v30, v9
    v_cmp_gt_u32 s[46:47], v31, v9
    v_addc_co_u32 v7, vcc, 0, v7, s[40:41]
    v_addc_co_u32 v8, vcc, 0, v8, s[42:43]
    v_addc_co_u32 v7, vcc, 0, v7, s[44:45]
    v_addc_co_u32 v8, vcc, 0, v8, s[46:47]
    s_waitcnt lgkmcnt(1)
    v_cmp_gt_u32 s[40:41], v32, v9
    v_cmp_gt_u32 s[42:43], v33, v9
    v_cmp_gt_u32 s[44:45], v34, v9
    v_cmp_gt_u32 s[46:47], v35, v9
    v_addc_co_u32 v7, vcc, 0, v7, s[40:41]
    v_addc_co_u32 v8, vcc, 0, v8, s[42:43]
    v_addc_co_u32 v7, vcc, 0, v7, s[44:45]
    v_addc_co_u32 v8, vcc, 0, v8, s[46:47]
    s_waitcnt lgkmcnt(0)
    v_cmp_gt_u32 s[40:41], v36, v9
    v_cmp_gt_u32 s[42:43], v37, v9
    v_cmp_gt_u32 s[44:45], v38, v9
    v_cmp_gt_u32 s[46:47], v39, v9
    v_addc_co_u32 v7, vcc, 0, v7, s[40:41]
    v_addc_co_u32 v8, vcc, 0, v8, s[42:43]
    v_addc_co_u32 v7, vcc, 0, v7, s[44:45]
    v_addc_co_u32 v8, vcc, 0, v8, s[46:47]
    v_add_u32 v7, v7, v8
    v_cmp_eq_u32 vcc, 7, v7
    s_mov_b32 s52, 0
    s_ff1_i32_b32 s3, vcc_lo
    s_and_b32 s40, s3, 15
    v_readlane_b32 s53, v9, s40
    s_cmp_lt_i32 s3, 0
    s_cselect_b32 s53, 0, s53
    v_cmp_le_u32 vcc, s53, v103
    s_cmp_eq_u32 s33, 3
    s_cselect_b64 vcc, 0, vcc
    s_cbranch_vccz L_h2_none
    v_mov_b32 v3, 0x1000000
    s_mov_b32 s3, 2359296
    v_cndmask_b32 v3, v3, v101, vcc
    v_cvt_pk_bf16_f32 v208, v184, v185
    v_cvt_pk_bf16_f32 v209, v186, v187
    v_cvt_pk_bf16_f32 v210, v188, v189
    v_cvt_pk_bf16_f32 v211, v190, v191
    v_cvt_pk_bf16_f32 v212, v192, v193
    v_cvt_pk_bf16_f32 v213, v194, v195
    v_cvt_pk_bf16_f32 v214, v196, v197
    v_cvt_pk_bf16_f32 v215, v198, v199
    v_cvt_pk_bf16_f32 v216, v200, v201
    v_cvt_pk_bf16_f32 v217, v202, v203
    v_cvt_pk_bf16_f32 v218, v204, v205
    v_cvt_pk_bf16_f32 v219, v206, v207
    buffer_store_dwordx4 v[208:211], v3, s[24:27], s3 offen offset:0 sc1
    buffer_store_dwordx4 v[212:215], v3, s[24:27], s3 offen offset:128 sc1
    buffer_store_dwordx4 v[216:219], v3, s[24:27], s3 offen offset:256 sc1
L_h2_none:
    s_cmp_eq_u64 s[28:29], 0
    s_cbranch_scc1 L_keys_done
    s_mov_b32 s40, 32768
    s_mov_b64 exec, s[28:29]
    s_branch L_keys_chk2
L_poll_keys2:
    s_mov_b64 exec, vcc
    buffer_load_dwordx4 v[16:19], v60, s[8:11], s34 offen sc1
    buffer_load_dwordx4 v[20:23], v60, s[8:11], s34 offen offset:16 sc1
L_keys_chk2:
    s_waitcnt vmcnt(0)
    v_min3_u32 v3, v16, v17, v18
    v_min3_u32 v4, v19, v20, v21
    v_min3_u32 v3, v3, v22, v23
    v_min_u32 v3, v3, v4
    v_cmp_eq_u32 vcc, 0, v3
    s_sub_u32 s40, s40, 1
    s_cselect_b64 vcc, 0, vcc
    s_cbranch_vccnz L_poll_keys2
    s_mov_b64 exec, -1
L_keys_done:
    v_cmp_le_u32 s[40:41], s53, v16
    v_cmp_le_u32 s[42:43], s53, v17
    v_cmp_le_u32 s[44:45], s53, v18
    v_cmp_le_u32 s[46:47], s53, v19
    v_mbcnt_lo_u32_b32 v24, s40, 0
    v_mbcnt_hi_u32_b32 v24, s41, v24
    v_add_u32 v24, s52, v24
    s_bcnt1_i32_b64 s3, s[40:41]
    v_min_u32 v24, 7, v24
    s_add_u32 s52, s52, s3
    v_lshl_add_u32 v24, v24, 2, v46
    v_cndmask_b32 v24, v47, v24, s[40:41]
    ds_write_b32 v24, v16
    v_mbcnt_lo_u32_b32 v25, s42, 0
    v_mbcnt_hi_u32_b32 v25, s43, v25
    v_add_u32 v25, s52, v25
    s_bcnt1_i32_b64 s3, s[42:43]
    v_min_u32 v25, 7, v25
    s_add_u32 s52, s52, s3
    v_lshl_add_u32 v25, v25, 2, v46
    v_cndmask_b32 v25, v47, v25, s[42:43]
    ds_write_b32 v25, v17
    v_mbcnt_lo_u32_b32 v26, s44, 0
    v_mbcnt_hi_u32_b32 v26, s45, v26
    v_add_u32 v26, s52, v26
    s_bcnt1_i32_b64 s3, s[44:45]
    v_min_u32 v26, 7, v26
    s_add_u32 s52, s52, s3
    v_lshl_add_u32 v26, v26, 2, v46
    v_cndmask_b32 v26, v47, v26, s[44:45]
    ds_write_b32 v26, v18
    v_mbcnt_lo_u32_b32 v27, s46, 0
    v_mbcnt_hi_u32_b32 v27, s47, v27
    v_add_u32 v27, s52, v27
    s_bcnt1_i32_b64 s3, s[46:47]
    v_min_u32 v27, 7, v27
    s_add_u32 s52, s52, s3
    v_lshl_add_u32 v27, v27, 2, v46
    v_cndmask_b32 v27, v47, v27, s[46:47]
    ds_write_b32 v27, v19
    v_cmp_le_u32 s[40:41], s53, v20
    v_cmp_le_u32 s[42:43], s53, v21
    v_cmp_le_u32 s[44:45], s53, v22
    v_cmp_le_u32 s[46:47], s53, v23
    v_mbcnt_lo_u32_b32 v24, s40, 0
    v_mbcnt_hi_u32_b32 v24, s41, v24
    v_add_u32 v24, s52, v24
    s_bcnt1_i32_b64 s3, s[40:41]
    v_min_u32 v24, 7, v24
    s_add_u32 s52, s52, s3
    v_lshl_add_u32 v24, v24, 2, v46
    v_cndmask_b32 v24, v47, v24, s[40:41]
    ds_write_b32 v24, v20
    v_mbcnt_lo_u32_b32 v25, s42, 0
    v_mbcnt_hi_u32_b32 v25, s43, v25
    v_add_u32 v25, s52, v25
    s_bcnt1_i32_b64 s3, s[42:43]
    v_min_u32 v25, 7, v25
    s_add_u32 s52, s52, s3
    v_lshl_add_u32 v25, v25, 2, v46
    v_cndmask_b32 v25, v47, v25, s[42:43]
    ds_write_b32 v25, v21
    v_mbcnt_lo_u32_b32 v26, s44, 0
    v_mbcnt_hi_u32_b32 v26, s45, v26
    v_add_u32 v26, s52, v26
    s_bcnt1_i32_b64 s3, s[44:45]
    v_min_u32 v26, 7, v26
    s_add_u32 s52, s52, s3
    v_lshl_add_u32 v26, v26, 2, v46
    v_cndmask_b32 v26, v47, v26, s[44:45]
    ds_write_b32 v26, v22
    v_mbcnt_lo_u32_b32 v27, s46, 0
    v_mbcnt_hi_u32_b32 v27, s47, v27
    v_add_u32 v27, s52, v27
    s_bcnt1_i32_b64 s3, s[46:47]
    v_min_u32 v27, 7, v27
    s_add_u32 s52, s52, s3
    v_lshl_add_u32 v27, v27, 2, v46
    v_cndmask_b32 v27, v47, v27, s[46:47]
    ds_write_b32 v27, v23
    s_cmp_le_u32 s52, 8
    s_cbranch_scc1 L_top_done
    v_mov_b32 v7, -1
    s_mov_b32 s3, 0
L_top_round:
    v_sub_u32 v24, v7, v16
    v_sub_u32 v25, v7, v17
    v_sub_u32 v26, v7, v18
    v_sub_u32 v27, v7, v19
    v_sub_u32 v28, v7, v20
    v_sub_u32 v29, v7, v21
    v_sub_u32 v30, v7, v22
    v_sub_u32 v31, v7, v23
    v_min3_u32 v8, v24, v25, v26
    v_min3_u32 v9, v27, v28, v29
    v_min3_u32 v8, v8, v30, v31
    v_min_u32 v8, v8, v9
    s_nop 1
    v_min_u32_dpp v8, v8, v8 row_ror:1 row_mask:0xf bank_mask:0xf
    s_nop 1
    v_min_u32_dpp v8, v8, v8 row_ror:2 row_mask:0xf bank_mask:0xf
    s_nop 1
    v_min_u32_dpp v8, v8, v8 row_ror:4 row_mask:0xf bank_mask:0xf
    s_nop 1
    v_min_u32_dpp v8, v8, v8 row_ror:8 row_mask:0xf bank_mask:0xf
    v_mov_b32 v9, v8
    s_nop 1
    v_permlane16_swap_b32 v8, v9
    v_min_u32 v8, v8, v9
    v_mov_b32 v9, v8
    v_cmp_eq_u32 vcc, s3, v10
    s_nop 0
    v_permlane32_swap_b32 v8, v9
    v_min_u32 v8, v8, v9
    v_sub_u32 v8, v7, v8
    v_subrev_u32 v7, 1, v8
    v_cndmask_b32 v11, v11, v8, vcc
    s_add_u32 s3, s3, 1
    s_cmp_lt_u32 s3, 8
    s_cbranch_scc1 L_top_round
    ds_write_b32 v6, v11
L_top_done:
    s_waitcnt lgkmcnt(0)
    s_barrier
    ds_read_b32 v11, v62
    ds_read_b128 v[16:19], v63 offset:0
    ds_read_b128 v[20:23], v63 offset:16
    ds_read_b128 v[24:27], v63 offset:32
    ds_read_b128 v[28:31], v63 offset:48
    ds_read_b128 v[32:35], v63 offset:64
    ds_read_b128 v[36:39], v63 offset:80
    ds_read_b128 v[40:43], v63 offset:96
    ds_read_b128 v[44:47], v63 offset:112
    v_mov_b32 v7, 0
    v_mov_b32 v8, 0
    s_waitcnt lgkmcnt(7)
    v_cmp_gt_u32 s[40:41], v16, v11
    v_cmp_gt_u32 s[42:43], v17, v11
    v_cmp_gt_u32 s[44:45], v18, v11
    v_cmp_gt_u32 s[46:47], v19, v11
    v_addc_co_u32 v7, vcc, 0, v7, s[40:41]
    v_addc_co_u32 v8, vcc, 0, v8, s[42:43]
    v_addc_co_u32 v7, vcc, 0, v7, s[44:45]
    v_addc_co_u32 v8, vcc, 0, v8, s[46:47]
    s_waitcnt lgkmcnt(6)
    v_cmp_gt_u32 s[40:41], v20, v11
    v_cmp_gt_u32 s[42:43], v21, v11
    v_cmp_gt_u32 s[44:45], v22, v11
    v_cmp_gt_u32 s[46:47], v23, v11
    v_addc_co_u32 v7, vcc, 0, v7, s[40:41]
    v_addc_co_u32 v8, vcc, 0, v8, s[42:43]
    v_addc_co_u32 v7, vcc, 0, v7, s[44:45]
    v_addc_co_u32 v8, vcc, 0, v8, s[46:47]
    s_waitcnt lgkmcnt(5)
    v_cmp_gt_u32 s[40:41], v24, v11
    v_cmp_gt_u32 s[42:43], v25, v11
    v_cmp_gt_u32 s[44:45], v26, v11
    v_cmp_gt_u32 s[46:47], v27, v11
    v_addc_co_u32 v7, vcc, 0, v7, s[40:41]
    v_addc_co_u32 v8, vcc, 0, v8, s[42:43]
    v_addc_co_u32 v7, vcc, 0, v7, s[44:45]
    v_addc_co_u32 v8, vcc, 0, v8, s[46:47]
    s_waitcnt lgkmcnt(4)
    v_cmp_gt_u32 s[40:41], v28, v11
    v_cmp_gt_u32 s[42:43], v29, v11
    v_cmp_gt_u32 s[44:45], v30, v11
    v_cmp_gt_u32 s[46:47], v31, v11
    v_addc_co_u32 v7, vcc, 0, v7, s[40:41]
    v_addc_co_u32 v8, vcc, 0, v8, s[42:43]
    v_addc_co_u32 v7, vcc, 0, v7, s[44:45]
    v_addc_co_u32 v8, vcc, 0, v8, s[46:47]
    s_waitcnt lgkmcnt(3)
    v_cmp_gt_u32 s[40:41], v32, v11
    v_cmp_gt_u32 s[42:43], v33, v11
    v_cmp_gt_u32 s[44:45], v34, v11
    v_cmp_gt_u32 s[46:47], v35, v11
    v_addc_co_u32 v7, vcc, 0, v7, s[40:41]
    v_addc_co_u32 v8, vcc, 0, v8, s[42:43]
    v_addc_co_u32 v7, vcc, 0, v7, s[44:45]
    v_addc_co_u32 v8, vcc, 0, v8, s[46:47]
    s_waitcnt lgkmcnt(2)
    v_cmp_gt_u32 s[40:41], v36, v11
    v_cmp_gt_u32 s[42:43], v37, v11
    v_cmp_gt_u32 s[44:45], v38, v11
    v_cmp_gt_u32 s[46:47], v39, v11
    v_addc_co_u32 v7, vcc, 0, v7, s[40:41]
    v_addc_co_u32 v8, vcc, 0, v8, s[42:43]
    v_addc_co_u32 v7, vcc, 0, v7, s[44:45]
    v_addc_co_u32 v8, vcc, 0, v8, s[46:47]
    s_waitcnt lgkmcnt(1)
    v_cmp_gt_u32 s[40:41], v40, v11
    v_cmp_gt_u32 s[42:43], v41, v11
    v_cmp_gt_u32 s[44:45], v42, v11
    v_cmp_gt_u32 s[46:47], v43, v11
    v_addc_co_u32 v7, vcc, 0, v7, s[40:41]
    v_addc_co_u32 v8, vcc, 0, v8, s[42:43]
    v_addc_co_u32 v7, vcc, 0, v7, s[44:45]
    v_addc_co_u32 v8, vcc, 0, v8, s[46:47]
    s_waitcnt lgkmcnt(0)
    v_cmp_gt_u32 s[40:41], v44, v11
    v_cmp_gt_u32 s[42:43], v45, v11
    v_cmp_gt_u32 s[44:45], v46, v11
    v_cmp_gt_u32 s[46:47], v47, v11
    v_addc_co_u32 v7, vcc, 0, v7, s[40:41]
    v_addc_co_u32 v8, vcc, 0, v8, s[42:43]
    v_addc_co_u32 v7, vcc, 0, v7, s[44:45]
    v_addc_co_u32 v8, vcc, 0, v8, s[46:47]
    v_add_u32 v7, v7, v8
    v_min_u32 v7, 8, v7
    v_lshl_add_u32 v7, v7, 2, s38
    ds_write_b32 v7, v11
    ds_read_b32 v11, v61
    v_mov_b32 v7, s38
    ds_read_b128 v[104:107], v7
    ds_read_b128 v[108:111], v7 offset:16
    s_waitcnt lgkmcnt(2)
    v_and_b32 v7, 0x7ff, v11
    v_mul_u32_u24 v7, 1152, v7
    v_add_u32 v12, v12, v7
    s_cmp_ge_u32 s32, 144
    s_cbranch_scc1 L_tail_final
    s_lshl_b32 s39, s33, 7
    s_add_u32 s39, s39, 2359296
    s_mov_b32 s38, 2359296
    buffer_load_dwordx4 v[72:75], v12, s[24:27], s39 offen sc1
    buffer_load_dwordx4 v[76:79], v12, s[24:27], s39 offen offset:512 sc1
    buffer_load_dwordx4 v[48:51], v12, s[24:27], s38 offen offset:1024 sc1
    v_lshl_add_u32 v9, v1, 10, v5
    v_and_b32 v4, 8, v2
    v_lshlrev_b32 v8, 2, v10
    v_lshl_add_u32 v10, v4, 7, v5
    s_waitcnt lgkmcnt(0)
    s_movk_i32 s3, 0x7ff
    v_bitop3_b32 v104, v104, s3, v100 bitop3:0x6a
    v_bitop3_b32 v105, v105, s3, v100 bitop3:0x6a
    v_bitop3_b32 v106, v106, s3, v100 bitop3:0x6a
    v_bitop3_b32 v107, v107, s3, v100 bitop3:0x6a
    v_bitop3_b32 v108, v108, s3, v100 bitop3:0x6a
    v_bitop3_b32 v109, v109, s3, v100 bitop3:0x6a
    v_bitop3_b32 v110, v110, s3, v100 bitop3:0x6a
    v_bitop3_b32 v111, v111, s3, v100 bitop3:0x6a
    v_lshl_or_b32 v104, v104, 3, 0
    v_lshl_or_b32 v105, v105, 3, 1
    v_lshl_or_b32 v106, v106, 3, 2
    v_lshl_or_b32 v107, v107, 3, 3
    v_lshl_or_b32 v108, v108, 3, 4
    v_lshl_or_b32 v109, v109, 3, 5
    v_lshl_or_b32 v110, v110, 3, 6
    v_lshl_or_b32 v111, v111, 3, 7
    v_min3_u32 v104, v104, v105, v106
    v_min3_u32 v107, v107, v108, v109
    v_min3_u32 v104, v104, v110, v111
    v_min_u32 v104, v104, v107
    v_cmp_gt_u32 vcc, 8, v104
    v_mov_b32 v105, 0x1000000
    s_mov_b32 s47, 0xffff0000
    v_cndmask_b32 v101, v101, v105, vcc
    s_cmp_eq_u32 s33, 3
    s_cselect_b64 s[52:53], 0, vcc
    v_pk_mul_f32 v[136:137], v[184:185], v[112:113]
    v_pk_mul_f32 v[138:139], v[186:187], v[114:115]
    v_pk_mul_f32 v[140:141], v[188:189], v[116:117]
    v_pk_mul_f32 v[142:143], v[190:191], v[118:119]
    v_pk_mul_f32 v[144:145], v[192:193], v[120:121]
    v_pk_mul_f32 v[146:147], v[194:195], v[122:123]
    v_pk_mul_f32 v[148:149], v[196:197], v[124:125]
    v_pk_mul_f32 v[150:151], v[198:199], v[126:127]
    v_pk_mul_f32 v[152:153], v[200:201], v[128:129]
    v_pk_mul_f32 v[154:155], v[202:203], v[130:131]
    v_pk_mul_f32 v[156:157], v[204:205], v[132:133]
    v_pk_mul_f32 v[158:159], v[206:207], v[134:135]
    v_cvt_pk_bf16_f32 v208, v136, v137
    v_cvt_pk_bf16_f32 v209, v138, v139
    v_cvt_pk_bf16_f32 v210, v140, v141
    v_cvt_pk_bf16_f32 v211, v142, v143
    v_cvt_pk_bf16_f32 v216, v144, v145
    v_cvt_pk_bf16_f32 v217, v146, v147
    v_cvt_pk_bf16_f32 v218, v148, v149
    v_cvt_pk_bf16_f32 v219, v150, v151
    v_cvt_pk_bf16_f32 v224, v152, v153
    v_cvt_pk_bf16_f32 v225, v154, v155
    v_cvt_pk_bf16_f32 v226, v156, v157
    v_cvt_pk_bf16_f32 v227, v158, v159
    v_lshlrev_b32 v136, 16, v208
    v_and_b32 v137, s47, v208
    v_lshlrev_b32 v138, 16, v209
    v_and_b32 v139, s47, v209
    v_lshlrev_b32 v140, 16, v210
    v_and_b32 v141, s47, v210
    v_lshlrev_b32 v142, 16, v211
    v_and_b32 v143, s47, v211
    v_lshlrev_b32 v144, 16, v216
    v_and_b32 v145, s47, v216
    v_lshlrev_b32 v146, 16, v217
    v_and_b32 v147, s47, v217
    v_lshlrev_b32 v148, 16, v218
    v_and_b32 v149, s47, v218
    v_lshlrev_b32 v150, 16, v219
    v_and_b32 v151, s47, v219
    v_lshlrev_b32 v152, 16, v224
    v_and_b32 v153, s47, v224
    v_lshlrev_b32 v154, 16, v225
    v_and_b32 v155, s47, v225
    v_lshlrev_b32 v156, 16, v226
    v_and_b32 v157, s47, v226
    v_lshlrev_b32 v158, 16, v227
    v_and_b32 v159, s47, v227
    v_pk_add_f32 v[136:137], v[136:137], v[160:161]
    v_pk_add_f32 v[138:139], v[138:139], v[162:163]
    v_pk_add_f32 v[140:141], v[140:141], v[164:165]
    v_pk_add_f32 v[142:143], v[142:143], v[166:167]
    v_pk_add_f32 v[144:145], v[144:145], v[168:169]
    v_pk_add_f32 v[146:147], v[146:147], v[170:171]
    v_pk_add_f32 v[148:149], v[148:149], v[172:173]
    v_pk_add_f32 v[150:151], v[150:151], v[174:175]
    v_pk_add_f32 v[152:153], v[152:153], v[176:177]
    v_pk_add_f32 v[154:155], v[154:155], v[178:179]
    v_pk_add_f32 v[156:157], v[156:157], v[180:181]
    v_pk_add_f32 v[158:159], v[158:159], v[182:183]
    v_cvt_pk_bf16_f32 v88, v136, v137
    v_cvt_pk_bf16_f32 v89, v138, v139
    v_cvt_pk_bf16_f32 v90, v140, v141
    v_cvt_pk_bf16_f32 v91, v142, v143
    v_cvt_pk_bf16_f32 v92, v144, v145
    v_cvt_pk_bf16_f32 v93, v146, v147
    v_cvt_pk_bf16_f32 v94, v148, v149
    v_cvt_pk_bf16_f32 v95, v150, v151
    v_cvt_pk_bf16_f32 v96, v152, v153
    v_cvt_pk_bf16_f32 v97, v154, v155
    v_cvt_pk_bf16_f32 v98, v156, v157
    v_cvt_pk_bf16_f32 v99, v158, v159
    s_mov_b32 s40, 32768
    s_branch L_h2_chk
L_h2_poll:
    buffer_load_dwordx4 v[72:75], v12, s[24:27], s39 offen sc1
    buffer_load_dwordx4 v[76:79], v12, s[24:27], s39 offen offset:512 sc1
    buffer_load_dwordx4 v[48:51], v12, s[24:27], s38 offen offset:1024 sc1
L_h2_chk:
    s_waitcnt vmcnt(1)
    ds_write_b128 v9, v[72:75] offset:8192
    ds_write_b128 v9, v[76:79] offset:12288
    v_max3_u32 v3, v72, v73, v74
    v_max3_u32 v4, v75, v76, v77
    v_max3_u32 v3, v3, v78, v79
    s_waitcnt vmcnt(0)
    v_max3_u32 v4, v4, v48, v49
    v_max3_u32 v3, v3, v50, v51
    v_max_u32 v3, v3, v4
    v_cmp_eq_u32 vcc, -1, v3
    s_sub_u32 s40, s40, 1
    s_cselect_b64 vcc, 0, vcc
    s_waitcnt lgkmcnt(0)
    s_cbranch_vccnz L_h2_poll
    v_mfma_f32_16x16x32_bf16 v[64:67], a[64:67], v[48:51], 0
    v_mfma_f32_16x16x32_bf16 v[68:71], a[68:71], v[48:51], 0
    s_cmp_eq_u64 s[52:53], 0
    s_cbranch_scc1 L_nosel_moe
    v_mul_u32_u24 v104, 1152, v104
    v_add_u32 v104, v104, v102
    v_cndmask_b32 v104, v105, v104, s[52:53]
    v_cvt_pk_bf16_f32 v232, v160, v161
    v_cvt_pk_bf16_f32 v233, v162, v163
    v_cvt_pk_bf16_f32 v234, v164, v165
    v_cvt_pk_bf16_f32 v235, v166, v167
    v_cvt_pk_bf16_f32 v236, v168, v169
    v_cvt_pk_bf16_f32 v237, v170, v171
    v_cvt_pk_bf16_f32 v238, v172, v173
    v_cvt_pk_bf16_f32 v239, v174, v175
    v_cvt_pk_bf16_f32 v240, v176, v177
    v_cvt_pk_bf16_f32 v241, v178, v179
    v_cvt_pk_bf16_f32 v242, v180, v181
    v_cvt_pk_bf16_f32 v243, v182, v183
    buffer_store_dwordx4 v[232:235], v104, s[24:27], 0 offen offset:0 sc1
    buffer_store_dwordx4 v[236:239], v104, s[24:27], 0 offen offset:128 sc1
    buffer_store_dwordx4 v[240:243], v104, s[24:27], 0 offen offset:256 sc1
L_nosel_moe:
    s_waitcnt lgkmcnt(0)
    s_barrier
    ds_read_b128 v[16:19], v5 offset:8192
    ds_read_b128 v[20:23], v5 offset:9216
    ds_read_b128 v[24:27], v5 offset:10240
    ds_read_b128 v[28:31], v5 offset:11264
    ds_read_b128 v[32:35], v5 offset:12288
    ds_read_b128 v[36:39], v5 offset:13312
    ds_read_b128 v[40:43], v5 offset:14336
    ds_read_b128 v[44:47], v5 offset:15360
    s_waitcnt lgkmcnt(7)
    v_mfma_f32_16x16x32_bf16 v[64:67], a[0:3], v[16:19], v[64:67]
    v_mfma_f32_16x16x32_bf16 v[68:71], a[4:7], v[16:19], v[68:71]
    s_waitcnt lgkmcnt(6)
    v_mfma_f32_16x16x32_bf16 v[64:67], a[8:11], v[20:23], v[64:67]
    v_mfma_f32_16x16x32_bf16 v[68:71], a[12:15], v[20:23], v[68:71]
    s_waitcnt lgkmcnt(5)
    v_mfma_f32_16x16x32_bf16 v[64:67], a[16:19], v[24:27], v[64:67]
    v_mfma_f32_16x16x32_bf16 v[68:71], a[20:23], v[24:27], v[68:71]
    s_waitcnt lgkmcnt(4)
    v_mfma_f32_16x16x32_bf16 v[64:67], a[24:27], v[28:31], v[64:67]
    v_mfma_f32_16x16x32_bf16 v[68:71], a[28:31], v[28:31], v[68:71]
    s_waitcnt lgkmcnt(3)
    v_mfma_f32_16x16x32_bf16 v[64:67], a[32:35], v[32:35], v[64:67]
    v_mfma_f32_16x16x32_bf16 v[68:71], a[36:39], v[32:35], v[68:71]
    s_waitcnt lgkmcnt(2)
    v_mfma_f32_16x16x32_bf16 v[64:67], a[40:43], v[36:39], v[64:67]
    v_mfma_f32_16x16x32_bf16 v[68:71], a[44:47], v[36:39], v[68:71]
    s_waitcnt lgkmcnt(1)
    v_mfma_f32_16x16x32_bf16 v[64:67], a[48:51], v[40:43], v[64:67]
    v_mfma_f32_16x16x32_bf16 v[68:71], a[52:55], v[40:43], v[68:71]
    s_waitcnt lgkmcnt(0)
    v_mfma_f32_16x16x32_bf16 v[64:67], a[56:59], v[44:47], v[64:67]
    v_mfma_f32_16x16x32_bf16 v[68:71], a[60:63], v[44:47], v[68:71]
    s_nop 7
    v_mov_b32_dpp v64, v68 quad_perm:[0,1,2,3] row_mask:0xf bank_mask:0xc
    v_mov_b32_dpp v65, v69 quad_perm:[0,1,2,3] row_mask:0xf bank_mask:0xc
    v_mov_b32_dpp v66, v70 quad_perm:[0,1,2,3] row_mask:0xf bank_mask:0xc
    v_mov_b32_dpp v67, v71 quad_perm:[0,1,2,3] row_mask:0xf bank_mask:0xc
    s_nop 0
    v_add_f32_dpp v4, v64, v64 row_ror:8 row_mask:0xf bank_mask:0xf
    v_add_f32_dpp v5, v65, v65 row_ror:8 row_mask:0xf bank_mask:0xf
    v_add_f32_dpp v6, v66, v66 row_ror:8 row_mask:0xf bank_mask:0xf
    v_add_f32_dpp v7, v67, v67 row_ror:8 row_mask:0xf bank_mask:0xf
    ds_write_b128 v9, v[4:7]
    s_waitcnt lgkmcnt(0)
    s_barrier
    ds_read_b128 v[16:19], v10
    ds_read_b128 v[20:23], v10 offset:2048
    s_waitcnt lgkmcnt(0)
    v_cvt_pk_bf16_f32 v32, v16, v17
    v_cvt_pk_bf16_f32 v33, v18, v19
    v_cvt_pk_bf16_f32 v34, v20, v21
    v_cvt_pk_bf16_f32 v35, v22, v23
    v_lshlrev_b32 v16, 16, v32
    v_and_b32 v17, 0xffff0000, v32
    v_lshlrev_b32 v18, 16, v33
    v_and_b32 v19, 0xffff0000, v33
    v_lshlrev_b32 v20, 16, v34
    v_and_b32 v21, 0xffff0000, v34
    v_lshlrev_b32 v22, 16, v35
    v_and_b32 v23, 0xffff0000, v35
    v_mul_f32 v32, 0xbfb8aa3b, v16
    v_mul_f32 v33, 0xbfb8aa3b, v17
    v_mul_f32 v34, 0xbfb8aa3b, v18
    v_mul_f32 v35, 0xbfb8aa3b, v19
    v_exp_f32 v32, v32
    v_exp_f32 v33, v33
    v_exp_f32 v34, v34
    v_exp_f32 v35, v35
    v_add_f32 v32, 1.0, v32
    v_add_f32 v33, 1.0, v33
    v_add_f32 v34, 1.0, v34
    v_add_f32 v35, 1.0, v35
    v_rcp_f32 v32, v32
    v_rcp_f32 v33, v33
    v_rcp_f32 v34, v34
    v_rcp_f32 v35, v35
    v_mul_f32 v16, v16, v32
    v_mul_f32 v17, v17, v33
    v_mul_f32 v18, v18, v34
    v_mul_f32 v19, v19, v35
    v_cvt_pk_bf16_f32 v24, v16, v17
    v_cvt_pk_bf16_f32 v25, v18, v19
    v_lshlrev_b32 v16, 16, v24
    v_and_b32 v17, 0xffff0000, v24
    v_lshlrev_b32 v18, 16, v25
    v_and_b32 v19, 0xffff0000, v25
    v_mul_f32 v16, v16, v20
    v_mul_f32 v17, v17, v21
    v_mul_f32 v18, v18, v22
    v_mul_f32 v19, v19, v23
    v_cvt_pk_bf16_f32 v40, v16, v17
    v_cvt_pk_bf16_f32 v41, v18, v19
    s_nop 0
    v_mov_b32_dpp v42, v40 row_ror:8 row_mask:0xf bank_mask:0xf
    v_mov_b32_dpp v43, v41 row_ror:8 row_mask:0xf bank_mask:0xf
    s_nop 1
    v_mfma_f32_16x16x32_bf16 v[48:51], a[72:75], v[40:43], 0
    v_mfma_f32_16x16x32_bf16 v[52:55], a[76:79], v[40:43], 0
    v_mfma_f32_16x16x32_bf16 v[56:59], a[80:83], v[40:43], 0
    v_mfma_f32_16x16x32_bf16 v[60:63], a[84:87], v[40:43], 0
    v_mfma_f32_16x16x32_bf16 v[64:67], a[88:91], v[40:43], 0
    v_mfma_f32_16x16x32_bf16 v[68:71], a[92:95], v[40:43], 0
    v_mfma_f32_16x16x32_bf16 v[72:75], a[96:99], v[40:43], 0
    v_mfma_f32_16x16x32_bf16 v[76:79], a[100:103], v[40:43], 0
    v_mfma_f32_16x16x32_bf16 v[80:83], a[104:107], v[40:43], 0
    s_movk_i32 s3, 0
    buffer_store_dwordx4 v[48:51], v15, s[16:19], s3 offen offset:0 sc1
    buffer_store_dwordx4 v[52:55], v15, s[16:19], s3 offen offset:2048 sc1
    s_movk_i32 s3, 4096
    buffer_store_dwordx4 v[56:59], v15, s[16:19], s3 offen offset:0 sc1
    buffer_store_dwordx4 v[60:63], v15, s[16:19], s3 offen offset:2048 sc1
    s_movk_i32 s3, 8192
    buffer_store_dwordx4 v[64:67], v15, s[16:19], s3 offen offset:0 sc1
    buffer_store_dwordx4 v[68:71], v15, s[16:19], s3 offen offset:2048 sc1
    s_movk_i32 s3, 12288
    buffer_store_dwordx4 v[72:75], v15, s[16:19], s3 offen offset:0 sc1
    buffer_store_dwordx4 v[76:79], v15, s[16:19], s3 offen offset:2048 sc1
    s_movk_i32 s3, 16384
    buffer_store_dwordx4 v[80:83], v15, s[16:19], s3 offen offset:0 sc1
    s_cmp_eq_u32 s33, 3
    s_cbranch_scc1 L_out_moe
    buffer_store_dwordx4 v[88:91], v101, s[76:79], 0 offen offset:0 sc1
    buffer_store_dwordx4 v[92:95], v101, s[76:79], 0 offen offset:128 sc1
    buffer_store_dwordx4 v[96:99], v101, s[76:79], 0 offen offset:256 sc1
L_out_moe:
    s_movk_i32 s38, 14336
    s_or_b32 s3, s32, s33
    s_cselect_b32 s3, 0x10000, s38
    buffer_store_dword v11, v8, s[8:11], s3 offen
    s_branch L_attn_end
L_tail_final:
    s_lshl_b32 s42, s37, 4
    s_add_u32 s43, s42, 2359296
    s_lshl_b32 s41, s37, 5
    s_add_u32 s41, s41, 11520
    buffer_load_dwordx4 v[52:55], v15, s[8:11], s41 offen sc1
    s_waitcnt lgkmcnt(0)
    s_movk_i32 s3, 0x7ff
    v_bitop3_b32 v104, v104, s3, v100 bitop3:0x6a
    v_bitop3_b32 v105, v105, s3, v100 bitop3:0x6a
    v_bitop3_b32 v106, v106, s3, v100 bitop3:0x6a
    v_bitop3_b32 v107, v107, s3, v100 bitop3:0x6a
    v_bitop3_b32 v108, v108, s3, v100 bitop3:0x6a
    v_bitop3_b32 v109, v109, s3, v100 bitop3:0x6a
    v_bitop3_b32 v110, v110, s3, v100 bitop3:0x6a
    v_bitop3_b32 v111, v111, s3, v100 bitop3:0x6a
    v_lshl_or_b32 v104, v104, 3, 0
    v_lshl_or_b32 v105, v105, 3, 1
    v_lshl_or_b32 v106, v106, 3, 2
    v_lshl_or_b32 v107, v107, 3, 3
    v_lshl_or_b32 v108, v108, 3, 4
    v_lshl_or_b32 v109, v109, 3, 5
    v_lshl_or_b32 v110, v110, 3, 6
    v_lshl_or_b32 v111, v111, 3, 7
    v_min3_u32 v104, v104, v105, v106
    v_min3_u32 v107, v107, v108, v109
    v_min3_u32 v104, v104, v110, v111
    v_min_u32 v104, v104, v107
    v_cmp_gt_u32 vcc, 8, v104
    v_mov_b32 v105, 0x1000000
    s_mov_b32 s47, 0xffff0000
    v_cndmask_b32 v101, v101, v105, vcc
    s_cmp_eq_u32 s33, 3
    s_cselect_b64 s[52:53], 0, vcc
    s_cmp_eq_u64 s[52:53], 0
    s_cbranch_scc1 L_nosel_fin
    v_mul_u32_u24 v104, 1152, v104
    v_add_u32 v104, v104, v102
    v_cndmask_b32 v104, v105, v104, s[52:53]
    v_cvt_pk_bf16_f32 v232, v160, v161
    v_cvt_pk_bf16_f32 v233, v162, v163
    v_cvt_pk_bf16_f32 v234, v164, v165
    v_cvt_pk_bf16_f32 v235, v166, v167
    v_cvt_pk_bf16_f32 v236, v168, v169
    v_cvt_pk_bf16_f32 v237, v170, v171
    v_cvt_pk_bf16_f32 v238, v172, v173
    v_cvt_pk_bf16_f32 v239, v174, v175
    v_cvt_pk_bf16_f32 v240, v176, v177
    v_cvt_pk_bf16_f32 v241, v178, v179
    v_cvt_pk_bf16_f32 v242, v180, v181
    v_cvt_pk_bf16_f32 v243, v182, v183
    buffer_store_dwordx4 v[232:235], v104, s[24:27], 0 offen offset:0 sc1
    buffer_store_dwordx4 v[236:239], v104, s[24:27], 0 offen offset:128 sc1
    buffer_store_dwordx4 v[240:243], v104, s[24:27], 0 offen offset:256 sc1
L_nosel_fin:
    v_pk_mul_f32 v[136:137], v[184:185], v[112:113]
    v_pk_mul_f32 v[138:139], v[186:187], v[114:115]
    v_pk_mul_f32 v[140:141], v[188:189], v[116:117]
    v_pk_mul_f32 v[142:143], v[190:191], v[118:119]
    v_pk_mul_f32 v[144:145], v[192:193], v[120:121]
    v_pk_mul_f32 v[146:147], v[194:195], v[122:123]
    v_pk_mul_f32 v[148:149], v[196:197], v[124:125]
    v_pk_mul_f32 v[150:151], v[198:199], v[126:127]
    v_pk_mul_f32 v[152:153], v[200:201], v[128:129]
    v_pk_mul_f32 v[154:155], v[202:203], v[130:131]
    v_pk_mul_f32 v[156:157], v[204:205], v[132:133]
    v_pk_mul_f32 v[158:159], v[206:207], v[134:135]
    v_cvt_pk_bf16_f32 v208, v136, v137
    v_cvt_pk_bf16_f32 v209, v138, v139
    v_cvt_pk_bf16_f32 v210, v140, v141
    v_cvt_pk_bf16_f32 v211, v142, v143
    v_cvt_pk_bf16_f32 v216, v144, v145
    v_cvt_pk_bf16_f32 v217, v146, v147
    v_cvt_pk_bf16_f32 v218, v148, v149
    v_cvt_pk_bf16_f32 v219, v150, v151
    v_cvt_pk_bf16_f32 v224, v152, v153
    v_cvt_pk_bf16_f32 v225, v154, v155
    v_cvt_pk_bf16_f32 v226, v156, v157
    v_cvt_pk_bf16_f32 v227, v158, v159
    v_lshlrev_b32 v136, 16, v208
    v_and_b32 v137, s47, v208
    v_lshlrev_b32 v138, 16, v209
    v_and_b32 v139, s47, v209
    v_lshlrev_b32 v140, 16, v210
    v_and_b32 v141, s47, v210
    v_lshlrev_b32 v142, 16, v211
    v_and_b32 v143, s47, v211
    v_lshlrev_b32 v144, 16, v216
    v_and_b32 v145, s47, v216
    v_lshlrev_b32 v146, 16, v217
    v_and_b32 v147, s47, v217
    v_lshlrev_b32 v148, 16, v218
    v_and_b32 v149, s47, v218
    v_lshlrev_b32 v150, 16, v219
    v_and_b32 v151, s47, v219
    v_lshlrev_b32 v152, 16, v224
    v_and_b32 v153, s47, v224
    v_lshlrev_b32 v154, 16, v225
    v_and_b32 v155, s47, v225
    v_lshlrev_b32 v156, 16, v226
    v_and_b32 v157, s47, v226
    v_lshlrev_b32 v158, 16, v227
    v_and_b32 v159, s47, v227
    v_pk_add_f32 v[136:137], v[136:137], v[160:161]
    v_pk_add_f32 v[138:139], v[138:139], v[162:163]
    v_pk_add_f32 v[140:141], v[140:141], v[164:165]
    v_pk_add_f32 v[142:143], v[142:143], v[166:167]
    v_pk_add_f32 v[144:145], v[144:145], v[168:169]
    v_pk_add_f32 v[146:147], v[146:147], v[170:171]
    v_pk_add_f32 v[148:149], v[148:149], v[172:173]
    v_pk_add_f32 v[150:151], v[150:151], v[174:175]
    v_pk_add_f32 v[152:153], v[152:153], v[176:177]
    v_pk_add_f32 v[154:155], v[154:155], v[178:179]
    v_pk_add_f32 v[156:157], v[156:157], v[180:181]
    v_pk_add_f32 v[158:159], v[158:159], v[182:183]
    v_cvt_pk_bf16_f32 v88, v136, v137
    v_cvt_pk_bf16_f32 v89, v138, v139
    v_cvt_pk_bf16_f32 v90, v140, v141
    v_cvt_pk_bf16_f32 v91, v142, v143
    v_cvt_pk_bf16_f32 v92, v144, v145
    v_cvt_pk_bf16_f32 v93, v146, v147
    v_cvt_pk_bf16_f32 v94, v148, v149
    v_cvt_pk_bf16_f32 v95, v150, v151
    v_cvt_pk_bf16_f32 v96, v152, v153
    v_cvt_pk_bf16_f32 v97, v154, v155
    v_cvt_pk_bf16_f32 v98, v156, v157
    v_cvt_pk_bf16_f32 v99, v158, v159
    s_cmp_eq_u32 s33, 3
    s_cbranch_scc1 L_out_fin
    buffer_store_dwordx4 v[88:91], v101, s[76:79], 0 offen offset:0 sc1
    buffer_store_dwordx4 v[92:95], v101, s[76:79], 0 offen offset:128 sc1
    buffer_store_dwordx4 v[96:99], v101, s[76:79], 0 offen offset:256 sc1
L_out_fin:
    s_cmp_ge_u32 s32, 216
    s_cbranch_scc1 L_attn_end
    v_not_b32 v7, v11
    v_ashrrev_i32 v7, 31, v7
    v_or_b32 v7, 0x80000000, v7
    v_xor_b32 v8, v11, v7
    v_cvt_pk_bf16_f32 v8, v8, v8
    v_and_b32 v8, 0xffff0000, v8
    v_mul_f32 v8, 0xbfb8aa3b, v8
    v_exp_f32 v8, v8
    s_nop 0
    v_add_f32 v8, 1.0, v8
    v_rcp_f32 v8, v8
    s_nop 0
    v_cvt_pk_bf16_f32 v8, v8, v8
    v_and_b32 v8, 0xffff0000, v8
    v_mul_u32_u24 v9, 1152, v10
    v_and_b32 v7, 8, v2
    v_add_u32 v9, v9, v7
    s_mov_b32 s40, 32768
L_poll_x1:
    buffer_load_dwordx2 v[58:59], v9, s[24:27], s42 offen sc1
    buffer_load_dwordx2 v[56:57], v12, s[24:27], s43 offen sc1
    s_waitcnt vmcnt(0)
    v_max_u32 v3, v58, v59
    v_max3_u32 v3, v3, v56, v57
    v_cmp_eq_u32 vcc, -1, v3
    s_sub_u32 s40, s40, 1
    s_cselect_b64 vcc, 0, vcc
    s_cbranch_vccnz L_poll_x1
    v_lshlrev_b32 v64, 16, v56
    v_and_b32 v65, 0xffff0000, v56
    v_lshlrev_b32 v68, 16, v58
    v_and_b32 v69, 0xffff0000, v58
    v_lshlrev_b32 v66, 16, v57
    v_and_b32 v67, 0xffff0000, v57
    v_lshlrev_b32 v70, 16, v59
    v_and_b32 v71, 0xffff0000, v59
    s_mov_b32 s40, 32768
    s_mov_b64 exec, 1
L_gate_y:
    buffer_load_dword v16, v0, s[48:51], 0 offen sc1
    s_waitcnt vmcnt(0)
    v_cmp_eq_u32 vcc, -1, v16
    s_sub_u32 s40, s40, 1
    s_cselect_b64 vcc, 0, vcc
    s_cbranch_vccnz L_gate_y
    s_mov_b32 s40, 32768
    s_mov_b64 vcc, -1
L_poll_y:
    s_mov_b64 exec, vcc
    s_mov_b32 s3, 0
    buffer_load_dwordx4 v[16:19], v0, s[48:51], s3 offen sc1
    s_add_u32 s3, s3, 18432
    buffer_load_dwordx4 v[20:23], v0, s[48:51], s3 offen sc1
    s_add_u32 s3, s3, 18432
    buffer_load_dwordx4 v[24:27], v0, s[48:51], s3 offen sc1
    s_add_u32 s3, s3, 18432
    buffer_load_dwordx4 v[28:31], v0, s[48:51], s3 offen sc1
    s_add_u32 s3, s3, 18432
    buffer_load_dwordx4 v[32:35], v0, s[48:51], s3 offen sc1
    s_add_u32 s3, s3, 18432
    buffer_load_dwordx4 v[36:39], v0, s[48:51], s3 offen sc1
    s_add_u32 s3, s3, 18432
    buffer_load_dwordx4 v[40:43], v0, s[48:51], s3 offen sc1
    s_add_u32 s3, s3, 18432
    buffer_load_dwordx4 v[44:47], v0, s[48:51], s3 offen sc1
    s_add_u32 s3, s3, 18432
    buffer_load_dwordx4 v[48:51], v0, s[48:51], s3 offen sc1
    s_add_u32 s3, s3, 18432
    s_waitcnt vmcnt(8)
    v_max_u32 v3, v16, v17
    v_max_u32 v4, v18, v19
    s_waitcnt vmcnt(7)
    v_max3_u32 v3, v3, v20, v21
    v_max3_u32 v4, v4, v22, v23
    s_waitcnt vmcnt(6)
    v_max3_u32 v3, v3, v24, v25
    v_max3_u32 v4, v4, v26, v27
    s_waitcnt vmcnt(5)
    v_max3_u32 v3, v3, v28, v29
    v_max3_u32 v4, v4, v30, v31
    s_waitcnt vmcnt(4)
    v_max3_u32 v3, v3, v32, v33
    v_max3_u32 v4, v4, v34, v35
    s_waitcnt vmcnt(3)
    v_max3_u32 v3, v3, v36, v37
    v_max3_u32 v4, v4, v38, v39
    s_waitcnt vmcnt(2)
    v_max3_u32 v3, v3, v40, v41
    v_max3_u32 v4, v4, v42, v43
    s_waitcnt vmcnt(1)
    v_max3_u32 v3, v3, v44, v45
    v_max3_u32 v4, v4, v46, v47
    s_waitcnt vmcnt(0)
    v_max3_u32 v3, v3, v48, v49
    v_max3_u32 v4, v4, v50, v51
    v_max_u32 v3, v3, v4
    v_cmp_eq_u32 vcc, -1, v3
    s_sub_u32 s40, s40, 1
    s_cselect_b64 vcc, 0, vcc
    s_cbranch_vccnz L_poll_y
    s_mov_b64 exec, -1
    v_pk_add_f32 v[16:17], v[16:17], v[20:21]
    v_pk_add_f32 v[18:19], v[18:19], v[22:23]
    v_pk_add_f32 v[24:25], v[24:25], v[28:29]
    v_pk_add_f32 v[26:27], v[26:27], v[30:31]
    v_pk_add_f32 v[32:33], v[32:33], v[36:37]
    v_pk_add_f32 v[34:35], v[34:35], v[38:39]
    v_pk_add_f32 v[40:41], v[40:41], v[44:45]
    v_pk_add_f32 v[42:43], v[42:43], v[46:47]
    v_pk_add_f32 v[16:17], v[16:17], v[24:25]
    v_pk_add_f32 v[18:19], v[18:19], v[26:27]
    v_pk_add_f32 v[32:33], v[32:33], v[40:41]
    v_pk_add_f32 v[34:35], v[34:35], v[42:43]
    v_pk_add_f32 v[16:17], v[16:17], v[48:49]
    v_pk_add_f32 v[18:19], v[18:19], v[50:51]
    v_pk_add_f32 v[16:17], v[16:17], v[32:33]
    v_pk_add_f32 v[18:19], v[18:19], v[34:35]
    v_mov_b32 v20, v16
    v_mov_b32 v21, v17
    v_mov_b32 v22, v18
    v_mov_b32 v23, v19
    s_nop 0
    v_permlane16_swap_b32 v16, v20
    v_permlane16_swap_b32 v17, v21
    v_permlane16_swap_b32 v18, v22
    v_permlane16_swap_b32 v19, v23
    v_add_f32 v16, v16, v20
    v_add_f32 v17, v17, v21
    v_add_f32 v18, v18, v22
    v_add_f32 v19, v19, v23
    v_mov_b32 v20, v16
    v_mov_b32 v21, v17
    v_mov_b32 v22, v18
    v_mov_b32 v23, v19
    s_nop 0
    v_permlane32_swap_b32 v16, v20
    v_permlane32_swap_b32 v17, v21
    v_permlane32_swap_b32 v18, v22
    v_permlane32_swap_b32 v19, v23
    v_add_f32 v16, v16, v20
    v_add_f32 v17, v17, v21
    v_add_f32 v18, v18, v22
    v_add_f32 v19, v19, v23
    ds_write_b128 v13, v[16:19]
    s_waitcnt lgkmcnt(0)
    s_barrier
    s_cmp_lg_u32 s33, 0
    s_cbranch_scc1 L_attn_end
    ds_read_b128 v[32:35], v14 offset:256
    ds_read_b128 v[36:39], v14 offset:512
    ds_read_b128 v[40:43], v14 offset:768
    s_waitcnt lgkmcnt(0)
    v_add_f32 v16, v16, v32
    v_add_f32 v36, v36, v40
    v_add_f32 v17, v17, v33
    v_add_f32 v37, v37, v41
    v_add_f32 v18, v18, v34
    v_add_f32 v38, v38, v42
    v_add_f32 v19, v19, v35
    v_add_f32 v39, v39, v43
    v_add_f32 v16, v16, v36
    v_add_f32 v17, v17, v37
    v_add_f32 v18, v18, v38
    v_add_f32 v19, v19, v39
    v_cvt_pk_bf16_f32 v24, v16, v17
    v_cvt_pk_bf16_f32 v25, v18, v19
    v_lshlrev_b32 v16, 16, v24
    v_and_b32 v17, 0xffff0000, v24
    v_lshlrev_b32 v18, 16, v25
    v_and_b32 v19, 0xffff0000, v25
    v_mul_f32 v16, v16, v8
    v_mul_f32 v17, v17, v8
    v_mul_f32 v18, v18, v8
    v_mul_f32 v19, v19, v8
    v_cvt_pk_bf16_f32 v24, v16, v17
    v_cvt_pk_bf16_f32 v25, v18, v19
    v_lshlrev_b32 v16, 16, v24
    v_and_b32 v17, 0xffff0000, v24
    v_lshlrev_b32 v18, 16, v25
    v_and_b32 v19, 0xffff0000, v25
    v_add_f32 v16, v16, v64
    v_add_f32 v17, v17, v65
    v_add_f32 v18, v18, v66
    v_add_f32 v19, v19, v67
    v_cvt_pk_bf16_f32 v24, v16, v17
    v_cvt_pk_bf16_f32 v25, v18, v19
    v_lshlrev_b32 v16, 16, v24
    v_and_b32 v17, 0xffff0000, v24
    v_lshlrev_b32 v18, 16, v25
    v_and_b32 v19, 0xffff0000, v25
    v_mul_f32 v16, v16, v52
    v_mul_f32 v17, v17, v53
    v_mul_f32 v18, v18, v54
    v_mul_f32 v19, v19, v55
    v_cvt_pk_bf16_f32 v24, v16, v17
    v_cvt_pk_bf16_f32 v25, v18, v19
    v_lshlrev_b32 v16, 16, v24
    v_and_b32 v17, 0xffff0000, v24
    v_lshlrev_b32 v18, 16, v25
    v_and_b32 v19, 0xffff0000, v25
    v_add_f32 v16, v16, v68
    v_add_f32 v17, v17, v69
    v_add_f32 v18, v18, v70
    v_add_f32 v19, v19, v71
    v_cvt_pk_bf16_f32 v20, v16, v17
    v_cvt_pk_bf16_f32 v21, v18, v19
    buffer_store_dwordx2 v[20:21], v12, s[76:79], s42 offen sc1
    s_branch L_attn_end
L_attn_retry:
    s_waitcnt vmcnt(0) lgkmcnt(0)
    s_mov_b32 s45, 1
    v_mov_b32 v28, 0xff800000
    v_mov_b32 v29, 0xff800000
    v_mov_b32 v30, 0xff800000
    v_mov_b32 v31, 0xff800000
    s_mov_b32 s48, s30
    s_mov_b32 s49, s31
    s_mov_b32 s50, 0x0
    s_mov_b32 s51, 0x20000
    s_mov_b32 s41, 0
L_attn_maxloop:
    s_barrier
    s_mov_b32 m0, s38
    s_nop 0
    buffer_load_dwordx4 v20, s[8:11], s41 offen offset:0 lds
    buffer_load_dwordx4 v21, s[8:11], s41 offen offset:1024 lds
    buffer_load_dwordx4 v22, s[8:11], s41 offen offset:2048 lds
    buffer_load_dwordx4 v23, s[8:11], s41 offen offset:3072 lds
    s_waitcnt vmcnt(0)
    s_barrier
    ds_read_b128 a[128:131], v8 offset:0
    ds_read_b128 a[132:135], v9 offset:0
    ds_read_b128 a[136:139], v10 offset:0
    ds_read_b128 a[140:143], v11 offset:0
    ds_read_b128 a[144:147], v8 offset:4096
    ds_read_b128 a[148:151], v9 offset:4096
    ds_read_b128 a[152:155], v10 offset:4096
    ds_read_b128 a[156:159], v11 offset:4096
    s_waitcnt lgkmcnt(7)
    v_mfma_f32_16x16x32_bf16 v[108:111], a[128:131], v[188:191], 0
    v_mfma_f32_16x16x32_bf16 v[116:119], a[128:131], v[204:207], 0
    v_mfma_f32_16x16x32_bf16 v[124:127], a[128:131], v[220:223], 0
    v_mfma_f32_16x16x32_bf16 v[132:135], a[128:131], v[236:239], 0
    s_waitcnt lgkmcnt(6)
    v_mfma_f32_16x16x32_bf16 v[108:111], a[132:135], v[192:195], v[108:111]
    v_mfma_f32_16x16x32_bf16 v[116:119], a[132:135], v[208:211], v[116:119]
    v_mfma_f32_16x16x32_bf16 v[124:127], a[132:135], v[224:227], v[124:127]
    v_mfma_f32_16x16x32_bf16 v[132:135], a[132:135], v[240:243], v[132:135]
    s_waitcnt lgkmcnt(5)
    v_mfma_f32_16x16x32_bf16 v[108:111], a[136:139], v[196:199], v[108:111]
    v_mfma_f32_16x16x32_bf16 v[116:119], a[136:139], v[212:215], v[116:119]
    v_mfma_f32_16x16x32_bf16 v[124:127], a[136:139], v[228:231], v[124:127]
    v_mfma_f32_16x16x32_bf16 v[132:135], a[136:139], v[244:247], v[132:135]
    s_waitcnt lgkmcnt(4)
    v_mfma_f32_16x16x32_bf16 v[108:111], a[140:143], v[200:203], v[108:111]
    v_mfma_f32_16x16x32_bf16 v[116:119], a[140:143], v[216:219], v[116:119]
    v_mfma_f32_16x16x32_bf16 v[124:127], a[140:143], v[232:235], v[124:127]
    v_mfma_f32_16x16x32_bf16 v[132:135], a[140:143], v[248:251], v[132:135]
    s_waitcnt lgkmcnt(3)
    v_mfma_f32_16x16x32_bf16 v[112:115], a[144:147], v[188:191], 0
    v_mfma_f32_16x16x32_bf16 v[120:123], a[144:147], v[204:207], 0
    v_mfma_f32_16x16x32_bf16 v[128:131], a[144:147], v[220:223], 0
    v_mfma_f32_16x16x32_bf16 v[136:139], a[144:147], v[236:239], 0
    s_waitcnt lgkmcnt(2)
    v_mfma_f32_16x16x32_bf16 v[112:115], a[148:151], v[192:195], v[112:115]
    v_mfma_f32_16x16x32_bf16 v[120:123], a[148:151], v[208:211], v[120:123]
    v_mfma_f32_16x16x32_bf16 v[128:131], a[148:151], v[224:227], v[128:131]
    v_mfma_f32_16x16x32_bf16 v[136:139], a[148:151], v[240:243], v[136:139]
    s_waitcnt lgkmcnt(1)
    v_mfma_f32_16x16x32_bf16 v[112:115], a[152:155], v[196:199], v[112:115]
    v_mfma_f32_16x16x32_bf16 v[120:123], a[152:155], v[212:215], v[120:123]
    v_mfma_f32_16x16x32_bf16 v[128:131], a[152:155], v[228:231], v[128:131]
    v_mfma_f32_16x16x32_bf16 v[136:139], a[152:155], v[244:247], v[136:139]
    s_waitcnt lgkmcnt(0)
    v_mfma_f32_16x16x32_bf16 v[112:115], a[156:159], v[200:203], v[112:115]
    v_mfma_f32_16x16x32_bf16 v[120:123], a[156:159], v[216:219], v[120:123]
    v_mfma_f32_16x16x32_bf16 v[128:131], a[156:159], v[232:235], v[128:131]
    v_mfma_f32_16x16x32_bf16 v[136:139], a[156:159], v[248:251], v[136:139]
    s_nop 7
    v_max3_f32 v32, v108, v109, v28
    v_max3_f32 v32, v110, v111, v32
    v_max3_f32 v32, v112, v113, v32
    v_max3_f32 v32, v114, v115, v32
    v_max3_f32 v33, v116, v117, v29
    v_max3_f32 v33, v118, v119, v33
    v_max3_f32 v33, v120, v121, v33
    v_max3_f32 v33, v122, v123, v33
    v_max3_f32 v34, v124, v125, v30
    v_max3_f32 v34, v126, v127, v34
    v_max3_f32 v34, v128, v129, v34
    v_max3_f32 v34, v130, v131, v34
    v_max3_f32 v35, v132, v133, v31
    v_max3_f32 v35, v134, v135, v35
    v_max3_f32 v35, v136, v137, v35
    v_max3_f32 v35, v138, v139, v35
    v_mov_b32 v28, v32
    v_mov_b32 v29, v33
    v_mov_b32 v30, v34
    v_mov_b32 v31, v35
    ds_read_b128 a[128:131], v8 offset:8192
    ds_read_b128 a[132:135], v9 offset:8192
    ds_read_b128 a[136:139], v10 offset:8192
    ds_read_b128 a[140:143], v11 offset:8192
    ds_read_b128 a[144:147], v8 offset:12288
    ds_read_b128 a[148:151], v9 offset:12288
    ds_read_b128 a[152:155], v10 offset:12288
    ds_read_b128 a[156:159], v11 offset:12288
    s_waitcnt lgkmcnt(7)
    v_mfma_f32_16x16x32_bf16 v[108:111], a[128:131], v[188:191], 0
    v_mfma_f32_16x16x32_bf16 v[116:119], a[128:131], v[204:207], 0
    v_mfma_f32_16x16x32_bf16 v[124:127], a[128:131], v[220:223], 0
    v_mfma_f32_16x16x32_bf16 v[132:135], a[128:131], v[236:239], 0
    s_waitcnt lgkmcnt(6)
    v_mfma_f32_16x16x32_bf16 v[108:111], a[132:135], v[192:195], v[108:111]
    v_mfma_f32_16x16x32_bf16 v[116:119], a[132:135], v[208:211], v[116:119]
    v_mfma_f32_16x16x32_bf16 v[124:127], a[132:135], v[224:227], v[124:127]
    v_mfma_f32_16x16x32_bf16 v[132:135], a[132:135], v[240:243], v[132:135]
    s_waitcnt lgkmcnt(5)
    v_mfma_f32_16x16x32_bf16 v[108:111], a[136:139], v[196:199], v[108:111]
    v_mfma_f32_16x16x32_bf16 v[116:119], a[136:139], v[212:215], v[116:119]
    v_mfma_f32_16x16x32_bf16 v[124:127], a[136:139], v[228:231], v[124:127]
    v_mfma_f32_16x16x32_bf16 v[132:135], a[136:139], v[244:247], v[132:135]
    s_waitcnt lgkmcnt(4)
    v_mfma_f32_16x16x32_bf16 v[108:111], a[140:143], v[200:203], v[108:111]
    v_mfma_f32_16x16x32_bf16 v[116:119], a[140:143], v[216:219], v[116:119]
    v_mfma_f32_16x16x32_bf16 v[124:127], a[140:143], v[232:235], v[124:127]
    v_mfma_f32_16x16x32_bf16 v[132:135], a[140:143], v[248:251], v[132:135]
    s_waitcnt lgkmcnt(3)
    v_mfma_f32_16x16x32_bf16 v[112:115], a[144:147], v[188:191], 0
    v_mfma_f32_16x16x32_bf16 v[120:123], a[144:147], v[204:207], 0
    v_mfma_f32_16x16x32_bf16 v[128:131], a[144:147], v[220:223], 0
    v_mfma_f32_16x16x32_bf16 v[136:139], a[144:147], v[236:239], 0
    s_waitcnt lgkmcnt(2)
    v_mfma_f32_16x16x32_bf16 v[112:115], a[148:151], v[192:195], v[112:115]
    v_mfma_f32_16x16x32_bf16 v[120:123], a[148:151], v[208:211], v[120:123]
    v_mfma_f32_16x16x32_bf16 v[128:131], a[148:151], v[224:227], v[128:131]
    v_mfma_f32_16x16x32_bf16 v[136:139], a[148:151], v[240:243], v[136:139]
    s_waitcnt lgkmcnt(1)
    v_mfma_f32_16x16x32_bf16 v[112:115], a[152:155], v[196:199], v[112:115]
    v_mfma_f32_16x16x32_bf16 v[120:123], a[152:155], v[212:215], v[120:123]
    v_mfma_f32_16x16x32_bf16 v[128:131], a[152:155], v[228:231], v[128:131]
    v_mfma_f32_16x16x32_bf16 v[136:139], a[152:155], v[244:247], v[136:139]
    s_waitcnt lgkmcnt(0)
    v_mfma_f32_16x16x32_bf16 v[112:115], a[156:159], v[200:203], v[112:115]
    v_mfma_f32_16x16x32_bf16 v[120:123], a[156:159], v[216:219], v[120:123]
    v_mfma_f32_16x16x32_bf16 v[128:131], a[156:159], v[232:235], v[128:131]
    v_mfma_f32_16x16x32_bf16 v[136:139], a[156:159], v[248:251], v[136:139]
    s_nop 7
    v_max3_f32 v32, v108, v109, v28
    v_max3_f32 v32, v110, v111, v32
    v_max3_f32 v32, v112, v113, v32
    v_max3_f32 v32, v114, v115, v32
    v_max3_f32 v33, v116, v117, v29
    v_max3_f32 v33, v118, v119, v33
    v_max3_f32 v33, v120, v121, v33
    v_max3_f32 v33, v122, v123, v33
    v_max3_f32 v34, v124, v125, v30
    v_max3_f32 v34, v126, v127, v34
    v_max3_f32 v34, v128, v129, v34
    v_max3_f32 v34, v130, v131, v34
    v_max3_f32 v35, v132, v133, v31
    v_max3_f32 v35, v134, v135, v35
    v_max3_f32 v35, v136, v137, v35
    v_max3_f32 v35, v138, v139, v35
    v_mov_b32 v28, v32
    v_mov_b32 v29, v33
    v_mov_b32 v30, v34
    v_mov_b32 v31, v35
    s_add_u32 s41, s41, 16384
    s_cmp_lt_u32 s41, 0x80000
    s_cbranch_scc1 L_attn_maxloop
    s_barrier
    s_add_u32 m0, s38, 0
    s_mov_b32 s42, 0x0
    buffer_load_dwordx4 v20, s[8:11], s42 offen offset:0 nt lds
    buffer_load_dwordx4 v21, s[8:11], s42 offen offset:1024 nt lds
    buffer_load_dwordx4 v22, s[8:11], s42 offen offset:2048 nt lds
    buffer_load_dwordx4 v23, s[8:11], s42 offen offset:3072 nt lds
    s_add_u32 m0, s38, 16384
    s_mov_b32 s42, 0x4000
    buffer_load_dwordx4 v20, s[8:11], s42 offen offset:0 nt lds
    buffer_load_dwordx4 v21, s[8:11], s42 offen offset:1024 nt lds
    buffer_load_dwordx4 v22, s[8:11], s42 offen offset:2048 nt lds
    buffer_load_dwordx4 v23, s[8:11], s42 offen offset:3072 nt lds
    s_add_u32 m0, s38, 32768
    s_mov_b32 s42, 0x8000
    buffer_load_dwordx4 v20, s[8:11], s42 offen offset:0 nt lds
    buffer_load_dwordx4 v21, s[8:11], s42 offen offset:1024 nt lds
    buffer_load_dwordx4 v22, s[8:11], s42 offen offset:2048 nt lds
    buffer_load_dwordx4 v23, s[8:11], s42 offen offset:3072 nt lds
    s_add_u32 m0, s38, 65536
    s_mov_b32 s42, 0x0
    buffer_load_dwordx4 v24, s[12:15], s42 offen offset:0 nt lds
    buffer_load_dwordx4 v25, s[12:15], s42 offen offset:1024 nt lds
    buffer_load_dwordx4 v24, s[12:15], s42 offen offset:2048 nt lds
    buffer_load_dwordx4 v25, s[12:15], s42 offen offset:3072 nt lds
    s_add_u32 m0, s38, 81920
    s_mov_b32 s42, 0x4000
    buffer_load_dwordx4 v24, s[12:15], s42 offen offset:0 nt lds
    buffer_load_dwordx4 v25, s[12:15], s42 offen offset:1024 nt lds
    buffer_load_dwordx4 v24, s[12:15], s42 offen offset:2048 nt lds
    buffer_load_dwordx4 v25, s[12:15], s42 offen offset:3072 nt lds
    s_waitcnt vmcnt(16)
    s_barrier
    s_branch L_attn_entry
L_attn_end:
L_attn_exit:
    s_endpgm
L_code_end:
.section .rodata,"a"
.p2align 6
.amdhsa_kernel prep_kernel
  .amdhsa_next_free_vgpr 72
  .amdhsa_next_free_sgpr 102
  .amdhsa_accum_offset 72
  .amdhsa_group_segment_fixed_size 0
  .amdhsa_kernarg_size 120
  .amdhsa_user_sgpr_count 2
  .amdhsa_user_sgpr_kernarg_segment_ptr 1
  .amdhsa_system_sgpr_workgroup_id_x 1
.end_amdhsa_kernel
.p2align 6
.amdhsa_kernel attn_kernel
  .amdhsa_next_free_vgpr 512
  .amdhsa_next_free_sgpr 102
  .amdhsa_accum_offset 256
  .amdhsa_group_segment_fixed_size 0
  .amdhsa_kernarg_size 120
  .amdhsa_user_sgpr_count 2
  .amdhsa_user_sgpr_kernarg_segment_ptr 1
  .amdhsa_system_sgpr_workgroup_id_x 1
.end_amdhsa_kernel
```
